```python
import torch

def _softmax(x, axis=-1):
    return torch.softmax(x, dim=axis)
def _gelu(x):
    return torch.nn.functional.gelu(x, approximate="tanh")
def _silu(x):
    return torch.nn.functional.silu(x)
def _sigmoid(x):
    return torch.sigmoid(x)
def _layernorm(x, axis=-1, eps=1e-5):
    m = x.mean(dim=axis, keepdim=True)
    v = x.var(dim=axis, keepdim=True, unbiased=False)
    return (x - m) / torch.sqrt(v + eps)
def _scatter_add(tgt, idx, src, axis=0):
    return tgt.clone().index_add_(axis, idx, src)
def _segment_sum(src, seg, n):
    out = torch.zeros((n,) + src.shape[1:], dtype=src.dtype)
    return out.index_add_(0, seg, src)
def _pad(x, pw):
    flat = tuple(v for pair in reversed(pw) for v in pair)
    return torch.nn.functional.pad(x, flat)

kernel_name = 'sequential_preLN__spectral_gfnet__mixer_channel_mlp__prompt'

def setup_inputs():

    _w = (lambda a: (lambda t: t.to(torch.bfloat16) if t.is_floating_point() else t)(torch.as_tensor(a)))
    def _A_setup():
        B, S, D = 1, 2048, 640
        Df = D // 2 + 1
        return {
            "x": _w((lambda *s: torch.randn(*s, dtype=torch.bfloat16) * 0.05)(B, S, D)),
            "w_r": _w((lambda *s: torch.randn(*s, dtype=torch.bfloat16) * 0.8)(S, Df) * 0.02),
            "w_i": _w((lambda *s: torch.randn(*s, dtype=torch.bfloat16) * 0.8)(S, Df) * 0.02),
        }
    _A_in = _A_setup()

    def _B_setup():
        B, S, D, F = 1, 2048, 640, 1536
        return {
            "x": _w((lambda *s: torch.randn(*s, dtype=torch.bfloat16) * 0.05)(B, S, D)),
            "w1": _w((lambda *s: torch.randn(*s, dtype=torch.bfloat16) * 0.8)(D, F) * (D ** -0.5)),
            "b1": _w((lambda *s: torch.randn(*s, dtype=torch.bfloat16) * 0.4)(F)),
            "w2": _w((lambda *s: torch.randn(*s, dtype=torch.bfloat16) * 0.05)(F, D) * (F ** -0.5)),
            "b2": _w((lambda *s: torch.randn(*s, dtype=torch.bfloat16) * 0.05)(D)),
        }
    _B_in = _B_setup()

    return {
        "A_x": _A_in["x"],
        "A_w_r": _A_in["w_r"],
        "A_w_i": _A_in["w_i"],
        "B_x": _B_in["x"],
        "B_w1": _B_in["w1"],
        "B_b1": _B_in["b1"],
        "B_w2": _B_in["w2"],
        "B_b2": _B_in["b2"],
    }

def reference(A_x, A_w_r, A_w_i, B_x, B_w1, B_b1, B_w2, B_b2):
    def _A_ref(x, w_r, w_i):
        B, S, D = x.shape
        X = (lambda x, axes=(-2,-1): torch.fft.rfft2(x.float(), dim=axes))(x, axes=(-2, -1))
        W = w_r + 1j * w_i
        X = X * W
        y = (lambda x, s, axes=(-2,-1): torch.fft.irfft2(x, s=s, dim=axes).to(torch.bfloat16))(X, (S, D), axes=(-2, -1))
        return y

    def _B_ref(x, w1, b1, w2, b2):
        y = _layernorm(x, axis=-1)
        h = _gelu(torch.einsum("bsd,df->bsf", y, w1) + b1)
        return torch.einsum("bsf,fd->bsd", h, w2) + b2

    x = A_x
    h = x + _A_ref(_layernorm(x, axis=-1), A_w_r, A_w_i)
    h2 = h + _B_ref(_layernorm(h, axis=-1), B_w1, B_b1, B_w2, B_b2)
    return h2
```

```asm
; @launch grid=(256,1,1) block=(256,1,1) lds=163840
.amdgcn_target "amdgcn-amd-amdhsa--gfx950"
.text
.globl sequential_preLN__spectral_gfnet__mixer_channel_mlp__prompt_kernel
.p2align 8
.type sequential_preLN__spectral_gfnet__mixer_channel_mlp__prompt_kernel,@function
sequential_preLN__spectral_gfnet__mixer_channel_mlp__prompt_kernel:
    s_load_dwordx2 s[4:5], s[0:1], 0
    s_load_dwordx2 s[32:33], s[0:1], 8
    s_load_dwordx2 s[36:37], s[0:1], 16
    s_load_dwordx2 s[12:13], s[0:1], 32
    s_load_dwordx2 s[20:21], s[0:1], 48
    s_load_dwordx2 s[40:41], s[0:1], 80
    s_getpc_b64 s[44:45]
L_pc:
    s_cmp_ge_u32 s2, 256
    s_cbranch_scc1 L_end
    s_bfe_u32 s88, s2, 0x20003
    s_lshl_b32 s88, s88, 15
    v_lshlrev_b32 v49, 7, v0
    v_add_u32 v49, s88, v49
    v_min_u32 v49, L_tab-L_pc, v49
    global_load_dword v48, v49, s[44:45]
    v_lshrrev_b32 v4, 6, v0
    v_and_b32 v1, 63, v0
    v_readfirstlane_b32 s46, v4
    v_lshlrev_b32 v14, 4, v1
    v_mul_u32_u24 v4, 781, v1
    s_mov_b32 s54, 80576
    s_and_b32 s49, s2, 7
    s_lshl_b32 s49, s49, 2
    s_lshr_b32 s88, s2, 6
    s_add_u32 s49, s49, s88
    s_bfe_u32 s50, s2, 0x30003
    s_lshr_b32 s88, s50, 2
    s_lshl_b32 s48, s49, 1
    s_add_u32 s48, s48, s88
    s_mul_i32 s51, s88, 43008
    s_lshl_b32 s91, s46, 9
    s_add_u32 s91, s91, s48
    s_mul_i32 s91, s91, 1280
    s_mul_i32 s92, s46, 10752
    s_add_u32 s92, s92, s51
    s_mov_b32 s6, 2621440
    s_mov_b32 s7, 0x20000
    s_lshl_b32 s88, s2, 2
    s_add_u32 s88, s88, s46
    s_lshl_b32 s88, s88, 7
    s_add_u32 s88, s88, L_tab-L_pc
    s_add_u32 s98, s44, s88
    s_addc_u32 s99, s45, 0
    v_and_b32 v2, 15, v0
    v_bfe_u32 v3, v0, 4, 2
    v_mov_b32 v16, v14
    s_waitcnt lgkmcnt(0)
    s_load_dwordx16 s[56:71], s[98:99], 0
    s_load_dwordx16 s[72:87], s[98:99], 64
    s_load_dword s47, s[40:41], 0
    s_load_dwordx2 s[16:17], s[0:1], 40
    s_load_dwordx2 s[24:25], s[0:1], 56
    s_load_dwordx2 s[28:29], s[0:1], 64
    s_mov_b32 m0, s92
    s_nop 0
    buffer_load_dwordx4 v16, s[4:7], s91 offen offset:0 lds
    v_add_u32 v17, 49984, v4
    v_add_u32 v18, 99968, v4
    v_lshrrev_b32 v17, 16, v17
    v_add_u32 v19, 149952, v4
    v_lshrrev_b32 v18, 16, v18
    v_add_u32 v20, 199936, v4
    v_mad_u32_u24 v17, v17, s54, v14
    buffer_load_dwordx4 v17, s[4:7], s91 offen offset:1024 lds
    v_lshrrev_b32 v19, 16, v19
    v_mad_u32_u24 v18, v18, s54, v14
    buffer_load_dwordx4 v18, s[4:7], s91 offen offset:2048 lds
    v_lshrrev_b32 v20, 16, v20
    v_add_u32 v21, 249920, v4
    v_mad_u32_u24 v19, v19, s54, v14
    v_add_u32 v22, 299904, v4
    v_mad_u32_u24 v20, v20, s54, v14
    v_lshrrev_b32 v21, 16, v21
    v_add_u32 v23, 349888, v4
    v_lshrrev_b32 v22, 16, v22
    v_add_u32 v24, 399872, v4
    v_mad_u32_u24 v21, v21, s54, v14
    v_lshrrev_b32 v23, 16, v23
    v_mad_u32_u24 v22, v22, s54, v14
    v_lshrrev_b32 v24, 16, v24
    buffer_load_dwordx4 v19, s[4:7], s91 offen offset:3072 lds
    v_add_u32 v25, 449856, v4
    v_mad_u32_u24 v23, v23, s54, v14
    v_add_u32 v26, 499840, v4
    v_mad_u32_u24 v24, v24, s54, v14
    v_lshrrev_b32 v25, 16, v25
    v_lshrrev_b32 v26, 16, v26
    v_mad_u32_u24 v25, v25, s54, v14
    v_mad_u32_u24 v26, v26, s54, v14
    s_and_b32 s53, s50, 3
    v_lshrrev_b32 v8, 2, v2
    s_lshl_b32 s88, s53, 2
    v_add_u32 v8, s88, v8
    v_and_b32 v9, 3, v2
    s_add_u32 m0, m0, 4096
    s_add_u32 s91, s91, 4096
    buffer_load_dwordx4 v20, s[4:7], s91 offen offset:0 lds
    v_lshl_add_u32 v10, v8, 2, v9
    v_cmp_eq_u32 vcc, 1, v10
    v_lshrrev_b32 v11, 1, v3
    v_lshlrev_b32 v11, 4, v11
    v_cndmask_b32 v8, v8, 16, vcc
    v_cndmask_b32 v10, v9, 0, vcc
    v_and_b32 v12, 1, v3
    v_cvt_f32_u32 v8, v8
    v_cvt_f32_u32 v10, v10
    v_lshl_add_u32 v11, v12, 2, v11
    v_mul_f32 v8, 0x3d000000, v8
    buffer_load_dwordx4 v21, s[4:7], s91 offen offset:1024 lds
    v_mul_f32 v10, 0xbe800000, v10
    v_cvt_f32_u32 v12, v11
    v_fma_f32 v10, v12, v8, v10
    v_cos_f32 v144, v10
    v_fmamk_f32 v145, v8, 0x3f800000, v10
    v_fmamk_f32 v146, v8, 0x40000000, v10
    v_fmamk_f32 v147, v8, 0x40400000, v10
    v_fmamk_f32 v148, v8, 0x41000000, v10
    v_fmamk_f32 v149, v8, 0x41100000, v10
    v_fmamk_f32 v150, v8, 0x41200000, v10
    v_fmamk_f32 v151, v8, 0x41300000, v10
    v_bfe_u32 v10, v1, 2, 2
    buffer_load_dwordx4 v22, s[4:7], s91 offen offset:2048 lds
    v_cmp_gt_u32 vcc, 2, v9
    v_and_b32 v8, 3, v1
    v_add_u32 v9, v11, v10
    v_mul_u32_u24 v8, 1344, v8
    v_mul_u32_u24 v9, 40, v9
    v_add3_u32 v30, v8, v9, s51
    v_lshlrev_b32 v9, 6, v3
    v_cos_f32 v145, v145
    v_cos_f32 v146, v146
    v_cos_f32 v147, v147
    buffer_load_dwordx4 v23, s[4:7], s91 offen offset:3072 lds
    v_cos_f32 v148, v148
    v_cos_f32 v149, v149
    v_cos_f32 v150, v150
    v_cos_f32 v151, v151
    v_add_u32 v9, s48, v9
    v_cvt_f32_u32 v8, v2
    v_cvt_f32_u32 v9, v9
    v_cvt_pk_bf16_f32 v60, v144, v145
    v_cvt_pk_bf16_f32 v61, v146, v147
    s_add_u32 m0, m0, 4096
    s_add_u32 s91, s91, 4096
    buffer_load_dwordx4 v24, s[4:7], s91 offen offset:0 lds
    v_cvt_pk_bf16_f32 v62, v148, v149
    v_cvt_pk_bf16_f32 v63, v150, v151
    v_mul_f32 v9, v8, v9
    v_cndmask_b32 v60, 0, v60, vcc
    v_cndmask_b32 v61, 0, v61, vcc
    v_cndmask_b32 v62, 0, v62, vcc
    v_cndmask_b32 v63, 0, v63, vcc
    v_mul_f32 v9, 0x3a000000, v9
    v_cvt_f32_u32 v11, v3
    v_cmp_eq_u32 vcc, 0, v2
    s_mul_i32 s55, s2, 171
    buffer_load_dwordx4 v25, s[4:7], s91 offen offset:1024 lds
    v_add_f32 v10, 0xbe800000, v9
    v_mul_f32 v11, 0.5, v11
    s_lshr_b32 s55, s55, 11
    v_mul_f32 v8, 0x3e000000, v8
    v_cndmask_b32 v10, v10, v11, vcc
    s_mul_i32 s3, s55, 0
    s_lshl_b32 s55, s2, 8
    s_nop 0
    v_fmamk_f32 v65, v8, 0x3f800000, v9
    v_fmamk_f32 v66, v8, 0x40000000, v9
    v_fmamk_f32 v67, v8, 0x40400000, v9
    v_fmamk_f32 v68, v8, 0x40800000, v9
    v_fmamk_f32 v69, v8, 0x40a00000, v9
    v_fmamk_f32 v70, v8, 0x40c00000, v9
    s_mov_b64 exec, 0xffffffff
    buffer_load_dwordx4 v26, s[4:7], s91 offen offset:2048 lds
    s_mov_b64 exec, -1
    s_nop 0
    v_fmamk_f32 v71, v8, 0x40e00000, v9
    v_fmamk_f32 v73, v8, 0x3f800000, v10
    v_fmamk_f32 v74, v8, 0x40000000, v10
    v_fmamk_f32 v75, v8, 0x40400000, v10
    v_fmamk_f32 v76, v8, 0x40800000, v10
    v_fmamk_f32 v77, v8, 0x40a00000, v10
    v_fmamk_f32 v78, v8, 0x40c00000, v10
    v_fmamk_f32 v79, v8, 0x40e00000, v10
    v_lshrrev_b32 v8, 3, v0
    s_add_u32 s3, s3, s55
    v_cos_f32 v72, v10
    s_mul_i32 s55, s46, 491520
    v_lshrrev_b32 v10, 1, v8
    s_add_u32 s31, s3, s55
    v_xor_b32 v10, v10, v8
    s_mul_i32 s55, s2, 205
    v_and_b32 v10, 1, v10
    s_lshr_b32 s55, s55, 10
    v_cos_f32 v64, v9
    v_and_b32 v9, 7, v0
    v_lshlrev_b32 v10, 2, v10
    s_mul_i32 s3, s55, 5
    v_xor_b32 v10, v10, v9
    v_mul_u32_u24 v50, 1344, v8
    s_sub_u32 s3, s2, s3
    v_lshl_add_u32 v50, v10, 4, v50
    s_lshl_b32 s96, s3, 8
    v_lshlrev_b32 v51, 2, v8
    v_and_b32 v10, 3, v8
    s_mul_i32 s3, s2, 137
    v_lshrrev_b32 v8, 2, v8
    s_lshl_b32 s88, s46, 3
    s_lshr_b32 s3, s3, 12
    v_lshl_add_u32 v8, v10, 3, v8
    v_add_u32 v29, s88, v30
    s_mul_i32 s52, s3, 6
    s_lshr_b32 s88, s50, 2
    v_lshlrev_b32 v11, 4, v8
    s_sub_u32 s55, s55, s52
    s_lshl_b32 s88, s88, 7
    v_lshl_add_u32 v11, v9, 2, v11
    v_lshlrev_b32 v10, 2, v8
    v_cmp_gt_u32 s[94:95], 4, v9
    s_mul_i32 s52, s55, 48
    s_lshl_b32 s89, s46, 3
    s_add_u32 s88, s88, 162816
    v_add_u32 v11, 86144, v11
    v_add_u32 v10, 86656, v10
    s_add_u32 s52, s52, s89
    v_add_u32 v51, s88, v51
    v_cndmask_b32 v28, v10, v11, s[94:95]
    s_mul_i32 s89, s55, 96
    s_and_b32 s97, s46, 1
    v_or_b32 v10, s53, v2
    v_cmp_eq_u32 vcc, 7, v9
    s_nop 1
    v_cndmask_b32 v28, v28, v51, vcc
    s_nop 0
    s_or_b64 s[94:95], s[94:95], vcc
    s_sub_u32 s89, s89, 352
    s_mul_i32 s97, s97, 46
    v_lshlrev_b32 v8, 7, v3
    v_cmp_eq_u32 vcc, 0, v10
    s_add_u32 s89, s89, s97
    v_add_u32 v8, 86144, v8
    v_mov_b32 v9, 86016
    s_lshl_b32 s97, s46, 1
    v_and_b32 v10, 31, v1
    v_cndmask_b32 v31, v9, v8, vcc
    s_add_u32 s89, s89, s97
    v_mov_b32 v8, 0
    v_lshl_add_u32 v9, v10, 2, v9
    s_mul_i32 s3, s3, 192
    s_cmp_lt_u32 s55, 4
    s_cselect_b32 s52, s52, s89
    s_cselect_b32 s89, 4, 8
    ds_write_b32 v9, v8
    s_add_u32 s52, s52, s3
    v_lshlrev_b32 v8, 1, v3
    s_lshr_b32 s55, s49, 1
    s_and_b32 s3, s49, 1
    v_xor_b32 v8, v8, v2
    s_mul_i32 s55, s55, 1284
    s_mul_i32 s3, s3, 640
    v_lshlrev_b32 v8, 4, v8
    s_add_u32 s55, s55, s3
    s_mul_i32 s3, s50, 80
    v_xor_b32 v9, 0x80, v8
    v_mul_u32_u24 v10, 61440, v3
    s_add_u32 s55, s55, s3
    v_add_u32 v32, v10, v8
    v_add_u32 v33, v10, v9
    s_and_b32 s3, s46, 1
    v_mul_u32_u24 v10, 1280, v3
    s_mul_i32 s89, s89, 1280
    s_mul_i32 s3, s3, 41088
    v_add_u32 v34, v10, v8
    v_mul_u32_u24 v8, 171, v1
    s_add_u32 s97, s55, s3
    v_add3_u32 v35, v10, v9, s89
    s_mul_i32 s52, s52, 1280
    s_mov_b32 s55, 82080
    v_lshrrev_b32 v9, 10, v8
    s_add_u32 s96, s96, s52
    v_mad_u32_u24 v36, v9, s55, v14
    s_mov_b32 s52, -1294272
    v_lshrrev_b32 v9, 4, v9
    v_mad_i32_i24 v36, v9, s52, v36
    v_add_u32 v9, 10944, v8
    v_lshrrev_b32 v9, 10, v9
    v_mad_u32_u24 v37, v9, s55, v14
    v_lshrrev_b32 v9, 4, v9
    v_mad_i32_i24 v37, v9, s52, v37
    v_add_u32 v9, 21888, v8
    s_lshl_b32 s88, s2, 2
    v_lshrrev_b32 v9, 10, v9
    s_add_u32 s88, s88, s46
    v_mad_u32_u24 v38, v9, s55, v14
    s_mul_i32 s88, s88, 48
    s_mov_b32 s10, 1314816
    s_mov_b32 s11, 0x20000
    s_cmp_lt_u32 s46, 2
    s_cselect_b32 s8, s32, s36
    s_cselect_b32 s9, s33, s37
    s_mul_i32 s93, s46, 3072
    s_add_u32 m0, s93, 106496
    s_nop 0
    buffer_load_dwordx4 v36, s[8:11], s97 offen offset:0 lds
    s_add_u32 m0, s93, 106496
    s_nop 0
    buffer_load_dwordx4 v37, s[8:11], s97 offen offset:1024 lds
    v_lshrrev_b32 v9, 4, v9
    s_add_u32 s88, s88, L_wd-L_pc
    v_mul_u32_u24 v39, 12, v3
    v_mad_i32_i24 v38, v9, s52, v38
    v_add_u32 v39, s88, v39
    s_mov_b32 s14, 1966080
    s_mov_b32 s15, 0x20000
    s_add_u32 m0, s93, 106496
    s_nop 0
    buffer_load_dwordx4 v38, s[8:11], s97 offen offset:2048 lds
    s_cmp_lt_u32 s2, 240
    s_cselect_b32 s31, s31, 1073741824
    s_cselect_b32 s96, s96, 1073741824
    v_add_u32 v33, 245760, v33
    s_mul_i32 s55, s2, 171
    s_lshr_b32 s55, s55, 11
    s_mul_i32 s55, s55, 12
    s_sub_u32 s3, s2, s55
    s_lshl_b32 s3, s3, 3
    s_lshl_b32 s55, s46, 1
    s_add_u32 s55, s55, s3
    global_load_dwordx3 v[56:58], v39, s[44:45]
    s_lshl_b32 m0, s46, 11
    s_add_u32 m0, m0, 98304
    s_nop 0
    buffer_load_dwordx4 v32, s[12:15], s31 offen lds
    s_mul_i32 s55, s55, 43
    v_bfe_u32 v11, v1, 2, 2
    s_lshr_b32 s55, s55, 9
    v_mul_u32_u24 v43, 176, v1
    v_add_u32 v8, s55, v11
    v_add_u32 v43, 87040, v43
    s_lshl_b32 s88, s46, 5
    v_lshlrev_b32 v13, 4, v2
    v_and_b32 v8, 7, v8
    s_lshl_b32 m0, s46, 11
    s_add_u32 m0, m0, 99328
    s_nop 0
    buffer_load_dwordx4 v33, s[12:15], s31 offen lds
    v_add_u32 v44, s88, v43
    v_lshl_add_u32 v40, v3, 15, v13
    v_lshl_add_u32 v8, v8, 2, v3
    v_min_u32 v13, 9, v2
    s_mul_i32 s88, s46, 2816
    v_and_b32 v9, 7, v8
    v_lshlrev_b32 v13, 4, v13
    s_add_u32 s88, s88, 87040
    v_mul_u32_u24 v45, 176, v3
    v_and_b32 v10, 3, v1
    v_lshrrev_b32 v12, 2, v1
    s_lshl_b32 s89, s46, 6
    v_lshlrev_b32 v9, 5, v9
    s_lshl_b32 s55, s46, 1
    v_add3_u32 v45, v45, v13, s88
    v_lshlrev_b32 v10, 3, v10
    v_and_b32 v13, 7, v12
    v_xor_b32 v9, s89, v9
    s_add_u32 s55, s55, s3
    v_lshl_add_u32 v12, v12, 8, v10
    v_add_u32 v10, 98304, v10
    v_lshl_add_u32 v8, v8, 8, v9
    s_add_u32 s55, s55, 1
    s_and_b32 s88, s49, 1
    s_lshl_b32 s90, s46, 11
    v_add_u32 v216, v8, v10
    s_mul_i32 s55, s55, 43
    v_xor_b32 v8, 0x1000, v8
    s_lshl_b32 s88, s88, 1
    s_lshl_b32 s90, s46, 3
    s_lshr_b32 s55, s55, 9
    v_add_u32 v217, v8, v10
    s_add_u32 s88, s88, s90
    v_add_u32 v8, s55, v11
    v_lshlrev_b32 v13, 5, v13
    s_add_u32 s88, s88, 106496
    v_lshlrev_b32 v239, 1, v3
    v_and_b32 v8, 7, v8
    v_add_u32 v12, 154624, v12
    v_xor_b32 v9, s89, v13
    v_add_u32 v239, s88, v239
    v_lshl_add_u32 v8, v8, 2, v3
    s_cmp_eq_u32 s49, 0
    s_cselect_b32 s88, 16, 0
    s_cselect_b32 s90, 15, 63
    v_sub_u32 v235, 63, v2
    v_add_u32 v220, v9, v12
    s_lshl_b32 s89, s46, 6
    v_and_b32 v9, 7, v8
    v_add_u32 v235, s88, v235
    s_add_u32 s89, s89, 32
    v_lshlrev_b32 v9, 5, v9
    v_add_u32 v234, 1, v235
    v_cmp_eq_u32_e64 vcc, 0, s88
    v_lshlrev_b32 v46, 5, v1
    v_xor_b32 v9, s89, v9
    v_and_b32 v234, s90, v234
    v_sub_u32 v236, 63, v2
    v_and_b32 v238, 2, v239
    v_add_u32 v46, s49, v46
    v_lshl_add_u32 v8, v8, 8, v9
    v_cndmask_b32 v234, v234, v236, vcc
    v_mul_u32_u24 v238, 0x10101, v238
    v_sub_u32 v47, 0, v46
    v_add_u32 v218, v8, v10
    v_and_b32 v239, -4, v239
    v_mul_u32_u24 v233, 96, v2
    v_mul_u32_u24 v235, 96, v235
    v_mul_u32_u24 v234, 96, v234
    v_lshlrev_b32 v87, 5, v3
    v_xor_b32 v8, 0x1000, v8
    v_xor_b32 v9, s89, v13
    v_lshl_or_b32 v238, v238, 8, v238
    v_and_b32 v47, 2047, v47
    v_add_u32 v233, v233, v239
    v_add_u32 v234, v234, v239
    v_add_u32 v235, v235, v239
    v_cos_f32 v65, v65
    v_cos_f32 v66, v66
    v_cos_f32 v67, v67
    v_cos_f32 v68, v68
    v_cos_f32 v69, v69
    v_cos_f32 v70, v70
    v_cos_f32 v71, v71
    v_cos_f32 v73, v73
    v_cos_f32 v74, v74
    v_cos_f32 v75, v75
    v_cos_f32 v76, v76
    v_cos_f32 v77, v77
    v_cos_f32 v78, v78
    v_cos_f32 v79, v79
    v_add_u32 v50, s51, v50
    v_add_u32 v87, 86656, v87
    s_mov_b32 s22, 1966080
    s_mov_b32 s23, 0x20000
    s_mov_b32 s42, 268435456
    s_mov_b32 s43, 0x20000
    s_mov_b32 s30, 0x3f803f80
    v_add_u32 v219, v8, v10
    v_add_u32 v221, v9, v12
    v_add_u32 v238, 0x05040100, v238
    v_mov_b32 v236, 1536
    v_mov_b32 v237, -1536
    v_lshlrev_b32 v239, 4, v2
    v_lshlrev_b32 v241, 2, v1
    v_mul_u32_u24 v46, 642, v46
    v_mul_u32_u24 v47, 642, v47
    s_waitcnt vmcnt(6)
    ds_read_b128 v[88:91], v50 offset:0
    ds_read_b128 v[92:95], v50 offset:128
    s_barrier
    ds_read_b128 v[96:99], v50 offset:256
    s_waitcnt lgkmcnt(0)
    s_add_u32 s88, s87, L_dft-L_pc+4096
    ds_read_b128 v[100:103], v50 offset:384
    v_add_u32 v49, s88, v14
    v_add_u32 v59, 8192, v49
    ds_read_b128 v[104:107], v50 offset:512
    s_mov_b32 s34, 1314816
    s_mov_b32 s35, 0x20000
    buffer_load_ushort v52, v46, s[32:35], s69 offen
    buffer_load_ushort v53, v47, s[32:35], s69 offen
    ds_read_b128 v[108:111], v50 offset:640
    ds_read_b128 v[112:115], v50 offset:768
    v_dot2_f32_bf16 v8, v88, s30, 0
    v_dot2_f32_bf16 v10, v88, v88, 0
    v_dot2_f32_bf16 v9, v89, s30, 0
    v_dot2_f32_bf16 v11, v89, v89, 0
    ds_read_b128 v[116:119], v50 offset:896
    s_nop 0
    v_dot2_f32_bf16 v8, v90, s30, v8
    v_dot2_f32_bf16 v10, v90, v90, v10
    v_dot2_f32_bf16 v9, v91, s30, v9
    v_dot2_f32_bf16 v11, v91, v91, v11
    v_dot2_f32_bf16 v8, v92, s30, v8
    v_dot2_f32_bf16 v10, v92, v92, v10
    v_dot2_f32_bf16 v9, v93, s30, v9
    v_dot2_f32_bf16 v11, v93, v93, v11
    ds_read_b128 v[120:123], v50 offset:1024
    v_dot2_f32_bf16 v8, v94, s30, v8
    v_dot2_f32_bf16 v10, v94, v94, v10
    v_dot2_f32_bf16 v9, v95, s30, v9
    v_dot2_f32_bf16 v11, v95, v95, v11
    v_dot2_f32_bf16 v8, v96, s30, v8
    v_dot2_f32_bf16 v10, v96, v96, v10
    v_dot2_f32_bf16 v9, v97, s30, v9
    v_dot2_f32_bf16 v11, v97, v97, v11
    ds_read_b128 v[124:127], v50 offset:1152
    v_dot2_f32_bf16 v8, v98, s30, v8
    v_dot2_f32_bf16 v10, v98, v98, v10
    v_dot2_f32_bf16 v9, v99, s30, v9
    v_dot2_f32_bf16 v11, v99, v99, v11
    s_waitcnt lgkmcnt(3)
    s_nop 0
    v_dot2_f32_bf16 v8, v100, s30, v8
    v_dot2_f32_bf16 v10, v100, v100, v10
    v_dot2_f32_bf16 v9, v101, s30, v9
    v_dot2_f32_bf16 v11, v101, v101, v11
    v_dot2_f32_bf16 v8, v102, s30, v8
    v_dot2_f32_bf16 v10, v102, v102, v10
    v_dot2_f32_bf16 v9, v103, s30, v9
    v_dot2_f32_bf16 v11, v103, v103, v11
    v_dot2_f32_bf16 v8, v104, s30, v8
    v_dot2_f32_bf16 v10, v104, v104, v10
    v_dot2_f32_bf16 v9, v105, s30, v9
    v_dot2_f32_bf16 v11, v105, v105, v11
    v_dot2_f32_bf16 v8, v106, s30, v8
    v_dot2_f32_bf16 v10, v106, v106, v10
    v_dot2_f32_bf16 v9, v107, s30, v9
    v_dot2_f32_bf16 v11, v107, v107, v11
    v_dot2_f32_bf16 v8, v108, s30, v8
    v_dot2_f32_bf16 v10, v108, v108, v10
    v_dot2_f32_bf16 v9, v109, s30, v9
    v_dot2_f32_bf16 v11, v109, v109, v11
    v_dot2_f32_bf16 v8, v110, s30, v8
    v_dot2_f32_bf16 v10, v110, v110, v10
    v_dot2_f32_bf16 v9, v111, s30, v9
    v_dot2_f32_bf16 v11, v111, v111, v11
    v_dot2_f32_bf16 v8, v112, s30, v8
    v_dot2_f32_bf16 v10, v112, v112, v10
    v_dot2_f32_bf16 v9, v113, s30, v9
    v_dot2_f32_bf16 v11, v113, v113, v11
    v_dot2_f32_bf16 v8, v114, s30, v8
    v_dot2_f32_bf16 v10, v114, v114, v10
    v_dot2_f32_bf16 v9, v115, s30, v9
    v_dot2_f32_bf16 v11, v115, v115, v11
    s_waitcnt lgkmcnt(0)
    s_nop 0
    v_dot2_f32_bf16 v8, v116, s30, v8
    v_dot2_f32_bf16 v10, v116, v116, v10
    v_dot2_f32_bf16 v9, v117, s30, v9
    v_dot2_f32_bf16 v11, v117, v117, v11
    v_dot2_f32_bf16 v8, v118, s30, v8
    v_dot2_f32_bf16 v10, v118, v118, v10
    v_dot2_f32_bf16 v9, v119, s30, v9
    v_dot2_f32_bf16 v11, v119, v119, v11
    v_dot2_f32_bf16 v8, v120, s30, v8
    v_dot2_f32_bf16 v10, v120, v120, v10
    v_dot2_f32_bf16 v9, v121, s30, v9
    v_dot2_f32_bf16 v11, v121, v121, v11
    v_dot2_f32_bf16 v8, v122, s30, v8
    v_dot2_f32_bf16 v10, v122, v122, v10
    v_dot2_f32_bf16 v9, v123, s30, v9
    v_dot2_f32_bf16 v11, v123, v123, v11
    v_dot2_f32_bf16 v8, v124, s30, v8
    v_dot2_f32_bf16 v10, v124, v124, v10
    v_dot2_f32_bf16 v9, v125, s30, v9
    v_dot2_f32_bf16 v11, v125, v125, v11
    v_dot2_f32_bf16 v8, v126, s30, v8
    v_dot2_f32_bf16 v10, v126, v126, v10
    v_dot2_f32_bf16 v9, v127, s30, v9
    v_dot2_f32_bf16 v11, v127, v127, v11
    s_nop 1
    v_add_f32 v8, v8, v9
    v_add_f32 v10, v10, v11
    s_nop 0
    v_add_f32_dpp v8, v8, v8 quad_perm:[1,0,3,2] row_mask:0xf bank_mask:0xf
    v_add_f32_dpp v10, v10, v10 quad_perm:[1,0,3,2] row_mask:0xf bank_mask:0xf
    s_nop 0
    v_add_f32_dpp v8, v8, v8 quad_perm:[2,3,0,1] row_mask:0xf bank_mask:0xf
    global_load_dwordx4 a[176:179], v49, s[44:45] offset:-4096
    s_nop 0
    v_add_f32_dpp v10, v10, v10 quad_perm:[2,3,0,1] row_mask:0xf bank_mask:0xf
    v_add_f32_dpp v8, v8, v8 row_half_mirror row_mask:0xf bank_mask:0xf
    v_mul_f32 v8, 0x3acccccd, v8
    v_add_f32_dpp v10, v10, v10 row_half_mirror row_mask:0xf bank_mask:0xf
    v_mul_f32 v10, 0x3acccccd, v10
    v_fma_f32 v10, -v8, v8, v10
    v_max_f32 v10, 0, v10
    v_add_f32 v10, 0x3727c5ac, v10
    v_rsq_f32 v10, v10
    v_mul_f32 v8, 0xc2000000, v8
    v_mul_f32 v10, 0x35cccccd, v10
    v_cndmask_b32 v8, v10, v8, s[94:95]
    ds_write_b32 v28, v8
    ds_read_b64_tr_b16 a[0:1], v29 offset:0
    global_load_dwordx4 a[180:183], v49, s[44:45] offset:-3072
    ds_read_b64_tr_b16 a[2:3], v29 offset:320
    ds_read_b64_tr_b16 a[4:5], v29 offset:5376
    ds_read_b64_tr_b16 a[6:7], v29 offset:5696
    ds_read_b64_tr_b16 a[8:9], v29 offset:10752
    ds_read_b64_tr_b16 a[10:11], v29 offset:11072
    ds_read_b64_tr_b16 a[12:13], v29 offset:16128
    ds_read_b64_tr_b16 a[14:15], v29 offset:16448
    ds_read_b64_tr_b16 a[16:17], v29 offset:21504
    global_load_dwordx4 a[184:187], v49, s[44:45] offset:-2048
    s_waitcnt lgkmcnt(9)
    s_barrier
    ds_read_b64_tr_b16 a[18:19], v29 offset:21824
    ds_read_b64_tr_b16 a[20:21], v29 offset:26880
    ds_read_b64_tr_b16 a[22:23], v29 offset:27200
    ds_read_b128 v[160:163], v31 offset:0
    s_mov_b32 s38, 1314816
    s_mov_b32 s39, 0x20000
    buffer_load_ushort v54, v46, s[36:39], s69 offen
    buffer_load_ushort v55, v47, s[36:39], s69 offen
    global_load_dwordx4 a[188:191], v49, s[44:45] offset:-1024
    ds_read_b128 v[164:167], v31 offset:16
    s_waitcnt vmcnt(10)
    v_cmp_gt_i32 vcc, 0, v56
    ds_read_b128 v[168:171], v31 offset:32
    s_nop 0
    v_cndmask_b32 v240, v236, v237, vcc
    v_cndmask_b32 v222, v233, v234, vcc
    v_cndmask_b32 v223, v233, v235, vcc
    v_cmp_gt_i32 vcc, 0, v57
    v_add_u32 v223, v223, v240
    s_waitcnt lgkmcnt(2)
    v_mfma_f32_16x16x32_bf16 v[88:91], a[0:3], v[60:63], v[160:163]
    ds_read_b128 v[172:175], v31 offset:48
    global_load_dwordx4 a[192:195], v49, s[44:45] offset:0
    ds_read_b128 v[176:179], v31 offset:64
    v_add_u32 v224, v223, v240
    v_cndmask_b32 v227, v233, v235, vcc
    v_add_u32 v225, v224, v240
    v_cndmask_b32 v240, v236, v237, vcc
    s_waitcnt lgkmcnt(3)
    v_mfma_f32_16x16x32_bf16 v[92:95], a[4:7], v[60:63], v[164:167]
    ds_read_b128 v[180:183], v31 offset:80
    v_cndmask_b32 v226, v233, v234, vcc
    s_waitcnt lgkmcnt(3)
    v_mfma_f32_16x16x32_bf16 v[96:99], a[8:11], v[60:63], v[168:171]
    ds_read_b128 v[184:187], v31 offset:96
    v_add_u32 v227, 32, v227
    v_cmp_gt_i32 vcc, 0, v58
    v_add_u32 v227, v227, v240
    v_add_u32 v228, v227, v240
    v_add_u32 v229, v228, v240
    s_waitcnt lgkmcnt(3)
    v_mfma_f32_16x16x32_bf16 v[100:103], a[12:15], v[60:63], v[172:175]
    ds_read_b128 v[188:191], v31 offset:112
    v_cndmask_b32 v240, v236, v237, vcc
    s_waitcnt lgkmcnt(3)
    v_mfma_f32_16x16x32_bf16 v[104:107], a[16:19], v[60:63], v[176:179]
    ds_read_b128 v[4:7], v87
    v_add_u32 v226, 32, v226
    v_and_b32 v230, 0x80000000, v56
    v_and_b32 v231, 0x80000000, v57
    v_xor_b32 v56, v56, v230
    s_waitcnt lgkmcnt(3)
    v_mfma_f32_16x16x32_bf16 v[108:111], a[20:23], v[60:63], v[180:183]
    ds_read_b128 v[8:11], v87 offset:16
    global_load_dwordx4 a[196:199], v49, s[44:45] offset:1024
    global_load_dwordx4 a[200:203], v49, s[44:45] offset:2048
    ds_read_b64_tr_b16 a[24:25], v29 offset:32256
    ds_read_b64_tr_b16 a[26:27], v29 offset:32576
    ds_read_b64_tr_b16 a[28:29], v29 offset:37632
    ds_read_b64_tr_b16 a[30:31], v29 offset:37952
    ds_read_b64_tr_b16 a[32:33], v30 offset:32
    ds_read_b64_tr_b16 a[34:35], v30 offset:352
    ds_read_b64_tr_b16 a[36:37], v30 offset:5408
    global_load_dwordx4 a[204:207], v49, s[44:45] offset:3072
    ds_read_b64_tr_b16 a[38:39], v30 offset:5728
    ds_read_b64_tr_b16 a[40:41], v30 offset:10784
    ds_read_b64_tr_b16 a[42:43], v30 offset:11104
    s_waitcnt vmcnt(11)
    v_lshlrev_b32 v52, 16, v52
    s_barrier
    s_waitcnt vmcnt(10)
    v_lshlrev_b32 v53, 16, v53
    s_waitcnt lgkmcnt(8)
    v_mfma_f32_16x16x32_bf16 v[112:115], a[24:27], v[60:63], v[184:187]
    ds_read_b64_tr_b16 a[44:45], v30 offset:16160
    v_and_b32 v232, 0x80000000, v58
    s_waitcnt lgkmcnt(7)
    v_mfma_f32_16x16x32_bf16 v[116:119], a[28:31], v[60:63], v[188:191]
    ds_read_b64_tr_b16 a[46:47], v30 offset:16480
    v_xor_b32 v57, v57, v231
    s_waitcnt lgkmcnt(6)
    v_mfma_f32_16x16x32_bf16 v[128:131], a[32:35], v[60:63], v[160:163]
    ds_read_b64_tr_b16 a[48:49], v30 offset:21536
    v_add_f32 v52, v52, v53
    s_waitcnt lgkmcnt(5)
    v_mfma_f32_16x16x32_bf16 v[132:135], a[36:39], v[60:63], v[164:167]
    ds_read_b64_tr_b16 a[50:51], v30 offset:21856
    v_add_u32 v56, v56, v239
    s_waitcnt lgkmcnt(4)
    v_mfma_f32_16x16x32_bf16 v[136:139], a[40:43], v[60:63], v[168:171]
    ds_read_b64_tr_b16 a[52:53], v30 offset:26912
    global_load_dwordx4 a[208:211], v59, s[44:45] offset:-4096
    global_load_dwordx4 a[212:215], v59, s[44:45] offset:-3072
    v_xor_b32 v58, v58, v232
    v_add_u32 v57, v57, v239
    s_waitcnt lgkmcnt(3)
    v_mfma_f32_16x16x32_bf16 v[140:143], a[44:47], v[60:63], v[172:175]
    ds_read_b64_tr_b16 a[54:55], v30 offset:27232
    ds_read_b64_tr_b16 a[56:57], v30 offset:32288
    v_mul_f32 v52, s70, v52
    v_add_u32 v58, v58, v239
    v_add_u32 v241, s68, v241
    v_mul_f32 v64, v64, v4
    s_waitcnt lgkmcnt(3)
    v_mfma_f32_16x16x32_bf16 v[144:147], a[48:51], v[60:63], v[176:179]
    ds_read_b64_tr_b16 a[58:59], v30 offset:32608
    global_load_dwordx4 a[216:219], v59, s[44:45] offset:-2048
    ds_read_b64_tr_b16 a[60:61], v30 offset:37664
    ds_read_b64_tr_b16 a[62:63], v30 offset:37984
    ds_read2st64_b32 v[194:195], v223 offset0:0 offset1:24
    v_cndmask_b32 v223, v233, v235, vcc
    v_add_u32 v223, 64, v223
    v_add_u32 v223, v223, v240
    v_mul_f32 v65, v65, v5
    s_waitcnt lgkmcnt(5)
    v_mfma_f32_16x16x32_bf16 v[148:151], a[52:55], v[60:63], v[180:183]
    v_mul_f32 v66, v66, v6
    v_mul_f32 v67, v67, v7
    v_mul_f32 v68, v68, v8
    v_mul_f32 v69, v69, v9
    v_mul_f32 v70, v70, v10
    v_mul_f32 v71, v71, v11
    v_mul_f32 v72, v72, v4
    s_waitcnt lgkmcnt(3)
    v_mfma_f32_16x16x32_bf16 v[152:155], a[56:59], v[60:63], v[184:187]
    global_load_dwordx4 a[220:223], v59, s[44:45] offset:-1024
    v_mul_f32 v73, v73, v5
    v_mul_f32 v74, v74, v6
    s_waitcnt lgkmcnt(1)
    v_mfma_f32_16x16x32_bf16 v[156:159], a[60:63], v[60:63], v[188:191]
    ds_read2st64_b32 v[192:193], v222 offset0:0 offset1:24
    v_cndmask_b32 v222, v233, v234, vcc
    v_add_u32 v222, 64, v222
    v_mul_f32 v75, v75, v7
    v_mul_f32 v76, v76, v8
    v_mul_f32 v77, v77, v9
    v_mul_f32 v78, v78, v10
    global_load_dwordx4 a[224:227], v59, s[44:45] offset:0
    s_waitcnt lgkmcnt(1)
    v_perm_b32 v245, v195, v194, v238
    v_xor_b32 v245, v245, v230
    ds_read2st64_b32 v[196:197], v224 offset0:0 offset1:24
    v_add_u32 v224, v223, v240
    v_mul_f32 v79, v79, v11
    v_cvt_pk_bf16_f32 v80, v64, v65
    v_cvt_pk_bf16_f32 v81, v66, v67
    v_cvt_pk_bf16_f32 v82, v68, v69
    v_cvt_pk_bf16_f32 v83, v70, v71
    v_cvt_pk_bf16_f32 v84, v72, v73
    v_cvt_pk_bf16_f32 v85, v74, v75
    v_cvt_pk_bf16_f32 v86, v76, v77
    v_cvt_pk_bf16_f32 v87, v78, v79
    v_cvt_pk_bf16_f32 v64, v88, v92
    v_cvt_pk_bf16_f32 v65, v96, v100
    global_load_dwordx4 a[228:231], v59, s[44:45] offset:1024
    ds_read2st64_b32 v[198:199], v225 offset0:0 offset1:24
    v_add_u32 v225, v224, v240
    s_waitcnt lgkmcnt(2)
    v_perm_b32 v244, v193, v192, v238
    v_xor_b32 v244, v244, v230
    v_cvt_pk_bf16_f32 v66, v104, v108
    v_cvt_pk_bf16_f32 v67, v112, v116
    v_cvt_pk_bf16_f32 v68, v89, v93
    v_cvt_pk_bf16_f32 v69, v97, v101
    v_mfma_f32_16x16x32_bf16 v[160:163], v[64:67], v[80:83], 0
    v_cvt_pk_bf16_f32 v70, v105, v109
    v_cvt_pk_bf16_f32 v71, v113, v117
    v_mfma_f32_16x16x32_bf16 v[164:167], v[64:67], v[84:87], 0
    ds_read2st64_b32 v[200:201], v226 offset0:0 offset1:24
    s_waitcnt vmcnt(12)
    v_lshlrev_b32 v54, 16, v54
    v_mfma_f32_16x16x32_bf16 v[168:171], v[68:71], v[80:83], 0
    global_load_dwordx4 a[232:235], v59, s[44:45] offset:2048
    v_mfma_f32_16x16x32_bf16 v[172:175], v[68:71], v[84:87], 0
    s_waitcnt vmcnt(12)
    v_lshlrev_b32 v55, 16, v55
    s_waitcnt lgkmcnt(2)
    v_perm_b32 v246, v197, v196, v238
    v_sub_f32 v54, v54, v55
    v_xor_b32 v246, v246, v230
    ds_read2st64_b32 v[202:203], v227 offset0:0 offset1:24
    v_mul_f32 v54, s70, v54
    s_waitcnt lgkmcnt(2)
    v_perm_b32 v247, v199, v198, v238
    global_load_dwordx4 a[236:239], v59, s[44:45] offset:3072
    v_xor_b32 v247, v247, v230
    buffer_store_dwordx4 v[244:247], v56, s[40:43], 0 offen sc1
    v_cvt_pk_bf16_f32 v52, v52, v54
    v_cvt_pk_bf16_f32 v72, v90, v94
    v_cvt_pk_bf16_f32 v73, v98, v102
    ds_read2st64_b32 v[204:205], v228 offset0:0 offset1:24
    v_cvt_pk_bf16_f32 v74, v106, v110
    s_waitcnt lgkmcnt(2)
    v_perm_b32 v248, v201, v200, v238
    v_xor_b32 v248, v248, v231
    v_cvt_pk_bf16_f32 v75, v114, v118
    v_cvt_pk_bf16_f32 v76, v91, v95
    v_cvt_pk_bf16_f32 v77, v99, v103
    v_mfma_f32_16x16x32_bf16 v[176:179], v[72:75], v[80:83], 0
    v_cvt_pk_bf16_f32 v78, v107, v111
    v_cvt_pk_bf16_f32 v79, v115, v119
    v_mfma_f32_16x16x32_bf16 v[180:183], v[72:75], v[84:87], 0
    v_cvt_pk_bf16_f32 v16, v128, v132
    v_cvt_pk_bf16_f32 v17, v136, v140
    v_mfma_f32_16x16x32_bf16 v[184:187], v[76:79], v[80:83], 0
    ds_read2st64_b32 v[206:207], v229 offset0:0 offset1:24
    s_waitcnt lgkmcnt(2)
    v_perm_b32 v249, v203, v202, v238
    v_mfma_f32_16x16x32_bf16 v[188:191], v[76:79], v[84:87], 0
    v_xor_b32 v249, v249, v231
    v_cvt_pk_bf16_f32 v18, v144, v148
    v_cvt_pk_bf16_f32 v19, v152, v156
    v_cvt_pk_bf16_f32 v20, v129, v133
    v_cvt_pk_bf16_f32 v21, v137, v141
    v_mfma_f32_16x16x32_bf16 v[88:91], v[16:19], v[80:83], 0
    v_cvt_pk_bf16_f32 v22, v145, v149
    v_cvt_pk_bf16_f32 v23, v153, v157
    v_mfma_f32_16x16x32_bf16 v[92:95], v[16:19], v[84:87], 0
    ds_read2st64_b32 v[208:209], v222 offset0:0 offset1:24
    s_waitcnt lgkmcnt(2)
    v_perm_b32 v250, v205, v204, v238
    v_mfma_f32_16x16x32_bf16 v[96:99], v[20:23], v[80:83], 0
    v_xor_b32 v250, v250, v231
    v_cvt_pk_bf16_f32 v24, v130, v134
    v_mfma_f32_16x16x32_bf16 v[100:103], v[20:23], v[84:87], 0
    s_nop 0
    v_cvt_pk_bf16_f32 v25, v138, v142
    v_cvt_pk_bf16_f32 v26, v146, v150
    v_cvt_pk_bf16_f32 v27, v154, v158
    v_cvt_pk_bf16_f32 v28, v131, v135
    v_cvt_pk_bf16_f32 v29, v139, v143
    v_mfma_f32_16x16x32_bf16 v[104:107], v[24:27], v[80:83], 0
    ds_read2st64_b32 v[210:211], v223 offset0:0 offset1:24
    s_waitcnt lgkmcnt(2)
    v_perm_b32 v251, v207, v206, v238
    v_mfma_f32_16x16x32_bf16 v[108:111], v[24:27], v[84:87], 0
    v_xor_b32 v251, v251, v231
    buffer_store_dwordx4 v[248:251], v57, s[40:43], 0 offen sc1
    v_cvt_pk_bf16_f32 v30, v147, v151
    v_cvt_pk_bf16_f32 v31, v155, v159
    v_cvt_pk_bf16_f32 v120, v160, v168
    v_cvt_pk_bf16_f32 v121, v176, v184
    v_mfma_f32_16x16x32_bf16 v[112:115], v[28:31], v[80:83], 0
    ds_read2st64_b32 v[212:213], v224 offset0:0 offset1:24
    s_waitcnt lgkmcnt(2)
    v_perm_b32 v252, v209, v208, v238
    v_mfma_f32_16x16x32_bf16 v[116:119], v[28:31], v[84:87], 0
    v_xor_b32 v252, v252, v232
    v_cvt_pk_bf16_f32 v122, v161, v169
    v_cvt_pk_bf16_f32 v123, v177, v185
    v_cvt_pk_bf16_f32 v124, v164, v172
    v_cvt_pk_bf16_f32 v125, v180, v188
    v_cvt_pk_bf16_f32 v126, v165, v173
    v_cvt_pk_bf16_f32 v127, v181, v189
    v_cvt_pk_bf16_f32 v80, v88, v96
    ds_read2st64_b32 v[214:215], v225 offset0:0 offset1:24
    v_cvt_pk_bf16_f32 v81, v104, v112
    s_waitcnt lgkmcnt(2)
    v_perm_b32 v253, v211, v210, v238
    v_xor_b32 v253, v253, v232
    v_cvt_pk_bf16_f32 v82, v89, v97
    v_cvt_pk_bf16_f32 v83, v105, v113
    v_cvt_pk_bf16_f32 v84, v92, v100
    v_cvt_pk_bf16_f32 v85, v108, v116
    v_cvt_pk_bf16_f32 v86, v93, v101
    v_cvt_pk_bf16_f32 v87, v109, v117
    ds_write_b128 v44, v[120:123] offset:0
    s_waitcnt lgkmcnt(2)
    v_perm_b32 v254, v213, v212, v238
    v_xor_b32 v254, v254, v232
    ds_write_b128 v44, v[124:127] offset:16
    s_waitcnt lgkmcnt(2)
    v_perm_b32 v255, v215, v214, v238
    v_xor_b32 v255, v255, v232
    buffer_store_dwordx4 v[252:255], v58, s[40:43], 0 offen sc1
    buffer_store_dword v52, v241, s[40:43], 0 offen sc1
    ds_read_b64_tr_b16 a[64:65], v216
    ds_read_b64_tr_b16 a[66:67], v217
    ds_read_b64_tr_b16 a[68:69], v218
    ds_read_b64_tr_b16 a[70:71], v219
    ds_write_b128 v43, v[80:83] offset:128
    ds_write_b128 v43, v[84:87] offset:144
    s_waitcnt lgkmcnt(4)
    buffer_store_dwordx4 a[64:67], v14, s[40:43], s61 offen sc1
    s_waitcnt lgkmcnt(2)
    buffer_store_dwordx4 a[68:71], v14, s[40:43], s62 offen sc1
    s_waitcnt lgkmcnt(0)
    s_barrier
    ds_read_b128 v[64:67], v45 offset:0
    ds_read_b128 v[68:71], v45 offset:704
    ds_read_b128 v[72:75], v45 offset:1408
    ds_read_b128 v[76:79], v45 offset:2112
    s_waitcnt lgkmcnt(3)
    buffer_store_dwordx4 v[64:67], v40, s[40:43], s67 offen sc1
    s_add_u32 s67, s67, 1048576
    s_waitcnt lgkmcnt(2)
    buffer_store_dwordx4 v[68:71], v40, s[40:43], s67 offen sc1
    s_add_u32 s67, s67, 1048576
    s_waitcnt lgkmcnt(1)
    buffer_store_dwordx4 v[72:75], v40, s[40:43], s67 offen sc1
    s_add_u32 s67, s67, 1048576
    s_waitcnt lgkmcnt(0)
    buffer_store_dwordx4 v[76:79], v40, s[40:43], s67 offen sc1
    s_mul_i32 s47, s47, 0x9E3779B1
    v_lshlrev_b32 v60, 2, v1
    s_add_u32 s47, s47, 0x7F4A7C15
    v_add_u32 v60, s74, v60
    v_and_b32 v61, 32, v1
    v_lshl_or_b32 v60, v61, 25, v60
    v_mov_b32 v64, s47
    v_and_b32 v143, 1, v3
    v_cvt_f32_u32 v144, v143
    v_lshrrev_b32 v143, v143, s79
    v_cmp_gt_u32 vcc, s77, v2
    v_and_b32 v143, 1, v143
    s_lshl_b32 m0, s46, 11
    s_add_u32 m0, m0, 154624
    s_nop 0
    buffer_load_dwordx4 v34, s[20:23], s96 offen lds
    v_cndmask_b32 v143, 0, v143, vcc
    v_sub_u32 v143, 0, v143
    v_cmp_gt_u32 vcc, 2, v3
    v_and_b32 v101, s81, v143
    v_and_b32 v102, s82, v143
    v_lshlrev_b32 v6, 8, v2
    v_cndmask_b32 v103, 0, v101, vcc
    v_cndmask_b32 v104, 0, v102, vcc
    v_lshl_add_u32 v6, v3, 4, v6
    v_cmp_gt_u32 vcc, 2, v3
    s_lshl_b32 m0, s46, 11
    s_add_u32 m0, m0, 155648
    s_nop 0
    buffer_load_dwordx4 v35, s[20:23], s96 offen lds
    v_mov_b32 v10, 1073741824
    v_add_u32 v7, 128, v6
    v_cndmask_b32 v7, v10, v7, vcc
    v_cmp_gt_u32 vcc, s77, v2
    v_and_b32 v9, 15, v1
    v_lshlrev_b32 v9, 6, v9
    v_cndmask_b32 v8, v10, v6, vcc
    v_bfe_u32 v12, v1, 4, 1
    v_cmp_gt_u32 vcc, 32, v1
    v_add_u32 v9, v9, v12
    v_mov_b32 v12, s56
    v_mov_b32 v13, s57
    v_cndmask_b32 v12, v13, v12, vcc
    v_add_u32 v9, v9, v12
    v_lshrrev_b32 v12, 4, v9
    v_and_b32 v9, 15, v9
    v_mul_u32_u24 v12, 2048, v12
    v_mul_u32_u24 v9, 128, v9
    v_min_u32 v11, 59, v1
    v_add_u32 v9, v9, v12
    v_mul_u32_u24 v12, 86, v11
    v_lshrrev_b32 v12, 8, v12
    v_mul_u32_u24 v13, 3, v12
    v_sub_u32 v11, v11, v13
    v_add_u32 v11, s58, v11
    v_mul_u32_u24 v12, 12, v12
    v_lshrrev_b32 v13, 3, v11
    v_lshlrev_b32 v142, 5, v2
    v_add_u32 v12, v12, v13
    v_add_u32 v142, s76, v142
    v_and_b32 v100, 2, v3
    v_bfe_u32 v11, v11, 1, 2
    v_bfe_u32 v13, v12, 3, 2
    v_cvt_f32_u32 v142, v142
    v_lshlrev_b32 v100, 1, v100
    v_lshl_add_u32 v11, v13, 2, v11
    v_mul_f32 v142, 0xbacccccd, v142
    v_mul_f32 v144, s78, v144
    v_cvt_f32_u32 v100, v100
    v_lshlrev_b32 v11, 6, v11
    v_and_b32 v13, 7, v12
    v_fma_f32 v144, v100, v142, v144
    v_lshl_add_u32 v11, v13, 3, v11
    v_lshrrev_b32 v13, 6, v12
    v_fmamk_f32 v107, v142, 0x3f800000, v144
    v_fmamk_f32 v108, v142, 0x40000000, v144
    v_fmamk_f32 v109, v142, 0x40400000, v144
    v_fmamk_f32 v118, v142, 0x41000000, v144
    v_fmamk_f32 v119, v142, 0x41100000, v144
    v_fmamk_f32 v120, v142, 0x41200000, v144
    v_fmamk_f32 v121, v142, 0x41300000, v144
    v_fmamk_f32 v130, v142, 0x41800000, v144
    v_fmamk_f32 v131, v142, 0x41880000, v144
    v_fmamk_f32 v132, v142, 0x41900000, v144
    v_fmamk_f32 v133, v142, 0x41980000, v144
    v_lshl_add_u32 v11, v13, 1, v11
    v_sin_f32 v111, v107
    v_sin_f32 v112, v108
    v_sin_f32 v113, v109
    v_sin_f32 v122, v118
    v_sin_f32 v123, v119
    v_sin_f32 v124, v120
    v_sin_f32 v125, v121
    v_sin_f32 v134, v130
    v_sin_f32 v135, v131
    v_sin_f32 v136, v132
    v_sin_f32 v137, v133
    v_bfe_u32 v13, v12, 5, 1
    v_sin_f32 v110, v144
    v_cos_f32 v106, v144
    v_cos_f32 v107, v107
    v_cos_f32 v108, v108
    v_cos_f32 v109, v109
    v_cos_f32 v118, v118
    v_cos_f32 v119, v119
    v_cos_f32 v120, v120
    v_cos_f32 v121, v121
    v_cos_f32 v130, v130
    v_cos_f32 v131, v131
    v_cos_f32 v132, v132
    v_cos_f32 v133, v133
    v_add_u32 v11, v11, v13
    s_cmp_lg_u32 s80, 0
    s_cselect_b64 s[96:97], -1, 0
    s_cselect_b32 s3, 0x80008000, 0
    v_lshrrev_b32 v13, 4, v11
    s_and_b32 s80, s80, 0x80008000
    v_cvt_pk_bf16_f32 v114, v106, v107
    v_cvt_pk_bf16_f32 v116, v110, v111
    v_cvt_pk_bf16_f32 v115, v108, v109
    v_cvt_pk_bf16_f32 v117, v112, v113
    v_cvt_pk_bf16_f32 v126, v118, v119
    v_cvt_pk_bf16_f32 v128, v122, v123
    v_cvt_pk_bf16_f32 v127, v120, v121
    v_cvt_pk_bf16_f32 v129, v124, v125
    v_cvt_pk_bf16_f32 v138, v130, v131
    v_cvt_pk_bf16_f32 v140, v134, v135
    v_cvt_pk_bf16_f32 v139, v132, v133
    v_cvt_pk_bf16_f32 v141, v136, v137
    v_mul_u32_u24 v5, 224, v2
    s_mul_i32 s95, s46, 7168
    v_and_b32 v11, 15, v11
    s_xor_b32 s3, s3, s80
    v_cndmask_b32 v194, v114, v116, s[96:97]
    v_cndmask_b32 v206, v116, v114, s[96:97]
    v_cndmask_b32 v195, v115, v117, s[96:97]
    v_cndmask_b32 v207, v117, v115, s[96:97]
    v_cndmask_b32 v198, v126, v128, s[96:97]
    v_cndmask_b32 v210, v128, v126, s[96:97]
    v_cndmask_b32 v199, v127, v129, s[96:97]
    v_cndmask_b32 v211, v129, v127, s[96:97]
    v_cndmask_b32 v202, v138, v140, s[96:97]
    v_cndmask_b32 v214, v140, v138, s[96:97]
    v_cndmask_b32 v203, v139, v141, s[96:97]
    v_cndmask_b32 v215, v141, v139, s[96:97]
    v_lshl_add_u32 v5, v3, 4, v5
    s_add_u32 s95, s95, 125952
    v_mul_u32_u24 v13, 2048, v13
    v_mul_u32_u24 v11, 128, v11
    v_bitop3_b32 v194, v194, s80, v102 bitop3:0x28
    v_bitop3_b32 v206, v206, s3, v102 bitop3:0x28
    v_and_b32 v192, v114, v101
    v_and_b32 v204, v116, v101
    v_bitop3_b32 v195, v195, s80, v102 bitop3:0x28
    v_bitop3_b32 v207, v207, s3, v102 bitop3:0x28
    v_and_b32 v193, v115, v101
    v_and_b32 v205, v117, v101
    v_bitop3_b32 v198, v198, s80, v102 bitop3:0x28
    v_bitop3_b32 v210, v210, s3, v102 bitop3:0x28
    v_and_b32 v196, v126, v101
    v_and_b32 v208, v128, v101
    v_bitop3_b32 v199, v199, s80, v102 bitop3:0x28
    v_bitop3_b32 v211, v211, s3, v102 bitop3:0x28
    v_and_b32 v197, v127, v101
    v_and_b32 v209, v129, v101
    v_bitop3_b32 v202, v202, s80, v104 bitop3:0x28
    v_bitop3_b32 v214, v214, s3, v104 bitop3:0x28
    v_and_b32 v200, v138, v103
    v_and_b32 v212, v140, v103
    v_bitop3_b32 v203, v203, s80, v104 bitop3:0x28
    v_bitop3_b32 v215, v215, s3, v104 bitop3:0x28
    v_and_b32 v201, v139, v103
    v_and_b32 v213, v141, v103
    v_add_u32 v5, s95, v5
    v_mul_u32_u24 v63, 128, v2
    v_add_u32 v11, v11, v13
    ds_write_b128 v5, v[192:195] offset:0
    v_add_u32 v63, s83, v63
    s_add_u32 s93, s84, 64
    ds_write_b128 v5, v[196:199] offset:64
    s_mul_i32 s94, s46, 3072
    s_mov_b32 s53, s86
    v_add_u32 v9, 131072, v9
    v_add_u32 v11, 131072, v11
    ds_write_b128 v5, v[200:203] offset:128
    ds_write_b128 v5, v[204:207] offset:3584
    s_waitcnt vmcnt(2)
    buffer_store_dword v64, v60, s[40:43], 0 offen sc1
    ds_write_b128 v5, v[208:211] offset:3648
    s_barrier
    ds_write_b128 v5, v[212:215] offset:3712
    s_xor_b32 s88, s48, 1
    s_lshl_b32 s89, s46, 9
    v_mul_u32_u24 v4, 781, v1
    s_add_u32 s88, s88, s89
    s_sub_u32 s89, 43008, s51
    s_mul_i32 s90, s46, 10752
    v_lshrrev_b32 v16, 16, v4
    v_add_u32 v17, 49984, v4
    v_add_u32 v18, 99968, v4
    s_mul_i32 s91, s88, 1280
    s_add_u32 s92, s89, s90
    v_mad_u32_u24 v16, v16, s54, v14
    s_mov_b32 m0, s92
    s_nop 0
    buffer_load_dwordx4 v16, s[4:7], s91 offen offset:0 lds
    v_lshrrev_b32 v17, 16, v17
    v_add_u32 v19, 149952, v4
    v_lshrrev_b32 v18, 16, v18
    v_add_u32 v20, 199936, v4
    v_mad_u32_u24 v17, v17, s54, v14
    buffer_load_dwordx4 v17, s[4:7], s91 offen offset:1024 lds
    v_lshrrev_b32 v19, 16, v19
    v_mad_u32_u24 v18, v18, s54, v14
    v_lshrrev_b32 v20, 16, v20
    v_add_u32 v21, 249920, v4
    buffer_load_dwordx4 v18, s[4:7], s91 offen offset:2048 lds
    v_mad_u32_u24 v19, v19, s54, v14
    v_add_u32 v22, 299904, v4
    v_mad_u32_u24 v20, v20, s54, v14
    v_lshrrev_b32 v21, 16, v21
    v_add_u32 v23, 349888, v4
    v_lshrrev_b32 v22, 16, v22
    v_add_u32 v24, 399872, v4
    v_mad_u32_u24 v21, v21, s54, v14
    v_lshrrev_b32 v23, 16, v23
    v_mad_u32_u24 v22, v22, s54, v14
    v_lshrrev_b32 v24, 16, v24
    v_add_u32 v25, 449856, v4
    v_mad_u32_u24 v23, v23, s54, v14
    buffer_load_dwordx4 v19, s[4:7], s91 offen offset:3072 lds
    v_add_u32 v26, 499840, v4
    v_mad_u32_u24 v24, v24, s54, v14
    v_lshrrev_b32 v25, 16, v25
    v_lshrrev_b32 v26, 16, v26
    v_mad_u32_u24 v25, v25, s54, v14
    v_mad_u32_u24 v26, v26, s54, v14
    s_add_u32 m0, m0, 4096
    s_add_u32 s91, s91, 4096
    buffer_load_dwordx4 v20, s[4:7], s91 offen offset:0 lds
    buffer_load_dwordx4 v21, s[4:7], s91 offen offset:1024 lds
    buffer_load_dwordx4 v22, s[4:7], s91 offen offset:2048 lds
    buffer_load_dwordx4 v23, s[4:7], s91 offen offset:3072 lds
    s_add_u32 m0, m0, 4096
    s_add_u32 s91, s91, 4096
    buffer_load_dwordx4 v24, s[4:7], s91 offen offset:0 lds
    buffer_load_dwordx4 v25, s[4:7], s91 offen offset:1024 lds
    s_mov_b64 exec, 0xffffffff
    buffer_load_dwordx4 v26, s[4:7], s91 offen offset:2048 lds
    s_mov_b64 exec, -1
    buffer_load_dword v10, v63, s[40:43], 0 offen sc1
    s_waitcnt vmcnt(0)
    v_cmp_ne_u32 vcc, s47, v10
    s_nop 1
    s_cbranch_vccnz L_spin1
L_got1:
    buffer_load_dword v12, v9, s[40:43], 0 offen sc1
    buffer_load_dword v13, v11, s[40:43], 0 offen sc1
    s_add_u32 m0, s94, 86016
    s_nop 0
    buffer_load_dwordx4 v6, s[40:43], s84 offen sc1 lds
    s_add_u32 m0, s94, 87040
    s_nop 0
    buffer_load_dwordx4 v6, s[40:43], s93 offen sc1 lds
    s_add_u32 m0, s94, 88064
    s_nop 0
    buffer_load_dwordx4 v7, s[40:43], s84 offen sc1 lds
    s_mov_b32 s18, 3072
    s_mov_b32 s19, 0x20000
    s_mov_b32 s26, 1280
    s_mov_b32 s27, 0x20000
    s_mov_b32 s30, 2621440
    s_mov_b32 s31, 0x20000
    v_accvgpr_write_b32 a240, v50
    v_accvgpr_write_b32 a241, v51
    s_waitcnt vmcnt(4)
    v_cmp_ne_u32 vcc, s47, v12
    s_nop 1
    s_cbranch_vccnz L_spin2
L_got2:
    buffer_load_dwordx4 v[64:67], v8, s[40:43], s85 offen offset:0 sc1
    buffer_load_dwordx4 v[68:71], v8, s[40:43], s85 offen offset:64 sc1
    buffer_load_dwordx4 v[72:75], v8, s[40:43], s85 offen offset:128 sc1
    buffer_load_dwordx4 v[76:79], v8, s[40:43], s85 offen offset:192 sc1
    s_waitcnt vmcnt(7)
    v_cmp_ne_u32 vcc, s47, v13
    s_nop 1
    s_cbranch_vccnz L_spin3
L_got3:
    s_waitcnt vmcnt(4) lgkmcnt(0)
    s_barrier
    ds_read_b64_tr_b16 a[244:245], v220 offset:0
    ds_read_b64_tr_b16 a[246:247], v220 offset:4096
    ds_read_b64_tr_b16 a[248:249], v221 offset:0
    ds_read_b64_tr_b16 a[250:251], v221 offset:4096
    v_add_u32 v4, 86016, v14
    ds_read_b128 v[16:19], v4 offset:0
    ds_read_b128 v[28:31], v4 offset:3072
    v_lshrrev_b32 v5, 2, v1
    v_mul_u32_u24 v5, 224, v5
    ds_read_b128 v[20:23], v4 offset:1024
    v_and_b32 v6, 3, v1
    v_add_u32 v7, 98304, v14
    ds_read_b128 v[32:35], v4 offset:4096
    s_lshl_b32 s88, s46, 10
    v_lshl_add_u32 v5, v6, 3, v5
    ds_read_b128 v[24:27], v4 offset:2048
    buffer_load_dwordx4 a[0:3], v14, s[40:43], s53 offen offset:0 sc1
    s_waitcnt lgkmcnt(7)
    buffer_store_dwordx4 a[244:247], v14, s[40:43], s63 offen sc1
    v_add_u32 v6, s88, v7
    s_waitcnt lgkmcnt(4)
    v_mfma_f32_16x16x32_bf16 v[80:83], v[16:19], v[192:195], 0
    ds_read_b128 v[36:39], v4 offset:5120
    s_lshl_b32 s88, s46, 12
    v_mfma_f32_16x16x32_bf16 v[84:87], v[16:19], v[204:207], 0
    ds_read_b128 v[40:43], v4 offset:6144
    v_add_u32 v5, 125952, v5
    s_waitcnt lgkmcnt(5)
    v_mfma_f32_16x16x32_bf16 v[88:91], v[28:31], v[192:195], 0
    buffer_store_dwordx4 a[248:251], v14, s[40:43], s64 offen sc1
    v_mfma_f32_16x16x32_bf16 v[92:95], v[28:31], v[204:207], 0
    ds_read_b128 v[52:55], v4 offset:9216
    v_add_u32 v7, s88, v7
    s_waitcnt lgkmcnt(4)
    v_mfma_f32_16x16x32_bf16 v[80:83], v[20:23], v[196:199], v[80:83]
    ds_read_b128 v[44:47], v4 offset:7168
    s_mov_b32 s89, 0
    v_mfma_f32_16x16x32_bf16 v[84:87], v[20:23], v[208:211], v[84:87]
    buffer_load_dwordx4 a[4:7], v14, s[40:43], s53 offen offset:1024 sc1
    v_mfma_f32_16x16x32_bf16 v[88:91], v[32:35], v[196:199], v[88:91]
    ds_read_b128 v[56:59], v4 offset:10240
    s_mul_i32 s88, s46, 2816
    v_mfma_f32_16x16x32_bf16 v[92:95], v[32:35], v[208:211], v[92:95]
    ds_read_b128 v[48:51], v4 offset:8192
    s_add_u32 s88, s88, 114688
    s_waitcnt lgkmcnt(5)
    v_mfma_f32_16x16x32_bf16 v[80:83], v[24:27], v[200:203], v[80:83]
    ds_read_b128 v[60:63], v4 offset:11264
    v_mul_u32_u24 v32, 171, v1
    v_mfma_f32_16x16x32_bf16 v[84:87], v[24:27], v[212:215], v[84:87]
    ds_read_b64_tr_b16 v[168:169], v5 offset:0
    v_lshrrev_b32 v33, 12, v32
    v_mfma_f32_16x16x32_bf16 v[88:91], v[36:39], v[200:203], v[88:91]
    buffer_load_dwordx4 a[8:11], v14, s[40:43], s53 offen offset:2048 sc1
    v_mfma_f32_16x16x32_bf16 v[92:95], v[36:39], v[212:215], v[92:95]
    ds_read_b64_tr_b16 v[170:171], v5 offset:3584
    v_cvt_pk_bf16_f32 v112, v80, v81
    s_waitcnt lgkmcnt(5)
    v_mfma_f32_16x16x32_bf16 v[96:99], v[40:43], v[192:195], 0
    ds_read_b64_tr_b16 v[172:173], v5 offset:32
    v_cvt_pk_bf16_f32 v116, v84, v85
    v_mfma_f32_16x16x32_bf16 v[100:103], v[40:43], v[204:207], 0
    ds_read_b64_tr_b16 v[174:175], v5 offset:3616
    v_cvt_pk_bf16_f32 v113, v82, v83
    v_mfma_f32_16x16x32_bf16 v[104:107], v[52:55], v[192:195], 0
    ds_read_b64_tr_b16 v[176:177], v5 offset:64
    v_cvt_pk_bf16_f32 v117, v86, v87
    v_mfma_f32_16x16x32_bf16 v[108:111], v[52:55], v[204:207], 0
    ds_read_b64_tr_b16 v[178:179], v5 offset:3648
    v_cvt_pk_bf16_f32 v114, v88, v89
    v_mfma_f32_16x16x32_bf16 v[96:99], v[44:47], v[196:199], v[96:99]
    buffer_load_dwordx4 a[12:15], v14, s[40:43], s53 offen offset:3072 sc1
    v_mfma_f32_16x16x32_bf16 v[100:103], v[44:47], v[208:211], v[100:103]
    ds_read_b64_tr_b16 v[180:181], v5 offset:96
    s_add_u32 s53, s53, 4096
    s_waitcnt lgkmcnt(6)
    v_mfma_f32_16x16x32_bf16 v[104:107], v[56:59], v[196:199], v[104:107]
    ds_read_b64_tr_b16 v[182:183], v5 offset:3680
    v_cvt_pk_bf16_f32 v118, v92, v93
    v_mfma_f32_16x16x32_bf16 v[108:111], v[56:59], v[208:211], v[108:111]
    ds_read_b64_tr_b16 v[184:185], v5 offset:128
    v_cvt_pk_bf16_f32 v115, v90, v91
    v_mfma_f32_16x16x32_bf16 v[96:99], v[48:51], v[200:203], v[96:99]
    ds_read_b64_tr_b16 v[186:187], v5 offset:3712
    v_cvt_pk_bf16_f32 v119, v94, v95
    v_mfma_f32_16x16x32_bf16 v[100:103], v[48:51], v[212:215], v[100:103]
    ds_read_b64_tr_b16 v[188:189], v5 offset:7168
    v_cvt_pk_bf16_f32 v120, -v80, -v81
    v_mfma_f32_16x16x32_bf16 v[104:107], v[60:63], v[200:203], v[104:107]
    buffer_load_dwordx4 a[16:19], v14, s[40:43], s53 offen offset:0 sc1
    v_mfma_f32_16x16x32_bf16 v[108:111], v[60:63], v[212:215], v[108:111]
    ds_read_b64_tr_b16 v[190:191], v5 offset:10752
    v_cvt_pk_bf16_f32 v121, -v82, -v83
    v_mfma_f32_16x16x32_bf16 v[136:139], a[176:179], v[112:115], 0
    ds_read_b64_tr_b16 v[216:217], v5 offset:7200
    v_cvt_pk_bf16_f32 v122, -v88, -v89
    v_mfma_f32_16x16x32_bf16 v[140:143], a[176:179], v[116:119], 0
    ds_read_b64_tr_b16 v[218:219], v5 offset:10784
    v_cvt_pk_bf16_f32 v123, -v90, -v91
    v_mfma_f32_16x16x32_bf16 v[144:147], a[184:187], v[112:115], 0
    ds_read_b64_tr_b16 v[220:221], v5 offset:7232
    v_cvt_pk_bf16_f32 v124, v96, v97
    v_mfma_f32_16x16x32_bf16 v[148:151], a[184:187], v[116:119], 0
    ds_read_b64_tr_b16 v[222:223], v5 offset:10816
    v_cvt_pk_bf16_f32 v128, v100, v101
    v_mfma_f32_16x16x32_bf16 v[136:139], a[208:211], v[116:119], v[136:139]
    buffer_load_dwordx4 a[20:23], v14, s[40:43], s53 offen offset:1024 sc1
    v_mfma_f32_16x16x32_bf16 v[140:143], a[208:211], v[120:123], v[140:143]
    ds_read_b64_tr_b16 v[224:225], v5 offset:7264
    v_cvt_pk_bf16_f32 v125, v98, v99
    v_mfma_f32_16x16x32_bf16 v[144:147], a[216:219], v[116:119], v[144:147]
    ds_read_b64_tr_b16 v[226:227], v5 offset:10848
    v_cvt_pk_bf16_f32 v129, v102, v103
    v_mfma_f32_16x16x32_bf16 v[148:151], a[216:219], v[120:123], v[148:151]
    ds_read_b64_tr_b16 v[228:229], v5 offset:7296
    v_cvt_pk_bf16_f32 v126, v104, v105
    v_mfma_f32_16x16x32_bf16 v[152:155], a[192:195], v[112:115], 0
    ds_read_b64_tr_b16 v[230:231], v5 offset:10880
    v_cvt_pk_bf16_f32 v130, v108, v109
    v_mfma_f32_16x16x32_bf16 v[156:159], a[192:195], v[116:119], 0
    ds_read_b64_tr_b16 v[232:233], v5 offset:14336
    v_cvt_pk_bf16_f32 v127, v106, v107
    v_mfma_f32_16x16x32_bf16 v[160:163], a[200:203], v[112:115], 0
    buffer_load_dwordx4 a[24:27], v14, s[40:43], s53 offen offset:2048 sc1
    v_mfma_f32_16x16x32_bf16 v[164:167], a[200:203], v[116:119], 0
    ds_read_b64_tr_b16 v[234:235], v5 offset:17920
    v_cvt_pk_bf16_f32 v131, v110, v111
    v_mfma_f32_16x16x32_bf16 v[152:155], a[224:227], v[116:119], v[152:155]
    ds_read_b64_tr_b16 v[236:237], v5 offset:14368
    v_cvt_pk_bf16_f32 v132, -v96, -v97
    v_mfma_f32_16x16x32_bf16 v[156:159], a[224:227], v[120:123], v[156:159]
    ds_read_b64_tr_b16 v[238:239], v5 offset:17952
    v_cvt_pk_bf16_f32 v133, -v98, -v99
    v_mfma_f32_16x16x32_bf16 v[160:163], a[232:235], v[116:119], v[160:163]
    ds_read_b64_tr_b16 v[240:241], v5 offset:14400
    v_cvt_pk_bf16_f32 v134, -v104, -v105
    v_mfma_f32_16x16x32_bf16 v[164:167], a[232:235], v[120:123], v[164:167]
    ds_read_b64_tr_b16 v[242:243], v5 offset:17984
    v_cvt_pk_bf16_f32 v135, -v106, -v107
    v_mfma_f32_16x16x32_bf16 v[136:139], a[180:183], v[124:127], v[136:139]
    buffer_load_dwordx4 a[28:31], v14, s[40:43], s53 offen offset:3072 sc1
    v_mfma_f32_16x16x32_bf16 v[140:143], a[180:183], v[128:131], v[140:143]
    ds_read_b64_tr_b16 v[244:245], v5 offset:14432
    s_add_u32 s53, s53, 4096
    v_mfma_f32_16x16x32_bf16 v[144:147], a[188:191], v[124:127], v[144:147]
    ds_read_b64_tr_b16 v[246:247], v5 offset:18016
    s_waitcnt vmcnt(13)
    v_lshlrev_b32 v16, 16, v64
    v_mfma_f32_16x16x32_bf16 v[148:151], a[188:191], v[128:131], v[148:151]
    ds_read_b64_tr_b16 v[248:249], v5 offset:14464
    v_lshlrev_b32 v17, 16, v65
    v_mfma_f32_16x16x32_bf16 v[136:139], a[212:215], v[128:131], v[136:139]
    ds_read_b64_tr_b16 v[250:251], v5 offset:18048
    v_lshlrev_b32 v18, 16, v66
    v_mfma_f32_16x16x32_bf16 v[140:143], a[212:215], v[132:135], v[140:143]
    ds_read_b64_tr_b16 v[252:253], v5 offset:21504
    v_lshlrev_b32 v19, 16, v67
    v_mfma_f32_16x16x32_bf16 v[144:147], a[220:223], v[128:131], v[144:147]
    buffer_load_dwordx4 a[32:35], v14, s[40:43], s53 offen offset:0 sc1
    v_mfma_f32_16x16x32_bf16 v[148:151], a[220:223], v[132:135], v[148:151]
    ds_read_b64_tr_b16 v[254:255], v5 offset:25088
    s_waitcnt vmcnt(13)
    v_lshlrev_b32 v20, 16, v68
    v_mfma_f32_16x16x32_bf16 v[152:155], a[196:199], v[124:127], v[152:155]
    ds_read_b64_tr_b16 v[192:193], v5 offset:21536
    v_lshlrev_b32 v21, 16, v69
    v_mfma_f32_16x16x32_bf16 v[156:159], a[196:199], v[128:131], v[156:159]
    ds_read_b64_tr_b16 v[194:195], v5 offset:25120
    v_lshlrev_b32 v22, 16, v70
    v_mfma_f32_16x16x32_bf16 v[160:163], a[204:207], v[124:127], v[160:163]
    ds_read_b64_tr_b16 v[196:197], v5 offset:21568
    v_lshlrev_b32 v23, 16, v71
    v_mfma_f32_16x16x32_bf16 v[164:167], a[204:207], v[128:131], v[164:167]
    ds_read_b64_tr_b16 v[198:199], v5 offset:25152
    v_and_b32 v64, 0xffff0000, v64
    v_mfma_f32_16x16x32_bf16 v[152:155], a[228:231], v[128:131], v[152:155]
    buffer_load_dwordx4 a[36:39], v14, s[40:43], s53 offen offset:1024 sc1
    v_mfma_f32_16x16x32_bf16 v[156:159], a[228:231], v[132:135], v[156:159]
    ds_read_b64_tr_b16 v[200:201], v5 offset:21600
    v_and_b32 v65, 0xffff0000, v65
    v_mfma_f32_16x16x32_bf16 v[160:163], a[236:239], v[128:131], v[160:163]
    ds_read_b64_tr_b16 v[202:203], v5 offset:25184
    v_and_b32 v66, 0xffff0000, v66
    v_mfma_f32_16x16x32_bf16 v[164:167], a[236:239], v[132:135], v[164:167]
    ds_read_b64_tr_b16 v[204:205], v5 offset:21632
    s_nop 0
    v_and_b32 v67, 0xffff0000, v67
    v_and_b32 v68, 0xffff0000, v68
    v_and_b32 v69, 0xffff0000, v69
    v_and_b32 v70, 0xffff0000, v70
    v_and_b32 v71, 0xffff0000, v71
    v_mul_f32 v80, v140, v64
    v_mul_f32 v84, v136, v64
    v_mul_f32 v81, v141, v65
    v_mul_f32 v85, v137, v65
    v_mul_f32 v82, v142, v66
    v_mul_f32 v86, v138, v66
    buffer_load_dwordx4 a[40:43], v14, s[40:43], s53 offen offset:2048 sc1
    v_mul_f32 v83, v143, v67
    v_mul_f32 v87, v139, v67
    v_mul_f32 v88, v148, v68
    v_mul_f32 v92, v144, v68
    v_mul_f32 v89, v149, v69
    v_mul_f32 v93, v145, v69
    v_mul_f32 v90, v150, v70
    v_mul_f32 v94, v146, v70
    v_mul_f32 v91, v151, v71
    v_mul_f32 v95, v147, v71
    s_waitcnt vmcnt(14)
    v_lshlrev_b32 v24, 16, v72
    v_lshlrev_b32 v25, 16, v73
    v_lshlrev_b32 v26, 16, v74
    v_lshlrev_b32 v27, 16, v75
    s_waitcnt vmcnt(13)
    v_lshlrev_b32 v28, 16, v76
    v_lshlrev_b32 v29, 16, v77
    v_lshlrev_b32 v30, 16, v78
    v_lshlrev_b32 v31, 16, v79
    v_fma_f32 v80, v136, v16, -v80
    v_fmac_f32 v84, v140, v16
    buffer_load_dwordx4 a[44:47], v14, s[40:43], s53 offen offset:3072 sc1
    s_add_u32 s53, s53, 4096
    v_fma_f32 v81, v137, v17, -v81
    v_fmac_f32 v85, v141, v17
    v_fma_f32 v82, v138, v18, -v82
    v_fmac_f32 v86, v142, v18
    v_fma_f32 v83, v139, v19, -v83
    v_fmac_f32 v87, v143, v19
    v_fma_f32 v88, v144, v20, -v88
    v_fmac_f32 v92, v148, v20
    v_fma_f32 v89, v145, v21, -v89
    v_fmac_f32 v93, v149, v21
    v_fma_f32 v90, v146, v22, -v90
    v_fmac_f32 v94, v150, v22
    v_fma_f32 v91, v147, v23, -v91
    v_fmac_f32 v95, v151, v23
    v_and_b32 v72, 0xffff0000, v72
    v_and_b32 v73, 0xffff0000, v73
    v_and_b32 v74, 0xffff0000, v74
    v_and_b32 v75, 0xffff0000, v75
    v_and_b32 v76, 0xffff0000, v76
    v_and_b32 v77, 0xffff0000, v77
    v_and_b32 v78, 0xffff0000, v78
    buffer_load_dwordx4 a[48:51], v14, s[40:43], s53 offen offset:0 sc1
    v_and_b32 v79, 0xffff0000, v79
    v_cvt_pk_bf16_f32 v112, v80, v81
    v_cvt_pk_bf16_f32 v116, v84, v85
    v_cvt_pk_bf16_f32 v113, v82, v83
    v_cvt_pk_bf16_f32 v117, v86, v87
    v_cvt_pk_bf16_f32 v114, v88, v89
    v_cvt_pk_bf16_f32 v118, v92, v93
    v_cvt_pk_bf16_f32 v115, v90, v91
    v_cvt_pk_bf16_f32 v119, v94, v95
    v_mul_f32 v96, v156, v72
    v_mfma_f32_16x16x32_bf16 v[136:139], v[112:115], a[176:179], 0
    ds_read_b64_tr_b16 v[206:207], v5 offset:25216
    v_mul_f32 v100, v152, v72
    v_mfma_f32_16x16x32_bf16 v[140:143], v[116:119], a[176:179], 0
    s_mov_b32 s90, 160
    v_mul_f32 v97, v157, v73
    v_mul_f32 v101, v153, v73
    v_mfma_f32_16x16x32_bf16 v[144:147], v[112:115], a[184:187], 0
    v_mul_f32 v98, v158, v74
    v_mul_f32 v102, v154, v74
    v_mfma_f32_16x16x32_bf16 v[148:151], v[116:119], a[184:187], 0
    buffer_load_dwordx4 a[52:55], v14, s[40:43], s53 offen offset:1024 sc1
    v_mfma_f32_16x16x32_bf16 v[140:143], v[112:115], a[208:211], v[140:143]
    v_mul_f32 v99, v159, v75
    v_mul_f32 v103, v155, v75
    v_mfma_f32_16x16x32_bf16 v[148:151], v[112:115], a[216:219], v[148:151]
    v_mul_f32 v104, v164, v76
    v_mul_f32 v108, v160, v76
    v_mul_f32 v105, v165, v77
    v_mul_f32 v109, v161, v77
    v_mul_f32 v106, v166, v78
    v_mul_f32 v110, v162, v78
    v_mul_f32 v107, v167, v79
    v_mul_f32 v111, v163, v79
    v_fma_f32 v96, v152, v24, -v96
    v_fmac_f32 v100, v156, v24
    v_fma_f32 v97, v153, v25, -v97
    v_fmac_f32 v101, v157, v25
    v_fma_f32 v98, v154, v26, -v98
    v_fmac_f32 v102, v158, v26
    v_fma_f32 v99, v155, v27, -v99
    v_mfma_f32_16x16x32_bf16 v[152:155], v[112:115], a[192:195], 0
    buffer_load_dwordx4 a[56:59], v14, s[40:43], s53 offen offset:2048 sc1
    v_fmac_f32 v103, v159, v27
    v_mfma_f32_16x16x32_bf16 v[156:159], v[116:119], a[192:195], 0
    v_fma_f32 v104, v160, v28, -v104
    v_fmac_f32 v108, v164, v28
    v_mfma_f32_16x16x32_bf16 v[156:159], v[112:115], a[224:227], v[156:159]
    v_fma_f32 v105, v161, v29, -v105
    v_fmac_f32 v109, v165, v29
    v_fma_f32 v106, v162, v30, -v106
    v_fmac_f32 v110, v166, v30
    v_fma_f32 v107, v163, v31, -v107
    v_mfma_f32_16x16x32_bf16 v[160:163], v[112:115], a[200:203], 0
    v_fmac_f32 v111, v167, v31
    v_cvt_pk_bf16_f32 v120, -v84, -v85
    v_mfma_f32_16x16x32_bf16 v[164:167], v[116:119], a[200:203], 0
    v_cvt_pk_bf16_f32 v121, -v86, -v87
    v_cvt_pk_bf16_f32 v122, -v92, -v93
    v_mfma_f32_16x16x32_bf16 v[164:167], v[112:115], a[232:235], v[164:167]
    buffer_load_dwordx4 a[60:63], v14, s[40:43], s53 offen offset:3072 sc1
    s_add_u32 s53, s53, 4096
    v_cvt_pk_bf16_f32 v123, -v94, -v95
    v_cvt_pk_bf16_f32 v124, v96, v97
    v_cvt_pk_bf16_f32 v128, v100, v101
    v_mfma_f32_16x16x32_bf16 v[136:139], v[120:123], a[208:211], v[136:139]
    v_cvt_pk_bf16_f32 v125, v98, v99
    v_cvt_pk_bf16_f32 v129, v102, v103
    v_mfma_f32_16x16x32_bf16 v[144:147], v[120:123], a[216:219], v[144:147]
    v_cvt_pk_bf16_f32 v126, v104, v105
    v_cvt_pk_bf16_f32 v130, v108, v109
    v_mfma_f32_16x16x32_bf16 v[152:155], v[120:123], a[224:227], v[152:155]
    v_cvt_pk_bf16_f32 v127, v106, v107
    v_cvt_pk_bf16_f32 v131, v110, v111
    v_mfma_f32_16x16x32_bf16 v[160:163], v[120:123], a[232:235], v[160:163]
    v_cvt_pk_bf16_f32 v132, -v100, -v101
    v_cvt_pk_bf16_f32 v133, -v102, -v103
    v_mfma_f32_16x16x32_bf16 v[136:139], v[124:127], a[180:183], v[136:139]
    v_cvt_pk_bf16_f32 v134, -v108, -v109
    v_cvt_pk_bf16_f32 v135, -v110, -v111
    v_mfma_f32_16x16x32_bf16 v[140:143], v[128:131], a[180:183], v[140:143]
    buffer_load_dwordx4 a[64:67], v14, s[40:43], s53 offen offset:0 sc1
    v_mfma_f32_16x16x32_bf16 v[144:147], v[124:127], a[188:191], v[144:147]
    v_add_u32 v34, 0, v14
    v_mul_u32_u24 v35, 384, v33
    v_mfma_f32_16x16x32_bf16 v[148:151], v[128:131], a[188:191], v[148:151]
    v_mad_u32_u24 v24, v33, s89, v34
    v_sub_u32 v34, v34, v35
    v_mfma_f32_16x16x32_bf16 v[152:155], v[124:127], a[196:199], v[152:155]
    v_min_u32 v34, 304, v34
    v_mul_u32_u24 v33, 352, v33
    v_mfma_f32_16x16x32_bf16 v[156:159], v[128:131], a[196:199], v[156:159]
    v_cmp_le_u32 s[96:97], s90, v34
    v_add3_u32 v33, v33, v34, s88
    v_mfma_f32_16x16x32_bf16 v[160:163], v[124:127], a[204:207], v[160:163]
    v_add_u32 v34, 16, v33
    v_cndmask_b32 v27, v33, v34, s[96:97]
    v_mfma_f32_16x16x32_bf16 v[164:167], v[128:131], a[204:207], v[164:167]
    buffer_load_dwordx4 a[68:71], v14, s[40:43], s53 offen offset:1024 sc1
    v_mfma_f32_16x16x32_bf16 v[136:139], v[132:135], a[212:215], v[136:139]
    v_add_u32 v33, 10944, v32
    v_lshrrev_b32 v33, 12, v33
    v_mfma_f32_16x16x32_bf16 v[140:143], v[124:127], a[212:215], v[140:143]
    v_add_u32 v34, 1024, v14
    v_mul_u32_u24 v35, 384, v33
    v_mfma_f32_16x16x32_bf16 v[144:147], v[132:135], a[220:223], v[144:147]
    v_cvt_pk_bf16_f32 v80, v136, v137
    v_cvt_pk_bf16_f32 v81, v138, v139
    v_mfma_f32_16x16x32_bf16 v[148:151], v[124:127], a[220:223], v[148:151]
    v_cvt_pk_bf16_f32 v82, v140, v141
    v_cvt_pk_bf16_f32 v83, v142, v143
    v_mfma_f32_16x16x32_bf16 v[152:155], v[132:135], a[228:231], v[152:155]
    ds_write_b128 v6, v[80:83] offset:0
    v_mfma_f32_16x16x32_bf16 v[156:159], v[124:127], a[228:231], v[156:159]
    buffer_load_dwordx4 a[72:75], v14, s[40:43], s53 offen offset:2048 sc1
    v_mfma_f32_16x16x32_bf16 v[160:163], v[132:135], a[236:239], v[160:163]
    v_cvt_pk_bf16_f32 v84, v144, v145
    v_cvt_pk_bf16_f32 v85, v146, v147
    v_mfma_f32_16x16x32_bf16 v[164:167], v[124:127], a[236:239], v[164:167]
    v_cvt_pk_bf16_f32 v86, v148, v149
    v_cvt_pk_bf16_f32 v87, v150, v151
    v_cvt_pk_bf16_f32 v88, v152, v153
    v_cvt_pk_bf16_f32 v89, v154, v155
    v_cvt_pk_bf16_f32 v90, v156, v157
    v_cvt_pk_bf16_f32 v91, v158, v159
    v_cvt_pk_bf16_f32 v92, v160, v161
    v_cvt_pk_bf16_f32 v93, v162, v163
    v_cvt_pk_bf16_f32 v94, v164, v165
    v_cvt_pk_bf16_f32 v95, v166, v167
    ds_write_b128 v6, v[84:87] offset:4096
    buffer_load_dwordx4 a[76:79], v14, s[40:43], s53 offen offset:3072 sc1
    s_add_u32 s53, s53, 4096
    ds_write_b128 v6, v[88:91] offset:8192
    v_mad_u32_u24 v25, v33, s89, v34
    ds_write_b128 v6, v[92:95] offset:12288
    buffer_load_dwordx4 a[80:83], v14, s[40:43], s53 offen offset:0 sc1
    v_sub_u32 v34, v34, v35
    v_min_u32 v34, 304, v34
    v_mul_u32_u24 v33, 352, v33
    v_cmp_le_u32 s[96:97], s90, v34
    v_add3_u32 v33, v33, v34, s88
    v_add_u32 v34, 16, v33
    v_cndmask_b32 v28, v33, v34, s[96:97]
    v_add_u32 v33, 21888, v32
    v_lshrrev_b32 v33, 12, v33
    v_add_u32 v34, 2048, v14
    v_mul_u32_u24 v35, 384, v33
    v_mad_u32_u24 v26, v33, s89, v34
    v_sub_u32 v34, v34, v35
    v_mul_u32_u24 v8, 176, v2
    v_min_u32 v34, 304, v34
    v_mul_u32_u24 v33, 352, v33
    v_lshl_add_u32 v8, v3, 3, v8
    v_cmp_le_u32 s[96:97], s90, v34
    v_add3_u32 v33, v33, v34, s88
    v_add_u32 v8, s88, v8
    v_add_u32 v34, 16, v33
    buffer_load_dwordx4 a[84:87], v14, s[40:43], s53 offen offset:1024 sc1
    v_cndmask_b32 v29, v33, v34, s[96:97]
    s_waitcnt vmcnt(21)
    s_waitcnt lgkmcnt(0)
    s_barrier
    ds_read_b128 v[96:99], v7 offset:0
    ds_read_b128 v[100:103], v7 offset:1024
    ds_read_b128 v[104:107], v7 offset:2048
    ds_read_b128 v[108:111], v7 offset:3072
    buffer_load_dwordx4 a[88:91], v14, s[40:43], s53 offen offset:2048 sc1
    s_waitcnt lgkmcnt(3)
    v_mfma_f32_16x16x32_bf16 v[112:115], v[168:171], v[96:99], 0
    v_mfma_f32_16x16x32_bf16 v[116:119], v[172:175], v[96:99], 0
    v_mfma_f32_16x16x32_bf16 v[120:123], v[176:179], v[96:99], 0
    v_mfma_f32_16x16x32_bf16 v[124:127], v[180:183], v[96:99], 0
    buffer_load_dwordx4 a[92:95], v14, s[40:43], s53 offen offset:3072 sc1
    v_mfma_f32_16x16x32_bf16 v[128:131], v[184:187], v[96:99], 0
    s_waitcnt lgkmcnt(0)
    v_mfma_f32_16x16x32_bf16 v[112:115], v[188:191], v[100:103], v[112:115]
    v_mfma_f32_16x16x32_bf16 v[116:119], v[216:219], v[100:103], v[116:119]
    v_mfma_f32_16x16x32_bf16 v[120:123], v[220:223], v[100:103], v[120:123]
    v_mfma_f32_16x16x32_bf16 v[124:127], v[224:227], v[100:103], v[124:127]
    v_mfma_f32_16x16x32_bf16 v[128:131], v[228:231], v[100:103], v[128:131]
    v_mfma_f32_16x16x32_bf16 v[112:115], v[232:235], v[104:107], v[112:115]
    v_mfma_f32_16x16x32_bf16 v[116:119], v[236:239], v[104:107], v[116:119]
    v_mfma_f32_16x16x32_bf16 v[120:123], v[240:243], v[104:107], v[120:123]
    v_mfma_f32_16x16x32_bf16 v[124:127], v[244:247], v[104:107], v[124:127]
    v_mfma_f32_16x16x32_bf16 v[128:131], v[248:251], v[104:107], v[128:131]
    v_mfma_f32_16x16x32_bf16 v[112:115], v[252:255], v[108:111], v[112:115]
    v_mfma_f32_16x16x32_bf16 v[116:119], v[192:195], v[108:111], v[116:119]
    v_mfma_f32_16x16x32_bf16 v[120:123], v[196:199], v[108:111], v[120:123]
    v_cvt_pk_bf16_f32 v136, v112, v113
    v_cvt_pk_bf16_f32 v137, v114, v115
    v_mfma_f32_16x16x32_bf16 v[124:127], v[200:203], v[108:111], v[124:127]
    ds_write_b64 v8, v[136:137] offset:0
    v_mfma_f32_16x16x32_bf16 v[128:131], v[204:207], v[108:111], v[128:131]
    s_nop 0
    v_cvt_pk_bf16_f32 v138, v116, v117
    v_cvt_pk_bf16_f32 v139, v118, v119
    v_cvt_pk_bf16_f32 v140, v120, v121
    v_cvt_pk_bf16_f32 v141, v122, v123
    v_cvt_pk_bf16_f32 v142, v124, v125
    v_cvt_pk_bf16_f32 v143, v126, v127
    ds_write_b64 v8, v[138:139] offset:32
    s_nop 0
    v_cvt_pk_bf16_f32 v144, v128, v129
    v_cvt_pk_bf16_f32 v145, v130, v131
    ds_write_b64 v8, v[140:141] offset:64
    ds_write_b64 v8, v[142:143] offset:96
    ds_write_b64 v8, v[144:145] offset:128
    ds_read_b128 v[176:179], v27
    ds_read_b128 v[180:183], v28
    ds_read_b128 v[184:187], v29
    s_waitcnt lgkmcnt(2)
    buffer_store_dwordx4 v[176:179], v24, s[40:43], s65 offen sc1
    s_waitcnt lgkmcnt(1)
    buffer_store_dwordx4 v[180:183], v25, s[40:43], s65 offen sc1
    s_waitcnt lgkmcnt(0)
    buffer_store_dwordx4 v[184:187], v26, s[40:43], s65 offen sc1
    v_lshlrev_b32 v188, 2, v1
    v_add_u32 v188, s66, v188
    v_and_b32 v203, 32, v1
    s_getreg_b32 s55, hwreg(HW_REG_XCC_ID)
    v_lshl_or_b32 v188, v203, 25, v188
    v_mov_b32 v202, s47
    v_writelane_b32 v202, s55, 1
    s_add_u32 s53, s53, 4096
    s_sub_u32 s89, 43008, s51
    v_accvgpr_read_b32 v50, a240
    s_sub_u32 s89, s89, s51
    v_add_u32 v50, s89, v50
    ds_read_b128 v[216:219], v50 offset:0
    ds_read_b128 v[220:223], v50 offset:128
    s_mov_b32 s89, 0x3f803f80
    v_accvgpr_read_b32 v51, a241
    ds_read_b128 v[224:227], v50 offset:256
    v_xor_b32 v51, 128, v51
    v_lshlrev_b32 v6, 2, v3
    ds_read_b128 v[228:231], v50 offset:384
    v_sub_u32 v6, v2, v6
    v_cmp_eq_u32 vcc, 0, v6
    ds_read_b128 v[232:235], v50 offset:512
    s_lshr_b32 s88, s46, 1
    v_cndmask_b32 v208, 0, 1.0, vcc
    ds_read_b128 v[236:239], v50 offset:640
    v_cmp_eq_u32 vcc, 1, v6
    s_mul_i32 s88, s88, 43008
    ds_read_b128 v[240:243], v50 offset:768
    v_cndmask_b32 v209, 0, 1.0, vcc
    s_waitcnt lgkmcnt(6)
    v_dot2_f32_bf16 v12, v216, s89, 0
    v_dot2_f32_bf16 v13, v217, s89, 0
    ds_read_b128 v[244:247], v50 offset:896
    v_dot2_f32_bf16 v12, v218, s89, v12
    v_dot2_f32_bf16 v13, v219, s89, v13
    s_waitcnt lgkmcnt(6)
    v_dot2_f32_bf16 v12, v220, s89, v12
    v_dot2_f32_bf16 v13, v221, s89, v13
    ds_read_b128 v[248:251], v50 offset:1024
    v_dot2_f32_bf16 v12, v222, s89, v12
    v_dot2_f32_bf16 v13, v223, s89, v13
    s_waitcnt lgkmcnt(6)
    v_dot2_f32_bf16 v12, v224, s89, v12
    v_dot2_f32_bf16 v13, v225, s89, v13
    ds_read_b128 v[252:255], v50 offset:1152
    v_dot2_f32_bf16 v12, v226, s89, v12
    v_dot2_f32_bf16 v13, v227, s89, v13
    s_waitcnt lgkmcnt(5)
    v_dot2_f32_bf16 v12, v228, s89, v12
    v_dot2_f32_bf16 v13, v229, s89, v13
    v_dot2_f32_bf16 v12, v230, s89, v12
    v_dot2_f32_bf16 v13, v231, s89, v13
    v_dot2_f32_bf16 v12, v232, s89, v12
    v_dot2_f32_bf16 v13, v233, s89, v13
    v_dot2_f32_bf16 v12, v234, s89, v12
    v_dot2_f32_bf16 v13, v235, s89, v13
    s_waitcnt lgkmcnt(3)
    s_nop 0
    v_dot2_f32_bf16 v12, v236, s89, v12
    v_dot2_f32_bf16 v13, v237, s89, v13
    v_dot2_f32_bf16 v12, v238, s89, v12
    v_dot2_f32_bf16 v13, v239, s89, v13
    v_dot2_f32_bf16 v12, v240, s89, v12
    v_dot2_f32_bf16 v13, v241, s89, v13
    v_dot2_f32_bf16 v12, v242, s89, v12
    v_dot2_f32_bf16 v13, v243, s89, v13
    s_waitcnt lgkmcnt(2)
    v_dot2_f32_bf16 v12, v244, s89, v12
    v_dot2_f32_bf16 v13, v245, s89, v13
    v_dot2_f32_bf16 v12, v246, s89, v12
    v_dot2_f32_bf16 v13, v247, s89, v13
    s_waitcnt lgkmcnt(1)
    v_dot2_f32_bf16 v12, v248, s89, v12
    v_dot2_f32_bf16 v13, v249, s89, v13
    v_dot2_f32_bf16 v12, v250, s89, v12
    v_dot2_f32_bf16 v13, v251, s89, v13
    s_waitcnt lgkmcnt(0)
    v_dot2_f32_bf16 v12, v252, s89, v12
    v_dot2_f32_bf16 v13, v253, s89, v13
    v_dot2_f32_bf16 v12, v254, s89, v12
    v_dot2_f32_bf16 v13, v255, s89, v13
    s_nop 2
    v_add_f32 v12, v12, v13
    s_nop 1
    v_add_f32_dpp v12, v12, v12 quad_perm:[1,0,3,2] row_mask:0xf bank_mask:0xf
    s_nop 1
    v_add_f32_dpp v12, v12, v12 quad_perm:[2,3,0,1] row_mask:0xf bank_mask:0xf
    s_nop 1
    v_add_f32_dpp v12, v12, v12 row_half_mirror row_mask:0xf bank_mask:0xf
    v_mul_f32 v12, 0xbd4ccccd, v12
    ds_write_b32 v51, v12
    s_and_b32 s89, s46, 1
    s_mul_i32 s89, s89, 21504
    s_add_u32 s90, s88, s89
    s_lshl_b32 s88, s46, 6
    v_cmp_eq_u32 vcc, 2, v6
    s_add_u32 s88, s88, 162816
    v_lshlrev_b32 v5, 2, v2
    v_add_u32 v5, s88, v5
    v_cndmask_b32 v210, 0, 1.0, vcc
    v_cmp_eq_u32 vcc, 3, v6
    v_and_b32 v6, 3, v1
    s_add_u32 s88, s50, 0
    v_mul_u32_u24 v6, 40, v6
    s_and_b32 s88, s88, 7
    s_mul_i32 s88, s88, 160
    v_cndmask_b32 v211, 0, 1.0, vcc
    v_cvt_pk_bf16_f32 v190, v208, v209
    v_cvt_pk_bf16_f32 v191, v210, v211
    s_mul_i32 s89, s46, 1048576
    v_lshrrev_b32 v7, 1, v3
    v_lshlrev_b32 v7, 3, v7
    v_and_b32 v8, 1, v3
    s_waitcnt lgkmcnt(0)
    s_barrier
    v_lshl_add_u32 v7, v8, 1, v7
    v_cvt_f32_u32 v7, v7
    v_cmp_eq_u32 vcc, 0, v3
    s_mul_i32 s96, s46, 10240
    ds_read_b32 v13, v5
    v_lshrrev_b32 v5, 2, v1
    v_mul_u32_u24 v5, 1344, v5
    v_add3_u32 v5, v5, v6, s90
    v_add_u32 v192, s88, v5
    s_add_u32 s88, s50, 1
    s_and_b32 s88, s88, 7
    s_mul_i32 s88, s88, 160
    v_add_u32 v193, s88, v5
    s_add_u32 s88, s50, 2
    s_and_b32 s88, s88, 7
    s_mul_i32 s88, s88, 160
    v_add_u32 v194, s88, v5
    s_add_u32 s88, s50, 3
    ds_read_b64_tr_b16 a[240:241], v192 offset:0
    ds_read_b64_tr_b16 a[242:243], v193 offset:0
    s_and_b32 s88, s88, 7
    s_mul_i32 s88, s88, 160
    v_add_u32 v195, s88, v5
    s_add_u32 s88, s50, 4
    s_and_b32 s88, s88, 7
    s_mul_i32 s88, s88, 160
    v_add_u32 v196, s88, v5
    s_add_u32 s88, s50, 5
    s_and_b32 s88, s88, 7
    s_mul_i32 s88, s88, 160
    v_add_u32 v197, s88, v5
    s_add_u32 s88, s50, 6
    s_waitcnt lgkmcnt(2)
    v_mul_f32 v204, 0x3d000000, v13
    v_mul_f32 v205, 0x3d000000, v13
    v_mul_f32 v206, 0x3d000000, v13
    v_mul_f32 v207, 0x3d000000, v13
    s_and_b32 s88, s88, 7
    s_mul_i32 s88, s88, 160
    v_add_u32 v198, s88, v5
    s_add_u32 s88, s50, 7
    s_waitcnt lgkmcnt(1)
    v_mfma_f32_16x16x16_bf16 v[212:215], a[240:241], v[190:191], v[204:207]
    ds_read_b64_tr_b16 a[244:245], v194 offset:0
    s_and_b32 s88, s88, 7
    s_waitcnt lgkmcnt(1)
    v_mfma_f32_16x16x16_bf16 v[216:219], a[242:243], v[190:191], v[204:207]
    ds_read_b64_tr_b16 a[240:241], v192 offset:8
    s_mul_i32 s88, s88, 160
    ds_read_b64_tr_b16 a[242:243], v193 offset:8
    v_add_u32 v199, s88, v5
    ds_read_b64_tr_b16 a[246:247], v195 offset:0
    s_nop 2
    v_pk_mov_b32 v[16:17], v[212:213], v[216:217] op_sel:[0,0]
    ds_read_b64_tr_b16 a[248:249], v196 offset:0
    ds_read_b64_tr_b16 a[250:251], v197 offset:0
    v_pk_mov_b32 v[24:25], v[212:213], v[216:217] op_sel:[1,1]
    v_pk_mov_b32 v[32:33], v[214:215], v[218:219] op_sel:[0,0]
    v_pk_mov_b32 v[40:41], v[214:215], v[218:219] op_sel:[1,1]
    v_mul_u32_u24 v5, 205, v1
    s_waitcnt lgkmcnt(5)
    v_mfma_f32_16x16x16_bf16 v[220:223], a[244:245], v[190:191], v[204:207]
    ds_read_b64_tr_b16 a[252:253], v198 offset:0
    s_mov_b32 s88, 16224
    s_waitcnt lgkmcnt(5)
    v_mfma_f32_16x16x16_bf16 v[212:215], a[240:241], v[190:191], v[204:207]
    ds_read_b64_tr_b16 a[254:255], v199 offset:0
    v_lshrrev_b32 v6, 11, v5
    s_waitcnt lgkmcnt(5)
    v_mfma_f32_16x16x16_bf16 v[216:219], a[242:243], v[190:191], v[204:207]
    ds_read_b64_tr_b16 a[240:241], v192 offset:16
    v_mad_u32_u24 v184, v6, s88, v14
    s_waitcnt lgkmcnt(5)
    v_mfma_f32_16x16x16_bf16 v[224:227], a[246:247], v[190:191], v[204:207]
    ds_read_b64_tr_b16 a[242:243], v193 offset:16
    v_add_u32 v6, 13120, v5
    s_waitcnt lgkmcnt(5)
    v_mfma_f32_16x16x16_bf16 v[228:231], a[248:249], v[190:191], v[204:207]
    ds_read_b64_tr_b16 a[244:245], v194 offset:8
    v_lshrrev_b32 v6, 11, v6
    s_waitcnt lgkmcnt(5)
    v_mfma_f32_16x16x16_bf16 v[232:235], a[250:251], v[190:191], v[204:207]
    ds_read_b64_tr_b16 a[246:247], v195 offset:8
    v_mad_u32_u24 v185, v6, s88, v14
    s_waitcnt lgkmcnt(5)
    v_mfma_f32_16x16x16_bf16 v[236:239], a[252:253], v[190:191], v[204:207]
    ds_read_b64_tr_b16 a[248:249], v196 offset:8
    v_add_u32 v6, 26240, v5
    s_waitcnt lgkmcnt(5)
    v_mfma_f32_16x16x16_bf16 v[240:243], a[254:255], v[190:191], v[204:207]
    ds_read_b64_tr_b16 a[250:251], v197 offset:8
    ds_read_b64_tr_b16 a[252:253], v198 offset:8
    buffer_load_dwordx4 a[96:99], v14, s[40:43], s53 offen offset:0 sc1
    ds_read_b64_tr_b16 a[254:255], v199 offset:8
    s_waitcnt vmcnt(1)
    buffer_store_dword v202, v188, s[40:43], 0 offen sc1
    v_pk_mov_b32 v[48:49], v[212:213], v[216:217] op_sel:[0,0]
    v_pk_mov_b32 v[56:57], v[212:213], v[216:217] op_sel:[1,1]
    v_pk_mov_b32 v[64:65], v[214:215], v[218:219] op_sel:[0,0]
    v_pk_mov_b32 v[72:73], v[214:215], v[218:219] op_sel:[1,1]
    s_waitcnt lgkmcnt(6)
    v_mfma_f32_16x16x16_bf16 v[212:215], a[240:241], v[190:191], v[204:207]
    v_lshrrev_b32 v6, 11, v6
    v_mad_u32_u24 v186, v6, s88, v14
    v_mfma_f32_16x16x16_bf16 v[216:219], a[242:243], v[190:191], v[204:207]
    ds_read_b64_tr_b16 a[240:241], v192 offset:24
    buffer_load_dwordx4 a[100:103], v14, s[40:43], s53 offen offset:1024 sc1
    ds_read_b64_tr_b16 a[242:243], v193 offset:24
    v_pk_mov_b32 v[18:19], v[220:221], v[224:225] op_sel:[0,0]
    v_pk_mov_b32 v[26:27], v[220:221], v[224:225] op_sel:[1,1]
    v_pk_mov_b32 v[34:35], v[222:223], v[226:227] op_sel:[0,0]
    v_pk_mov_b32 v[42:43], v[222:223], v[226:227] op_sel:[1,1]
    s_waitcnt lgkmcnt(4)
    v_mfma_f32_16x16x16_bf16 v[220:223], a[244:245], v[190:191], v[204:207]
    v_add_u32 v6, 39360, v5
    v_lshrrev_b32 v6, 11, v6
    v_mfma_f32_16x16x16_bf16 v[224:227], a[246:247], v[190:191], v[204:207]
    ds_read_b64_tr_b16 a[244:245], v194 offset:16
    v_mad_u32_u24 v187, v6, s88, v14
    ds_read_b64_tr_b16 a[246:247], v195 offset:16
    buffer_load_dwordx4 a[104:107], v14, s[40:43], s53 offen offset:2048 sc1
    v_pk_mov_b32 v[20:21], v[228:229], v[232:233] op_sel:[0,0]
    v_pk_mov_b32 v[28:29], v[228:229], v[232:233] op_sel:[1,1]
    v_pk_mov_b32 v[36:37], v[230:231], v[234:235] op_sel:[0,0]
    v_pk_mov_b32 v[44:45], v[230:231], v[234:235] op_sel:[1,1]
    v_mfma_f32_16x16x16_bf16 v[228:231], a[248:249], v[190:191], v[204:207]
    v_add_u32 v6, 52480, v5
    v_lshrrev_b32 v6, 11, v6
    v_mfma_f32_16x16x16_bf16 v[232:235], a[250:251], v[190:191], v[204:207]
    ds_read_b64_tr_b16 a[248:249], v196 offset:16
    v_mad_u32_u24 v200, v6, s88, v14
    ds_read_b64_tr_b16 a[250:251], v197 offset:16
    s_mul_i32 s88, s49, 384
    s_add_u32 s88, s88, s89
    buffer_load_dwordx4 a[108:111], v14, s[40:43], s53 offen offset:3072 sc1
    s_add_u32 s53, s53, 4096
    v_pk_mov_b32 v[22:23], v[236:237], v[240:241] op_sel:[0,0]
    v_pk_mov_b32 v[30:31], v[236:237], v[240:241] op_sel:[1,1]
    v_pk_mov_b32 v[38:39], v[238:239], v[242:243] op_sel:[0,0]
    v_pk_mov_b32 v[46:47], v[238:239], v[242:243] op_sel:[1,1]
    s_waitcnt lgkmcnt(3)
    v_mfma_f32_16x16x16_bf16 v[236:239], a[252:253], v[190:191], v[204:207]
    s_add_u32 s92, s88, 1048576
    s_lshr_b32 s88, s49, 3
    s_lshl_b32 s88, s88, 8
    v_mfma_f32_16x16x16_bf16 v[240:243], a[254:255], v[190:191], v[204:207]
    ds_read_b64_tr_b16 a[252:253], v198 offset:16
    v_min_u32 v5, 39, v1
    ds_read_b64_tr_b16 a[254:255], v199 offset:16
    buffer_load_dwordx4 a[112:115], v14, s[40:43], s53 offen offset:0 sc1
    v_pk_mov_b32 v[80:81], v[212:213], v[216:217] op_sel:[0,0]
    v_pk_mov_b32 v[88:89], v[212:213], v[216:217] op_sel:[1,1]
    v_pk_mov_b32 v[96:97], v[214:215], v[218:219] op_sel:[0,0]
    v_pk_mov_b32 v[104:105], v[214:215], v[218:219] op_sel:[1,1]
    v_mfma_f32_16x16x16_bf16 v[212:215], a[240:241], v[190:191], v[204:207]
    s_mul_i32 s89, s46, 96
    v_add_u32 v4, s88, v0
    s_mul_i32 s88, s50, 160
    v_mfma_f32_16x16x16_bf16 v[216:219], a[242:243], v[190:191], v[204:207]
    ds_read_b64_tr_b16 a[240:241], v192 offset:32
    v_lshlrev_b32 v6, 2, v5
    buffer_load_dword v201, v6, s[24:27], s88 offen
    ds_read_b64_tr_b16 a[242:243], v193 offset:32
    buffer_load_dwordx4 a[116:119], v14, s[40:43], s53 offen offset:1024 sc1
    v_pk_mov_b32 v[50:51], v[220:221], v[224:225] op_sel:[0,0]
    v_pk_mov_b32 v[58:59], v[220:221], v[224:225] op_sel:[1,1]
    v_pk_mov_b32 v[66:67], v[222:223], v[226:227] op_sel:[0,0]
    v_pk_mov_b32 v[74:75], v[222:223], v[226:227] op_sel:[1,1]
    v_mfma_f32_16x16x16_bf16 v[220:223], a[244:245], v[190:191], v[204:207]
    s_mul_i32 s88, s50, 384
    v_min_u32 v5, 23, v1
    s_add_u32 s88, s88, s89
    s_waitcnt lgkmcnt(2)
    v_mfma_f32_16x16x16_bf16 v[224:227], a[246:247], v[190:191], v[204:207]
    ds_read_b64_tr_b16 a[244:245], v194 offset:24
    ds_read_b64_tr_b16 a[246:247], v195 offset:24
    v_lshlrev_b32 v6, 2, v5
    buffer_load_dword v189, v6, s[16:19], s88 offen
    buffer_load_dwordx4 a[120:123], v14, s[40:43], s53 offen offset:2048 sc1
    v_pk_mov_b32 v[52:53], v[228:229], v[232:233] op_sel:[0,0]
    v_pk_mov_b32 v[60:61], v[228:229], v[232:233] op_sel:[1,1]
    v_pk_mov_b32 v[68:69], v[230:231], v[234:235] op_sel:[0,0]
    v_pk_mov_b32 v[76:77], v[230:231], v[234:235] op_sel:[1,1]
    v_mfma_f32_16x16x16_bf16 v[228:231], a[248:249], v[190:191], v[204:207]
    s_and_b32 s88, s46, 1
    s_lshl_b32 s88, s88, 4
    v_add_u32 v5, s88, v2
    v_mfma_f32_16x16x16_bf16 v[232:235], a[250:251], v[190:191], v[204:207]
    ds_read_b64_tr_b16 a[248:249], v196 offset:24
    s_lshr_b32 s88, s46, 1
    ds_read_b64_tr_b16 a[250:251], v197 offset:24
    buffer_load_dwordx4 a[124:127], v14, s[40:43], s53 offen offset:3072 sc1
    s_add_u32 s53, s53, 4096
    v_pk_mov_b32 v[54:55], v[236:237], v[240:241] op_sel:[0,0]
    v_pk_mov_b32 v[62:63], v[236:237], v[240:241] op_sel:[1,1]
    v_pk_mov_b32 v[70:71], v[238:239], v[242:243] op_sel:[0,0]
    v_pk_mov_b32 v[78:79], v[238:239], v[242:243] op_sel:[1,1]
    v_mfma_f32_16x16x16_bf16 v[236:239], a[252:253], v[190:191], v[204:207]
    s_lshl_b32 s89, s49, 1
    s_add_u32 s88, s88, s89
    v_lshlrev_b32 v6, 6, v5
    v_mfma_f32_16x16x16_bf16 v[240:243], a[254:255], v[190:191], v[204:207]
    ds_read_b64_tr_b16 a[252:253], v198 offset:24
    v_add_u32 v6, s88, v6
    ds_read_b64_tr_b16 a[254:255], v199 offset:24
    v_cvt_f32_u32 v6, v6
    buffer_load_dwordx4 a[128:131], v14, s[40:43], s53 offen offset:0 sc1
    v_pk_mov_b32 v[112:113], v[212:213], v[216:217] op_sel:[0,0]
    v_pk_mov_b32 v[120:121], v[212:213], v[216:217] op_sel:[1,1]
    v_pk_mov_b32 v[128:129], v[214:215], v[218:219] op_sel:[0,0]
    v_pk_mov_b32 v[136:137], v[214:215], v[218:219] op_sel:[1,1]
    s_waitcnt lgkmcnt(3)
    v_mfma_f32_16x16x16_bf16 v[212:215], a[240:241], v[190:191], v[204:207]
    v_mul_f32 v6, 0x3a000000, v6
    v_mul_f32 v7, v6, v7
    v_mfma_f32_16x16x16_bf16 v[216:219], a[242:243], v[190:191], v[204:207]
    v_cvt_f32_u32 v5, v5
    v_add_f32 v8, 0xbe800000, v7
    v_mul_f32 v5, 0.5, v5
    v_cndmask_b32 v9, v8, v5, vcc
    v_and_b32 v5, 3, v2
    buffer_load_dwordx4 a[132:135], v14, s[40:43], s53 offen offset:1024 sc1
    v_pk_mov_b32 v[82:83], v[220:221], v[224:225] op_sel:[0,0]
    v_pk_mov_b32 v[90:91], v[220:221], v[224:225] op_sel:[1,1]
    v_pk_mov_b32 v[98:99], v[222:223], v[226:227] op_sel:[0,0]
    v_pk_mov_b32 v[106:107], v[222:223], v[226:227] op_sel:[1,1]
    v_mfma_f32_16x16x16_bf16 v[220:223], a[244:245], v[190:191], v[204:207]
    v_add_u32 v5, s50, v5
    v_add_u32 v5, 0, v5
    v_mfma_f32_16x16x16_bf16 v[224:227], a[246:247], v[190:191], v[204:207]
    ds_read_b64_tr_b16 a[244:245], v194 offset:32
    v_fmamk_f32 v210, v6, 0x3f800000, v7
    ds_read_b64_tr_b16 a[246:247], v195 offset:32
    v_fmamk_f32 v211, v6, 0x3f800000, v8
    v_and_b32 v5, 7, v5
    buffer_load_dwordx4 a[136:139], v14, s[40:43], s53 offen offset:2048 sc1
    v_pk_mov_b32 v[84:85], v[228:229], v[232:233] op_sel:[0,0]
    v_pk_mov_b32 v[92:93], v[228:229], v[232:233] op_sel:[1,1]
    v_pk_mov_b32 v[100:101], v[230:231], v[234:235] op_sel:[0,0]
    v_pk_mov_b32 v[108:109], v[230:231], v[234:235] op_sel:[1,1]
    v_mfma_f32_16x16x16_bf16 v[228:231], a[248:249], v[190:191], v[204:207]
    s_waitcnt lgkmcnt(2)
    v_cos_f32 v208, v7
    v_mfma_f32_16x16x16_bf16 v[232:235], a[250:251], v[190:191], v[204:207]
    ds_read_b64_tr_b16 a[248:249], v196 offset:32
    v_cmp_eq_u32 vcc, 1, v3
    ds_read_b64_tr_b16 a[250:251], v197 offset:32
    v_cos_f32 v209, v9
    buffer_load_dwordx4 a[140:143], v14, s[40:43], s53 offen offset:3072 sc1
    s_add_u32 s53, s53, 4096
    v_pk_mov_b32 v[86:87], v[236:237], v[240:241] op_sel:[0,0]
    v_pk_mov_b32 v[94:95], v[236:237], v[240:241] op_sel:[1,1]
    v_pk_mov_b32 v[102:103], v[238:239], v[242:243] op_sel:[0,0]
    v_pk_mov_b32 v[110:111], v[238:239], v[242:243] op_sel:[1,1]
    v_mfma_f32_16x16x16_bf16 v[236:239], a[252:253], v[190:191], v[204:207]
    v_cos_f32 v210, v210
    v_mfma_f32_16x16x16_bf16 v[240:243], a[254:255], v[190:191], v[204:207]
    ds_read_b64_tr_b16 a[252:253], v198 offset:32
    v_cos_f32 v211, v211
    ds_read_b64_tr_b16 a[254:255], v199 offset:32
    buffer_load_dwordx4 a[144:147], v14, s[40:43], s53 offen offset:0 sc1
    v_pk_mov_b32 v[144:145], v[212:213], v[216:217] op_sel:[0,0]
    v_pk_mov_b32 v[152:153], v[212:213], v[216:217] op_sel:[1,1]
    v_pk_mov_b32 v[160:161], v[214:215], v[218:219] op_sel:[0,0]
    v_pk_mov_b32 v[168:169], v[214:215], v[218:219] op_sel:[1,1]
    v_fmamk_f32 v212, v6, 0x40800000, v7
    v_fmamk_f32 v213, v6, 0x40800000, v8
    v_fmamk_f32 v214, v6, 0x40a00000, v7
    v_fmamk_f32 v215, v6, 0x40a00000, v8
    v_lshrrev_b32 v6, 2, v2
    v_lshl_add_u32 v5, v5, 2, v6
    v_and_b32 v8, 1, v3
    v_cvt_f32_u32 v5, v5
    v_lshrrev_b32 v7, 1, v3
    v_cvt_f32_u32 v8, v8
    v_mul_f32 v6, 0x3d000000, v5
    v_cvt_f32_u32 v7, v7
    buffer_load_dwordx4 a[148:151], v14, s[40:43], s53 offen offset:1024 sc1
    v_mul_f32 v8, 0xbe800000, v8
    v_fma_f32 v7, v7, v6, v8
    v_mul_f32 v5, 0.5, v5
    v_cndmask_b32 v9, v7, v5, vcc
    v_cos_f32 v212, v212
    v_cos_f32 v213, v213
    v_cos_f32 v214, v214
    v_cos_f32 v215, v215
    v_and_b32 v5, 3, v2
    v_add_u32 v5, s50, v5
    v_cvt_pk_bf16_f32 v244, v208, v209
    v_cvt_pk_bf16_f32 v245, v210, v211
    v_cvt_pk_bf16_f32 v246, v212, v213
    v_cvt_pk_bf16_f32 v247, v214, v215
    v_add_u32_e64 v5, 4, v5
    v_fmamk_f32 v209, v6, 0x40000000, v7
    v_fmamk_f32 v210, v6, 0x40800000, v7
    v_fmamk_f32 v211, v6, 0x40c00000, v7
    v_fmamk_f32 v212, v6, 0x41000000, v7
    v_fmamk_f32 v213, v6, 0x41200000, v7
    v_fmamk_f32 v214, v6, 0x41400000, v7
    v_fmamk_f32 v215, v6, 0x41600000, v7
    v_and_b32 v5, 7, v5
    v_lshrrev_b32 v6, 2, v2
    v_lshl_add_u32 v5, v5, 2, v6
    v_and_b32 v8, 1, v3
    v_cvt_f32_u32 v5, v5
    v_lshrrev_b32 v7, 1, v3
    v_cvt_f32_u32 v8, v8
    v_pk_mov_b32 v[114:115], v[220:221], v[224:225] op_sel:[0,0]
    v_pk_mov_b32 v[122:123], v[220:221], v[224:225] op_sel:[1,1]
    v_pk_mov_b32 v[130:131], v[222:223], v[226:227] op_sel:[0,0]
    v_pk_mov_b32 v[138:139], v[222:223], v[226:227] op_sel:[1,1]
    s_waitcnt lgkmcnt(0)
    v_mfma_f32_16x16x16_bf16 v[220:223], a[244:245], v[190:191], v[204:207]
    s_barrier
    v_cos_f32 v208, v9
    v_mfma_f32_16x16x16_bf16 v[224:227], a[246:247], v[190:191], v[204:207]
    v_cos_f32 v209, v209
    v_cos_f32 v210, v210
    v_cos_f32 v211, v211
    v_pk_mov_b32 v[116:117], v[228:229], v[232:233] op_sel:[0,0]
    v_pk_mov_b32 v[124:125], v[228:229], v[232:233] op_sel:[1,1]
    v_pk_mov_b32 v[132:133], v[230:231], v[234:235] op_sel:[0,0]
    v_pk_mov_b32 v[140:141], v[230:231], v[234:235] op_sel:[1,1]
    v_mfma_f32_16x16x16_bf16 v[228:231], a[248:249], v[190:191], v[204:207]
    v_cos_f32 v212, v212
    v_mfma_f32_16x16x16_bf16 v[232:235], a[250:251], v[190:191], v[204:207]
    v_cos_f32 v213, v213
    v_cos_f32 v214, v214
    v_cos_f32 v215, v215
    v_pk_mov_b32 v[118:119], v[236:237], v[240:241] op_sel:[0,0]
    v_pk_mov_b32 v[126:127], v[236:237], v[240:241] op_sel:[1,1]
    v_pk_mov_b32 v[134:135], v[238:239], v[242:243] op_sel:[0,0]
    v_pk_mov_b32 v[142:143], v[238:239], v[242:243] op_sel:[1,1]
    v_mfma_f32_16x16x16_bf16 v[236:239], a[252:253], v[190:191], v[204:207]
    v_mul_f32 v6, 0x3d000000, v5
    v_cvt_f32_u32 v7, v7
    v_mfma_f32_16x16x16_bf16 v[240:243], a[254:255], v[190:191], v[204:207]
    v_mul_f32 v8, 0xbe800000, v8
    v_cmp_eq_u32 vcc, 1, v3
    v_fma_f32 v7, v7, v6, v8
    v_mul_f32 v5, 0.5, v5
    v_cvt_pk_bf16_f32 v248, v208, v209
    v_cvt_pk_bf16_f32 v249, v210, v211
    v_cvt_pk_bf16_f32 v250, v212, v213
    v_cvt_pk_bf16_f32 v251, v214, v215
    v_cndmask_b32 v9, v7, v5, vcc
    v_fmamk_f32 v209, v6, 0x40000000, v7
    v_fmamk_f32 v210, v6, 0x40800000, v7
    v_fmamk_f32 v211, v6, 0x40c00000, v7
    v_fmamk_f32 v212, v6, 0x41000000, v7
    v_fmamk_f32 v213, v6, 0x41200000, v7
    v_fmamk_f32 v214, v6, 0x41400000, v7
    v_fmamk_f32 v215, v6, 0x41600000, v7
    v_cos_f32 v208, v9
    v_cos_f32 v209, v209
    v_cos_f32 v210, v210
    v_cos_f32 v211, v211
    v_cos_f32 v212, v212
    v_cos_f32 v213, v213
    v_cos_f32 v214, v214
    v_cos_f32 v215, v215
    v_mul_u32_u24 v4, 128, v4
    v_mul_f32 v13, 0xbd000000, v13
    v_pk_mov_b32 v[146:147], v[220:221], v[224:225] op_sel:[0,0]
    v_pk_mov_b32 v[154:155], v[220:221], v[224:225] op_sel:[1,1]
    v_pk_mov_b32 v[162:163], v[222:223], v[226:227] op_sel:[0,0]
    v_pk_mov_b32 v[170:171], v[222:223], v[226:227] op_sel:[1,1]
    v_pk_mov_b32 v[148:149], v[228:229], v[232:233] op_sel:[0,0]
    v_pk_mov_b32 v[156:157], v[228:229], v[232:233] op_sel:[1,1]
    v_pk_mov_b32 v[164:165], v[230:231], v[234:235] op_sel:[0,0]
    v_pk_mov_b32 v[172:173], v[230:231], v[234:235] op_sel:[1,1]
    v_pk_mov_b32 v[150:151], v[236:237], v[240:241] op_sel:[0,0]
    v_pk_mov_b32 v[158:159], v[236:237], v[240:241] op_sel:[1,1]
    v_pk_mov_b32 v[166:167], v[238:239], v[242:243] op_sel:[0,0]
    v_pk_mov_b32 v[174:175], v[238:239], v[242:243] op_sel:[1,1]
    v_add_u32 v4, 393216, v4
    v_cvt_pk_bf16_f32 v252, v208, v209
    v_cvt_pk_bf16_f32 v253, v210, v211
    v_cvt_pk_bf16_f32 v254, v212, v213
    v_cvt_pk_bf16_f32 v255, v214, v215
    buffer_load_dword v182, v4, s[40:43], 0 offen sc1
    s_waitcnt vmcnt(0)
    v_cmp_ne_u32 vcc, s47, v182
    s_nop 1
    s_cbranch_vccnz L_spin4
L_got4:
    s_add_u32 m0, s96, 0
    s_add_u32 s93, s92, 0
    buffer_load_dwordx4 v184, s[40:43], s93 offen offset:0 sc1 lds
    buffer_load_dwordx4 v185, s[40:43], s93 offen offset:1024 sc1 lds
    v_min_u32 v5, 39, v1
    s_mul_i32 s88, s46, 192
    v_min_u32 v6, 23, v1
    v_lshlrev_b32 v5, 3, v5
    s_add_u32 s88, s88, 136704
    v_lshlrev_b32 v6, 3, v6
    v_add_u32 v5, 135680, v5
    v_and_b32 v9, 0xffff0000, v201
    v_lshlrev_b32 v8, 16, v201
    v_mov_b32 v10, 0
    buffer_load_dwordx4 v186, s[40:43], s93 offen offset:2048 sc1 lds
    v_mov_b32 v11, 0
    v_add_u32 v6, s88, v6
    v_and_b32 v179, 0xffff0000, v189
    v_lshlrev_b32 v178, 16, v189
    ds_write_b64 v5, v[8:9]
    ds_write_b64 v5, v[10:11] offset:512
    v_lshrrev_b32 v5, 1, v3
    buffer_load_dwordx4 v187, s[40:43], s93 offen offset:3072 sc1 lds
    ds_write_b64 v6, v[178:179]
    v_lshlrev_b32 v5, 7, v5
    v_and_b32 v6, 1, v3
    v_lshl_add_u32 v5, v6, 2, v5
    v_bfe_u32 v6, v1, 3, 1
    v_lshl_add_u32 v5, v6, 1, v5
    s_mul_i32 s88, s50, 245760
    s_mul_i32 s90, s46, 61440
    s_and_b32 s89, s49, 3
    v_bfe_u32 v6, v1, 1, 1
    s_add_u32 m0, s96, 4096
    s_add_u32 s93, s92, 4096
    buffer_load_dwordx4 v200, s[40:43], s93 offen offset:0 sc1 lds
    s_add_u32 s88, s88, s90
    s_mul_i32 s89, s89, 2560
    v_add_u32 v5, v5, v6
    s_add_u32 s88, s88, s89
    v_mul_u32_u24 v5, 160, v5
    v_bfe_u32 v6, v1, 2, 1
    s_add_u32 s94, s88, 16777216
    v_lshl_add_u32 v5, v6, 4, v5
    v_and_b32 v6, 1, v1
    s_lshr_b32 s88, s46, 1
    v_lshl_add_u32 v5, v6, 3, v5
    s_add_u32 m0, s96, 5120
    s_add_u32 s93, s92, 524288
    buffer_load_dwordx4 v184, s[40:43], s93 offen offset:0 sc1 lds
    s_mul_i32 s88, s88, 40960
    v_add_u32 v5, s88, v5
    s_lshl_b32 s88, s46, 10
    v_add_u32 v12, s88, v14
    s_lshl_b32 s88, s46, 6
    s_add_u32 s88, s88, 135168
    v_lshlrev_b32 v9, 2, v2
    v_add_u32 v9, s88, v9
    v_lshrrev_b32 v6, 2, v2
    s_mul_i32 s88, s46, 5376
    v_cmp_eq_u32 vcc, v6, v3
    buffer_load_dwordx4 v185, s[40:43], s93 offen offset:1024 sc1 lds
    v_mul_u32_u24 v10, 336, v2
    v_mul_u32_u24 v6, 80, v3
    s_add_u32 s88, s88, 142336
    v_add3_u32 v10, v10, v6, s88
    v_min_u32 v4, 19, v1
    v_mov_b32 v7, 135424
    v_and_b32 v6, 3, v2
    v_lshlrev_b32 v4, 7, v4
    v_add_u32 v11, 86016, v12
    v_cndmask_b32 v9, v7, v9, vcc
    v_cmp_eq_u32 s[76:77], 1, v6
    v_cmp_eq_u32 s[78:79], 2, v6
    v_cmp_eq_u32 s[80:81], 3, v6
    buffer_load_dwordx4 v186, s[40:43], s93 offen offset:2048 sc1 lds
    buffer_load_dwordx4 v187, s[40:43], s93 offen offset:3072 sc1 lds
    s_add_u32 m0, s96, 9216
    s_add_u32 s93, s92, 528384
    buffer_load_dwordx4 v200, s[40:43], s93 offen offset:0 sc1 lds
    s_add_u32 m0, s96, 40960
    s_add_u32 s93, s92, 160
    buffer_load_dwordx4 v184, s[40:43], s93 offen offset:0 sc1 lds
    buffer_load_dwordx4 v185, s[40:43], s93 offen offset:1024 sc1 lds
    buffer_load_dwordx4 v186, s[40:43], s93 offen offset:2048 sc1 lds
    buffer_load_dwordx4 v187, s[40:43], s93 offen offset:3072 sc1 lds
    s_add_u32 m0, s96, 45056
    s_add_u32 s93, s92, 4256
    buffer_load_dwordx4 v200, s[40:43], s93 offen offset:0 sc1 lds
    s_add_u32 m0, s96, 46080
    s_add_u32 s93, s92, 524448
    buffer_load_dwordx4 v184, s[40:43], s93 offen offset:0 sc1 lds
    buffer_load_dwordx4 v185, s[40:43], s93 offen offset:1024 sc1 lds
    buffer_load_dwordx4 v186, s[40:43], s93 offen offset:2048 sc1 lds
    buffer_load_dwordx4 v187, s[40:43], s93 offen offset:3072 sc1 lds
    s_add_u32 m0, s96, 50176
    s_add_u32 s93, s92, 528544
    buffer_load_dwordx4 v200, s[40:43], s93 offen offset:0 sc1 lds
    s_waitcnt vmcnt(0)
    s_barrier
    ds_read_b64_tr_b16 a[240:241], v5 offset:0
    ds_read_b64_tr_b16 a[242:243], v5 offset:10240
    ds_read_b64_tr_b16 a[244:245], v5 offset:1280
    ds_read_b64_tr_b16 a[246:247], v5 offset:11520
    ds_read_b64_tr_b16 a[248:249], v5 offset:2560
    ds_read_b64_tr_b16 a[250:251], v5 offset:12800
    buffer_load_dwordx4 a[152:155], v14, s[40:43], s53 offen offset:2048 sc1
    ds_read_b64_tr_b16 a[252:253], v5 offset:3840
    ds_read_b64_tr_b16 a[254:255], v5 offset:14080
    ds_read_b64_tr_b16 v[176:177], v5 offset:5120
    ds_read_b64_tr_b16 v[178:179], v5 offset:15360
    s_mul_i32 s84, s50, 245760
    s_mul_i32 s85, s46, 61440
    s_add_u32 s84, s84, s85
    s_waitcnt lgkmcnt(8)
    v_mfma_f32_16x16x32_bf16 v[208:211], a[240:243], v[244:247], 0
    ds_read_b64_tr_b16 v[180:181], v5 offset:6400
    s_mul_i32 s85, s46, 13312
    s_waitcnt lgkmcnt(7)
    v_mfma_f32_16x16x32_bf16 v[212:215], a[244:247], v[244:247], 0
    ds_read_b64_tr_b16 v[182:183], v5 offset:16640
    s_add_u32 s85, s85, 32768
    s_waitcnt lgkmcnt(6)
    v_mfma_f32_16x16x32_bf16 v[216:219], a[248:251], v[244:247], 0
    buffer_load_dwordx4 a[156:159], v14, s[40:43], s53 offen offset:3072 sc1
    s_add_u32 s53, s53, 4096
    s_waitcnt lgkmcnt(4)
    v_mfma_f32_16x16x32_bf16 v[220:223], a[252:255], v[244:247], 0
    ds_read_b64_tr_b16 v[184:185], v5 offset:7680
    v_cvt_pk_bf16_f32 v192, v208, v212
    s_waitcnt lgkmcnt(3)
    v_mfma_f32_16x16x32_bf16 v[224:227], v[176:179], v[244:247], 0
    ds_read_b64_tr_b16 v[186:187], v5 offset:17920
    ds_read_b64_tr_b16 v[188:189], v5 offset:8960
    ds_read_b64_tr_b16 v[190:191], v5 offset:19200
    v_cvt_pk_bf16_f32 v196, v209, v213
    v_cvt_pk_bf16_f32 v200, v210, v214
    v_cvt_pk_bf16_f32 v204, v211, v215
    s_waitcnt lgkmcnt(4)
    v_mfma_f32_16x16x32_bf16 v[228:231], v[180:183], v[244:247], 0
    ds_read_b64_tr_b16 a[240:241], v5 offset:32
    buffer_load_dwordx4 a[160:163], v14, s[40:43], s53 offen offset:0 sc1
    v_cvt_pk_bf16_f32 v193, v216, v220
    v_cvt_pk_bf16_f32 v197, v217, v221
    v_cvt_pk_bf16_f32 v201, v218, v222
    v_cvt_pk_bf16_f32 v205, v219, v223
    s_nop 1
    v_cvt_pk_bf16_f32 v194, v224, v228
    v_cvt_pk_bf16_f32 v198, v225, v229
    v_cvt_pk_bf16_f32 v202, v226, v230
    s_waitcnt lgkmcnt(3)
    v_mfma_f32_16x16x32_bf16 v[232:235], v[184:187], v[244:247], 0
    ds_read_b64_tr_b16 a[242:243], v5 offset:10272
    v_cvt_pk_bf16_f32 v206, v227, v231
    s_waitcnt lgkmcnt(2)
    v_mfma_f32_16x16x32_bf16 v[236:239], v[188:191], v[244:247], 0
    ds_read_b64_tr_b16 a[244:245], v5 offset:1312
    ds_read_b64_tr_b16 a[246:247], v5 offset:11552
    ds_read_b64_tr_b16 a[248:249], v5 offset:2592
    buffer_load_dwordx4 a[164:167], v14, s[40:43], s53 offen offset:1024 sc1
    s_nop 3
    v_cvt_pk_bf16_f32 v195, v232, v236
    s_nop 1
    v_mfma_f32_16x16x32_bf16 v[16:19], v[248:251], v[192:195], v[16:19]
    ds_read_b64_tr_b16 a[250:251], v5 offset:12832
    v_cvt_pk_bf16_f32 v199, v233, v237
    v_mfma_f32_16x16x32_bf16 v[20:23], v[252:255], v[192:195], v[20:23]
    ds_read_b64_tr_b16 a[252:253], v5 offset:3872
    v_cvt_pk_bf16_f32 v203, v234, v238
    v_mfma_f32_16x16x32_bf16 v[24:27], v[248:251], v[196:199], v[24:27]
    ds_read_b64_tr_b16 a[254:255], v5 offset:14112
    v_cvt_pk_bf16_f32 v207, v235, v239
    v_mfma_f32_16x16x32_bf16 v[32:35], v[248:251], v[200:203], v[32:35]
    s_add_u32 s84, s84, 16817152
    v_add_f32 v176, v16, v13
    v_cvt_pk_bf16_f32 v16, v16, v17
    v_mfma_f32_16x16x32_bf16 v[40:43], v[248:251], v[204:207], v[40:43]
    buffer_load_dwordx4 a[168:171], v14, s[40:43], s53 offen offset:2048 sc1
    v_mfma_f32_16x16x32_bf16 v[28:31], v[252:255], v[196:199], v[28:31]
    s_mov_b32 m0, s85
    v_add_f32 v177, v24, v13
    v_add_f32 v178, v32, v13
    v_mfma_f32_16x16x32_bf16 v[36:39], v[252:255], v[200:203], v[36:39]
    s_or_b32 s88, s2, s46
    v_add_f32 v179, v40, v13
    v_cvt_pk_bf16_f32 v24, v24, v25
    v_mfma_f32_16x16x32_bf16 v[44:47], v[252:255], v[204:207], v[44:47]
    ds_write_b128 v10, v[176:179] offset:0
    s_waitcnt lgkmcnt(2)
    v_mfma_f32_16x16x32_bf16 v[208:211], a[240:243], v[244:247], 0
    s_cmp_eq_u32 s88, 0
    s_cselect_b32 s88, 0, 1073741824
    v_cvt_pk_bf16_f32 v32, v32, v33
    v_mfma_f32_16x16x32_bf16 v[212:215], a[244:247], v[244:247], 0
    buffer_load_dwordx4 a[172:175], v14, s[40:43], s53 offen offset:3072 sc1
    v_mfma_f32_16x16x32_bf16 v[216:219], a[248:251], v[244:247], 0
    ds_read_b64_tr_b16 a[240:241], v5 offset:64
    s_add_u32 s53, s53, 4096
    s_waitcnt lgkmcnt(2)
    v_mfma_f32_16x16x32_bf16 v[220:223], a[252:255], v[244:247], 0
    ds_read_b64_tr_b16 a[242:243], v5 offset:10304
    v_cvt_pk_bf16_f32 v40, v40, v41
    v_cvt_pk_bf16_f32 v17, v18, v19
    v_cvt_pk_bf16_f32 v25, v26, v27
    v_cvt_pk_bf16_f32 v33, v34, v35
    v_cvt_pk_bf16_f32 v41, v42, v43
    v_cvt_pk_bf16_f32 v18, v20, v21
    v_cvt_pk_bf16_f32 v19, v22, v23
    v_cvt_pk_bf16_f32 v26, v28, v29
    v_cvt_pk_bf16_f32 v27, v30, v31
    v_mfma_f32_16x16x32_bf16 v[240:243], v[16:19], v[16:19], 0
    ds_read_b64_tr_b16 v[20:21], v5 offset:5152
    v_cvt_pk_bf16_f32 v34, v36, v37
    v_mfma_f32_16x16x32_bf16 v[240:243], v[24:27], v[24:27], v[240:243]
    buffer_load_dwordx4 a[176:179], v14, s[40:43], s53 offen offset:0 sc1
    v_cvt_pk_bf16_f32 v35, v38, v39
    v_cvt_pk_bf16_f32 v42, v44, v45
    v_cvt_pk_bf16_f32 v43, v46, v47
    v_mfma_f32_16x16x32_bf16 v[240:243], v[32:35], v[32:35], v[240:243]
    ds_read_b64_tr_b16 v[22:23], v5 offset:15392
    v_cvt_pk_bf16_f32 v192, v208, v212
    v_mfma_f32_16x16x32_bf16 v[240:243], v[40:43], v[40:43], v[240:243]
    ds_read_b64_tr_b16 v[28:29], v5 offset:6432
    ds_read_b64_tr_b16 v[30:31], v5 offset:16672
    ds_read_b64_tr_b16 v[36:37], v5 offset:7712
    ds_read_b64_tr_b16 v[38:39], v5 offset:17952
    ds_read_b64_tr_b16 v[44:45], v5 offset:8992
    ds_read_b64_tr_b16 v[46:47], v5 offset:19232
    buffer_load_dwordx4 a[180:183], v14, s[40:43], s53 offen offset:1024 sc1
    v_cvt_pk_bf16_f32 v196, v209, v213
    v_cvt_pk_bf16_f32 v200, v210, v214
    v_cvt_pk_bf16_f32 v204, v211, v215
    s_waitcnt lgkmcnt(7)
    v_mfma_f32_16x16x32_bf16 v[208:211], a[240:243], v[244:247], 0
    ds_read_b64_tr_b16 a[244:245], v5 offset:1344
    v_cvt_pk_bf16_f32 v193, v216, v220
    s_waitcnt lgkmcnt(7)
    v_mfma_f32_16x16x32_bf16 v[224:227], v[20:23], v[244:247], 0
    ds_read_b64_tr_b16 a[246:247], v5 offset:11584
    v_cvt_pk_bf16_f32 v197, v217, v221
    s_waitcnt lgkmcnt(6)
    v_mfma_f32_16x16x32_bf16 v[228:231], v[28:31], v[244:247], 0
    ds_read_b64_tr_b16 a[248:249], v5 offset:2624
    v_cvt_pk_bf16_f32 v201, v218, v222
    s_waitcnt lgkmcnt(5)
    v_mfma_f32_16x16x32_bf16 v[232:235], v[36:39], v[244:247], 0
    ds_read_b64_tr_b16 a[250:251], v5 offset:12864
    v_cvt_pk_bf16_f32 v205, v219, v223
    s_waitcnt lgkmcnt(4)
    v_mfma_f32_16x16x32_bf16 v[236:239], v[44:47], v[244:247], 0
    buffer_load_dwordx4 a[184:187], v14, s[40:43], s53 offen offset:2048 sc1
    v_cvt_pk_bf16_f32 v194, v224, v228
    v_cvt_pk_bf16_f32 v198, v225, v229
    v_cvt_pk_bf16_f32 v202, v226, v230
    v_cvt_pk_bf16_f32 v206, v227, v231
    s_nop 2
    v_cvt_pk_bf16_f32 v195, v232, v236
    s_nop 1
    v_mfma_f32_16x16x32_bf16 v[48:51], v[248:251], v[192:195], v[48:51]
    ds_read_b64_tr_b16 a[252:253], v5 offset:3904
    v_cvt_pk_bf16_f32 v199, v233, v237
    v_mfma_f32_16x16x32_bf16 v[52:55], v[252:255], v[192:195], v[52:55]
    ds_read_b64_tr_b16 a[254:255], v5 offset:14144
    v_cvt_pk_bf16_f32 v203, v234, v238
    v_mfma_f32_16x16x32_bf16 v[56:59], v[248:251], v[196:199], v[56:59]
    buffer_load_dwordx4 a[188:191], v14, s[40:43], s53 offen offset:3072 sc1
    v_mfma_f32_16x16x32_bf16 v[64:67], v[248:251], v[200:203], v[64:67]
    ds_read_b64_tr_b16 a[240:241], v5 offset:96
    s_add_u32 s53, s53, 4096
    v_mfma_f32_16x16x32_bf16 v[60:63], v[252:255], v[196:199], v[60:63]
    ds_read_b64_tr_b16 a[242:243], v5 offset:10336
    v_cvt_pk_bf16_f32 v207, v235, v239
    v_mfma_f32_16x16x32_bf16 v[68:71], v[252:255], v[200:203], v[68:71]
    ds_write_b128 v11, v[16:19] offset:0
    v_mfma_f32_16x16x32_bf16 v[72:75], v[248:251], v[204:207], v[72:75]
    ds_write_b128 v11, v[24:27] offset:4096
    v_mfma_f32_16x16x32_bf16 v[76:79], v[252:255], v[204:207], v[76:79]
    buffer_load_dwordx4 a[192:195], v14, s[40:43], s53 offen offset:0 sc1
    s_waitcnt lgkmcnt(4)
    v_mfma_f32_16x16x32_bf16 v[212:215], a[244:247], v[244:247], 0
    ds_write_b128 v11, v[32:35] offset:8192
    v_mfma_f32_16x16x32_bf16 v[216:219], a[248:251], v[244:247], 0
    v_add_f32 v180, v48, v13
    v_add_f32 v181, v56, v13
    v_mfma_f32_16x16x32_bf16 v[220:223], a[252:255], v[244:247], 0
    ds_write_b128 v11, v[40:43] offset:12288
    buffer_load_dwordx4 a[196:199], v14, s[40:43], s53 offen offset:1024 sc1
    v_add_f32 v182, v64, v13
    v_add_f32 v183, v72, v13
    v_cvt_pk_bf16_f32 v48, v48, v49
    v_cvt_pk_bf16_f32 v56, v56, v57
    v_cvt_pk_bf16_f32 v64, v64, v65
    v_cvt_pk_bf16_f32 v72, v72, v73
    v_cvt_pk_bf16_f32 v49, v50, v51
    v_cvt_pk_bf16_f32 v57, v58, v59
    v_cvt_pk_bf16_f32 v65, v66, v67
    v_cvt_pk_bf16_f32 v73, v74, v75
    v_cvt_pk_bf16_f32 v50, v52, v53
    v_cvt_pk_bf16_f32 v51, v54, v55
    v_cvt_pk_bf16_f32 v58, v60, v61
    v_cvt_pk_bf16_f32 v59, v62, v63
    v_mfma_f32_16x16x32_bf16 v[240:243], v[48:51], v[48:51], v[240:243]
    ds_read_b64_tr_b16 v[52:53], v5 offset:5184
    v_cvt_pk_bf16_f32 v66, v68, v69
    v_mfma_f32_16x16x32_bf16 v[240:243], v[56:59], v[56:59], v[240:243]
    ds_read_b64_tr_b16 v[54:55], v5 offset:15424
    buffer_load_dwordx4 a[200:203], v14, s[40:43], s53 offen offset:2048 sc1
    v_cvt_pk_bf16_f32 v67, v70, v71
    v_cvt_pk_bf16_f32 v74, v76, v77
    v_cvt_pk_bf16_f32 v75, v78, v79
    v_mfma_f32_16x16x32_bf16 v[240:243], v[64:67], v[64:67], v[240:243]
    ds_read_b64_tr_b16 v[60:61], v5 offset:6464
    v_cvt_pk_bf16_f32 v192, v208, v212
    v_mfma_f32_16x16x32_bf16 v[240:243], v[72:75], v[72:75], v[240:243]
    ds_read_b64_tr_b16 v[62:63], v5 offset:16704
    ds_read_b64_tr_b16 v[68:69], v5 offset:7744
    ds_read_b64_tr_b16 v[70:71], v5 offset:17984
    ds_read_b64_tr_b16 v[76:77], v5 offset:9024
    v_cvt_pk_bf16_f32 v196, v209, v213
    v_cvt_pk_bf16_f32 v200, v210, v214
    v_cvt_pk_bf16_f32 v204, v211, v215
    s_waitcnt lgkmcnt(7)
    v_mfma_f32_16x16x32_bf16 v[208:211], a[240:243], v[244:247], 0
    buffer_load_dwordx4 a[204:207], v14, s[40:43], s53 offen offset:3072 sc1
    s_waitcnt lgkmcnt(5)
    v_mfma_f32_16x16x32_bf16 v[224:227], v[52:55], v[244:247], 0
    ds_read_b64_tr_b16 v[78:79], v5 offset:19264
    s_add_u32 s53, s53, 4096
    v_cvt_pk_bf16_f32 v193, v216, v220
    v_cvt_pk_bf16_f32 v197, v217, v221
    v_cvt_pk_bf16_f32 v201, v218, v222
    v_cvt_pk_bf16_f32 v205, v219, v223
    s_waitcnt lgkmcnt(4)
    v_mfma_f32_16x16x32_bf16 v[228:231], v[60:63], v[244:247], 0
    ds_read_b64_tr_b16 a[244:245], v5 offset:1376
    v_and_b32 v8, 7, v1
    s_waitcnt lgkmcnt(3)
    v_mfma_f32_16x16x32_bf16 v[232:235], v[68:71], v[244:247], 0
    ds_read_b64_tr_b16 a[246:247], v5 offset:11616
    s_nop 2
    v_cvt_pk_bf16_f32 v194, v224, v228
    buffer_load_dwordx4 a[208:211], v14, s[40:43], s53 offen offset:0 sc1
    v_cvt_pk_bf16_f32 v198, v225, v229
    v_cvt_pk_bf16_f32 v202, v226, v230
    s_waitcnt lgkmcnt(2)
    v_mfma_f32_16x16x32_bf16 v[236:239], v[76:79], v[244:247], 0
    ds_read_b64_tr_b16 a[248:249], v5 offset:2656
    v_cvt_pk_bf16_f32 v206, v227, v231
    ds_read_b64_tr_b16 a[250:251], v5 offset:12896
    ds_read_b64_tr_b16 a[252:253], v5 offset:3936
    s_nop 3
    v_cvt_pk_bf16_f32 v195, v232, v236
    s_nop 1
    v_mfma_f32_16x16x32_bf16 v[80:83], v[248:251], v[192:195], v[80:83]
    ds_read_b64_tr_b16 a[254:255], v5 offset:14176
    v_cvt_pk_bf16_f32 v199, v233, v237
    v_mfma_f32_16x16x32_bf16 v[84:87], v[252:255], v[192:195], v[84:87]
    buffer_load_dwordx4 a[212:215], v14, s[40:43], s53 offen offset:1024 sc1
    v_mfma_f32_16x16x32_bf16 v[88:91], v[248:251], v[196:199], v[88:91]
    ds_read_b64_tr_b16 a[240:241], v5 offset:128
    v_cvt_pk_bf16_f32 v203, v234, v238
    v_mfma_f32_16x16x32_bf16 v[92:95], v[252:255], v[196:199], v[92:95]
    ds_read_b64_tr_b16 a[242:243], v5 offset:10368
    v_cvt_pk_bf16_f32 v207, v235, v239
    v_mfma_f32_16x16x32_bf16 v[96:99], v[248:251], v[200:203], v[96:99]
    ds_write_b128 v11, v[48:51] offset:16384
    v_mfma_f32_16x16x32_bf16 v[104:107], v[248:251], v[204:207], v[104:107]
    ds_write_b128 v11, v[56:59] offset:20480
    v_mfma_f32_16x16x32_bf16 v[100:103], v[252:255], v[200:203], v[100:103]
    buffer_load_dwordx4 a[216:219], v14, s[40:43], s53 offen offset:2048 sc1
    v_mfma_f32_16x16x32_bf16 v[108:111], v[252:255], v[204:207], v[108:111]
    ds_write_b128 v11, v[64:67] offset:24576
    s_waitcnt lgkmcnt(3)
    v_mfma_f32_16x16x32_bf16 v[212:215], a[244:247], v[244:247], 0
    v_add_f32 v184, v80, v13
    v_add_f32 v185, v88, v13
    v_mfma_f32_16x16x32_bf16 v[216:219], a[248:251], v[244:247], 0
    ds_write_b128 v11, v[72:75] offset:28672
    v_mfma_f32_16x16x32_bf16 v[220:223], a[252:255], v[244:247], 0
    buffer_load_dwordx4 a[220:223], v14, s[40:43], s53 offen offset:3072 sc1
    s_add_u32 s53, s53, 4096
    v_add_f32 v186, v96, v13
    v_add_f32 v187, v104, v13
    v_cvt_pk_bf16_f32 v80, v80, v81
    v_cvt_pk_bf16_f32 v88, v88, v89
    v_cvt_pk_bf16_f32 v96, v96, v97
    v_cvt_pk_bf16_f32 v104, v104, v105
    v_cvt_pk_bf16_f32 v81, v82, v83
    v_cvt_pk_bf16_f32 v89, v90, v91
    v_cvt_pk_bf16_f32 v97, v98, v99
    v_cvt_pk_bf16_f32 v105, v106, v107
    v_cvt_pk_bf16_f32 v82, v84, v85
    v_cvt_pk_bf16_f32 v83, v86, v87
    v_cvt_pk_bf16_f32 v90, v92, v93
    v_cvt_pk_bf16_f32 v91, v94, v95
    v_mfma_f32_16x16x32_bf16 v[240:243], v[80:83], v[80:83], v[240:243]
    ds_read_b64_tr_b16 v[84:85], v5 offset:5216
    v_cvt_pk_bf16_f32 v98, v100, v101
    v_mfma_f32_16x16x32_bf16 v[240:243], v[88:91], v[88:91], v[240:243]
    buffer_load_dwordx4 a[224:227], v14, s[40:43], s53 offen offset:0 sc1
    v_cvt_pk_bf16_f32 v99, v102, v103
    v_cvt_pk_bf16_f32 v106, v108, v109
    v_cvt_pk_bf16_f32 v107, v110, v111
    v_mfma_f32_16x16x32_bf16 v[240:243], v[96:99], v[96:99], v[240:243]
    ds_read_b64_tr_b16 v[86:87], v5 offset:15456
    v_cvt_pk_bf16_f32 v192, v208, v212
    v_mfma_f32_16x16x32_bf16 v[240:243], v[104:107], v[104:107], v[240:243]
    ds_read_b64_tr_b16 v[92:93], v5 offset:6496
    ds_read_b64_tr_b16 v[94:95], v5 offset:16736
    ds_read_b64_tr_b16 v[100:101], v5 offset:7776
    ds_read_b64_tr_b16 v[102:103], v5 offset:18016
    ds_read_b64_tr_b16 v[108:109], v5 offset:9056
    ds_read_b64_tr_b16 v[110:111], v5 offset:19296
    buffer_load_dwordx4 a[228:231], v14, s[40:43], s53 offen offset:1024 sc1
    v_cvt_pk_bf16_f32 v196, v209, v213
    v_cvt_pk_bf16_f32 v200, v210, v214
    v_cvt_pk_bf16_f32 v204, v211, v215
    v_mfma_f32_16x16x32_bf16 v[208:211], a[240:243], v[244:247], 0
    ds_read_b64_tr_b16 a[244:245], v5 offset:1408
    v_cvt_pk_bf16_f32 v193, v216, v220
    s_waitcnt lgkmcnt(7)
    v_mfma_f32_16x16x32_bf16 v[224:227], v[84:87], v[244:247], 0
    ds_read_b64_tr_b16 a[246:247], v5 offset:11648
    v_cvt_pk_bf16_f32 v197, v217, v221
    s_waitcnt lgkmcnt(6)
    v_mfma_f32_16x16x32_bf16 v[228:231], v[92:95], v[244:247], 0
    ds_read_b64_tr_b16 a[248:249], v5 offset:2688
    v_cvt_pk_bf16_f32 v201, v218, v222
    s_waitcnt lgkmcnt(5)
    v_mfma_f32_16x16x32_bf16 v[232:235], v[100:103], v[244:247], 0
    ds_read_b64_tr_b16 a[250:251], v5 offset:12928
    v_cvt_pk_bf16_f32 v205, v219, v223
    s_waitcnt lgkmcnt(4)
    v_mfma_f32_16x16x32_bf16 v[236:239], v[108:111], v[244:247], 0
    buffer_load_dwordx4 a[232:235], v14, s[40:43], s53 offen offset:2048 sc1
    v_cvt_pk_bf16_f32 v194, v224, v228
    v_cvt_pk_bf16_f32 v198, v225, v229
    v_cvt_pk_bf16_f32 v202, v226, v230
    v_cvt_pk_bf16_f32 v206, v227, v231
    s_nop 2
    v_cvt_pk_bf16_f32 v195, v232, v236
    s_nop 1
    v_mfma_f32_16x16x32_bf16 v[112:115], v[248:251], v[192:195], v[112:115]
    ds_read_b64_tr_b16 a[252:253], v5 offset:3968
    v_cvt_pk_bf16_f32 v199, v233, v237
    v_mfma_f32_16x16x32_bf16 v[116:119], v[252:255], v[192:195], v[116:119]
    ds_read_b64_tr_b16 a[254:255], v5 offset:14208
    v_cvt_pk_bf16_f32 v203, v234, v238
    v_mfma_f32_16x16x32_bf16 v[120:123], v[248:251], v[196:199], v[120:123]
    ds_write_b128 v11, v[80:83] offset:32768
    v_mfma_f32_16x16x32_bf16 v[128:131], v[248:251], v[200:203], v[128:131]
    buffer_load_dwordx4 a[236:239], v14, s[40:43], s53 offen offset:3072 sc1
    v_mfma_f32_16x16x32_bf16 v[124:127], v[252:255], v[196:199], v[124:127]
    ds_write_b128 v11, v[88:91] offset:36864
    v_mfma_f32_16x16x32_bf16 v[132:135], v[252:255], v[200:203], v[132:135]
    ds_write_b128 v11, v[96:99] offset:40960
    s_waitcnt lgkmcnt(3)
    v_mfma_f32_16x16x32_bf16 v[212:215], a[244:247], v[244:247], 0
    v_cvt_pk_bf16_f32 v207, v235, v239
    v_add_f32 v188, v112, v13
    v_mfma_f32_16x16x32_bf16 v[216:219], a[248:251], v[244:247], 0
    ds_write_b128 v11, v[104:107] offset:45056
    v_mfma_f32_16x16x32_bf16 v[136:139], v[248:251], v[204:207], v[136:139]
    v_add_f32 v189, v120, v13
    v_add_f32 v190, v128, v13
    v_mfma_f32_16x16x32_bf16 v[140:143], v[252:255], v[204:207], v[140:143]
    v_cvt_pk_bf16_f32 v112, v112, v113
    v_cvt_pk_bf16_f32 v120, v120, v121
    v_mfma_f32_16x16x32_bf16 v[220:223], a[252:255], v[244:247], 0
    ds_write_b128 v10, v[180:183] offset:16
    v_add_f32_e64 v191, v136, v13
    v_cvt_pk_bf16_f32 v128, v128, v129
    v_cvt_pk_bf16_f32 v136, v136, v137
    v_cvt_pk_bf16_f32 v113, v114, v115
    v_cvt_pk_bf16_f32 v121, v122, v123
    v_cvt_pk_bf16_f32 v129, v130, v131
    v_cvt_pk_bf16_f32 v137, v138, v139
    v_cvt_pk_bf16_f32 v114, v116, v117
    v_cvt_pk_bf16_f32 v115, v118, v119
    v_cvt_pk_bf16_f32 v122, v124, v125
    v_cvt_pk_bf16_f32 v123, v126, v127
    v_mfma_f32_16x16x32_bf16 v[240:243], v[112:115], v[112:115], v[240:243]
    ds_read_b64_tr_b16 v[116:117], v5 offset:5248
    v_cvt_pk_bf16_f32 v130, v132, v133
    v_mfma_f32_16x16x32_bf16 v[240:243], v[120:123], v[120:123], v[240:243]
    ds_read_b64_tr_b16 v[118:119], v5 offset:15488
    v_cvt_pk_bf16_f32 v131, v134, v135
    v_cvt_pk_bf16_f32 v138, v140, v141
    v_cvt_pk_bf16_f32 v139, v142, v143
    v_mfma_f32_16x16x32_bf16 v[240:243], v[128:131], v[128:131], v[240:243]
    ds_read_b64_tr_b16 v[124:125], v5 offset:6528
    v_mul_u32_u24 v8, 128, v8
    v_mfma_f32_16x16x32_bf16 v[240:243], v[136:139], v[136:139], v[240:243]
    ds_read_b64_tr_b16 v[126:127], v5 offset:16768
    buffer_load_dwordx2 v[6:7], v8, s[40:43], s59 offen sc1
    ds_read_b64_tr_b16 v[132:133], v5 offset:7808
    ds_read_b64_tr_b16 v[134:135], v5 offset:18048
    ds_read_b64_tr_b16 v[140:141], v5 offset:9088
    v_cvt_pk_bf16_f32 v192, v208, v212
    v_cvt_pk_bf16_f32 v193, v216, v220
    v_cvt_pk_bf16_f32 v196, v209, v213
    v_cvt_pk_bf16_f32 v197, v217, v221
    s_waitcnt lgkmcnt(5)
    v_mfma_f32_16x16x32_bf16 v[224:227], v[116:119], v[244:247], 0
    ds_read_b64_tr_b16 v[142:143], v5 offset:19328
    v_cvt_pk_bf16_f32 v200, v210, v214
    v_cvt_pk_bf16_f32 v201, v218, v222
    v_cvt_pk_bf16_f32 v204, v211, v215
    v_cvt_pk_bf16_f32 v205, v219, v223
    s_waitcnt lgkmcnt(4)
    v_mfma_f32_16x16x32_bf16 v[228:231], v[124:127], v[244:247], 0
    ds_write_b128 v10, v[184:187] offset:32
    s_waitcnt lgkmcnt(3)
    v_mfma_f32_16x16x32_bf16 v[232:235], v[132:135], v[244:247], 0
    ds_write_b128 v10, v[188:191] offset:48
    s_waitcnt lgkmcnt(2)
    v_mfma_f32_16x16x32_bf16 v[236:239], v[140:143], v[244:247], 0
    s_barrier
    v_cvt_pk_bf16_f32 v194, v224, v228
    v_cvt_pk_bf16_f32 v198, v225, v229
    v_cvt_pk_bf16_f32 v202, v226, v230
    v_cvt_pk_bf16_f32 v206, v227, v231
    buffer_load_dwordx4 v14, s[40:43], s84 offen offset:0 sc1 lds
    buffer_load_dwordx4 v14, s[40:43], s84 offen offset:1024 sc1 lds
    s_nop 0
    v_cvt_pk_bf16_f32 v195, v232, v236
    v_cvt_pk_bf16_f32 v199, v233, v237
    s_nop 0
    v_mfma_f32_16x16x32_bf16 v[144:147], v[248:251], v[192:195], v[144:147]
    ds_write_b128 v12, v[112:115] offset:0
    v_mfma_f32_16x16x32_bf16 v[148:151], v[252:255], v[192:195], v[148:151]
    buffer_load_dwordx4 v14, s[40:43], s84 offen offset:2048 sc1 lds
    v_mfma_f32_16x16x32_bf16 v[152:155], v[248:251], v[196:199], v[152:155]
    ds_write_b128 v12, v[120:123] offset:4096
    v_mfma_f32_16x16x32_bf16 v[156:159], v[252:255], v[196:199], v[156:159]
    ds_write_b128 v12, v[128:131] offset:8192
    buffer_load_dwordx4 v14, s[40:43], s84 offen offset:3072 sc1 lds
    s_add_u32 s84, s84, 4096
    s_add_u32 m0, m0, 4096
    v_cvt_pk_bf16_f32 v203, v234, v238
    v_add_f32 v176, v144, v13
    v_cvt_pk_bf16_f32 v207, v235, v239
    v_mfma_f32_16x16x32_bf16 v[160:163], v[248:251], v[200:203], v[160:163]
    ds_write_b128 v12, v[136:139] offset:12288
    v_mfma_f32_16x16x32_bf16 v[164:167], v[252:255], v[200:203], v[164:167]
    buffer_load_dwordx4 v14, s[40:43], s84 offen offset:0 sc1 lds
    v_mfma_f32_16x16x32_bf16 v[168:171], v[248:251], v[204:207], v[168:171]
    v_cvt_pk_bf16_f32 v144, v144, v145
    v_cvt_pk_bf16_f32 v145, v146, v147
    v_mfma_f32_16x16x32_bf16 v[172:175], v[252:255], v[204:207], v[172:175]
    buffer_load_dwordx4 v14, s[40:43], s84 offen offset:1024 sc1 lds
    v_cvt_pk_bf16_f32 v146, v148, v149
    v_cvt_pk_bf16_f32 v147, v150, v151
    v_add_f32 v177, v152, v13
    v_cvt_pk_bf16_f32 v152, v152, v153
    v_mfma_f32_16x16x32_bf16 v[240:243], v[144:147], v[144:147], v[240:243]
    ds_write_b128 v12, v[144:147] offset:16384
    v_cvt_pk_bf16_f32 v153, v154, v155
    buffer_load_dwordx4 v14, s[40:43], s84 offen offset:2048 sc1 lds
    v_cvt_pk_bf16_f32 v154, v156, v157
    v_cvt_pk_bf16_f32 v155, v158, v159
    v_add_f32 v178, v160, v13
    v_cvt_pk_bf16_f32 v160, v160, v161
    v_mfma_f32_16x16x32_bf16 v[240:243], v[152:155], v[152:155], v[240:243]
    ds_write_b128 v12, v[152:155] offset:20480
    v_cvt_pk_bf16_f32 v161, v162, v163
    buffer_load_dwordx4 v14, s[40:43], s84 offen offset:3072 sc1 lds
    s_add_u32 s84, s84, 4096
    s_add_u32 m0, m0, 4096
    v_cvt_pk_bf16_f32 v162, v164, v165
    v_cvt_pk_bf16_f32 v163, v166, v167
    v_add_f32 v179, v168, v13
    v_cvt_pk_bf16_f32 v168, v168, v169
    v_mfma_f32_16x16x32_bf16 v[240:243], v[160:163], v[160:163], v[240:243]
    ds_write_b128 v12, v[160:163] offset:24576
    buffer_load_dwordx4 v14, s[40:43], s84 offen offset:0 sc1 lds
    v_cvt_pk_bf16_f32 v169, v170, v171
    v_cvt_pk_bf16_f32 v170, v172, v173
    v_cvt_pk_bf16_f32 v171, v174, v175
    s_nop 1
    v_mfma_f32_16x16x32_bf16 v[240:243], v[168:171], v[168:171], v[240:243]
    ds_write_b128 v12, v[168:171] offset:28672
    buffer_load_dwordx4 v14, s[40:43], s84 offen offset:1024 sc1 lds
    ds_write_b128 v10, v[176:179] offset:64
    buffer_load_dwordx4 v14, s[40:43], s84 offen offset:2048 sc1 lds
    s_waitcnt lgkmcnt(1)
    s_barrier
    buffer_load_dwordx4 v14, s[40:43], s84 offen offset:3072 sc1 lds
    s_add_u32 s84, s84, 4096
    s_add_u32 m0, m0, 4096
    s_nop 0
    buffer_load_dwordx4 v14, s[40:43], s84 offen offset:0 sc1 lds
    s_waitcnt vmcnt(13)
    v_cmp_ne_u32 vcc, s47, v6
    v_cmp_ne_u32 s[96:97], s55, v7
    s_nop 1
    s_or_b64 vcc, vcc, s[96:97]
    s_cmp_eq_u64 vcc, 0
    s_cselect_b32 s55, 1, 0
    v_mov_b32 v6, 1073741824
    v_writelane_b32 v6, s88, 0
    v_mov_b32 v7, s47
    buffer_store_dword v7, v6, s[40:43], 0 offen sc1
    s_nop 0
    v_cndmask_b32 v7, v240, v241, s[76:77]
    v_cndmask_b32 v7, v7, v242, s[78:79]
    v_cndmask_b32 v7, v7, v243, s[80:81]
    v_mul_f32 v7, 0x3acccccd, v7
    v_add_f32 v8, 0x3727c5ac, v7
    v_rsq_f32 v8, v8
    s_nop 0
    v_mul_f32 v7, v7, v8
    v_fmaak_f32 v7, v7, v8, 0x3727c5ac
    v_rsq_f32 v7, v7
    s_nop 0
    v_mul_f32 v7, v7, v8
    ds_write_b32 v9, v7
    v_add_u32 v5, 86016, v14
    ds_read_b128 v[52:55], v5 offset:0
    ds_read_b128 v[56:59], v5 offset:4096
    s_mul_i32 s88, s49, 196608
    s_mul_i32 s89, s50, 6144
    ds_read_b128 v[60:63], v5 offset:8192
    s_add_u32 s89, s88, s89
    s_add_u32 s92, s89, 18874368
    ds_read_b128 v[64:67], v5 offset:12288
    s_mul_i32 s89, s46, 12288
    s_add_u32 s88, s88, s89
    ds_read_b128 v[68:71], v5 offset:16384
    s_add_u32 s94, s88, 18874368
    v_lshrrev_b32 v7, 1, v3
    s_lshl_b32 s88, s46, 10
    v_lshlrev_b32 v7, 8, v7
    v_add_u32 v6, s88, v14
    v_lshl_add_u32 v7, v2, 4, v7
    v_and_b32 v8, 1, v3
    s_lshl_b32 s88, s46, 9
    v_lshl_add_u32 v7, v8, 3, v7
    s_waitcnt lgkmcnt(4)
    v_mfma_f32_16x16x32_bf16 v[16:19], a[0:3], v[52:55], 0
    s_add_u32 s88, s88, 4096
    v_add_u32 v7, s88, v7
    s_mul_i32 s88, s46, 192
    v_mfma_f32_16x16x32_bf16 v[20:23], a[4:7], v[52:55], 0
    s_add_u32 s88, s88, 136704
    v_lshlrev_b32 v8, 4, v3
    s_barrier
    v_mfma_f32_16x16x32_bf16 v[24:27], a[8:11], v[52:55], 0
    s_mov_b32 s86, 0xbdd2d3e8
    v_add_u32 v8, s88, v8
    v_mov_b32 v100, 0xc0135761
    s_waitcnt lgkmcnt(2)
    v_mfma_f32_16x16x32_bf16 v[16:19], a[12:15], v[56:59], v[16:19]
    ds_read_b128 v[52:55], v5 offset:20480
    v_mov_b32 v101, 0xc0135761
    v_mfma_f32_16x16x32_bf16 v[20:23], a[16:19], v[56:59], v[20:23]
    ds_read_b128 v[72:75], v8 offset:0
    s_mov_b32 s87, 0xbdd2d3e8
    v_mfma_f32_16x16x32_bf16 v[24:27], a[20:23], v[56:59], v[24:27]
    ds_read_b128 v[76:79], v8 offset:64
    s_mul_i32 s88, s50, 245760
    v_mfma_f32_16x16x32_bf16 v[16:19], a[24:27], v[60:63], v[16:19]
    ds_read_b128 v[56:59], v5 offset:24576
    s_mul_i32 s89, s46, 61440
    v_mfma_f32_16x16x32_bf16 v[20:23], a[28:31], v[60:63], v[20:23]
    ds_read_b128 v[80:83], v8 offset:128
    v_lshlrev_b32 v8, 2, v2
    v_mfma_f32_16x16x32_bf16 v[24:27], a[32:35], v[60:63], v[24:27]
    s_add_u32 s88, s88, s89
    v_add_u32 v8, 135168, v8
    s_add_u32 s93, s88, 16777216
    s_waitcnt lgkmcnt(5)
    v_mfma_f32_16x16x32_bf16 v[16:19], a[36:39], v[64:67], v[16:19]
    ds_read_b128 v[60:63], v5 offset:28672
    s_lshl_b32 s88, s49, 7
    v_mfma_f32_16x16x32_bf16 v[20:23], a[40:43], v[64:67], v[20:23]
    ds_read_b32 v84, v8 offset:0
    s_lshl_b32 s89, s50, 2
    v_mfma_f32_16x16x32_bf16 v[24:27], a[44:47], v[64:67], v[24:27]
    ds_read_b32 v85, v8 offset:64
    s_add_u32 s89, s89, s88
    v_mfma_f32_16x16x32_bf16 v[16:19], a[48:51], v[68:71], v[16:19]
    ds_read_b128 v[64:67], v5 offset:32768
    s_add_u32 s89, s89, s46
    v_mfma_f32_16x16x32_bf16 v[20:23], a[52:55], v[68:71], v[20:23]
    ds_read_b32 v86, v8 offset:128
    s_mul_i32 s89, s89, 4
    v_mfma_f32_16x16x32_bf16 v[24:27], a[56:59], v[68:71], v[24:27]
    ds_read_b32 v87, v8 offset:192
    s_add_u32 s89, s89, 524288
    s_waitcnt lgkmcnt(6)
    v_mfma_f32_16x16x32_bf16 v[16:19], a[60:63], v[52:55], v[16:19]
    ds_read_b128 v[68:71], v5 offset:36864
    v_mov_b32 v9, 1073741824
    v_writelane_b32 v9, s89, 0
    v_mfma_f32_16x16x32_bf16 v[20:23], a[64:67], v[52:55], v[20:23]
    buffer_load_dwordx4 v[116:119], v14, s[40:43], s93 offen offset:0 sc1
    v_mfma_f32_16x16x32_bf16 v[24:27], a[68:71], v[52:55], v[24:27]
    buffer_load_dwordx4 v[120:123], v14, s[40:43], s93 offen offset:1024 sc1
    v_mfma_f32_16x16x32_bf16 v[16:19], a[72:75], v[56:59], v[16:19]
    ds_read_b128 v[52:55], v5 offset:40960
    v_mov_b32 v11, s47
    v_mfma_f32_16x16x32_bf16 v[20:23], a[76:79], v[56:59], v[20:23]
    s_lshl_b32 s89, s46, 3
    s_add_u32 s88, s88, s89
    v_and_b32 v10, 7, v1
    v_mfma_f32_16x16x32_bf16 v[24:27], a[80:83], v[56:59], v[24:27]
    buffer_load_dwordx4 v[124:127], v14, s[40:43], s93 offen offset:2048 sc1
    s_waitcnt lgkmcnt(3)
    v_mfma_f32_16x16x32_bf16 v[16:19], a[84:87], v[60:63], v[16:19]
    ds_read_b128 v[56:59], v5 offset:45056
    v_add_u32 v10, s88, v10
    v_mfma_f32_16x16x32_bf16 v[20:23], a[88:91], v[60:63], v[20:23]
    s_mov_b32 s79, 128
    v_mul_u32_u24 v10, 4, v10
    v_add_u32 v10, 524288, v10
    v_mfma_f32_16x16x32_bf16 v[24:27], a[92:95], v[60:63], v[24:27]
    s_mov_b32 s80, 256
    s_mov_b32 s81, 384
    s_cmp_eq_u32 s46, 0
    s_cselect_b32 s96, 336, 0
    s_cselect_b32 s88, 142336, 0
    s_cmp_eq_u32 s46, 1
    s_cselect_b32 s88, 135680, s88
    s_cmp_ge_u32 s46, 2
    s_cselect_b32 s88, 136192, s88
    v_mfma_f32_16x16x32_bf16 v[16:19], a[96:99], v[64:67], v[16:19]
    ds_read_b128 v[60:63], v14 offset:0
    v_mul_u32_u24 v4, s96, v2
    v_mfma_f32_16x16x32_bf16 v[20:23], a[100:103], v[64:67], v[20:23]
    buffer_load_dwordx4 v[128:131], v14, s[40:43], s93 offen offset:3072 sc1
    v_mfma_f32_16x16x32_bf16 v[24:27], a[104:107], v[64:67], v[24:27]
    s_add_u32 s93, s93, 4096
    v_lshl_add_u32 v4, v3, 4, v4
    v_add_u32 v4, s88, v4
    s_waitcnt lgkmcnt(2)
    v_mfma_f32_16x16x32_bf16 v[16:19], a[108:111], v[68:71], v[16:19]
    ds_read_b128 v[64:67], v14 offset:4096
    v_add_u32 v12, s85, v14
    v_mfma_f32_16x16x32_bf16 v[20:23], a[112:115], v[68:71], v[20:23]
    buffer_load_dwordx4 v[132:135], v14, s[40:43], s93 offen offset:0 sc1
    v_mfma_f32_16x16x32_bf16 v[24:27], a[116:119], v[68:71], v[24:27]
    s_lshl_b32 s96, s96, 4
    s_mul_i32 s88, s46, 5440
    v_cmp_gt_u32 s[82:83], 40, v1
    v_mfma_f32_16x16x32_bf16 v[16:19], a[120:123], v[52:55], v[16:19]
    ds_read_b128 v[68:71], v14 offset:8192
    s_mul_i32 s89, s49, 2560
    v_mfma_f32_16x16x32_bf16 v[20:23], a[124:127], v[52:55], v[20:23]
    buffer_load_dwordx4 v[136:139], v14, s[40:43], s93 offen offset:1024 sc1
    v_mfma_f32_16x16x32_bf16 v[24:27], a[128:131], v[52:55], v[24:27]
    s_mov_b32 s91, 0xbdd2d3e8
    s_waitcnt lgkmcnt(2)
    v_mfma_f32_16x16x32_bf16 v[16:19], a[132:135], v[56:59], v[16:19]
    ds_read_b128 v[52:55], v14 offset:12288
    v_mfma_f32_16x16x32_bf16 v[20:23], a[136:139], v[56:59], v[20:23]
    buffer_load_dwordx4 v[140:143], v14, s[40:43], s93 offen offset:2048 sc1
    v_mfma_f32_16x16x32_bf16 v[24:27], a[140:143], v[56:59], v[24:27]
    v_mfma_f32_16x16x32_bf16 v[16:19], a[144:147], v[60:63], v[16:19]
    ds_read_b128 v[56:59], v14 offset:16384
    v_mfma_f32_16x16x32_bf16 v[20:23], a[148:151], v[60:63], v[20:23]
    v_mfma_f32_16x16x32_bf16 v[24:27], a[152:155], v[60:63], v[24:27]
    buffer_load_dwordx4 v[144:147], v14, s[40:43], s93 offen offset:3072 sc1
    s_waitcnt lgkmcnt(2)
    v_mfma_f32_16x16x32_bf16 v[16:19], a[156:159], v[64:67], v[16:19]
    ds_read_b128 v[60:63], v14 offset:20480
    s_add_u32 s93, s93, 4096
    v_mfma_f32_16x16x32_bf16 v[20:23], a[160:163], v[64:67], v[20:23]
    v_mfma_f32_16x16x32_bf16 v[24:27], a[164:167], v[64:67], v[24:27]
    v_mfma_f32_16x16x32_bf16 v[16:19], a[168:171], v[68:71], v[16:19]
    ds_read_b128 v[64:67], v14 offset:24576
    v_mfma_f32_16x16x32_bf16 v[20:23], a[172:175], v[68:71], v[20:23]
    buffer_load_dwordx4 v[148:151], v14, s[40:43], s93 offen offset:0 sc1
    v_mfma_f32_16x16x32_bf16 v[24:27], a[176:179], v[68:71], v[24:27]
    s_waitcnt lgkmcnt(2)
    v_mfma_f32_16x16x32_bf16 v[16:19], a[180:183], v[52:55], v[16:19]
    ds_read_b128 v[68:71], v14 offset:28672
    v_mfma_f32_16x16x32_bf16 v[20:23], a[184:187], v[52:55], v[20:23]
    v_mfma_f32_16x16x32_bf16 v[24:27], a[188:191], v[52:55], v[24:27]
    buffer_load_dwordx4 v[152:155], v14, s[40:43], s93 offen offset:1024 sc1
    v_mfma_f32_16x16x32_bf16 v[16:19], a[192:195], v[56:59], v[16:19]
    ds_read_b128 v[52:55], v5 offset:1024
    v_mfma_f32_16x16x32_bf16 v[20:23], a[196:199], v[56:59], v[20:23]
    v_mfma_f32_16x16x32_bf16 v[24:27], a[200:203], v[56:59], v[24:27]
    s_waitcnt lgkmcnt(2)
    v_mfma_f32_16x16x32_bf16 v[16:19], a[204:207], v[60:63], v[16:19]
    ds_read_b128 v[56:59], v5 offset:5120
    v_mfma_f32_16x16x32_bf16 v[20:23], a[208:211], v[60:63], v[20:23]
    v_mfma_f32_16x16x32_bf16 v[24:27], a[212:215], v[60:63], v[24:27]
    buffer_load_dwordx4 v[156:159], v14, s[40:43], s93 offen offset:2048 sc1
    v_mfma_f32_16x16x32_bf16 v[16:19], a[216:219], v[64:67], v[16:19]
    ds_read_b128 v[60:63], v5 offset:9216
    v_mfma_f32_16x16x32_bf16 v[20:23], a[220:223], v[64:67], v[20:23]
    v_mfma_f32_16x16x32_bf16 v[24:27], a[224:227], v[64:67], v[24:27]
    s_waitcnt lgkmcnt(2)
    v_mfma_f32_16x16x32_bf16 v[16:19], a[228:231], v[68:71], v[16:19]
    ds_read_b128 v[64:67], v5 offset:13312
    v_mfma_f32_16x16x32_bf16 v[20:23], a[232:235], v[68:71], v[20:23]
    v_mfma_f32_16x16x32_bf16 v[24:27], a[236:239], v[68:71], v[24:27]
    buffer_load_dwordx4 v[160:163], v14, s[40:43], s93 offen offset:3072 sc1
    v_mfma_f32_16x16x32_bf16 v[28:31], a[0:3], v[52:55], 0
    ds_read_b128 v[68:71], v5 offset:17408
    s_add_u32 s93, s93, 4096
    v_pk_fma_f32 v[16:17], v[16:17], v[84:85], v[72:73] op_sel:[0,0,0] op_sel_hi:[1,0,1]
    v_pk_fma_f32 v[18:19], v[18:19], v[84:85], v[74:75] op_sel:[0,0,0] op_sel_hi:[1,0,1]
    v_pk_fma_f32 v[20:21], v[20:21], v[84:85], v[76:77] op_sel:[0,0,0] op_sel_hi:[1,0,1]
    v_pk_fma_f32 v[22:23], v[22:23], v[84:85], v[78:79] op_sel:[0,0,0] op_sel_hi:[1,0,1]
    v_pk_fma_f32 v[24:25], v[24:25], v[84:85], v[80:81] op_sel:[0,0,0] op_sel_hi:[1,0,1]
    v_pk_fma_f32 v[26:27], v[26:27], v[84:85], v[82:83] op_sel:[0,0,0] op_sel_hi:[1,0,1]
    v_pk_mul_f32 v[88:89], v[16:17], v[16:17]
    v_pk_mul_f32 v[90:91], v[18:19], v[18:19]
    v_pk_mul_f32 v[92:93], v[20:21], v[20:21]
    v_pk_mul_f32 v[94:95], v[22:23], v[22:23]
    v_pk_mul_f32 v[96:97], v[24:25], v[24:25]
    v_pk_mul_f32 v[98:99], v[26:27], v[26:27]
    v_pk_fma_f32 v[88:89], v[88:89], s[86:87], v[100:101]
    v_pk_fma_f32 v[90:91], v[90:91], s[86:87], v[100:101]
    v_pk_fma_f32 v[92:93], v[92:93], s[86:87], v[100:101]
    v_pk_fma_f32 v[94:95], v[94:95], s[86:87], v[100:101]
    v_pk_fma_f32 v[96:97], v[96:97], s[86:87], v[100:101]
    v_pk_fma_f32 v[98:99], v[98:99], s[86:87], v[100:101]
    v_pk_mul_f32 v[88:89], v[88:89], v[16:17]
    v_pk_mul_f32 v[90:91], v[90:91], v[18:19]
    v_pk_mul_f32 v[92:93], v[92:93], v[20:21]
    v_pk_mul_f32 v[94:95], v[94:95], v[22:23]
    v_pk_mul_f32 v[96:97], v[96:97], v[24:25]
    v_pk_mul_f32 v[98:99], v[98:99], v[26:27]
    v_mfma_f32_16x16x32_bf16 v[32:35], a[4:7], v[52:55], 0
    buffer_load_dwordx4 v[164:167], v14, s[40:43], s93 offen offset:0 sc1
    v_exp_f32 v88, v88
    v_exp_f32 v89, v89
    v_mfma_f32_16x16x32_bf16 v[36:39], a[8:11], v[52:55], 0
    s_waitcnt lgkmcnt(0)
    v_exp_f32 v90, v90
    v_exp_f32 v91, v91
    v_exp_f32 v92, v92
    v_mfma_f32_16x16x32_bf16 v[28:31], a[12:15], v[56:59], v[28:31]
    ds_read_b128 v[52:55], v5 offset:21504
    v_exp_f32 v93, v93
    v_exp_f32 v94, v94
    v_mfma_f32_16x16x32_bf16 v[32:35], a[16:19], v[56:59], v[32:35]
    buffer_load_dwordx4 v[168:171], v14, s[40:43], s93 offen offset:1024 sc1
    v_exp_f32 v95, v95
    v_exp_f32 v96, v96
    v_mfma_f32_16x16x32_bf16 v[36:39], a[20:23], v[56:59], v[36:39]
    v_exp_f32 v97, v97
    v_exp_f32 v98, v98
    v_exp_f32 v99, v99
    v_mfma_f32_16x16x32_bf16 v[28:31], a[24:27], v[60:63], v[28:31]
    ds_read_b128 v[56:59], v5 offset:25600
    v_add_f32 v88, 1.0, v88
    v_add_f32 v89, 1.0, v89
    v_add_f32 v90, 1.0, v90
    v_add_f32 v91, 1.0, v91
    v_mfma_f32_16x16x32_bf16 v[32:35], a[28:31], v[60:63], v[32:35]
    buffer_load_dwordx4 v[172:175], v14, s[40:43], s93 offen offset:2048 sc1
    v_add_f32 v92, 1.0, v92
    v_add_f32 v93, 1.0, v93
    v_add_f32 v94, 1.0, v94
    v_mfma_f32_16x16x32_bf16 v[36:39], a[32:35], v[60:63], v[36:39]
    v_add_f32 v95, 1.0, v95
    v_add_f32 v96, 1.0, v96
    v_add_f32 v97, 1.0, v97
    v_add_f32 v98, 1.0, v98
    v_add_f32 v99, 1.0, v99
    v_mfma_f32_16x16x32_bf16 v[28:31], a[36:39], v[64:67], v[28:31]
    ds_read_b128 v[60:63], v5 offset:29696
    v_rcp_f32 v88, v88
    v_rcp_f32 v89, v89
    v_mfma_f32_16x16x32_bf16 v[32:35], a[40:43], v[64:67], v[32:35]
    buffer_load_dwordx4 v[176:179], v14, s[40:43], s93 offen offset:3072 sc1
    v_rcp_f32 v90, v90
    v_rcp_f32 v91, v91
    v_mfma_f32_16x16x32_bf16 v[36:39], a[44:47], v[64:67], v[36:39]
    s_add_u32 s93, s93, 4096
    v_rcp_f32 v92, v92
    v_rcp_f32 v93, v93
    v_rcp_f32 v94, v94
    v_mfma_f32_16x16x32_bf16 v[28:31], a[48:51], v[68:71], v[28:31]
    ds_read_b128 v[64:67], v5 offset:33792
    v_rcp_f32 v95, v95
    v_mfma_f32_16x16x32_bf16 v[32:35], a[52:55], v[68:71], v[32:35]
    buffer_load_dwordx4 v[180:183], v14, s[40:43], s93 offen offset:0 sc1
    v_mfma_f32_16x16x32_bf16 v[36:39], a[56:59], v[68:71], v[36:39]
    s_waitcnt lgkmcnt(1)
    v_rcp_f32 v96, v96
    v_mfma_f32_16x16x32_bf16 v[28:31], a[60:63], v[52:55], v[28:31]
    ds_read_b128 v[68:71], v5 offset:37888
    v_rcp_f32 v97, v97
    v_mfma_f32_16x16x32_bf16 v[32:35], a[64:67], v[52:55], v[32:35]
    v_rcp_f32 v98, v98
    v_mfma_f32_16x16x32_bf16 v[36:39], a[68:71], v[52:55], v[36:39]
    v_rcp_f32 v99, v99
    v_mfma_f32_16x16x32_bf16 v[28:31], a[72:75], v[56:59], v[28:31]
    ds_read_b128 v[52:55], v5 offset:41984
    v_mul_f32 v88, v88, v16
    v_mfma_f32_16x16x32_bf16 v[32:35], a[76:79], v[56:59], v[32:35]
    buffer_load_dwordx4 v[184:187], v14, s[40:43], s93 offen offset:1024 sc1
    v_mfma_f32_16x16x32_bf16 v[36:39], a[80:83], v[56:59], v[36:39]
    v_mul_f32 v89, v89, v17
    v_mul_f32 v90, v90, v18
    v_mfma_f32_16x16x32_bf16 v[28:31], a[84:87], v[60:63], v[28:31]
    ds_read_b128 v[56:59], v5 offset:46080
    v_mul_f32 v91, v91, v19
    v_mfma_f32_16x16x32_bf16 v[32:35], a[88:91], v[60:63], v[32:35]
    v_mul_f32 v92, v92, v20
    v_mul_f32 v93, v93, v21
    v_mfma_f32_16x16x32_bf16 v[36:39], a[92:95], v[60:63], v[36:39]
    s_waitcnt lgkmcnt(2)
    v_mul_f32 v94, v94, v22
    v_mul_f32 v95, v95, v23
    v_mfma_f32_16x16x32_bf16 v[28:31], a[96:99], v[64:67], v[28:31]
    ds_read_b128 v[60:63], v14 offset:1024
    v_mul_f32 v96, v96, v24
    v_mfma_f32_16x16x32_bf16 v[32:35], a[100:103], v[64:67], v[32:35]
    v_mul_f32 v97, v97, v25
    v_mul_f32 v98, v98, v26
    v_mfma_f32_16x16x32_bf16 v[36:39], a[104:107], v[64:67], v[36:39]
    buffer_load_dwordx4 v[188:191], v14, s[40:43], s93 offen offset:2048 sc1
    v_mfma_f32_16x16x32_bf16 v[28:31], a[108:111], v[68:71], v[28:31]
    ds_read_b128 v[64:67], v14 offset:5120
    v_mul_f32 v99, v99, v27
    v_mfma_f32_16x16x32_bf16 v[32:35], a[112:115], v[68:71], v[32:35]
    v_cvt_pk_bf16_f32 v102, v88, v89
    v_cvt_pk_bf16_f32 v103, v90, v91
    v_mfma_f32_16x16x32_bf16 v[36:39], a[116:119], v[68:71], v[36:39]
    s_waitcnt lgkmcnt(2)
    v_cvt_pk_bf16_f32 v104, v92, v93
    v_cvt_pk_bf16_f32 v105, v94, v95
    v_mfma_f32_16x16x32_bf16 v[28:31], a[120:123], v[52:55], v[28:31]
    buffer_store_dwordx4 v[102:105], v6, s[40:43], s92 offen sc1
    v_mfma_f32_16x16x32_bf16 v[32:35], a[124:127], v[52:55], v[32:35]
    ds_read_b128 v[68:71], v14 offset:9216
    v_cvt_pk_bf16_f32 v106, v96, v97
    v_mfma_f32_16x16x32_bf16 v[36:39], a[128:131], v[52:55], v[36:39]
    buffer_load_dwordx4 v[192:195], v14, s[40:43], s93 offen offset:3072 sc1
    v_mfma_f32_16x16x32_bf16 v[28:31], a[132:135], v[56:59], v[28:31]
    ds_read_b128 v[52:55], v14 offset:13312
    v_cvt_pk_bf16_f32 v107, v98, v99
    v_mfma_f32_16x16x32_bf16 v[32:35], a[136:139], v[56:59], v[32:35]
    buffer_store_dwordx2 v[106:107], v7, s[40:43], s92 offen sc1
    v_mfma_f32_16x16x32_bf16 v[36:39], a[140:143], v[56:59], v[36:39]
    s_add_u32 s92, s92, 49152
    s_add_u32 s93, s93, 4096
    s_waitcnt lgkmcnt(2)
    v_mfma_f32_16x16x32_bf16 v[28:31], a[144:147], v[60:63], v[28:31]
    ds_read_b128 v[56:59], v14 offset:17408
    v_mfma_f32_16x16x32_bf16 v[32:35], a[148:151], v[60:63], v[32:35]
    v_mfma_f32_16x16x32_bf16 v[36:39], a[152:155], v[60:63], v[36:39]
    buffer_load_dwordx4 v[196:199], v14, s[40:43], s93 offen offset:0 sc1
    v_mfma_f32_16x16x32_bf16 v[28:31], a[156:159], v[64:67], v[28:31]
    ds_read_b128 v[60:63], v14 offset:21504
    v_mfma_f32_16x16x32_bf16 v[32:35], a[160:163], v[64:67], v[32:35]
    v_mfma_f32_16x16x32_bf16 v[36:39], a[164:167], v[64:67], v[36:39]
    s_waitcnt lgkmcnt(2)
    v_mfma_f32_16x16x32_bf16 v[28:31], a[168:171], v[68:71], v[28:31]
    ds_read_b128 v[64:67], v14 offset:25600
    v_mfma_f32_16x16x32_bf16 v[32:35], a[172:175], v[68:71], v[32:35]
    v_mfma_f32_16x16x32_bf16 v[36:39], a[176:179], v[68:71], v[36:39]
    buffer_load_dwordx4 v[200:203], v14, s[40:43], s93 offen offset:1024 sc1
    v_mfma_f32_16x16x32_bf16 v[28:31], a[180:183], v[52:55], v[28:31]
    ds_read_b128 v[68:71], v14 offset:29696
    v_mfma_f32_16x16x32_bf16 v[32:35], a[184:187], v[52:55], v[32:35]
    v_mfma_f32_16x16x32_bf16 v[36:39], a[188:191], v[52:55], v[36:39]
    s_waitcnt lgkmcnt(2)
    v_mfma_f32_16x16x32_bf16 v[28:31], a[192:195], v[56:59], v[28:31]
    ds_read_b128 v[52:55], v5 offset:2048
    v_mfma_f32_16x16x32_bf16 v[32:35], a[196:199], v[56:59], v[32:35]
    v_mfma_f32_16x16x32_bf16 v[36:39], a[200:203], v[56:59], v[36:39]
    v_mfma_f32_16x16x32_bf16 v[28:31], a[204:207], v[60:63], v[28:31]
    ds_read_b128 v[56:59], v5 offset:6144
    v_mfma_f32_16x16x32_bf16 v[32:35], a[208:211], v[60:63], v[32:35]
    buffer_load_dwordx4 v[204:207], v14, s[40:43], s93 offen offset:2048 sc1
    v_mfma_f32_16x16x32_bf16 v[36:39], a[212:215], v[60:63], v[36:39]
    s_waitcnt lgkmcnt(2)
    v_mfma_f32_16x16x32_bf16 v[28:31], a[216:219], v[64:67], v[28:31]
    ds_read_b128 v[60:63], v5 offset:10240
    v_mfma_f32_16x16x32_bf16 v[32:35], a[220:223], v[64:67], v[32:35]
    v_mfma_f32_16x16x32_bf16 v[36:39], a[224:227], v[64:67], v[36:39]
    v_mfma_f32_16x16x32_bf16 v[28:31], a[228:231], v[68:71], v[28:31]
    ds_read_b128 v[64:67], v5 offset:14336
    v_mfma_f32_16x16x32_bf16 v[32:35], a[232:235], v[68:71], v[32:35]
    buffer_load_dwordx4 v[208:211], v14, s[40:43], s93 offen offset:3072 sc1
    v_mfma_f32_16x16x32_bf16 v[36:39], a[236:239], v[68:71], v[36:39]
    s_add_u32 s93, s93, 4096
    s_waitcnt lgkmcnt(2)
    v_mfma_f32_16x16x32_bf16 v[40:43], a[0:3], v[52:55], 0
    ds_read_b128 v[68:71], v5 offset:18432
    s_nop 0
    v_pk_fma_f32 v[28:29], v[28:29], v[84:85], v[72:73] op_sel:[0,1,0] op_sel_hi:[1,1,1]
    v_pk_fma_f32 v[30:31], v[30:31], v[84:85], v[74:75] op_sel:[0,1,0] op_sel_hi:[1,1,1]
    v_pk_fma_f32 v[32:33], v[32:33], v[84:85], v[76:77] op_sel:[0,1,0] op_sel_hi:[1,1,1]
    v_pk_fma_f32 v[34:35], v[34:35], v[84:85], v[78:79] op_sel:[0,1,0] op_sel_hi:[1,1,1]
    v_pk_fma_f32 v[36:37], v[36:37], v[84:85], v[80:81] op_sel:[0,1,0] op_sel_hi:[1,1,1]
    v_pk_fma_f32 v[38:39], v[38:39], v[84:85], v[82:83] op_sel:[0,1,0] op_sel_hi:[1,1,1]
    v_pk_mul_f32 v[88:89], v[28:29], v[28:29]
    v_pk_mul_f32 v[90:91], v[30:31], v[30:31]
    v_pk_mul_f32 v[92:93], v[32:33], v[32:33]
    v_pk_mul_f32 v[94:95], v[34:35], v[34:35]
    v_pk_mul_f32 v[96:97], v[36:37], v[36:37]
    v_pk_mul_f32 v[98:99], v[38:39], v[38:39]
    v_pk_fma_f32 v[88:89], v[88:89], s[86:87], v[100:101]
    v_pk_fma_f32 v[90:91], v[90:91], s[86:87], v[100:101]
    v_pk_fma_f32 v[92:93], v[92:93], s[86:87], v[100:101]
    v_pk_fma_f32 v[94:95], v[94:95], s[86:87], v[100:101]
    v_pk_fma_f32 v[96:97], v[96:97], s[86:87], v[100:101]
    v_pk_fma_f32 v[98:99], v[98:99], s[86:87], v[100:101]
    v_pk_mul_f32 v[88:89], v[88:89], v[28:29]
    v_pk_mul_f32 v[90:91], v[90:91], v[30:31]
    v_pk_mul_f32 v[92:93], v[92:93], v[32:33]
    v_pk_mul_f32 v[94:95], v[94:95], v[34:35]
    v_pk_mul_f32 v[96:97], v[96:97], v[36:37]
    v_pk_mul_f32 v[98:99], v[98:99], v[38:39]
    v_mfma_f32_16x16x32_bf16 v[44:47], a[4:7], v[52:55], 0
    buffer_load_dwordx4 v[212:215], v14, s[40:43], s93 offen offset:0 sc1
    v_exp_f32 v88, v88
    v_exp_f32 v89, v89
    v_mfma_f32_16x16x32_bf16 v[48:51], a[8:11], v[52:55], 0
    buffer_load_dwordx4 v[216:219], v14, s[40:43], s93 offen offset:1024 sc1
    v_exp_f32 v90, v90
    v_exp_f32 v91, v91
    v_mfma_f32_16x16x32_bf16 v[40:43], a[12:15], v[56:59], v[40:43]
    ds_read_b128 v[52:55], v5 offset:22528
    v_exp_f32 v92, v92
    v_exp_f32 v93, v93
    v_mfma_f32_16x16x32_bf16 v[44:47], a[16:19], v[56:59], v[44:47]
    v_exp_f32 v94, v94
    v_exp_f32 v95, v95
    v_exp_f32 v96, v96
    v_mfma_f32_16x16x32_bf16 v[48:51], a[20:23], v[56:59], v[48:51]
    buffer_load_dwordx4 v[220:223], v14, s[40:43], s93 offen offset:2048 sc1
    v_exp_f32 v97, v97
    v_exp_f32 v98, v98
    s_waitcnt lgkmcnt(1)
    v_mfma_f32_16x16x32_bf16 v[40:43], a[24:27], v[60:63], v[40:43]
    ds_read_b128 v[56:59], v5 offset:26624
    v_exp_f32 v99, v99
    v_add_f32 v88, 1.0, v88
    v_add_f32 v89, 1.0, v89
    v_mfma_f32_16x16x32_bf16 v[44:47], a[28:31], v[60:63], v[44:47]
    v_add_f32 v90, 1.0, v90
    v_add_f32 v91, 1.0, v91
    v_add_f32 v92, 1.0, v92
    v_add_f32 v93, 1.0, v93
    v_add_f32 v94, 1.0, v94
    v_mfma_f32_16x16x32_bf16 v[48:51], a[32:35], v[60:63], v[48:51]
    buffer_load_dwordx4 v[224:227], v14, s[40:43], s93 offen offset:3072 sc1
    v_add_f32 v95, 1.0, v95
    v_add_f32 v96, 1.0, v96
    v_add_f32 v97, 1.0, v97
    v_mfma_f32_16x16x32_bf16 v[40:43], a[36:39], v[64:67], v[40:43]
    ds_read_b128 v[60:63], v5 offset:30720
    v_add_f32 v98, 1.0, v98
    v_add_f32 v99, 1.0, v99
    v_rcp_f32 v88, v88
    v_mfma_f32_16x16x32_bf16 v[44:47], a[40:43], v[64:67], v[44:47]
    s_add_u32 s93, s93, 4096
    v_rcp_f32 v89, v89
    v_rcp_f32 v90, v90
    v_rcp_f32 v91, v91
    v_mfma_f32_16x16x32_bf16 v[48:51], a[44:47], v[64:67], v[48:51]
    v_rcp_f32 v92, v92
    v_rcp_f32 v93, v93
    v_rcp_f32 v94, v94
    v_mfma_f32_16x16x32_bf16 v[40:43], a[48:51], v[68:71], v[40:43]
    ds_read_b128 v[64:67], v5 offset:34816
    v_rcp_f32 v95, v95
    v_mfma_f32_16x16x32_bf16 v[44:47], a[52:55], v[68:71], v[44:47]
    buffer_load_dwordx4 v[228:231], v14, s[40:43], s93 offen offset:0 sc1
    v_mfma_f32_16x16x32_bf16 v[48:51], a[56:59], v[68:71], v[48:51]
    s_waitcnt lgkmcnt(1)
    v_rcp_f32 v96, v96
    v_mfma_f32_16x16x32_bf16 v[40:43], a[60:63], v[52:55], v[40:43]
    ds_read_b128 v[68:71], v5 offset:38912
    v_rcp_f32 v97, v97
    v_mfma_f32_16x16x32_bf16 v[44:47], a[64:67], v[52:55], v[44:47]
    v_rcp_f32 v98, v98
    v_mfma_f32_16x16x32_bf16 v[48:51], a[68:71], v[52:55], v[48:51]
    buffer_load_dwordx4 v[232:235], v14, s[40:43], s93 offen offset:1024 sc1
    v_mfma_f32_16x16x32_bf16 v[40:43], a[72:75], v[56:59], v[40:43]
    ds_read_b128 v[52:55], v5 offset:43008
    v_rcp_f32 v99, v99
    v_mfma_f32_16x16x32_bf16 v[44:47], a[76:79], v[56:59], v[44:47]
    v_mul_f32 v88, v88, v28
    v_mul_f32 v89, v89, v29
    v_mfma_f32_16x16x32_bf16 v[48:51], a[80:83], v[56:59], v[48:51]
    v_mul_f32 v90, v90, v30
    v_mul_f32 v91, v91, v31
    v_mfma_f32_16x16x32_bf16 v[40:43], a[84:87], v[60:63], v[40:43]
    ds_read_b128 v[56:59], v5 offset:47104
    v_mul_f32 v92, v92, v32
    v_mfma_f32_16x16x32_bf16 v[44:47], a[88:91], v[60:63], v[44:47]
    s_waitcnt vmcnt(10)
    s_cmp_lg_u32 s55, 0
    s_cbranch_scc0 L_slow5
    buffer_store_dword v11, v9, s[40:43], 0 offen
L_back5:
    v_mfma_f32_16x16x32_bf16 v[48:51], a[92:95], v[60:63], v[48:51]
    buffer_load_dwordx4 v[236:239], v14, s[40:43], s93 offen offset:2048 sc1
    s_waitcnt lgkmcnt(2)
    v_mfma_f32_16x16x32_bf16 v[40:43], a[96:99], v[64:67], v[40:43]
    ds_read_b128 v[60:63], v14 offset:2048
    v_mul_f32 v93, v93, v33
    v_mfma_f32_16x16x32_bf16 v[44:47], a[100:103], v[64:67], v[44:47]
    v_mul_f32 v94, v94, v34
    v_mul_f32 v95, v95, v35
    v_mfma_f32_16x16x32_bf16 v[48:51], a[104:107], v[64:67], v[48:51]
    v_mul_f32 v96, v96, v36
    v_mul_f32 v97, v97, v37
    v_mfma_f32_16x16x32_bf16 v[40:43], a[108:111], v[68:71], v[40:43]
    ds_read_b128 v[64:67], v14 offset:6144
    v_mul_f32 v98, v98, v38
    v_mfma_f32_16x16x32_bf16 v[44:47], a[112:115], v[68:71], v[44:47]
    v_mul_f32 v99, v99, v39
    v_cvt_pk_bf16_f32 v108, v88, v89
    v_mfma_f32_16x16x32_bf16 v[48:51], a[116:119], v[68:71], v[48:51]
    buffer_load_dwordx4 v[240:243], v14, s[40:43], s93 offen offset:3072 sc1
    s_waitcnt lgkmcnt(2)
    v_mfma_f32_16x16x32_bf16 v[40:43], a[120:123], v[52:55], v[40:43]
    ds_read_b128 v[68:71], v14 offset:10240
    v_cvt_pk_bf16_f32 v109, v90, v91
    v_mfma_f32_16x16x32_bf16 v[44:47], a[124:127], v[52:55], v[44:47]
    s_add_u32 s93, s93, 4096
    v_cvt_pk_bf16_f32 v110, v92, v93
    v_cvt_pk_bf16_f32 v111, v94, v95
    v_mfma_f32_16x16x32_bf16 v[48:51], a[128:131], v[52:55], v[48:51]
    buffer_store_dwordx4 v[108:111], v6, s[40:43], s92 offen sc1
    v_mfma_f32_16x16x32_bf16 v[40:43], a[132:135], v[56:59], v[40:43]
    ds_read_b128 v[52:55], v14 offset:14336
    v_cvt_pk_bf16_f32 v112, v96, v97
    v_mfma_f32_16x16x32_bf16 v[44:47], a[136:139], v[56:59], v[44:47]
    v_cvt_pk_bf16_f32 v113, v98, v99
    v_mul_u32_u24 v28, 272, v3
    v_mfma_f32_16x16x32_bf16 v[48:51], a[140:143], v[56:59], v[48:51]
    buffer_store_dwordx2 v[112:113], v7, s[40:43], s92 offen sc1
    s_waitcnt lgkmcnt(2)
    v_mfma_f32_16x16x32_bf16 v[40:43], a[144:147], v[60:63], v[40:43]
    ds_read_b128 v[56:59], v14 offset:18432
    s_add_u32 s92, s92, 49152
    v_mfma_f32_16x16x32_bf16 v[44:47], a[148:151], v[60:63], v[44:47]
    buffer_load_dwordx4 v[244:247], v14, s[40:43], s93 offen offset:0 sc1
    v_mfma_f32_16x16x32_bf16 v[48:51], a[152:155], v[60:63], v[48:51]
    v_lshl_add_u32 v28, v2, 4, v28
    v_add_u32 v28, s88, v28
    v_mfma_f32_16x16x32_bf16 v[40:43], a[156:159], v[64:67], v[40:43]
    ds_read_b128 v[60:63], v14 offset:22528
    v_min_u32 v31, 39, v1
    v_mfma_f32_16x16x32_bf16 v[44:47], a[160:163], v[64:67], v[44:47]
    s_lshl_b32 s88, s46, 2
    v_mul_u32_u24 v29, 205, v31
    v_lshrrev_b32 v29, 11, v29
    v_mfma_f32_16x16x32_bf16 v[48:51], a[164:167], v[64:67], v[48:51]
    buffer_load_dwordx4 v[248:251], v14, s[40:43], s93 offen offset:1024 sc1
    s_waitcnt lgkmcnt(2)
    v_mfma_f32_16x16x32_bf16 v[40:43], a[168:171], v[68:71], v[40:43]
    ds_read_b128 v[64:67], v14 offset:26624
    v_mul_u32_u24 v30, 10, v29
    v_mfma_f32_16x16x32_bf16 v[44:47], a[172:175], v[68:71], v[44:47]
    buffer_load_dword v13, v10, s[40:43], 0 offen sc1
    v_mfma_f32_16x16x32_bf16 v[48:51], a[176:179], v[68:71], v[48:51]
    v_add_u32 v29, s88, v29
    v_sub_u32 v31, v31, v30
    v_mfma_f32_16x16x32_bf16 v[40:43], a[180:183], v[52:55], v[40:43]
    ds_read_b128 v[68:71], v14 offset:30720
    v_mul_u32_u24 v30, 81920, v29
    v_mfma_f32_16x16x32_bf16 v[44:47], a[184:187], v[52:55], v[44:47]
    s_mul_i32 s88, s50, 160
    v_lshl_add_u32 v30, v31, 4, v30
    v_mul_u32_u24 v31, 544, v31
    v_mfma_f32_16x16x32_bf16 v[48:51], a[188:191], v[52:55], v[48:51]
    buffer_load_dwordx4 v[252:255], v14, s[40:43], s93 offen offset:2048 sc1
    s_waitcnt lgkmcnt(2)
    v_mfma_f32_16x16x32_bf16 v[40:43], a[192:195], v[56:59], v[40:43]
    ds_read_b128 v[52:55], v5 offset:3072
    v_lshl_add_u32 v29, v29, 4, v31
    v_mfma_f32_16x16x32_bf16 v[44:47], a[196:199], v[56:59], v[44:47]
    s_add_u32 s97, s88, s89
    v_mov_b32 v31, 1073741824
    v_cndmask_b32 v30, v31, v30, s[82:83]
    v_mfma_f32_16x16x32_bf16 v[48:51], a[200:203], v[56:59], v[48:51]
    s_add_u32 s98, s97, 0
    v_mfma_f32_16x16x32_bf16 v[40:43], a[204:207], v[60:63], v[40:43]
    ds_read_b128 v[56:59], v5 offset:7168
    v_mfma_f32_16x16x32_bf16 v[44:47], a[208:211], v[60:63], v[44:47]
    v_mfma_f32_16x16x32_bf16 v[48:51], a[212:215], v[60:63], v[48:51]
    buffer_load_dwordx4 a[240:243], v14, s[40:43], s93 offen offset:3072 sc1
    s_waitcnt lgkmcnt(2)
    v_mfma_f32_16x16x32_bf16 v[40:43], a[216:219], v[64:67], v[40:43]
    ds_read_b128 v[60:63], v5 offset:11264
    s_add_u32 s93, s93, 4096
    v_mfma_f32_16x16x32_bf16 v[44:47], a[220:223], v[64:67], v[44:47]
    v_mfma_f32_16x16x32_bf16 v[48:51], a[224:227], v[64:67], v[48:51]
    v_mfma_f32_16x16x32_bf16 v[40:43], a[228:231], v[68:71], v[40:43]
    ds_read_b128 v[64:67], v5 offset:15360
    v_mfma_f32_16x16x32_bf16 v[44:47], a[232:235], v[68:71], v[44:47]
    v_mfma_f32_16x16x32_bf16 v[48:51], a[236:239], v[68:71], v[48:51]
    buffer_load_dwordx4 a[244:247], v14, s[40:43], s93 offen offset:0 sc1
    s_waitcnt lgkmcnt(2)
    v_mfma_f32_16x16x32_bf16 v[16:19], a[0:3], v[52:55], 0
    ds_read_b128 v[68:71], v5 offset:19456
    v_pk_fma_f32 v[40:41], v[40:41], v[86:87], v[72:73] op_sel:[0,0,0] op_sel_hi:[1,0,1]
    v_pk_fma_f32 v[42:43], v[42:43], v[86:87], v[74:75] op_sel:[0,0,0] op_sel_hi:[1,0,1]
    v_pk_fma_f32 v[44:45], v[44:45], v[86:87], v[76:77] op_sel:[0,0,0] op_sel_hi:[1,0,1]
    v_pk_fma_f32 v[46:47], v[46:47], v[86:87], v[78:79] op_sel:[0,0,0] op_sel_hi:[1,0,1]
    v_pk_fma_f32 v[48:49], v[48:49], v[86:87], v[80:81] op_sel:[0,0,0] op_sel_hi:[1,0,1]
    v_pk_fma_f32 v[50:51], v[50:51], v[86:87], v[82:83] op_sel:[0,0,0] op_sel_hi:[1,0,1]
    v_pk_mul_f32 v[88:89], v[40:41], v[40:41]
    v_pk_mul_f32 v[90:91], v[42:43], v[42:43]
    v_pk_mul_f32 v[92:93], v[44:45], v[44:45]
    v_pk_mul_f32 v[94:95], v[46:47], v[46:47]
    v_pk_mul_f32 v[96:97], v[48:49], v[48:49]
    v_pk_mul_f32 v[98:99], v[50:51], v[50:51]
    v_pk_fma_f32 v[88:89], v[88:89], s[86:87], v[100:101]
    v_pk_fma_f32 v[90:91], v[90:91], s[86:87], v[100:101]
    v_pk_fma_f32 v[92:93], v[92:93], s[86:87], v[100:101]
    v_pk_fma_f32 v[94:95], v[94:95], s[86:87], v[100:101]
    v_pk_fma_f32 v[96:97], v[96:97], s[86:87], v[100:101]
    v_pk_fma_f32 v[98:99], v[98:99], s[86:87], v[100:101]
    v_pk_mul_f32 v[88:89], v[88:89], v[40:41]
    v_pk_mul_f32 v[90:91], v[90:91], v[42:43]
    v_pk_mul_f32 v[92:93], v[92:93], v[44:45]
    v_pk_mul_f32 v[94:95], v[94:95], v[46:47]
    v_pk_mul_f32 v[96:97], v[96:97], v[48:49]
    v_pk_mul_f32 v[98:99], v[98:99], v[50:51]
    v_mfma_f32_16x16x32_bf16 v[20:23], a[4:7], v[52:55], 0
    buffer_load_dwordx4 a[248:251], v14, s[40:43], s93 offen offset:1024 sc1
    v_exp_f32 v88, v88
    v_exp_f32 v89, v89
    v_mfma_f32_16x16x32_bf16 v[24:27], a[8:11], v[52:55], 0
    v_exp_f32 v90, v90
    v_exp_f32 v91, v91
    v_exp_f32 v92, v92
    v_mfma_f32_16x16x32_bf16 v[16:19], a[12:15], v[56:59], v[16:19]
    ds_read_b128 v[52:55], v5 offset:23552
    v_exp_f32 v93, v93
    v_exp_f32 v94, v94
    v_mfma_f32_16x16x32_bf16 v[20:23], a[16:19], v[56:59], v[20:23]
    buffer_load_dwordx4 a[252:255], v14, s[40:43], s93 offen offset:2048 sc1
    v_exp_f32 v95, v95
    v_exp_f32 v96, v96
    v_mfma_f32_16x16x32_bf16 v[24:27], a[20:23], v[56:59], v[24:27]
    s_add_u32 s93, s93, 16384
    v_exp_f32 v97, v97
    v_exp_f32 v98, v98
    v_exp_f32 v99, v99
    s_waitcnt lgkmcnt(1)
    v_mfma_f32_16x16x32_bf16 v[16:19], a[24:27], v[60:63], v[16:19]
    ds_read_b128 v[56:59], v5 offset:27648
    v_add_f32 v88, 1.0, v88
    v_add_f32 v89, 1.0, v89
    v_add_f32 v90, 1.0, v90
    v_add_f32 v91, 1.0, v91
    v_mfma_f32_16x16x32_bf16 v[20:23], a[28:31], v[60:63], v[20:23]
    v_add_f32 v92, 1.0, v92
    v_add_f32 v93, 1.0, v93
    v_add_f32 v94, 1.0, v94
    v_add_f32 v95, 1.0, v95
    v_add_f32 v96, 1.0, v96
    v_mfma_f32_16x16x32_bf16 v[24:27], a[32:35], v[60:63], v[24:27]
    v_add_f32 v97, 1.0, v97
    v_add_f32 v98, 1.0, v98
    v_add_f32 v99, 1.0, v99
    v_rcp_f32 v88, v88
    v_mfma_f32_16x16x32_bf16 v[16:19], a[36:39], v[64:67], v[16:19]
    ds_read_b128 v[60:63], v5 offset:31744
    v_rcp_f32 v89, v89
    v_rcp_f32 v90, v90
    v_mfma_f32_16x16x32_bf16 v[20:23], a[40:43], v[64:67], v[20:23]
    v_rcp_f32 v91, v91
    v_rcp_f32 v92, v92
    v_rcp_f32 v93, v93
    v_mfma_f32_16x16x32_bf16 v[24:27], a[44:47], v[64:67], v[24:27]
    v_rcp_f32 v94, v94
    v_rcp_f32 v95, v95
    v_rcp_f32 v96, v96
    v_mfma_f32_16x16x32_bf16 v[16:19], a[48:51], v[68:71], v[16:19]
    ds_read_b128 v[64:67], v5 offset:35840
    v_rcp_f32 v97, v97
    v_rcp_f32 v98, v98
    v_mfma_f32_16x16x32_bf16 v[20:23], a[52:55], v[68:71], v[20:23]
    v_rcp_f32 v99, v99
    v_mul_f32 v88, v88, v40
    v_mul_f32 v89, v89, v41
    v_mul_f32 v90, v90, v42
    v_mfma_f32_16x16x32_bf16 v[24:27], a[56:59], v[68:71], v[24:27]
    v_mul_f32 v91, v91, v43
    v_mul_f32 v92, v92, v44
    v_mul_f32 v93, v93, v45
    v_mul_f32 v94, v94, v46
    v_mul_f32 v95, v95, v47
    s_waitcnt lgkmcnt(1)
    v_mfma_f32_16x16x32_bf16 v[16:19], a[60:63], v[52:55], v[16:19]
    ds_read_b128 v[68:71], v5 offset:39936
    v_mul_f32 v96, v96, v48
    v_mul_f32 v97, v97, v49
    v_mul_f32 v98, v98, v50
    v_mul_f32 v99, v99, v51
    v_mfma_f32_16x16x32_bf16 v[20:23], a[64:67], v[52:55], v[20:23]
    s_waitcnt vmcnt(8)
    s_cmp_lg_u32 s55, 0
    s_cbranch_scc0 L_slow6
    buffer_store_dword v11, v9, s[40:43], s79 offen
L_back6:
    v_cvt_pk_bf16_f32 v102, v88, v89
    v_cvt_pk_bf16_f32 v103, v90, v91
    v_cvt_pk_bf16_f32 v104, v92, v93
    v_mfma_f32_16x16x32_bf16 v[24:27], a[68:71], v[52:55], v[24:27]
    v_cvt_pk_bf16_f32 v105, v94, v95
    v_cvt_pk_bf16_f32 v106, v96, v97
    v_cvt_pk_bf16_f32 v107, v98, v99
    v_mfma_f32_16x16x32_bf16 v[16:19], a[72:75], v[56:59], v[16:19]
    buffer_store_dwordx4 v[102:105], v6, s[40:43], s92 offen sc1
    v_mfma_f32_16x16x32_bf16 v[20:23], a[76:79], v[56:59], v[20:23]
    buffer_store_dwordx2 v[106:107], v7, s[40:43], s92 offen sc1
    v_mfma_f32_16x16x32_bf16 v[24:27], a[80:83], v[56:59], v[24:27]
    ds_read_b128 v[52:55], v5 offset:44032
    s_add_u32 s92, s92, 49152
    v_mfma_f32_16x16x32_bf16 v[16:19], a[84:87], v[60:63], v[16:19]
    ds_read_b128 v[56:59], v5 offset:48128
    v_mfma_f32_16x16x32_bf16 v[20:23], a[88:91], v[60:63], v[20:23]
    ds_read_b128 a[80:83], v12 offset:0
    v_mfma_f32_16x16x32_bf16 v[24:27], a[92:95], v[60:63], v[24:27]
    ds_read_b128 a[84:87], v12 offset:1024
    s_waitcnt vmcnt(8)
    v_cmp_ne_u32 vcc, s47, v13
    s_nop 1
    s_cbranch_vccnz L_spin7
L_got7:
    s_waitcnt lgkmcnt(4)
    v_mfma_f32_16x16x32_bf16 v[16:19], a[96:99], v[64:67], v[16:19]
    ds_read_b128 v[60:63], v14 offset:3072
    v_mfma_f32_16x16x32_bf16 v[20:23], a[100:103], v[64:67], v[20:23]
    buffer_load_dwordx4 a[0:3], v14, s[40:43], s94 offen offset:0 sc1
    v_mfma_f32_16x16x32_bf16 v[24:27], a[104:107], v[64:67], v[24:27]
    buffer_load_dwordx4 a[4:7], v14, s[40:43], s94 offen offset:1024 sc1
    v_mfma_f32_16x16x32_bf16 v[16:19], a[108:111], v[68:71], v[16:19]
    ds_read_b128 v[64:67], v14 offset:7168
    v_mfma_f32_16x16x32_bf16 v[20:23], a[112:115], v[68:71], v[20:23]
    ds_read_b128 a[88:91], v12 offset:2048
    v_mfma_f32_16x16x32_bf16 v[24:27], a[116:119], v[68:71], v[24:27]
    buffer_load_dwordx4 a[8:11], v14, s[40:43], s94 offen offset:2048 sc1
    s_waitcnt lgkmcnt(4)
    v_mfma_f32_16x16x32_bf16 v[16:19], a[120:123], v[52:55], v[16:19]
    ds_read_b128 v[68:71], v14 offset:11264
    v_mfma_f32_16x16x32_bf16 v[20:23], a[124:127], v[52:55], v[20:23]
    ds_read_b128 a[92:95], v12 offset:3072
    v_mfma_f32_16x16x32_bf16 v[24:27], a[128:131], v[52:55], v[24:27]
    ds_read_b128 a[96:99], v12 offset:4096
    v_mfma_f32_16x16x32_bf16 v[16:19], a[132:135], v[56:59], v[16:19]
    ds_read_b128 v[52:55], v14 offset:15360
    v_mfma_f32_16x16x32_bf16 v[20:23], a[136:139], v[56:59], v[20:23]
    buffer_load_dwordx4 a[12:15], v14, s[40:43], s94 offen offset:3072 sc1
    v_mfma_f32_16x16x32_bf16 v[24:27], a[140:143], v[56:59], v[24:27]
    ds_read_b128 a[100:103], v12 offset:5120
    s_add_u32 s94, s94, 4096
    s_waitcnt lgkmcnt(5)
    v_mfma_f32_16x16x32_bf16 v[16:19], a[144:147], v[60:63], v[16:19]
    ds_read_b128 v[56:59], v14 offset:19456
    v_mfma_f32_16x16x32_bf16 v[20:23], a[148:151], v[60:63], v[20:23]
    buffer_load_dwordx4 a[16:19], v14, s[40:43], s94 offen offset:0 sc1
    v_mfma_f32_16x16x32_bf16 v[24:27], a[152:155], v[60:63], v[24:27]
    ds_read_b128 a[104:107], v12 offset:6144
    v_mfma_f32_16x16x32_bf16 v[16:19], a[156:159], v[64:67], v[16:19]
    ds_read_b128 v[60:63], v14 offset:23552
    v_mfma_f32_16x16x32_bf16 v[20:23], a[160:163], v[64:67], v[20:23]
    ds_read_b128 a[108:111], v12 offset:7168
    v_mfma_f32_16x16x32_bf16 v[24:27], a[164:167], v[64:67], v[24:27]
    buffer_load_dwordx4 a[20:23], v14, s[40:43], s94 offen offset:1024 sc1
    s_waitcnt lgkmcnt(5)
    v_mfma_f32_16x16x32_bf16 v[16:19], a[168:171], v[68:71], v[16:19]
    ds_read_b128 v[64:67], v14 offset:27648
    v_mfma_f32_16x16x32_bf16 v[20:23], a[172:175], v[68:71], v[20:23]
    ds_read_b128 a[112:115], v12 offset:8192
    v_mfma_f32_16x16x32_bf16 v[24:27], a[176:179], v[68:71], v[24:27]
    ds_read_b128 a[116:119], v12 offset:9216
    v_mfma_f32_16x16x32_bf16 v[16:19], a[180:183], v[52:55], v[16:19]
    ds_read_b128 v[68:71], v14 offset:31744
    v_mfma_f32_16x16x32_bf16 v[20:23], a[184:187], v[52:55], v[20:23]
    buffer_load_dwordx4 a[24:27], v14, s[40:43], s94 offen offset:2048 sc1
    v_mfma_f32_16x16x32_bf16 v[24:27], a[188:191], v[52:55], v[24:27]
    ds_read_b128 a[120:123], v12 offset:10240
    s_waitcnt lgkmcnt(5)
    v_mfma_f32_16x16x32_bf16 v[16:19], a[192:195], v[56:59], v[16:19]
    ds_read_b128 v[52:55], v4 offset:0
    v_mfma_f32_16x16x32_bf16 v[20:23], a[196:199], v[56:59], v[20:23]
    buffer_load_dwordx4 a[28:31], v14, s[40:43], s94 offen offset:3072 sc1
    v_mfma_f32_16x16x32_bf16 v[24:27], a[200:203], v[56:59], v[24:27]
    ds_read_b128 a[124:127], v12 offset:11264
    s_add_u32 s94, s94, 4096
    v_mfma_f32_16x16x32_bf16 v[16:19], a[204:207], v[60:63], v[16:19]
    ds_read_b128 v[56:59], v4 offset:64
    v_mfma_f32_16x16x32_bf16 v[20:23], a[208:211], v[60:63], v[20:23]
    ds_read_b128 a[128:131], v12 offset:12288
    v_mfma_f32_16x16x32_bf16 v[24:27], a[212:215], v[60:63], v[24:27]
    buffer_load_dword v0, v10, s[40:43], s79 offen sc1
    s_waitcnt lgkmcnt(5)
    v_mfma_f32_16x16x32_bf16 v[16:19], a[216:219], v[64:67], v[16:19]
    buffer_load_dwordx4 a[32:35], v14, s[40:43], s94 offen offset:0 sc1
    v_mfma_f32_16x16x32_bf16 v[20:23], a[220:223], v[64:67], v[20:23]
    ds_read_b128 v[60:63], v4 offset:128
    v_mfma_f32_16x16x32_bf16 v[24:27], a[224:227], v[64:67], v[24:27]
    v_mfma_f32_16x16x32_bf16 v[16:19], a[228:231], v[68:71], v[16:19]
    buffer_load_dwordx4 a[36:39], v14, s[40:43], s94 offen offset:1024 sc1
    v_mfma_f32_16x16x32_bf16 v[20:23], a[232:235], v[68:71], v[20:23]
    ds_read_b128 v[64:67], v4 offset:192
    s_waitcnt lgkmcnt(2)
    s_barrier
    v_mfma_f32_16x16x32_bf16 v[24:27], a[236:239], v[68:71], v[24:27]
    ds_read_b128 v[68:71], v4 offset:256
    buffer_load_dwordx4 a[40:43], v14, s[40:43], s94 offen offset:2048 sc1
    v_pk_fma_f32 v[16:17], v[16:17], v[86:87], v[72:73] op_sel:[0,1,0] op_sel_hi:[1,1,1]
    v_pk_fma_f32 v[18:19], v[18:19], v[86:87], v[74:75] op_sel:[0,1,0] op_sel_hi:[1,1,1]
    v_pk_fma_f32 v[20:21], v[20:21], v[86:87], v[76:77] op_sel:[0,1,0] op_sel_hi:[1,1,1]
    v_pk_fma_f32 v[22:23], v[22:23], v[86:87], v[78:79] op_sel:[0,1,0] op_sel_hi:[1,1,1]
    s_nop 1
    v_pk_fma_f32 v[24:25], v[24:25], v[86:87], v[80:81] op_sel:[0,1,0] op_sel_hi:[1,1,1]
    v_pk_fma_f32 v[26:27], v[26:27], v[86:87], v[82:83] op_sel:[0,1,0] op_sel_hi:[1,1,1]
    v_pk_mul_f32 v[88:89], v[16:17], v[16:17]
    v_pk_mul_f32 v[90:91], v[18:19], v[18:19]
    v_pk_mul_f32 v[92:93], v[20:21], v[20:21]
    v_pk_mul_f32 v[94:95], v[22:23], v[22:23]
    v_pk_mul_f32 v[96:97], v[24:25], v[24:25]
    v_pk_mul_f32 v[98:99], v[26:27], v[26:27]
    v_pk_fma_f32 v[88:89], v[88:89], s[86:87], v[100:101]
    v_pk_fma_f32 v[90:91], v[90:91], s[86:87], v[100:101]
    v_pk_fma_f32 v[92:93], v[92:93], s[86:87], v[100:101]
    v_pk_fma_f32 v[94:95], v[94:95], s[86:87], v[100:101]
    v_pk_fma_f32 v[96:97], v[96:97], s[86:87], v[100:101]
    v_pk_fma_f32 v[98:99], v[98:99], s[86:87], v[100:101]
    v_pk_mul_f32 v[88:89], v[88:89], v[16:17]
    v_pk_mul_f32 v[90:91], v[90:91], v[18:19]
    v_pk_mul_f32 v[92:93], v[92:93], v[20:21]
    v_pk_mul_f32 v[94:95], v[94:95], v[22:23]
    v_pk_mul_f32 v[96:97], v[96:97], v[24:25]
    v_pk_mul_f32 v[98:99], v[98:99], v[26:27]
    buffer_load_dwordx4 a[44:47], v14, s[40:43], s94 offen offset:3072 sc1
    buffer_load_dwordx4 a[48:51], v14, s[40:43], s93 offen offset:0 sc1
    v_exp_f32 v88, v88
    v_exp_f32 v89, v89
    v_exp_f32 v90, v90
    v_exp_f32 v91, v91
    v_exp_f32 v92, v92
    v_exp_f32 v93, v93
    v_exp_f32 v94, v94
    buffer_load_dwordx4 a[52:55], v14, s[40:43], s93 offen offset:1024 sc1
    v_exp_f32 v95, v95
    v_exp_f32 v96, v96
    v_exp_f32 v97, v97
    v_exp_f32 v98, v98
    v_exp_f32 v99, v99
    v_add_f32 v88, 1.0, v88
    v_add_f32 v89, 1.0, v89
    buffer_load_dwordx4 a[56:59], v14, s[40:43], s93 offen offset:2048 sc1
    v_add_f32 v90, 1.0, v90
    v_add_f32 v91, 1.0, v91
    v_add_f32 v92, 1.0, v92
    v_add_f32 v93, 1.0, v93
    v_add_f32 v94, 1.0, v94
    v_add_f32 v95, 1.0, v95
    v_add_f32 v96, 1.0, v96
    v_add_f32 v97, 1.0, v97
    v_add_f32 v98, 1.0, v98
    v_add_f32 v99, 1.0, v99
    v_rcp_f32 v88, v88
    v_rcp_f32 v89, v89
    buffer_load_dwordx4 a[60:63], v14, s[40:43], s93 offen offset:3072 sc1
    v_rcp_f32 v90, v90
    v_rcp_f32 v91, v91
    v_rcp_f32 v92, v92
    v_rcp_f32 v93, v93
    v_rcp_f32 v94, v94
    v_rcp_f32 v95, v95
    v_rcp_f32 v96, v96
    s_waitcnt vmcnt(16)
    v_mfma_f32_16x16x32_bf16 v[52:55], v[116:119], a[0:3], v[52:55]
    s_cmp_lg_u32 s55, 0
    s_cbranch_scc0 L_slow8
    buffer_store_dword v11, v9, s[40:43], s80 offen
L_back8:
    v_rcp_f32 v97, v97
    v_rcp_f32 v98, v98
    v_mfma_f32_16x16x32_bf16 v[56:59], v[120:123], a[0:3], v[56:59]
    s_add_u32 s93, s93, 4096
    buffer_load_dwordx4 a[64:67], v14, s[40:43], s93 offen offset:0 sc1
    v_rcp_f32 v99, v99
    s_waitcnt lgkmcnt(0)
    v_mfma_f32_16x16x32_bf16 v[60:63], v[124:127], a[0:3], v[60:63]
    buffer_load_dwordx4 a[68:71], v14, s[40:43], s93 offen offset:1024 sc1
    v_mul_f32 v88, v88, v16
    v_mul_f32 v89, v89, v17
    v_mul_f32 v90, v90, v18
    v_mfma_f32_16x16x32_bf16 v[64:67], v[128:131], a[0:3], v[64:67]
    s_add_u32 s94, s94, 40960
    v_mul_f32 v91, v91, v19
    v_mul_f32 v92, v92, v20
    v_mul_f32 v93, v93, v21
    v_mul_f32 v94, v94, v22
    v_mul_f32 v95, v95, v23
    v_mfma_f32_16x16x32_bf16 v[68:71], v[132:135], a[0:3], v[68:71]
    buffer_load_dwordx4 a[72:75], v14, s[40:43], s93 offen offset:2048 sc1
    v_mul_f32 v96, v96, v24
    v_mul_f32 v97, v97, v25
    v_mul_f32 v98, v98, v26
    s_waitcnt vmcnt(19)
    v_mfma_f32_16x16x32_bf16 v[52:55], v[136:139], a[4:7], v[52:55]
    v_mul_f32 v99, v99, v27
    v_cvt_pk_bf16_f32 v108, v88, v89
    v_cvt_pk_bf16_f32 v109, v90, v91
    v_cvt_pk_bf16_f32 v110, v92, v93
    v_cvt_pk_bf16_f32 v111, v94, v95
    v_mfma_f32_16x16x32_bf16 v[56:59], v[140:143], a[4:7], v[56:59]
    buffer_store_dwordx4 v[108:111], v6, s[40:43], s92 offen sc1
    v_cvt_pk_bf16_f32 v112, v96, v97
    v_cvt_pk_bf16_f32 v113, v98, v99
    v_add_u32 v4, s96, v4
    v_mfma_f32_16x16x32_bf16 v[60:63], v[144:147], a[4:7], v[60:63]
    ds_read_b128 v[32:35], v4 offset:0
    v_mfma_f32_16x16x32_bf16 v[64:67], v[148:151], a[4:7], v[64:67]
    ds_read_b128 v[36:39], v4 offset:64
    v_mfma_f32_16x16x32_bf16 v[68:71], v[152:155], a[4:7], v[68:71]
    buffer_store_dwordx2 v[112:113], v7, s[40:43], s92 offen sc1
    s_waitcnt vmcnt(20)
    v_mfma_f32_16x16x32_bf16 v[52:55], v[156:159], a[8:11], v[52:55]
    buffer_load_dwordx4 a[76:79], v14, s[40:43], s93 offen offset:3072 sc1
    v_mfma_f32_16x16x32_bf16 v[56:59], v[160:163], a[8:11], v[56:59]
    ds_read_b128 v[40:43], v4 offset:128
    v_mfma_f32_16x16x32_bf16 v[60:63], v[164:167], a[8:11], v[60:63]
    ds_read_b128 v[44:47], v4 offset:192
    v_mfma_f32_16x16x32_bf16 v[64:67], v[168:171], a[8:11], v[64:67]
    ds_read_b128 v[48:51], v4 offset:256
    v_add_u32 v4, s96, v4
    v_mfma_f32_16x16x32_bf16 v[68:71], v[172:175], a[8:11], v[68:71]
    s_waitcnt vmcnt(20)
    v_mfma_f32_16x16x32_bf16 v[52:55], v[176:179], a[12:15], v[52:55]
    v_mfma_f32_16x16x32_bf16 v[56:59], v[180:183], a[12:15], v[56:59]
    s_waitcnt vmcnt(15)
    v_cmp_ne_u32 vcc, s47, v0
    s_nop 1
    s_cbranch_vccnz L_spin9
L_got9:
    v_mfma_f32_16x16x32_bf16 v[60:63], v[184:187], a[12:15], v[60:63]
    buffer_load_dwordx4 a[132:135], v14, s[40:43], s94 offen offset:0 sc1
    v_mfma_f32_16x16x32_bf16 v[64:67], v[188:191], a[12:15], v[64:67]
    buffer_load_dwordx4 a[136:139], v14, s[40:43], s94 offen offset:1024 sc1
    v_mfma_f32_16x16x32_bf16 v[68:71], v[192:195], a[12:15], v[68:71]
    v_mfma_f32_16x16x32_bf16 v[52:55], v[196:199], a[16:19], v[52:55]
    v_mfma_f32_16x16x32_bf16 v[56:59], v[200:203], a[16:19], v[56:59]
    buffer_load_dword v15, v10, s[40:43], s80 offen sc1
    v_mfma_f32_16x16x32_bf16 v[60:63], v[204:207], a[16:19], v[60:63]
    buffer_load_dwordx4 a[140:143], v14, s[40:43], s94 offen offset:2048 sc1
    v_mfma_f32_16x16x32_bf16 v[64:67], v[208:211], a[16:19], v[64:67]
    v_mfma_f32_16x16x32_bf16 v[68:71], v[212:215], a[16:19], v[68:71]
    v_mfma_f32_16x16x32_bf16 v[52:55], v[216:219], a[20:23], v[52:55]
    v_mfma_f32_16x16x32_bf16 v[56:59], v[220:223], a[20:23], v[56:59]
    buffer_load_dwordx4 a[144:147], v14, s[40:43], s94 offen offset:3072 sc1
    v_mfma_f32_16x16x32_bf16 v[60:63], v[224:227], a[20:23], v[60:63]
    s_add_u32 s94, s94, 4096
    v_mfma_f32_16x16x32_bf16 v[64:67], v[228:231], a[20:23], v[64:67]
    v_mfma_f32_16x16x32_bf16 v[68:71], v[232:235], a[20:23], v[68:71]
    v_mfma_f32_16x16x32_bf16 v[52:55], v[236:239], a[24:27], v[52:55]
    buffer_load_dwordx4 a[148:151], v14, s[40:43], s94 offen offset:0 sc1
    v_mfma_f32_16x16x32_bf16 v[56:59], v[240:243], a[24:27], v[56:59]
    v_mfma_f32_16x16x32_bf16 v[60:63], v[244:247], a[24:27], v[60:63]
    v_mfma_f32_16x16x32_bf16 v[64:67], v[248:251], a[24:27], v[64:67]
    v_mfma_f32_16x16x32_bf16 v[68:71], v[252:255], a[24:27], v[68:71]
    buffer_load_dwordx4 a[152:155], v14, s[40:43], s94 offen offset:1024 sc1
    v_mfma_f32_16x16x32_bf16 v[52:55], a[240:243], a[28:31], v[52:55]
    v_mfma_f32_16x16x32_bf16 v[56:59], a[244:247], a[28:31], v[56:59]
    v_mfma_f32_16x16x32_bf16 v[60:63], a[248:251], a[28:31], v[60:63]
    v_mfma_f32_16x16x32_bf16 v[64:67], a[252:255], a[28:31], v[64:67]
    buffer_load_dwordx4 a[156:159], v14, s[40:43], s94 offen offset:2048 sc1
    v_mfma_f32_16x16x32_bf16 v[68:71], a[80:83], a[28:31], v[68:71]
    s_waitcnt vmcnt(14)
    v_mfma_f32_16x16x32_bf16 v[52:55], a[84:87], a[32:35], v[52:55]
    v_mfma_f32_16x16x32_bf16 v[56:59], a[88:91], a[32:35], v[56:59]
    v_mfma_f32_16x16x32_bf16 v[60:63], a[92:95], a[32:35], v[60:63]
    buffer_load_dwordx4 a[160:163], v14, s[40:43], s94 offen offset:3072 sc1
    v_mfma_f32_16x16x32_bf16 v[64:67], a[96:99], a[32:35], v[64:67]
    s_add_u32 s94, s94, 4096
    v_mfma_f32_16x16x32_bf16 v[68:71], a[100:103], a[32:35], v[68:71]
    v_mfma_f32_16x16x32_bf16 v[52:55], a[104:107], a[36:39], v[52:55]
    v_mfma_f32_16x16x32_bf16 v[56:59], a[108:111], a[36:39], v[56:59]
    buffer_load_dwordx4 a[164:167], v14, s[40:43], s94 offen offset:0 sc1
    v_mfma_f32_16x16x32_bf16 v[60:63], a[112:115], a[36:39], v[60:63]
    v_mfma_f32_16x16x32_bf16 v[64:67], a[116:119], a[36:39], v[64:67]
    v_mfma_f32_16x16x32_bf16 v[68:71], a[120:123], a[36:39], v[68:71]
    v_mfma_f32_16x16x32_bf16 v[52:55], a[124:127], a[40:43], v[52:55]
    buffer_load_dwordx4 a[168:171], v14, s[40:43], s94 offen offset:1024 sc1
    v_mfma_f32_16x16x32_bf16 v[56:59], a[128:131], a[40:43], v[56:59]
    v_mfma_f32_16x16x32_bf16 v[60:63], a[48:51], a[40:43], v[60:63]
    v_mfma_f32_16x16x32_bf16 v[64:67], a[52:55], a[40:43], v[64:67]
    v_mfma_f32_16x16x32_bf16 v[68:71], a[56:59], a[40:43], v[68:71]
    buffer_load_dwordx4 a[172:175], v14, s[40:43], s94 offen offset:2048 sc1
    v_mfma_f32_16x16x32_bf16 v[52:55], a[60:63], a[44:47], v[52:55]
    s_waitcnt vmcnt(17)
    v_mfma_f32_16x16x32_bf16 v[56:59], a[64:67], a[44:47], v[56:59]
    s_waitcnt vmcnt(16)
    v_mfma_f32_16x16x32_bf16 v[60:63], a[68:71], a[44:47], v[60:63]
    ds_write_b128 v28, v[52:55] offset:0
    s_waitcnt vmcnt(15)
    v_mfma_f32_16x16x32_bf16 v[64:67], a[72:75], a[44:47], v[64:67]
    buffer_load_dwordx4 a[176:179], v14, s[40:43], s94 offen offset:3072 sc1
    s_add_u32 s94, s94, 40960
    ds_write_b128 v28, v[56:59] offset:1088
    s_nop 0
    ds_write_b128 v28, v[60:63] offset:2176
    s_nop 2
    ds_write_b128 v28, v[64:67] offset:3264
    s_waitcnt vmcnt(14)
    s_cmp_lg_u32 s55, 0
    s_cbranch_scc0 L_slow10
    buffer_store_dword v11, v9, s[40:43], s81 offen
L_back10:
    s_waitcnt vmcnt(14)
    v_mfma_f32_16x16x32_bf16 v[68:71], a[76:79], a[44:47], v[68:71]
    ds_read_b128 v[52:55], v4 offset:0
    ds_read_b128 v[56:59], v4 offset:64
    s_nop 5
    ds_write_b128 v28, v[68:71] offset:4352
    s_waitcnt vmcnt(13) lgkmcnt(4)
    v_mfma_f32_16x16x32_bf16 v[32:35], v[116:119], a[132:135], v[32:35]
    ds_read_b128 v[60:63], v4 offset:128
    v_mfma_f32_16x16x32_bf16 v[36:39], v[120:123], a[132:135], v[36:39]
    v_mfma_f32_16x16x32_bf16 v[40:43], v[124:127], a[132:135], v[40:43]
    ds_read_b128 v[64:67], v4 offset:192
    s_waitcnt vmcnt(11)
    v_cmp_ne_u32 vcc, s47, v15
    s_nop 1
    s_cbranch_vccnz L_spin11
L_got11:
    v_mfma_f32_16x16x32_bf16 v[44:47], v[128:131], a[132:135], v[44:47]
    buffer_load_dwordx4 a[180:183], v14, s[40:43], s94 offen offset:0 sc1
    v_mfma_f32_16x16x32_bf16 v[48:51], v[132:135], a[132:135], v[48:51]
    buffer_load_dwordx4 a[184:187], v14, s[40:43], s94 offen offset:1024 sc1
    v_mfma_f32_16x16x32_bf16 v[32:35], v[136:139], a[136:139], v[32:35]
    ds_read_b128 v[68:71], v4 offset:256
    v_add_u32 v4, s96, v4
    v_mfma_f32_16x16x32_bf16 v[36:39], v[140:143], a[136:139], v[36:39]
    s_waitcnt lgkmcnt(3)
    s_barrier
    v_mfma_f32_16x16x32_bf16 v[40:43], v[144:147], a[136:139], v[40:43]
    v_mfma_f32_16x16x32_bf16 v[44:47], v[148:151], a[136:139], v[44:47]
    ds_read_b128 v[72:75], v29 offset:0
    v_mfma_f32_16x16x32_bf16 v[48:51], v[152:155], a[136:139], v[48:51]
    ds_read_b128 v[76:79], v29 offset:5440
    s_waitcnt vmcnt(12)
    v_mfma_f32_16x16x32_bf16 v[32:35], v[156:159], a[140:143], v[32:35]
    ds_read_b128 v[80:83], v29 offset:10880
    v_mfma_f32_16x16x32_bf16 v[36:39], v[160:163], a[140:143], v[36:39]
    ds_read_b128 v[84:87], v29 offset:16320
    v_mfma_f32_16x16x32_bf16 v[40:43], v[164:167], a[140:143], v[40:43]
    ds_read_b128 v[88:91], v29 offset:272
    v_mfma_f32_16x16x32_bf16 v[44:47], v[168:171], a[140:143], v[44:47]
    buffer_load_dword v13, v10, s[40:43], s81 offen sc1
    v_mfma_f32_16x16x32_bf16 v[48:51], v[172:175], a[140:143], v[48:51]
    buffer_load_dwordx4 a[188:191], v14, s[40:43], s94 offen offset:2048 sc1
    s_waitcnt vmcnt(13)
    v_mfma_f32_16x16x32_bf16 v[32:35], v[176:179], a[144:147], v[32:35]
    buffer_load_dwordx4 a[192:195], v14, s[40:43], s94 offen offset:3072 sc1
    v_mfma_f32_16x16x32_bf16 v[36:39], v[180:183], a[144:147], v[36:39]
    ds_read_b128 v[92:95], v29 offset:5712
    s_add_u32 s94, s94, 4096
    v_mfma_f32_16x16x32_bf16 v[40:43], v[184:187], a[144:147], v[40:43]
    ds_read_b128 v[96:99], v29 offset:11152
    s_waitcnt lgkmcnt(4)
    v_add_f32 v72, v72, v76
    v_mfma_f32_16x16x32_bf16 v[44:47], v[188:191], a[144:147], v[44:47]
    buffer_load_dwordx4 a[196:199], v14, s[40:43], s94 offen offset:0 sc1
    v_mfma_f32_16x16x32_bf16 v[48:51], v[192:195], a[144:147], v[48:51]
    ds_read_b128 v[100:103], v29 offset:16592
    s_waitcnt lgkmcnt(3)
    v_add_f32 v80, v80, v84
    s_waitcnt vmcnt(14)
    v_mfma_f32_16x16x32_bf16 v[32:35], v[196:199], a[148:151], v[32:35]
    v_add_f32 v73, v73, v77
    v_add_f32 v81, v81, v85
    v_mfma_f32_16x16x32_bf16 v[36:39], v[200:203], a[148:151], v[36:39]
    buffer_load_dwordx4 a[200:203], v14, s[40:43], s94 offen offset:1024 sc1
    v_mfma_f32_16x16x32_bf16 v[40:43], v[204:207], a[148:151], v[40:43]
    v_add_f32 v74, v74, v78
    v_add_f32 v82, v82, v86
    v_mfma_f32_16x16x32_bf16 v[44:47], v[208:211], a[148:151], v[44:47]
    v_add_f32 v75, v75, v79
    v_add_f32 v83, v83, v87
    v_mfma_f32_16x16x32_bf16 v[48:51], v[212:215], a[148:151], v[48:51]
    s_waitcnt lgkmcnt(1)
    v_add_f32 v88, v88, v92
    s_waitcnt vmcnt(14)
    v_mfma_f32_16x16x32_bf16 v[32:35], v[216:219], a[152:155], v[32:35]
    buffer_load_dwordx4 a[204:207], v14, s[40:43], s94 offen offset:2048 sc1
    v_mfma_f32_16x16x32_bf16 v[36:39], v[220:223], a[152:155], v[36:39]
    s_waitcnt lgkmcnt(0)
    v_add_f32 v96, v96, v100
    v_mfma_f32_16x16x32_bf16 v[40:43], v[224:227], a[152:155], v[40:43]
    v_add_f32 v89, v89, v93
    v_add_f32 v97, v97, v101
    v_mfma_f32_16x16x32_bf16 v[44:47], v[228:231], a[152:155], v[44:47]
    v_add_f32 v90, v90, v94
    v_add_f32 v98, v98, v102
    v_mfma_f32_16x16x32_bf16 v[48:51], v[232:235], a[152:155], v[48:51]
    buffer_load_dwordx4 a[208:211], v14, s[40:43], s94 offen offset:3072 sc1
    s_waitcnt vmcnt(9)
    v_mfma_f32_16x16x32_bf16 v[32:35], v[236:239], a[156:159], v[32:35]
    s_add_u32 s94, s94, 4096
    v_add_f32 v91, v91, v95
    v_add_f32 v99, v99, v103
    v_mfma_f32_16x16x32_bf16 v[36:39], v[240:243], a[156:159], v[36:39]
    v_add_f32 v72, v72, v80
    v_add_f32 v73, v73, v81
    v_mfma_f32_16x16x32_bf16 v[40:43], v[244:247], a[156:159], v[40:43]
    v_add_f32 v74, v74, v82
    v_add_f32 v75, v75, v83
    v_mfma_f32_16x16x32_bf16 v[44:47], v[248:251], a[156:159], v[44:47]
    buffer_load_dwordx4 a[212:215], v14, s[40:43], s94 offen offset:0 sc1
    v_mfma_f32_16x16x32_bf16 v[48:51], v[252:255], a[156:159], v[48:51]
    v_add_f32 v88, v88, v96
    v_add_f32 v89, v89, v97
    v_mfma_f32_16x16x32_bf16 v[32:35], a[240:243], a[160:163], v[32:35]
    v_add_f32 v90, v90, v98
    v_add_f32 v91, v91, v99
    v_mfma_f32_16x16x32_bf16 v[36:39], a[244:247], a[160:163], v[36:39]
    v_cvt_pk_bf16_f32 v106, v72, v73
    v_cvt_pk_bf16_f32 v107, v74, v75
    v_mfma_f32_16x16x32_bf16 v[40:43], a[248:251], a[160:163], v[40:43]
    buffer_load_dwordx4 a[216:219], v14, s[40:43], s94 offen offset:1024 sc1
    v_mfma_f32_16x16x32_bf16 v[44:47], a[252:255], a[160:163], v[44:47]
    v_cvt_pk_bf16_f32 v108, v88, v89
    v_cvt_pk_bf16_f32 v109, v90, v91
    v_mfma_f32_16x16x32_bf16 v[48:51], a[80:83], a[160:163], v[48:51]
    v_mfma_f32_16x16x32_bf16 v[32:35], a[84:87], a[164:167], v[32:35]
    v_mfma_f32_16x16x32_bf16 v[36:39], a[88:91], a[164:167], v[36:39]
    buffer_load_dwordx4 a[220:223], v14, s[40:43], s94 offen offset:2048 sc1
    v_mfma_f32_16x16x32_bf16 v[40:43], a[92:95], a[164:167], v[40:43]
    v_mfma_f32_16x16x32_bf16 v[44:47], a[96:99], a[164:167], v[44:47]
    v_mfma_f32_16x16x32_bf16 v[48:51], a[100:103], a[164:167], v[48:51]
    v_mfma_f32_16x16x32_bf16 v[32:35], a[104:107], a[168:171], v[32:35]
    buffer_load_dwordx4 a[224:227], v14, s[40:43], s94 offen offset:3072 sc1
    v_mfma_f32_16x16x32_bf16 v[36:39], a[108:111], a[168:171], v[36:39]
    s_add_u32 s94, s94, 40960
    v_mfma_f32_16x16x32_bf16 v[40:43], a[112:115], a[168:171], v[40:43]
    v_mfma_f32_16x16x32_bf16 v[44:47], a[116:119], a[168:171], v[44:47]
    v_mfma_f32_16x16x32_bf16 v[48:51], a[120:123], a[168:171], v[48:51]
    buffer_store_dwordx4 v[106:109], v30, s[28:31], s98 offen
    v_mfma_f32_16x16x32_bf16 v[32:35], a[124:127], a[172:175], v[32:35]
    s_add_u32 s98, s97, 1310720
    v_mfma_f32_16x16x32_bf16 v[36:39], a[128:131], a[172:175], v[36:39]
    v_mfma_f32_16x16x32_bf16 v[40:43], a[48:51], a[172:175], v[40:43]
    v_mfma_f32_16x16x32_bf16 v[44:47], a[52:55], a[172:175], v[44:47]
    v_mfma_f32_16x16x32_bf16 v[48:51], a[56:59], a[172:175], v[48:51]
    v_mfma_f32_16x16x32_bf16 v[32:35], a[60:63], a[176:179], v[32:35]
    v_mfma_f32_16x16x32_bf16 v[36:39], a[64:67], a[176:179], v[36:39]
    v_mfma_f32_16x16x32_bf16 v[40:43], a[68:71], a[176:179], v[40:43]
    ds_write_b128 v28, v[32:35] offset:21760
    v_mfma_f32_16x16x32_bf16 v[44:47], a[72:75], a[176:179], v[44:47]
    ds_write_b128 v28, v[36:39] offset:22848
    v_mfma_f32_16x16x32_bf16 v[48:51], a[76:79], a[176:179], v[48:51]
    s_waitcnt vmcnt(13)
    v_mfma_f32_16x16x32_bf16 v[52:55], v[116:119], a[180:183], v[52:55]
    ds_write_b128 v28, v[40:43] offset:23936
    v_mfma_f32_16x16x32_bf16 v[56:59], v[120:123], a[180:183], v[56:59]
    s_waitcnt vmcnt(11)
    v_cmp_ne_u32 vcc, s47, v13
    s_nop 1
    s_cbranch_vccnz L_spin12
L_got12:
    v_mfma_f32_16x16x32_bf16 v[60:63], v[124:127], a[180:183], v[60:63]
    buffer_load_dwordx4 a[0:3], v14, s[40:43], s94 offen offset:0 sc1
    v_mfma_f32_16x16x32_bf16 v[64:67], v[128:131], a[180:183], v[64:67]
    buffer_load_dwordx4 a[4:7], v14, s[40:43], s94 offen offset:1024 sc1
    v_mfma_f32_16x16x32_bf16 v[68:71], v[132:135], a[180:183], v[68:71]
    ds_read_b128 v[32:35], v4 offset:0
    v_mfma_f32_16x16x32_bf16 v[52:55], v[136:139], a[184:187], v[52:55]
    ds_read_b128 v[36:39], v4 offset:64
    v_mfma_f32_16x16x32_bf16 v[56:59], v[140:143], a[184:187], v[56:59]
    buffer_load_dwordx4 a[8:11], v14, s[40:43], s94 offen offset:2048 sc1
    v_mfma_f32_16x16x32_bf16 v[60:63], v[144:147], a[184:187], v[60:63]
    ds_write_b128 v28, v[44:47] offset:25024
    v_mfma_f32_16x16x32_bf16 v[64:67], v[148:151], a[184:187], v[64:67]
    ds_write_b128 v28, v[48:51] offset:26112
    v_mfma_f32_16x16x32_bf16 v[68:71], v[152:155], a[184:187], v[68:71]
    buffer_load_dwordx4 a[12:15], v14, s[40:43], s94 offen offset:3072 sc1
    s_waitcnt vmcnt(14)
    v_mfma_f32_16x16x32_bf16 v[52:55], v[156:159], a[188:191], v[52:55]
    s_add_u32 s94, s94, 4096
    v_mfma_f32_16x16x32_bf16 v[56:59], v[160:163], a[188:191], v[56:59]
    ds_read_b128 v[40:43], v4 offset:128
    v_mfma_f32_16x16x32_bf16 v[60:63], v[164:167], a[188:191], v[60:63]
    buffer_load_dwordx4 a[16:19], v14, s[40:43], s94 offen offset:0 sc1
    v_mfma_f32_16x16x32_bf16 v[64:67], v[168:171], a[188:191], v[64:67]
    ds_read_b128 v[44:47], v4 offset:192
    v_mfma_f32_16x16x32_bf16 v[68:71], v[172:175], a[188:191], v[68:71]
    ds_read_b128 v[48:51], v4 offset:256
    s_waitcnt vmcnt(14)
    v_mfma_f32_16x16x32_bf16 v[52:55], v[176:179], a[192:195], v[52:55]
    s_waitcnt lgkmcnt(3)
    s_barrier
    v_mfma_f32_16x16x32_bf16 v[56:59], v[180:183], a[192:195], v[56:59]
    buffer_load_dwordx4 a[20:23], v14, s[40:43], s94 offen offset:1024 sc1
    v_mfma_f32_16x16x32_bf16 v[60:63], v[184:187], a[192:195], v[60:63]
    v_mfma_f32_16x16x32_bf16 v[64:67], v[188:191], a[192:195], v[64:67]
    ds_read_b128 v[72:75], v29 offset:21760
    v_mfma_f32_16x16x32_bf16 v[68:71], v[192:195], a[192:195], v[68:71]
    ds_read_b128 v[76:79], v29 offset:27200
    s_waitcnt vmcnt(14)
    v_mfma_f32_16x16x32_bf16 v[52:55], v[196:199], a[196:199], v[52:55]
    buffer_load_dwordx4 a[24:27], v14, s[40:43], s94 offen offset:2048 sc1
    v_mfma_f32_16x16x32_bf16 v[56:59], v[200:203], a[196:199], v[56:59]
    ds_read_b128 v[80:83], v29 offset:32640
    v_mfma_f32_16x16x32_bf16 v[60:63], v[204:207], a[196:199], v[60:63]
    ds_read_b128 v[84:87], v29 offset:38080
    v_mfma_f32_16x16x32_bf16 v[64:67], v[208:211], a[196:199], v[64:67]
    ds_read_b128 v[88:91], v29 offset:22032
    v_mfma_f32_16x16x32_bf16 v[68:71], v[212:215], a[196:199], v[68:71]
    buffer_load_dwordx4 a[28:31], v14, s[40:43], s94 offen offset:3072 sc1
    s_waitcnt vmcnt(15)
    v_mfma_f32_16x16x32_bf16 v[52:55], v[216:219], a[200:203], v[52:55]
    ds_read_b128 v[92:95], v29 offset:27472
    s_add_u32 s94, s94, 4096
    v_mfma_f32_16x16x32_bf16 v[56:59], v[220:223], a[200:203], v[56:59]
    ds_read_b128 v[96:99], v29 offset:32912
    s_waitcnt lgkmcnt(5)
    v_add_f32 v72, v72, v76
    v_mfma_f32_16x16x32_bf16 v[60:63], v[224:227], a[200:203], v[60:63]
    buffer_load_dwordx4 a[32:35], v14, s[40:43], s94 offen offset:0 sc1
    v_mfma_f32_16x16x32_bf16 v[64:67], v[228:231], a[200:203], v[64:67]
    ds_read_b128 v[100:103], v29 offset:38352
    s_waitcnt lgkmcnt(4)
    v_add_f32 v80, v80, v84
    v_mfma_f32_16x16x32_bf16 v[68:71], v[232:235], a[200:203], v[68:71]
    s_waitcnt vmcnt(15)
    v_add_f32 v73, v73, v77
    v_add_f32 v81, v81, v85
    v_mfma_f32_16x16x32_bf16 v[52:55], v[236:239], a[204:207], v[52:55]
    v_add_f32 v74, v74, v78
    v_add_f32 v82, v82, v86
    v_mfma_f32_16x16x32_bf16 v[56:59], v[240:243], a[204:207], v[56:59]
    buffer_load_dwordx4 a[36:39], v14, s[40:43], s94 offen offset:1024 sc1
    v_mfma_f32_16x16x32_bf16 v[60:63], v[244:247], a[204:207], v[60:63]
    v_add_f32 v75, v75, v79
    v_add_f32 v83, v83, v87
    v_mfma_f32_16x16x32_bf16 v[64:67], v[248:251], a[204:207], v[64:67]
    s_waitcnt lgkmcnt(1)
    v_add_f32 v88, v88, v92
    v_mfma_f32_16x16x32_bf16 v[68:71], v[252:255], a[204:207], v[68:71]
    s_waitcnt lgkmcnt(0)
    v_add_f32 v96, v96, v100
    s_waitcnt vmcnt(15)
    v_mfma_f32_16x16x32_bf16 v[52:55], a[240:243], a[208:211], v[52:55]
    buffer_load_dwordx4 a[40:43], v14, s[40:43], s94 offen offset:2048 sc1
    v_mfma_f32_16x16x32_bf16 v[56:59], a[244:247], a[208:211], v[56:59]
    v_add_f32 v89, v89, v93
    v_add_f32 v97, v97, v101
    v_mfma_f32_16x16x32_bf16 v[60:63], a[248:251], a[208:211], v[60:63]
    v_add_f32 v90, v90, v94
    v_add_f32 v98, v98, v102
    v_mfma_f32_16x16x32_bf16 v[64:67], a[252:255], a[208:211], v[64:67]
    v_add_f32 v91, v91, v95
    v_add_f32 v99, v99, v103
    v_mfma_f32_16x16x32_bf16 v[68:71], a[80:83], a[208:211], v[68:71]
    buffer_load_dwordx4 a[44:47], v14, s[40:43], s94 offen offset:3072 sc1
    s_waitcnt vmcnt(16)
    v_mfma_f32_16x16x32_bf16 v[52:55], a[84:87], a[212:215], v[52:55]
    v_add_f32 v72, v72, v80
    v_add_f32 v73, v73, v81
    v_mfma_f32_16x16x32_bf16 v[56:59], a[88:91], a[212:215], v[56:59]
    v_add_f32 v74, v74, v82
    v_add_f32 v75, v75, v83
    v_mfma_f32_16x16x32_bf16 v[60:63], a[92:95], a[212:215], v[60:63]
    v_add_f32 v88, v88, v96
    v_add_f32 v89, v89, v97
    v_mfma_f32_16x16x32_bf16 v[64:67], a[96:99], a[212:215], v[64:67]
    v_add_f32 v90, v90, v98
    v_add_f32 v91, v91, v99
    v_mfma_f32_16x16x32_bf16 v[68:71], a[100:103], a[212:215], v[68:71]
    s_waitcnt vmcnt(15)
    v_cvt_pk_bf16_f32 v106, v72, v73
    v_cvt_pk_bf16_f32 v107, v74, v75
    v_mfma_f32_16x16x32_bf16 v[52:55], a[104:107], a[216:219], v[52:55]
    v_cvt_pk_bf16_f32 v108, v88, v89
    v_cvt_pk_bf16_f32 v109, v90, v91
    v_mfma_f32_16x16x32_bf16 v[56:59], a[108:111], a[216:219], v[56:59]
    buffer_store_dwordx4 v[106:109], v30, s[28:31], s98 offen
    v_mfma_f32_16x16x32_bf16 v[60:63], a[112:115], a[216:219], v[60:63]
    s_add_u32 s98, s97, 1280
    v_mfma_f32_16x16x32_bf16 v[64:67], a[116:119], a[216:219], v[64:67]
    v_mfma_f32_16x16x32_bf16 v[68:71], a[120:123], a[216:219], v[68:71]
    s_waitcnt vmcnt(15)
    v_mfma_f32_16x16x32_bf16 v[52:55], a[124:127], a[220:223], v[52:55]
    v_mfma_f32_16x16x32_bf16 v[56:59], a[128:131], a[220:223], v[56:59]
    v_mfma_f32_16x16x32_bf16 v[60:63], a[48:51], a[220:223], v[60:63]
    v_mfma_f32_16x16x32_bf16 v[64:67], a[52:55], a[220:223], v[64:67]
    v_mfma_f32_16x16x32_bf16 v[68:71], a[56:59], a[220:223], v[68:71]
    s_waitcnt vmcnt(14)
    v_mfma_f32_16x16x32_bf16 v[52:55], a[60:63], a[224:227], v[52:55]
    v_mfma_f32_16x16x32_bf16 v[56:59], a[64:67], a[224:227], v[56:59]
    v_mfma_f32_16x16x32_bf16 v[60:63], a[68:71], a[224:227], v[60:63]
    ds_write_b128 v28, v[52:55] offset:0
    v_mfma_f32_16x16x32_bf16 v[64:67], a[72:75], a[224:227], v[64:67]
    ds_write_b128 v28, v[56:59] offset:1088
    v_mfma_f32_16x16x32_bf16 v[68:71], a[76:79], a[224:227], v[68:71]
    s_waitcnt vmcnt(12)
    v_mfma_f32_16x16x32_bf16 v[32:35], v[116:119], a[0:3], v[32:35]
    ds_write_b128 v28, v[60:63] offset:2176
    v_mfma_f32_16x16x32_bf16 v[36:39], v[120:123], a[0:3], v[36:39]
    v_mfma_f32_16x16x32_bf16 v[40:43], v[124:127], a[0:3], v[40:43]
    v_mfma_f32_16x16x32_bf16 v[44:47], v[128:131], a[0:3], v[44:47]
    ds_write_b128 v28, v[64:67] offset:3264
    v_mfma_f32_16x16x32_bf16 v[48:51], v[132:135], a[0:3], v[48:51]
    s_waitcnt vmcnt(11)
    v_mfma_f32_16x16x32_bf16 v[32:35], v[136:139], a[4:7], v[32:35]
    ds_write_b128 v28, v[68:71] offset:4352
    v_mfma_f32_16x16x32_bf16 v[36:39], v[140:143], a[4:7], v[36:39]
    v_mfma_f32_16x16x32_bf16 v[40:43], v[144:147], a[4:7], v[40:43]
    v_mfma_f32_16x16x32_bf16 v[44:47], v[148:151], a[4:7], v[44:47]
    v_mfma_f32_16x16x32_bf16 v[48:51], v[152:155], a[4:7], v[48:51]
    s_waitcnt vmcnt(10)
    v_mfma_f32_16x16x32_bf16 v[32:35], v[156:159], a[8:11], v[32:35]
    v_mfma_f32_16x16x32_bf16 v[36:39], v[160:163], a[8:11], v[36:39]
    v_mfma_f32_16x16x32_bf16 v[40:43], v[164:167], a[8:11], v[40:43]
    s_waitcnt lgkmcnt(0)
    s_barrier
    v_mfma_f32_16x16x32_bf16 v[44:47], v[168:171], a[8:11], v[44:47]
    v_mfma_f32_16x16x32_bf16 v[48:51], v[172:175], a[8:11], v[48:51]
    s_waitcnt vmcnt(9)
    v_mfma_f32_16x16x32_bf16 v[32:35], v[176:179], a[12:15], v[32:35]
    ds_read_b128 v[72:75], v29 offset:0
    v_mfma_f32_16x16x32_bf16 v[36:39], v[180:183], a[12:15], v[36:39]
    ds_read_b128 v[76:79], v29 offset:5440
    v_mfma_f32_16x16x32_bf16 v[40:43], v[184:187], a[12:15], v[40:43]
    ds_read_b128 v[80:83], v29 offset:10880
    v_mfma_f32_16x16x32_bf16 v[44:47], v[188:191], a[12:15], v[44:47]
    ds_read_b128 v[84:87], v29 offset:16320
    v_mfma_f32_16x16x32_bf16 v[48:51], v[192:195], a[12:15], v[48:51]
    ds_read_b128 v[88:91], v29 offset:272
    s_waitcnt vmcnt(8)
    v_mfma_f32_16x16x32_bf16 v[32:35], v[196:199], a[16:19], v[32:35]
    ds_read_b128 v[92:95], v29 offset:5712
    v_mfma_f32_16x16x32_bf16 v[36:39], v[200:203], a[16:19], v[36:39]
    ds_read_b128 v[96:99], v29 offset:11152
    v_mfma_f32_16x16x32_bf16 v[40:43], v[204:207], a[16:19], v[40:43]
    ds_read_b128 v[100:103], v29 offset:16592
    s_waitcnt lgkmcnt(6)
    v_add_f32 v72, v72, v76
    v_mfma_f32_16x16x32_bf16 v[44:47], v[208:211], a[16:19], v[44:47]
    v_add_f32 v73, v73, v77
    v_add_f32 v74, v74, v78
    v_mfma_f32_16x16x32_bf16 v[48:51], v[212:215], a[16:19], v[48:51]
    s_waitcnt lgkmcnt(4)
    v_add_f32 v80, v80, v84
    s_waitcnt vmcnt(7)
    v_mfma_f32_16x16x32_bf16 v[32:35], v[216:219], a[20:23], v[32:35]
    v_add_f32 v81, v81, v85
    v_add_f32 v82, v82, v86
    v_mfma_f32_16x16x32_bf16 v[36:39], v[220:223], a[20:23], v[36:39]
    v_add_f32 v75, v75, v79
    v_add_f32 v83, v83, v87
    v_mfma_f32_16x16x32_bf16 v[40:43], v[224:227], a[20:23], v[40:43]
    s_waitcnt lgkmcnt(2)
    v_add_f32 v88, v88, v92
    v_mfma_f32_16x16x32_bf16 v[44:47], v[228:231], a[20:23], v[44:47]
    s_waitcnt lgkmcnt(0)
    v_add_f32 v96, v96, v100
    v_mfma_f32_16x16x32_bf16 v[48:51], v[232:235], a[20:23], v[48:51]
    s_waitcnt vmcnt(6)
    v_add_f32 v89, v89, v93
    v_add_f32 v97, v97, v101
    v_mfma_f32_16x16x32_bf16 v[32:35], v[236:239], a[24:27], v[32:35]
    v_add_f32 v90, v90, v94
    v_add_f32 v98, v98, v102
    v_mfma_f32_16x16x32_bf16 v[36:39], v[240:243], a[24:27], v[36:39]
    v_add_f32 v91, v91, v95
    v_add_f32 v99, v99, v103
    v_mfma_f32_16x16x32_bf16 v[40:43], v[244:247], a[24:27], v[40:43]
    v_add_f32 v72, v72, v80
    v_add_f32 v73, v73, v81
    v_mfma_f32_16x16x32_bf16 v[44:47], v[248:251], a[24:27], v[44:47]
    v_add_f32 v74, v74, v82
    v_add_f32 v75, v75, v83
    v_mfma_f32_16x16x32_bf16 v[48:51], v[252:255], a[24:27], v[48:51]
    s_waitcnt vmcnt(5)
    v_add_f32 v88, v88, v96
    v_add_f32 v89, v89, v97
    v_mfma_f32_16x16x32_bf16 v[32:35], a[240:243], a[28:31], v[32:35]
    v_add_f32 v90, v90, v98
    v_add_f32 v91, v91, v99
    v_mfma_f32_16x16x32_bf16 v[36:39], a[244:247], a[28:31], v[36:39]
    v_cvt_pk_bf16_f32 v106, v72, v73
    v_cvt_pk_bf16_f32 v107, v74, v75
    v_mfma_f32_16x16x32_bf16 v[40:43], a[248:251], a[28:31], v[40:43]
    v_cvt_pk_bf16_f32 v108, v88, v89
    v_cvt_pk_bf16_f32 v109, v90, v91
    v_mfma_f32_16x16x32_bf16 v[44:47], a[252:255], a[28:31], v[44:47]
    buffer_store_dwordx4 v[106:109], v30, s[28:31], s98 offen
    v_mfma_f32_16x16x32_bf16 v[48:51], a[80:83], a[28:31], v[48:51]
    s_add_u32 s98, s97, 1312000
    s_waitcnt vmcnt(5)
    v_mfma_f32_16x16x32_bf16 v[32:35], a[84:87], a[32:35], v[32:35]
    s_waitcnt vmcnt(4)
    v_mfma_f32_16x16x32_bf16 v[32:35], a[104:107], a[36:39], v[32:35]
    s_waitcnt vmcnt(3)
    v_mfma_f32_16x16x32_bf16 v[32:35], a[124:127], a[40:43], v[32:35]
    s_waitcnt vmcnt(2)
    v_mfma_f32_16x16x32_bf16 v[32:35], a[60:63], a[44:47], v[32:35]
    v_mfma_f32_16x16x32_bf16 v[36:39], a[88:91], a[32:35], v[36:39]
    v_mfma_f32_16x16x32_bf16 v[36:39], a[108:111], a[36:39], v[36:39]
    ds_write_b128 v28, v[32:35] offset:21760
    v_mfma_f32_16x16x32_bf16 v[36:39], a[128:131], a[40:43], v[36:39]
    v_mfma_f32_16x16x32_bf16 v[36:39], a[64:67], a[44:47], v[36:39]
    v_mfma_f32_16x16x32_bf16 v[40:43], a[92:95], a[32:35], v[40:43]
    v_mfma_f32_16x16x32_bf16 v[40:43], a[112:115], a[36:39], v[40:43]
    ds_write_b128 v28, v[36:39] offset:22848
    v_mfma_f32_16x16x32_bf16 v[40:43], a[48:51], a[40:43], v[40:43]
    v_mfma_f32_16x16x32_bf16 v[40:43], a[68:71], a[44:47], v[40:43]
    v_mfma_f32_16x16x32_bf16 v[44:47], a[96:99], a[32:35], v[44:47]
    v_mfma_f32_16x16x32_bf16 v[44:47], a[116:119], a[36:39], v[44:47]
    ds_write_b128 v28, v[40:43] offset:23936
    v_mfma_f32_16x16x32_bf16 v[44:47], a[52:55], a[40:43], v[44:47]
    v_mfma_f32_16x16x32_bf16 v[44:47], a[72:75], a[44:47], v[44:47]
    v_mfma_f32_16x16x32_bf16 v[48:51], a[100:103], a[32:35], v[48:51]
    v_mfma_f32_16x16x32_bf16 v[48:51], a[120:123], a[36:39], v[48:51]
    ds_write_b128 v28, v[44:47] offset:25024
    v_mfma_f32_16x16x32_bf16 v[48:51], a[56:59], a[40:43], v[48:51]
    v_mfma_f32_16x16x32_bf16 v[48:51], a[76:79], a[44:47], v[48:51]
    s_nop 7
    ds_write_b128 v28, v[48:51] offset:26112
    s_waitcnt lgkmcnt(0)
    s_barrier
    ds_read_b128 v[72:75], v29 offset:21760
    ds_read_b128 v[76:79], v29 offset:27200
    ds_read_b128 v[80:83], v29 offset:32640
    ds_read_b128 v[84:87], v29 offset:38080
    ds_read_b128 v[88:91], v29 offset:22032
    ds_read_b128 v[92:95], v29 offset:27472
    ds_read_b128 v[96:99], v29 offset:32912
    ds_read_b128 v[100:103], v29 offset:38352
    s_waitcnt lgkmcnt(6)
    v_add_f32 v72, v72, v76
    v_add_f32 v73, v73, v77
    v_add_f32 v74, v74, v78
    v_add_f32 v75, v75, v79
    s_waitcnt lgkmcnt(4)
    v_add_f32 v80, v80, v84
    v_add_f32 v81, v81, v85
    v_add_f32 v82, v82, v86
    v_add_f32 v83, v83, v87
    v_add_f32 v72, v72, v80
    v_add_f32 v73, v73, v81
    v_add_f32 v74, v74, v82
    s_waitcnt lgkmcnt(2)
    v_add_f32 v88, v88, v92
    v_add_f32 v89, v89, v93
    v_add_f32 v90, v90, v94
    v_add_f32 v91, v91, v95
    v_add_f32 v75, v75, v83
    v_cvt_pk_bf16_f32 v106, v72, v73
    v_cvt_pk_bf16_f32 v107, v74, v75
    s_waitcnt lgkmcnt(0)
    v_add_f32 v96, v96, v100
    v_add_f32 v97, v97, v101
    v_add_f32 v98, v98, v102
    v_add_f32 v99, v99, v103
    v_add_f32 v88, v88, v96
    v_add_f32 v89, v89, v97
    v_add_f32 v90, v90, v98
    v_add_f32 v91, v91, v99
    v_cvt_pk_bf16_f32 v108, v88, v89
    v_cvt_pk_bf16_f32 v109, v90, v91
    buffer_store_dwordx4 v[106:109], v30, s[28:31], s98 offen
    s_nop 1
L_end:
    s_endpgm
L_spin1:
    s_mov_b32 s52, 0
    buffer_load_dword v10, v63, s[40:43], 0 offen sc1
    s_sleep 4
    buffer_load_dword v61, v63, s[40:43], 0 offen sc1
L_poll1:
    s_sleep 4
    buffer_load_dword v62, v63, s[40:43], 0 offen sc1
    s_waitcnt vmcnt(2)
    v_cmp_ne_u32 vcc, s47, v10
    s_add_u32 s52, s52, 1
    s_nop 0
    s_cbranch_vccz L_out1
    s_sleep 4
    buffer_load_dword v10, v63, s[40:43], 0 offen sc1
    s_waitcnt vmcnt(2)
    v_cmp_ne_u32 vcc, s47, v61
    s_add_u32 s52, s52, 1
    s_nop 0
    s_cbranch_vccz L_out1
    s_sleep 4
    buffer_load_dword v61, v63, s[40:43], 0 offen sc1
    s_waitcnt vmcnt(2)
    v_cmp_ne_u32 vcc, s47, v62
    s_add_u32 s52, s52, 1
    s_nop 0
    s_cbranch_vccz L_out1
    s_cmp_le_u32 s52, 1200000
    s_cbranch_scc1 L_poll1
L_out1:
    s_nop 4
    s_branch L_got1
L_spin2:
    s_mov_b32 s52, 0
L_poll2:
    s_sleep 1
    buffer_load_dword v12, v9, s[40:43], 0 offen sc1
    s_waitcnt vmcnt(0)
    s_add_u32 s52, s52, 1
    v_cmp_ne_u32 vcc, s47, v12
    s_cmp_gt_u32 s52, 400000
    s_cbranch_scc1 L_out2
    s_nop 0
    s_cbranch_vccnz L_poll2
L_out2:
    s_nop 4
    s_branch L_got2
L_spin3:
    s_mov_b32 s52, 0
L_poll3:
    s_sleep 1
    buffer_load_dword v13, v11, s[40:43], 0 offen sc1
    s_waitcnt vmcnt(0)
    s_add_u32 s52, s52, 1
    v_cmp_ne_u32 vcc, s47, v13
    s_cmp_gt_u32 s52, 400000
    s_cbranch_scc1 L_out3
    s_nop 0
    s_cbranch_vccnz L_poll3
L_out3:
    s_nop 4
    s_branch L_got3
L_spin4:
    s_mov_b32 s52, 0
    buffer_load_dword v182, v4, s[40:43], 0 offen sc1
    s_sleep 4
    buffer_load_dword v180, v4, s[40:43], 0 offen sc1
L_poll4:
    s_sleep 4
    buffer_load_dword v181, v4, s[40:43], 0 offen sc1
    s_waitcnt vmcnt(2)
    v_cmp_ne_u32 vcc, s47, v182
    s_add_u32 s52, s52, 1
    s_nop 0
    s_cbranch_vccz L_out4
    s_sleep 4
    buffer_load_dword v182, v4, s[40:43], 0 offen sc1
    s_waitcnt vmcnt(2)
    v_cmp_ne_u32 vcc, s47, v180
    s_add_u32 s52, s52, 1
    s_nop 0
    s_cbranch_vccz L_out4
    s_sleep 4
    buffer_load_dword v180, v4, s[40:43], 0 offen sc1
    s_waitcnt vmcnt(2)
    v_cmp_ne_u32 vcc, s47, v181
    s_add_u32 s52, s52, 1
    s_nop 0
    s_cbranch_vccz L_out4
    s_cmp_le_u32 s52, 1200000
    s_cbranch_scc1 L_poll4
L_out4:
    s_nop 4
    s_branch L_got4
L_slow5:
    buffer_store_dword v11, v9, s[40:43], 0 offen sc1
    s_branch L_back5
L_slow6:
    buffer_store_dword v11, v9, s[40:43], s79 offen sc1
    s_branch L_back6
L_spin7:
    s_mov_b32 s52, 0
L_poll7:
    s_sleep 1
    buffer_load_dword v13, v10, s[40:43], 0 offen sc1
    s_waitcnt vmcnt(0)
    s_add_u32 s52, s52, 1
    v_cmp_ne_u32 vcc, s47, v13
    s_cmp_gt_u32 s52, 400000
    s_cbranch_scc1 L_out7
    s_nop 0
    s_cbranch_vccnz L_poll7
L_out7:
    s_nop 4
    s_branch L_got7
L_slow8:
    buffer_store_dword v11, v9, s[40:43], s80 offen sc1
    s_branch L_back8
L_spin9:
    s_mov_b32 s52, 0
L_poll9:
    s_sleep 1
    buffer_load_dword v0, v10, s[40:43], s79 offen sc1
    s_waitcnt vmcnt(0)
    s_add_u32 s52, s52, 1
    v_cmp_ne_u32 vcc, s47, v0
    s_cmp_gt_u32 s52, 400000
    s_cbranch_scc1 L_out9
    s_nop 0
    s_cbranch_vccnz L_poll9
L_out9:
    s_nop 4
    s_branch L_got9
L_slow10:
    buffer_store_dword v11, v9, s[40:43], s81 offen sc1
    s_branch L_back10
L_spin11:
    s_mov_b32 s52, 0
L_poll11:
    s_sleep 1
    buffer_load_dword v15, v10, s[40:43], s80 offen sc1
    s_waitcnt vmcnt(0)
    s_add_u32 s52, s52, 1
    v_cmp_ne_u32 vcc, s47, v15
    s_cmp_gt_u32 s52, 400000
    s_cbranch_scc1 L_out11
    s_nop 0
    s_cbranch_vccnz L_poll11
L_out11:
    s_nop 4
    s_branch L_got11
L_spin12:
    s_mov_b32 s52, 0
L_poll12:
    s_sleep 1
    buffer_load_dword v13, v10, s[40:43], s81 offen sc1
    s_waitcnt vmcnt(0)
    s_add_u32 s52, s52, 1
    v_cmp_ne_u32 vcc, s47, v13
    s_cmp_gt_u32 s52, 400000
    s_cbranch_scc1 L_out12
    s_nop 0
    s_cbranch_vccnz L_poll12
L_out12:
    s_nop 4
    s_branch L_got12
.p2align 8
.type L_dft,@object
L_dft:
.long 0x3f803f80,0x3f803f80,0x3f803f80,0x3f803f80
.long 0x3f7f3f80,0x3f753f7b,0xbdc9248d,0xbe95be48
.long 0x3f7b3f80,0x3f553f6d,0xbf7bbf80,0xbf55bf6d
.long 0x3f753f80,0x3f223f55,0x3e95a554,0x3f463f0e
.long 0x3f6d3f80,0x3ec43f35,0x3f6d3f80,0x3ec43f35
.long 0x3f623f80,0x3dc93f0e,0xbef1248d,0xbf7fbf55
.long 0x3f553f80,0xbe483ec4,0xbf55bf80,0x3e48bec4
.long 0x3f463f80,0xbef13e48,0x3f22a554,0x3f623f7b
.long 0x3f353f80,0xbf35248d,0x3f353f80,0xbf35248d
.long 0x3f223f80,0xbf62be48,0xbf46248d,0xbef1bf7b
.long 0x3f0e3f80,0xbf7bbec4,0xbf0ebf80,0x3f7b3ec4
.long 0x3ef13f80,0xbf7fbf0e,0x3f62a554,0xbdc93f55
.long 0x3ec43f80,0xbf6dbf35,0x3ec43f80,0xbf6dbf35
.long 0x3e953f80,0xbf46bf55,0xbf75248d,0x3f22bf0e
.long 0x3e483f80,0xbf0ebf6d,0xbe48bf80,0x3f0e3f6d
.long 0x3dc93f80,0xbe95bf7b,0x3f7fa554,0xbf753e48
.long 0x3f803f80,0x3f803f80,0x3f803f80,0x3f803f80
.long 0x3f623f6d,0x3f463f55,0xbef1bec4,0xbf22bf0e
.long 0x3f0e3f35,0x3e483ec4,0xbf0ebf35,0xbe48bec4
.long 0x3dc93ec4,0xbef1be48,0x3f7f3f6d,0x3f623f7b
.long 0xbec4248d,0xbf6dbf35,0xbec4248d,0xbf6dbf35
.long 0xbf46bec4,0xbf75bf7b,0xbf22bf6d,0x3e95be48
.long 0xbf7bbf35,0xbf0ebf6d,0x3f7b3f35,0x3f0e3f6d
.long 0xbf75bf6d,0x3dc9bf0e,0xbe953ec4,0xbf7fbf55
.long 0xbf35bf80,0x3f35a554,0xbf35bf80,0x3f35a554
.long 0xbe95bf6d,0x3f7f3f0e,0x3f753ec4,0x3dc93f55
.long 0x3e48bf35,0x3f553f6d,0xbe483f35,0xbf55bf6d
.long 0x3f22bec4,0x3e953f7b,0xbf46bf6d,0x3f753e48
.long 0x3f6da554,0xbec43f35,0x3f6da554,0xbec43f35
.long 0x3f7f3ec4,0xbf623e48,0xbdc93f6d,0xbef1bf7b
.long 0x3f553f35,0xbf7bbec4,0xbf55bf35,0x3f7b3ec4
.long 0x3ef13f6d,0xbf22bf55,0x3f62bec4,0xbf463f0e
.long 0x3f803f80,0x3f803f80,0x3f803f80,0x3f803f80
.long 0x3f223f35,0x3ef13f0e,0xbf46bf35,0xbf62bf55
.long 0xbe48248d,0xbf0ebec4,0x3e48a554,0x3f0e3ec4
.long 0xbf62bf35,0xbf7fbf7b,0x3ef13f35,0xbdc93e48
.long 0xbf6dbf80,0xbec4bf35,0xbf6dbf80,0xbec4bf35
.long 0xbe95bf35,0x3f223e48,0x3f753f35,0x3f463f7b
.long 0x3f0ea554,0x3f7b3f6d,0xbf0e248d,0xbf7bbf6d
.long 0x3f7f3f35,0x3e953f55,0xbdc9bf35,0x3f753f0e
.long 0x3f353f80,0xbf35248d,0x3f353f80,0xbf35248d
.long 0xbdc93f35,0xbf75bf55,0xbf7fbf35,0x3e95bf0e
.long 0xbf55248d,0xbe48bf6d,0x3f55a554,0x3e483f6d
.long 0xbf75bf35,0x3f46be48,0xbe953f35,0xbf22bf7b
.long 0xbec4bf80,0x3f6d3f35,0xbec4bf80,0x3f6d3f35
.long 0x3ef1bf35,0x3dc93f7b,0x3f623f35,0xbf7fbe48
.long 0x3f7ba554,0xbf553ec4,0xbf7b248d,0x3f55bec4
.long 0x3f463f35,0xbf62bf0e,0x3f22bf35,0xbef13f55
.long 0x3f803f80,0x3f803f80,0x3f803f80,0x3f803f80
.long 0x3e953ec4,0x3dc93e48,0xbf75bf6d,0xbf7fbf7b
.long 0xbf55bf35,0xbf7bbf6d,0x3f553f35,0x3f7b3f6d
.long 0xbf46bf6d,0xbe95bf0e,0xbf22bec4,0xbf75bf55
.long 0x3ec4a554,0x3f6d3f35,0x3ec4a554,0x3f6d3f35
.long 0x3f7f3f6d,0x3ef13f55,0xbdc93ec4,0xbf62bf0e
.long 0x3e483f35,0xbf55bec4,0xbe48bf35,0x3f553ec4
.long 0xbf62bec4,0xbf22bf7b,0x3ef13f6d,0xbf46be48
.long 0xbf35bf80,0x3f35a554,0xbf35bf80,0x3f35a554
.long 0x3ef1bec4,0x3f463f7b,0x3f623f6d,0xbf223e48
.long 0x3f7b3f35,0xbf0e3ec4,0xbf7bbf35,0x3f0ebec4
.long 0x3dc93f6d,0xbf62bf55,0x3f7f3ec4,0xbef13f0e
.long 0xbf6d248d,0x3ec4bf35,0xbf6d248d,0x3ec4bf35
.long 0xbf22bf6d,0x3f753f0e,0x3f46bec4,0xbe953f55
.long 0x3f0ebf35,0xbe483f6d,0xbf0e3f35,0x3e48bf6d
.long 0x3f753ec4,0xbf7fbe48,0x3e95bf6d,0xbdc93f7b
.long 0x3f803f80,0x3f803f80,0x3f803f80,0x3f803f80
.long 0xbf7fbf80,0xbf75bf7b,0x3dc9a554,0x3e953e48
.long 0x3f7b3f80,0x3f553f6d,0xbf7bbf80,0xbf55bf6d
.long 0xbf75bf80,0xbf22bf55,0xbe95248d,0xbf46bf0e
.long 0x3f6d3f80,0x3ec43f35,0x3f6d3f80,0x3ec43f35
.long 0xbf62bf80,0xbdc9bf0e,0x3ef1a554,0x3f7f3f55
.long 0x3f553f80,0xbe483ec4,0xbf55bf80,0x3e48bec4
.long 0xbf46bf80,0x3ef1be48,0xbf22248d,0xbf62bf7b
.long 0x3f353f80,0xbf35248d,0x3f353f80,0xbf35248d
.long 0xbf22bf80,0x3f623e48,0x3f46a554,0x3ef13f7b
.long 0x3f0e3f80,0xbf7bbec4,0xbf0ebf80,0x3f7b3ec4
.long 0xbef1bf80,0x3f7f3f0e,0xbf62248d,0x3dc9bf55
.long 0x3ec43f80,0xbf6dbf35,0x3ec43f80,0xbf6dbf35
.long 0xbe95bf80,0x3f463f55,0x3f75a554,0xbf223f0e
.long 0x3e483f80,0xbf0ebf6d,0xbe48bf80,0x3f0e3f6d
.long 0xbdc9bf80,0x3e953f7b,0xbf7f248d,0x3f75be48
.long 0x3f803f80,0x3f803f80,0x3f803f80,0x3f803f80
.long 0xbf62bf6d,0xbf46bf55,0x3ef13ec4,0x3f223f0e
.long 0x3f0e3f35,0x3e483ec4,0xbf0ebf35,0xbe48bec4
.long 0xbdc9bec4,0x3ef13e48,0xbf7fbf6d,0xbf62bf7b
.long 0xbec4248d,0xbf6dbf35,0xbec4248d,0xbf6dbf35
.long 0x3f463ec4,0x3f753f7b,0x3f223f6d,0xbe953e48
.long 0xbf7bbf35,0xbf0ebf6d,0x3f7b3f35,0x3f0e3f6d
.long 0x3f753f6d,0xbdc93f0e,0x3e95bec4,0x3f7f3f55
.long 0xbf35bf80,0x3f35a554,0xbf35bf80,0x3f35a554
.long 0x3e953f6d,0xbf7fbf0e,0xbf75bec4,0xbdc9bf55
.long 0x3e48bf35,0x3f553f6d,0xbe483f35,0xbf55bf6d
.long 0xbf223ec4,0xbe95bf7b,0x3f463f6d,0xbf75be48
.long 0x3f6da554,0xbec43f35,0x3f6da554,0xbec43f35
.long 0xbf7fbec4,0x3f62be48,0x3dc9bf6d,0x3ef13f7b
.long 0x3f553f35,0xbf7bbec4,0xbf55bf35,0x3f7b3ec4
.long 0xbef1bf6d,0x3f223f55,0xbf623ec4,0x3f46bf0e
.long 0x3f803f80,0x3f803f80,0x3f803f80,0x3f803f80
.long 0xbf22bf35,0xbef1bf0e,0x3f463f35,0x3f623f55
.long 0xbe48248d,0xbf0ebec4,0x3e48a554,0x3f0e3ec4
.long 0x3f623f35,0x3f7f3f7b,0xbef1bf35,0x3dc9be48
.long 0xbf6dbf80,0xbec4bf35,0xbf6dbf80,0xbec4bf35
.long 0x3e953f35,0xbf22be48,0xbf75bf35,0xbf46bf7b
.long 0x3f0ea554,0x3f7b3f6d,0xbf0e248d,0xbf7bbf6d
.long 0xbf7fbf35,0xbe95bf55,0x3dc93f35,0xbf75bf0e
.long 0x3f353f80,0xbf35248d,0x3f353f80,0xbf35248d
.long 0x3dc9bf35,0x3f753f55,0x3f7f3f35,0xbe953f0e
.long 0xbf55248d,0xbe48bf6d,0x3f55a554,0x3e483f6d
.long 0x3f753f35,0xbf463e48,0x3e95bf35,0x3f223f7b
.long 0xbec4bf80,0x3f6d3f35,0xbec4bf80,0x3f6d3f35
.long 0xbef13f35,0xbdc9bf7b,0xbf62bf35,0x3f7f3e48
.long 0x3f7ba554,0xbf553ec4,0xbf7b248d,0x3f55bec4
.long 0xbf46bf35,0x3f623f0e,0xbf223f35,0x3ef1bf55
.long 0x3f803f80,0x3f803f80,0x3f803f80,0x3f803f80
.long 0xbe95bec4,0xbdc9be48,0x3f753f6d,0x3f7f3f7b
.long 0xbf55bf35,0xbf7bbf6d,0x3f553f35,0x3f7b3f6d
.long 0x3f463f6d,0x3e953f0e,0x3f223ec4,0x3f753f55
.long 0x3ec4a554,0x3f6d3f35,0x3ec4a554,0x3f6d3f35
.long 0xbf7fbf6d,0xbef1bf55,0x3dc9bec4,0x3f623f0e
.long 0x3e483f35,0xbf55bec4,0xbe48bf35,0x3f553ec4
.long 0x3f623ec4,0x3f223f7b,0xbef1bf6d,0x3f463e48
.long 0xbf35bf80,0x3f35a554,0xbf35bf80,0x3f35a554
.long 0xbef13ec4,0xbf46bf7b,0xbf62bf6d,0x3f22be48
.long 0x3f7b3f35,0xbf0e3ec4,0xbf7bbf35,0x3f0ebec4
.long 0xbdc9bf6d,0x3f623f55,0xbf7fbec4,0x3ef1bf0e
.long 0xbf6d248d,0x3ec4bf35,0xbf6d248d,0x3ec4bf35
.long 0x3f223f6d,0xbf75bf0e,0xbf463ec4,0x3e95bf55
.long 0x3f0ebf35,0xbe483f6d,0xbf0e3f35,0x3e48bf6d
.long 0xbf75bec4,0x3f7f3e48,0xbe953f6d,0x3dc9bf7b
.long 0x248d3f80,0xa554bf80,0x248d3f80,0xa554bf80
.long 0xbdc93f80,0x3e95bf7b,0xbf7f248d,0x3f753e48
.long 0xbe483f80,0x3f0ebf6d,0x3e48bf80,0xbf0e3f6d
.long 0xbe953f80,0x3f46bf55,0x3f75a554,0xbf22bf0e
.long 0xbec43f80,0x3f6dbf35,0xbec43f80,0x3f6dbf35
.long 0xbef13f80,0x3f7fbf0e,0xbf62248d,0x3dc93f55
.long 0xbf0e3f80,0x3f7bbec4,0x3f0ebf80,0xbf7b3ec4
.long 0xbf223f80,0x3f62be48,0x3f46a554,0x3ef1bf7b
.long 0xbf353f80,0x3f35a554,0xbf353f80,0x3f35a554
.long 0xbf463f80,0x3ef13e48,0xbf22248d,0xbf623f7b
.long 0xbf553f80,0x3e483ec4,0x3f55bf80,0xbe48bec4
.long 0xbf623f80,0xbdc93f0e,0x3ef1a554,0x3f7fbf55
.long 0xbf6d3f80,0xbec43f35,0xbf6d3f80,0xbec43f35
.long 0xbf753f80,0xbf223f55,0xbe95248d,0xbf463f0e
.long 0xbf7b3f80,0xbf553f6d,0x3f7bbf80,0x3f55bf6d
.long 0xbf7f3f80,0xbf753f7b,0x3dc9a554,0x3e95be48
.long 0x248d3f80,0xa554bf80,0x248d3f80,0xa554bf80
.long 0xbef13f6d,0x3f22bf55,0xbf62bec4,0x3f463f0e
.long 0xbf553f35,0x3f7bbec4,0x3f55bf35,0xbf7b3ec4
.long 0xbf7f3ec4,0x3f623e48,0x3dc93f6d,0x3ef1bf7b
.long 0xbf6d248d,0x3ec43f35,0xbf6d248d,0x3ec43f35
.long 0xbf22bec4,0xbe953f7b,0x3f46bf6d,0xbf753e48
.long 0xbe48bf35,0xbf553f6d,0x3e483f35,0x3f55bf6d
.long 0x3e95bf6d,0xbf7f3f0e,0xbf753ec4,0xbdc93f55
.long 0x3f35bf80,0xbf35248d,0x3f35bf80,0xbf35248d
.long 0x3f75bf6d,0xbdc9bf0e,0x3e953ec4,0x3f7fbf55
.long 0x3f7bbf35,0x3f0ebf6d,0xbf7b3f35,0xbf0e3f6d
.long 0x3f46bec4,0x3f75bf7b,0x3f22bf6d,0xbe95be48
.long 0x3ec4a554,0x3f6dbf35,0x3ec4a554,0x3f6dbf35
.long 0xbdc93ec4,0x3ef1be48,0xbf7f3f6d,0xbf623f7b
.long 0xbf0e3f35,0xbe483ec4,0x3f0ebf35,0x3e48bec4
.long 0xbf623f6d,0xbf463f55,0x3ef1bec4,0x3f22bf0e
.long 0x248d3f80,0xa554bf80,0x248d3f80,0xa554bf80
.long 0xbf463f35,0x3f62bf0e,0xbf22bf35,0x3ef13f55
.long 0xbf7b248d,0x3f553ec4,0x3f7ba554,0xbf55bec4
.long 0xbef1bf35,0xbdc93f7b,0xbf623f35,0x3f7fbe48
.long 0x3ec4bf80,0xbf6d3f35,0x3ec4bf80,0xbf6d3f35
.long 0x3f75bf35,0xbf46be48,0x3e953f35,0x3f22bf7b
.long 0x3f55a554,0x3e48bf6d,0xbf55248d,0xbe483f6d
.long 0x3dc93f35,0x3f75bf55,0x3f7fbf35,0xbe95bf0e
.long 0xbf353f80,0x3f35a554,0xbf353f80,0x3f35a554
.long 0xbf7f3f35,0xbe953f55,0x3dc9bf35,0xbf753f0e
.long 0xbf0e248d,0xbf7b3f6d,0x3f0ea554,0x3f7bbf6d
.long 0x3e95bf35,0xbf223e48,0xbf753f35,0xbf463f7b
.long 0x3f6dbf80,0x3ec4bf35,0x3f6dbf80,0x3ec4bf35
.long 0x3f62bf35,0x3f7fbf7b,0xbef13f35,0x3dc93e48
.long 0x3e48a554,0x3f0ebec4,0xbe48248d,0xbf0e3ec4
.long 0xbf223f35,0xbef13f0e,0x3f46bf35,0x3f62bf55
.long 0x248d3f80,0xa554bf80,0x248d3f80,0xa554bf80
.long 0xbf753ec4,0x3f7fbe48,0xbe95bf6d,0x3dc93f7b
.long 0xbf0ebf35,0x3e483f6d,0x3f0e3f35,0xbe48bf6d
.long 0x3f22bf6d,0xbf753f0e,0xbf46bec4,0x3e953f55
.long 0x3f6da554,0xbec4bf35,0x3f6da554,0xbec4bf35
.long 0xbdc93f6d,0x3f62bf55,0xbf7f3ec4,0x3ef13f0e
.long 0xbf7b3f35,0x3f0e3ec4,0x3f7bbf35,0xbf0ebec4
.long 0xbef1bec4,0xbf463f7b,0xbf623f6d,0x3f223e48
.long 0x3f35bf80,0xbf35248d,0x3f35bf80,0xbf35248d
.long 0x3f62bec4,0x3f22bf7b,0xbef13f6d,0x3f46be48
.long 0xbe483f35,0x3f55bec4,0x3e48bf35,0xbf553ec4
.long 0xbf7f3f6d,0xbef13f55,0x3dc93ec4,0x3f62bf0e
.long 0xbec4248d,0xbf6d3f35,0xbec4248d,0xbf6d3f35
.long 0x3f46bf6d,0x3e95bf0e,0x3f22bec4,0x3f75bf55
.long 0x3f55bf35,0x3f7bbf6d,0xbf553f35,0xbf7b3f6d
.long 0xbe953ec4,0xbdc93e48,0x3f75bf6d,0x3f7fbf7b
.long 0x248d3f80,0xa554bf80,0x248d3f80,0xa554bf80
.long 0x3dc9bf80,0xbe953f7b,0x3f7fa554,0xbf75be48
.long 0xbe483f80,0x3f0ebf6d,0x3e48bf80,0xbf0e3f6d
.long 0x3e95bf80,0xbf463f55,0xbf75248d,0x3f223f0e
.long 0xbec43f80,0x3f6dbf35,0xbec43f80,0x3f6dbf35
.long 0x3ef1bf80,0xbf7f3f0e,0x3f62a554,0xbdc9bf55
.long 0xbf0e3f80,0x3f7bbec4,0x3f0ebf80,0xbf7b3ec4
.long 0x3f22bf80,0xbf623e48,0xbf46248d,0xbef13f7b
.long 0xbf353f80,0x3f35a554,0xbf353f80,0x3f35a554
.long 0x3f46bf80,0xbef1be48,0x3f22a554,0x3f62bf7b
.long 0xbf553f80,0x3e483ec4,0x3f55bf80,0xbe48bec4
.long 0x3f62bf80,0x3dc9bf0e,0xbef1248d,0xbf7f3f55
.long 0xbf6d3f80,0xbec43f35,0xbf6d3f80,0xbec43f35
.long 0x3f75bf80,0x3f22bf55,0x3e95a554,0x3f46bf0e
.long 0xbf7b3f80,0xbf553f6d,0x3f7bbf80,0x3f55bf6d
.long 0x3f7fbf80,0x3f75bf7b,0xbdc9248d,0xbe953e48
.long 0x248d3f80,0xa554bf80,0x248d3f80,0xa554bf80
.long 0x3ef1bf6d,0xbf223f55,0x3f623ec4,0xbf46bf0e
.long 0xbf553f35,0x3f7bbec4,0x3f55bf35,0xbf7b3ec4
.long 0x3f7fbec4,0xbf62be48,0xbdc9bf6d,0xbef13f7b
.long 0xbf6d248d,0x3ec43f35,0xbf6d248d,0x3ec43f35
.long 0x3f223ec4,0x3e95bf7b,0xbf463f6d,0x3f75be48
.long 0xbe48bf35,0xbf553f6d,0x3e483f35,0x3f55bf6d
.long 0xbe953f6d,0x3f7fbf0e,0x3f75bec4,0x3dc9bf55
.long 0x3f35bf80,0xbf35248d,0x3f35bf80,0xbf35248d
.long 0xbf753f6d,0x3dc93f0e,0xbe95bec4,0xbf7f3f55
.long 0x3f7bbf35,0x3f0ebf6d,0xbf7b3f35,0xbf0e3f6d
.long 0xbf463ec4,0xbf753f7b,0xbf223f6d,0x3e953e48
.long 0x3ec4a554,0x3f6dbf35,0x3ec4a554,0x3f6dbf35
.long 0x3dc9bec4,0xbef13e48,0x3f7fbf6d,0x3f62bf7b
.long 0xbf0e3f35,0xbe483ec4,0x3f0ebf35,0x3e48bec4
.long 0x3f62bf6d,0x3f46bf55,0xbef13ec4,0xbf223f0e
.long 0x248d3f80,0xa554bf80,0x248d3f80,0xa554bf80
.long 0x3f46bf35,0xbf623f0e,0x3f223f35,0xbef1bf55
.long 0xbf7b248d,0x3f553ec4,0x3f7ba554,0xbf55bec4
.long 0x3ef13f35,0x3dc9bf7b,0x3f62bf35,0xbf7f3e48
.long 0x3ec4bf80,0xbf6d3f35,0x3ec4bf80,0xbf6d3f35
.long 0xbf753f35,0x3f463e48,0xbe95bf35,0xbf223f7b
.long 0x3f55a554,0x3e48bf6d,0xbf55248d,0xbe483f6d
.long 0xbdc9bf35,0xbf753f55,0xbf7f3f35,0x3e953f0e
.long 0xbf353f80,0x3f35a554,0xbf353f80,0x3f35a554
.long 0x3f7fbf35,0x3e95bf55,0xbdc93f35,0x3f75bf0e
.long 0xbf0e248d,0xbf7b3f6d,0x3f0ea554,0x3f7bbf6d
.long 0xbe953f35,0x3f22be48,0x3f75bf35,0x3f46bf7b
.long 0x3f6dbf80,0x3ec4bf35,0x3f6dbf80,0x3ec4bf35
.long 0xbf623f35,0xbf7f3f7b,0x3ef1bf35,0xbdc9be48
.long 0x3e48a554,0x3f0ebec4,0xbe48248d,0xbf0e3ec4
.long 0x3f22bf35,0x3ef1bf0e,0xbf463f35,0xbf623f55
.long 0x248d3f80,0xa554bf80,0x248d3f80,0xa554bf80
.long 0x3f75bec4,0xbf7f3e48,0x3e953f6d,0xbdc9bf7b
.long 0xbf0ebf35,0x3e483f6d,0x3f0e3f35,0xbe48bf6d
.long 0xbf223f6d,0x3f75bf0e,0x3f463ec4,0xbe95bf55
.long 0x3f6da554,0xbec4bf35,0x3f6da554,0xbec4bf35
.long 0x3dc9bf6d,0xbf623f55,0x3f7fbec4,0xbef1bf0e
.long 0xbf7b3f35,0x3f0e3ec4,0x3f7bbf35,0xbf0ebec4
.long 0x3ef13ec4,0x3f46bf7b,0x3f62bf6d,0xbf22be48
.long 0x3f35bf80,0xbf35248d,0x3f35bf80,0xbf35248d
.long 0xbf623ec4,0xbf223f7b,0x3ef1bf6d,0xbf463e48
.long 0xbe483f35,0x3f55bec4,0x3e48bf35,0xbf553ec4
.long 0x3f7fbf6d,0x3ef1bf55,0xbdc9bec4,0xbf623f0e
.long 0xbec4248d,0xbf6d3f35,0xbec4248d,0xbf6d3f35
.long 0xbf463f6d,0xbe953f0e,0xbf223ec4,0xbf753f55
.long 0x3f55bf35,0x3f7bbf6d,0xbf553f35,0xbf7b3f6d
.long 0x3e95bec4,0x3dc9be48,0xbf753f6d,0xbf7f3f7b
.long 0xbf803f80,0xbf803f80,0xbf803f80,0xbf803f80
.long 0xbf7f3f80,0xbf753f7b,0x3dc9248d,0x3e95be48
.long 0xbf7b3f80,0xbf553f6d,0x3f7bbf80,0x3f55bf6d
.long 0xbf753f80,0xbf223f55,0xbe95a554,0xbf463f0e
.long 0xbf6d3f80,0xbec43f35,0xbf6d3f80,0xbec43f35
.long 0xbf623f80,0xbdc93f0e,0x3ef1248d,0x3f7fbf55
.long 0xbf553f80,0x3e483ec4,0x3f55bf80,0xbe48bec4
.long 0xbf463f80,0x3ef13e48,0xbf22a554,0xbf623f7b
.long 0xbf353f80,0x3f35248d,0xbf353f80,0x3f35248d
.long 0xbf223f80,0x3f62be48,0x3f46248d,0x3ef1bf7b
.long 0xbf0e3f80,0x3f7bbec4,0x3f0ebf80,0xbf7b3ec4
.long 0xbef13f80,0x3f7fbf0e,0xbf62a554,0x3dc93f55
.long 0xbec43f80,0x3f6dbf35,0xbec43f80,0x3f6dbf35
.long 0xbe953f80,0x3f46bf55,0x3f75248d,0xbf22bf0e
.long 0xbe483f80,0x3f0ebf6d,0x3e48bf80,0xbf0e3f6d
.long 0xbdc93f80,0x3e95bf7b,0xbf7fa554,0x3f753e48
.long 0xbf803f80,0xbf803f80,0xbf803f80,0xbf803f80
.long 0xbf623f6d,0xbf463f55,0x3ef1bec4,0x3f22bf0e
.long 0xbf0e3f35,0xbe483ec4,0x3f0ebf35,0x3e48bec4
.long 0xbdc93ec4,0x3ef1be48,0xbf7f3f6d,0xbf623f7b
.long 0x3ec4248d,0x3f6dbf35,0x3ec4248d,0x3f6dbf35
.long 0x3f46bec4,0x3f75bf7b,0x3f22bf6d,0xbe95be48
.long 0x3f7bbf35,0x3f0ebf6d,0xbf7b3f35,0xbf0e3f6d
.long 0x3f75bf6d,0xbdc9bf0e,0x3e953ec4,0x3f7fbf55
.long 0x3f35bf80,0xbf35a554,0x3f35bf80,0xbf35a554
.long 0x3e95bf6d,0xbf7f3f0e,0xbf753ec4,0xbdc93f55
.long 0xbe48bf35,0xbf553f6d,0x3e483f35,0x3f55bf6d
.long 0xbf22bec4,0xbe953f7b,0x3f46bf6d,0xbf753e48
.long 0xbf6da554,0x3ec43f35,0xbf6da554,0x3ec43f35
.long 0xbf7f3ec4,0x3f623e48,0x3dc93f6d,0x3ef1bf7b
.long 0xbf553f35,0x3f7bbec4,0x3f55bf35,0xbf7b3ec4
.long 0xbef13f6d,0x3f22bf55,0xbf62bec4,0x3f463f0e
.long 0xbf803f80,0xbf803f80,0xbf803f80,0xbf803f80
.long 0xbf223f35,0xbef13f0e,0x3f46bf35,0x3f62bf55
.long 0x3e48248d,0x3f0ebec4,0xbe48a554,0xbf0e3ec4
.long 0x3f62bf35,0x3f7fbf7b,0xbef13f35,0x3dc93e48
.long 0x3f6dbf80,0x3ec4bf35,0x3f6dbf80,0x3ec4bf35
.long 0x3e95bf35,0xbf223e48,0xbf753f35,0xbf463f7b
.long 0xbf0ea554,0xbf7b3f6d,0x3f0e248d,0x3f7bbf6d
.long 0xbf7f3f35,0xbe953f55,0x3dc9bf35,0xbf753f0e
.long 0xbf353f80,0x3f35248d,0xbf353f80,0x3f35248d
.long 0x3dc93f35,0x3f75bf55,0x3f7fbf35,0xbe95bf0e
.long 0x3f55248d,0x3e48bf6d,0xbf55a554,0xbe483f6d
.long 0x3f75bf35,0xbf46be48,0x3e953f35,0x3f22bf7b
.long 0x3ec4bf80,0xbf6d3f35,0x3ec4bf80,0xbf6d3f35
.long 0xbef1bf35,0xbdc93f7b,0xbf623f35,0x3f7fbe48
.long 0xbf7ba554,0x3f553ec4,0x3f7b248d,0xbf55bec4
.long 0xbf463f35,0x3f62bf0e,0xbf22bf35,0x3ef13f55
.long 0xbf803f80,0xbf803f80,0xbf803f80,0xbf803f80
.long 0xbe953ec4,0xbdc93e48,0x3f75bf6d,0x3f7fbf7b
.long 0x3f55bf35,0x3f7bbf6d,0xbf553f35,0xbf7b3f6d
.long 0x3f46bf6d,0x3e95bf0e,0x3f22bec4,0x3f75bf55
.long 0xbec4a554,0xbf6d3f35,0xbec4a554,0xbf6d3f35
.long 0xbf7f3f6d,0xbef13f55,0x3dc93ec4,0x3f62bf0e
.long 0xbe483f35,0x3f55bec4,0x3e48bf35,0xbf553ec4
.long 0x3f62bec4,0x3f22bf7b,0xbef13f6d,0x3f46be48
.long 0x3f35bf80,0xbf35a554,0x3f35bf80,0xbf35a554
.long 0xbef1bec4,0xbf463f7b,0xbf623f6d,0x3f223e48
.long 0xbf7b3f35,0x3f0e3ec4,0x3f7bbf35,0xbf0ebec4
.long 0xbdc93f6d,0x3f62bf55,0xbf7f3ec4,0x3ef13f0e
.long 0x3f6d248d,0xbec4bf35,0x3f6d248d,0xbec4bf35
.long 0x3f22bf6d,0xbf753f0e,0xbf46bec4,0x3e953f55
.long 0xbf0ebf35,0x3e483f6d,0x3f0e3f35,0xbe48bf6d
.long 0xbf753ec4,0x3f7fbe48,0xbe95bf6d,0x3dc93f7b
.long 0xbf803f80,0xbf803f80,0xbf803f80,0xbf803f80
.long 0x3f7fbf80,0x3f75bf7b,0xbdc9a554,0xbe953e48
.long 0xbf7b3f80,0xbf553f6d,0x3f7bbf80,0x3f55bf6d
.long 0x3f75bf80,0x3f22bf55,0x3e95248d,0x3f46bf0e
.long 0xbf6d3f80,0xbec43f35,0xbf6d3f80,0xbec43f35
.long 0x3f62bf80,0x3dc9bf0e,0xbef1a554,0xbf7f3f55
.long 0xbf553f80,0x3e483ec4,0x3f55bf80,0xbe48bec4
.long 0x3f46bf80,0xbef1be48,0x3f22248d,0x3f62bf7b
.long 0xbf353f80,0x3f35248d,0xbf353f80,0x3f35248d
.long 0x3f22bf80,0xbf623e48,0xbf46a554,0xbef13f7b
.long 0xbf0e3f80,0x3f7bbec4,0x3f0ebf80,0xbf7b3ec4
.long 0x3ef1bf80,0xbf7f3f0e,0x3f62248d,0xbdc9bf55
.long 0xbec43f80,0x3f6dbf35,0xbec43f80,0x3f6dbf35
.long 0x3e95bf80,0xbf463f55,0xbf75a554,0x3f223f0e
.long 0xbe483f80,0x3f0ebf6d,0x3e48bf80,0xbf0e3f6d
.long 0x3dc9bf80,0xbe953f7b,0x3f7f248d,0xbf75be48
.long 0xbf803f80,0xbf803f80,0xbf803f80,0xbf803f80
.long 0x3f62bf6d,0x3f46bf55,0xbef13ec4,0xbf223f0e
.long 0xbf0e3f35,0xbe483ec4,0x3f0ebf35,0x3e48bec4
.long 0x3dc9bec4,0xbef13e48,0x3f7fbf6d,0x3f62bf7b
.long 0x3ec4248d,0x3f6dbf35,0x3ec4248d,0x3f6dbf35
.long 0xbf463ec4,0xbf753f7b,0xbf223f6d,0x3e953e48
.long 0x3f7bbf35,0x3f0ebf6d,0xbf7b3f35,0xbf0e3f6d
.long 0xbf753f6d,0x3dc93f0e,0xbe95bec4,0xbf7f3f55
.long 0x3f35bf80,0xbf35a554,0x3f35bf80,0xbf35a554
.long 0xbe953f6d,0x3f7fbf0e,0x3f75bec4,0x3dc9bf55
.long 0xbe48bf35,0xbf553f6d,0x3e483f35,0x3f55bf6d
.long 0x3f223ec4,0x3e95bf7b,0xbf463f6d,0x3f75be48
.long 0xbf6da554,0x3ec43f35,0xbf6da554,0x3ec43f35
.long 0x3f7fbec4,0xbf62be48,0xbdc9bf6d,0xbef13f7b
.long 0xbf553f35,0x3f7bbec4,0x3f55bf35,0xbf7b3ec4
.long 0x3ef1bf6d,0xbf223f55,0x3f623ec4,0xbf46bf0e
.long 0xbf803f80,0xbf803f80,0xbf803f80,0xbf803f80
.long 0x3f22bf35,0x3ef1bf0e,0xbf463f35,0xbf623f55
.long 0x3e48248d,0x3f0ebec4,0xbe48a554,0xbf0e3ec4
.long 0xbf623f35,0xbf7f3f7b,0x3ef1bf35,0xbdc9be48
.long 0x3f6dbf80,0x3ec4bf35,0x3f6dbf80,0x3ec4bf35
.long 0xbe953f35,0x3f22be48,0x3f75bf35,0x3f46bf7b
.long 0xbf0ea554,0xbf7b3f6d,0x3f0e248d,0x3f7bbf6d
.long 0x3f7fbf35,0x3e95bf55,0xbdc93f35,0x3f75bf0e
.long 0xbf353f80,0x3f35248d,0xbf353f80,0x3f35248d
.long 0xbdc9bf35,0xbf753f55,0xbf7f3f35,0x3e953f0e
.long 0x3f55248d,0x3e48bf6d,0xbf55a554,0xbe483f6d
.long 0xbf753f35,0x3f463e48,0xbe95bf35,0xbf223f7b
.long 0x3ec4bf80,0xbf6d3f35,0x3ec4bf80,0xbf6d3f35
.long 0x3ef13f35,0x3dc9bf7b,0x3f62bf35,0xbf7f3e48
.long 0xbf7ba554,0x3f553ec4,0x3f7b248d,0xbf55bec4
.long 0x3f46bf35,0xbf623f0e,0x3f223f35,0xbef1bf55
.long 0xbf803f80,0xbf803f80,0xbf803f80,0xbf803f80
.long 0x3e95bec4,0x3dc9be48,0xbf753f6d,0xbf7f3f7b
.long 0x3f55bf35,0x3f7bbf6d,0xbf553f35,0xbf7b3f6d
.long 0xbf463f6d,0xbe953f0e,0xbf223ec4,0xbf753f55
.long 0xbec4a554,0xbf6d3f35,0xbec4a554,0xbf6d3f35
.long 0x3f7fbf6d,0x3ef1bf55,0xbdc9bec4,0xbf623f0e
.long 0xbe483f35,0x3f55bec4,0x3e48bf35,0xbf553ec4
.long 0xbf623ec4,0xbf223f7b,0x3ef1bf6d,0xbf463e48
.long 0x3f35bf80,0xbf35a554,0x3f35bf80,0xbf35a554
.long 0x3ef13ec4,0x3f46bf7b,0x3f62bf6d,0xbf22be48
.long 0xbf7b3f35,0x3f0e3ec4,0x3f7bbf35,0xbf0ebec4
.long 0x3dc9bf6d,0xbf623f55,0x3f7fbec4,0xbef1bf0e
.long 0x3f6d248d,0xbec4bf35,0x3f6d248d,0xbec4bf35
.long 0xbf223f6d,0x3f75bf0e,0x3f463ec4,0xbe95bf55
.long 0xbf0ebf35,0x3e483f6d,0x3f0e3f35,0xbe48bf6d
.long 0x3f75bec4,0xbf7f3e48,0x3e953f6d,0xbdc9bf7b
.long 0xa5543f80,0x248dbf80,0xa5543f80,0x248dbf80
.long 0x3dc93f80,0xbe95bf7b,0x3f7f248d,0xbf753e48
.long 0x3e483f80,0xbf0ebf6d,0xbe48bf80,0x3f0e3f6d
.long 0x3e953f80,0xbf46bf55,0xbf75a554,0x3f22bf0e
.long 0x3ec43f80,0xbf6dbf35,0x3ec43f80,0xbf6dbf35
.long 0x3ef13f80,0xbf7fbf0e,0x3f62248d,0xbdc93f55
.long 0x3f0e3f80,0xbf7bbec4,0xbf0ebf80,0x3f7b3ec4
.long 0x3f223f80,0xbf62be48,0xbf46a554,0xbef1bf7b
.long 0x3f353f80,0xbf35a554,0x3f353f80,0xbf35a554
.long 0x3f463f80,0xbef13e48,0x3f22248d,0x3f623f7b
.long 0x3f553f80,0xbe483ec4,0xbf55bf80,0x3e48bec4
.long 0x3f623f80,0x3dc93f0e,0xbef1a554,0xbf7fbf55
.long 0x3f6d3f80,0x3ec43f35,0x3f6d3f80,0x3ec43f35
.long 0x3f753f80,0x3f223f55,0x3e95248d,0x3f463f0e
.long 0x3f7b3f80,0x3f553f6d,0xbf7bbf80,0xbf55bf6d
.long 0x3f7f3f80,0x3f753f7b,0xbdc9a554,0xbe95be48
.long 0xa5543f80,0x248dbf80,0xa5543f80,0x248dbf80
.long 0x3ef13f6d,0xbf22bf55,0x3f62bec4,0xbf463f0e
.long 0x3f553f35,0xbf7bbec4,0xbf55bf35,0x3f7b3ec4
.long 0x3f7f3ec4,0xbf623e48,0xbdc93f6d,0xbef1bf7b
.long 0x3f6d248d,0xbec43f35,0x3f6d248d,0xbec43f35
.long 0x3f22bec4,0x3e953f7b,0xbf46bf6d,0x3f753e48
.long 0x3e48bf35,0x3f553f6d,0xbe483f35,0xbf55bf6d
.long 0xbe95bf6d,0x3f7f3f0e,0x3f753ec4,0x3dc93f55
.long 0xbf35bf80,0x3f35248d,0xbf35bf80,0x3f35248d
.long 0xbf75bf6d,0x3dc9bf0e,0xbe953ec4,0xbf7fbf55
.long 0xbf7bbf35,0xbf0ebf6d,0x3f7b3f35,0x3f0e3f6d
.long 0xbf46bec4,0xbf75bf7b,0xbf22bf6d,0x3e95be48
.long 0xbec4a554,0xbf6dbf35,0xbec4a554,0xbf6dbf35
.long 0x3dc93ec4,0xbef1be48,0x3f7f3f6d,0x3f623f7b
.long 0x3f0e3f35,0x3e483ec4,0xbf0ebf35,0xbe48bec4
.long 0x3f623f6d,0x3f463f55,0xbef1bec4,0xbf22bf0e
.long 0xa5543f80,0x248dbf80,0xa5543f80,0x248dbf80
.long 0x3f463f35,0xbf62bf0e,0x3f22bf35,0xbef13f55
.long 0x3f7b248d,0xbf553ec4,0xbf7ba554,0x3f55bec4
.long 0x3ef1bf35,0x3dc93f7b,0x3f623f35,0xbf7fbe48
.long 0xbec4bf80,0x3f6d3f35,0xbec4bf80,0x3f6d3f35
.long 0xbf75bf35,0x3f46be48,0xbe953f35,0xbf22bf7b
.long 0xbf55a554,0xbe48bf6d,0x3f55248d,0x3e483f6d
.long 0xbdc93f35,0xbf75bf55,0xbf7fbf35,0x3e95bf0e
.long 0x3f353f80,0xbf35a554,0x3f353f80,0xbf35a554
.long 0x3f7f3f35,0x3e953f55,0xbdc9bf35,0x3f753f0e
.long 0x3f0e248d,0x3f7b3f6d,0xbf0ea554,0xbf7bbf6d
.long 0xbe95bf35,0x3f223e48,0x3f753f35,0x3f463f7b
.long 0xbf6dbf80,0xbec4bf35,0xbf6dbf80,0xbec4bf35
.long 0xbf62bf35,0xbf7fbf7b,0x3ef13f35,0xbdc93e48
.long 0xbe48a554,0xbf0ebec4,0x3e48248d,0x3f0e3ec4
.long 0x3f223f35,0x3ef13f0e,0xbf46bf35,0xbf62bf55
.long 0xa5543f80,0x248dbf80,0xa5543f80,0x248dbf80
.long 0x3f753ec4,0xbf7fbe48,0x3e95bf6d,0xbdc93f7b
.long 0x3f0ebf35,0xbe483f6d,0xbf0e3f35,0x3e48bf6d
.long 0xbf22bf6d,0x3f753f0e,0x3f46bec4,0xbe953f55
.long 0xbf6da554,0x3ec4bf35,0xbf6da554,0x3ec4bf35
.long 0x3dc93f6d,0xbf62bf55,0x3f7f3ec4,0xbef13f0e
.long 0x3f7b3f35,0xbf0e3ec4,0xbf7bbf35,0x3f0ebec4
.long 0x3ef1bec4,0x3f463f7b,0x3f623f6d,0xbf223e48
.long 0xbf35bf80,0x3f35248d,0xbf35bf80,0x3f35248d
.long 0xbf62bec4,0xbf22bf7b,0x3ef13f6d,0xbf46be48
.long 0x3e483f35,0xbf55bec4,0xbe48bf35,0x3f553ec4
.long 0x3f7f3f6d,0x3ef13f55,0xbdc93ec4,0xbf62bf0e
.long 0x3ec4248d,0x3f6d3f35,0x3ec4248d,0x3f6d3f35
.long 0xbf46bf6d,0xbe95bf0e,0xbf22bec4,0xbf75bf55
.long 0xbf55bf35,0xbf7bbf6d,0x3f553f35,0x3f7b3f6d
.long 0x3e953ec4,0x3dc93e48,0xbf75bf6d,0xbf7fbf7b
.long 0xa5543f80,0x248dbf80,0xa5543f80,0x248dbf80
.long 0xbdc9bf80,0x3e953f7b,0xbf7fa554,0x3f75be48
.long 0x3e483f80,0xbf0ebf6d,0xbe48bf80,0x3f0e3f6d
.long 0xbe95bf80,0x3f463f55,0x3f75248d,0xbf223f0e
.long 0x3ec43f80,0xbf6dbf35,0x3ec43f80,0xbf6dbf35
.long 0xbef1bf80,0x3f7f3f0e,0xbf62a554,0x3dc9bf55
.long 0x3f0e3f80,0xbf7bbec4,0xbf0ebf80,0x3f7b3ec4
.long 0xbf22bf80,0x3f623e48,0x3f46248d,0x3ef13f7b
.long 0x3f353f80,0xbf35a554,0x3f353f80,0xbf35a554
.long 0xbf46bf80,0x3ef1be48,0xbf22a554,0xbf62bf7b
.long 0x3f553f80,0xbe483ec4,0xbf55bf80,0x3e48bec4
.long 0xbf62bf80,0xbdc9bf0e,0x3ef1248d,0x3f7f3f55
.long 0x3f6d3f80,0x3ec43f35,0x3f6d3f80,0x3ec43f35
.long 0xbf75bf80,0xbf22bf55,0xbe95a554,0xbf46bf0e
.long 0x3f7b3f80,0x3f553f6d,0xbf7bbf80,0xbf55bf6d
.long 0xbf7fbf80,0xbf75bf7b,0x3dc9248d,0x3e953e48
.long 0xa5543f80,0x248dbf80,0xa5543f80,0x248dbf80
.long 0xbef1bf6d,0x3f223f55,0xbf623ec4,0x3f46bf0e
.long 0x3f553f35,0xbf7bbec4,0xbf55bf35,0x3f7b3ec4
.long 0xbf7fbec4,0x3f62be48,0x3dc9bf6d,0x3ef13f7b
.long 0x3f6d248d,0xbec43f35,0x3f6d248d,0xbec43f35
.long 0xbf223ec4,0xbe95bf7b,0x3f463f6d,0xbf75be48
.long 0x3e48bf35,0x3f553f6d,0xbe483f35,0xbf55bf6d
.long 0x3e953f6d,0xbf7fbf0e,0xbf75bec4,0xbdc9bf55
.long 0xbf35bf80,0x3f35248d,0xbf35bf80,0x3f35248d
.long 0x3f753f6d,0xbdc93f0e,0x3e95bec4,0x3f7f3f55
.long 0xbf7bbf35,0xbf0ebf6d,0x3f7b3f35,0x3f0e3f6d
.long 0x3f463ec4,0x3f753f7b,0x3f223f6d,0xbe953e48
.long 0xbec4a554,0xbf6dbf35,0xbec4a554,0xbf6dbf35
.long 0xbdc9bec4,0x3ef13e48,0xbf7fbf6d,0xbf62bf7b
.long 0x3f0e3f35,0x3e483ec4,0xbf0ebf35,0xbe48bec4
.long 0xbf62bf6d,0xbf46bf55,0x3ef13ec4,0x3f223f0e
.long 0xa5543f80,0x248dbf80,0xa5543f80,0x248dbf80
.long 0xbf46bf35,0x3f623f0e,0xbf223f35,0x3ef1bf55
.long 0x3f7b248d,0xbf553ec4,0xbf7ba554,0x3f55bec4
.long 0xbef13f35,0xbdc9bf7b,0xbf62bf35,0x3f7f3e48
.long 0xbec4bf80,0x3f6d3f35,0xbec4bf80,0x3f6d3f35
.long 0x3f753f35,0xbf463e48,0x3e95bf35,0x3f223f7b
.long 0xbf55a554,0xbe48bf6d,0x3f55248d,0x3e483f6d
.long 0x3dc9bf35,0x3f753f55,0x3f7f3f35,0xbe953f0e
.long 0x3f353f80,0xbf35a554,0x3f353f80,0xbf35a554
.long 0xbf7fbf35,0xbe95bf55,0x3dc93f35,0xbf75bf0e
.long 0x3f0e248d,0x3f7b3f6d,0xbf0ea554,0xbf7bbf6d
.long 0x3e953f35,0xbf22be48,0xbf75bf35,0xbf46bf7b
.long 0xbf6dbf80,0xbec4bf35,0xbf6dbf80,0xbec4bf35
.long 0x3f623f35,0x3f7f3f7b,0xbef1bf35,0x3dc9be48
.long 0xbe48a554,0xbf0ebec4,0x3e48248d,0x3f0e3ec4
.long 0xbf22bf35,0xbef1bf0e,0x3f463f35,0x3f623f55
.long 0xa5543f80,0x248dbf80,0xa5543f80,0x248dbf80
.long 0xbf75bec4,0x3f7f3e48,0xbe953f6d,0x3dc9bf7b
.long 0x3f0ebf35,0xbe483f6d,0xbf0e3f35,0x3e48bf6d
.long 0x3f223f6d,0xbf75bf0e,0xbf463ec4,0x3e95bf55
.long 0xbf6da554,0x3ec4bf35,0xbf6da554,0x3ec4bf35
.long 0xbdc9bf6d,0x3f623f55,0xbf7fbec4,0x3ef1bf0e
.long 0x3f7b3f35,0xbf0e3ec4,0xbf7bbf35,0x3f0ebec4
.long 0xbef13ec4,0xbf46bf7b,0xbf62bf6d,0x3f22be48
.long 0xbf35bf80,0x3f35248d,0xbf35bf80,0x3f35248d
.long 0x3f623ec4,0x3f223f7b,0xbef1bf6d,0x3f463e48
.long 0x3e483f35,0xbf55bec4,0xbe48bf35,0x3f553ec4
.long 0xbf7fbf6d,0xbef1bf55,0x3dc9bec4,0x3f623f0e
.long 0x3ec4248d,0x3f6d3f35,0x3ec4248d,0x3f6d3f35
.long 0x3f463f6d,0x3e953f0e,0x3f223ec4,0x3f753f55
.long 0xbf55bf35,0xbf7bbf6d,0x3f553f35,0x3f7b3f6d
.long 0xbe95bec4,0xbdc9be48,0x3f753f6d,0x3f7f3f7b
.long 0x0,0x0,0x0,0x0
.long 0x3dc90000,0x3e953e48,0x3f7f3f80,0x3f753f7b
.long 0x3e480000,0x3f0e3ec4,0xbe48250d,0xbf0ebec4
.long 0x3e950000,0x3f463f0e,0xbf75bf80,0xbf22bf55
.long 0x3ec40000,0x3f6d3f35,0x3ec40000,0x3f6d3f35
.long 0x3ef10000,0x3f7f3f55,0x3f623f80,0x3dc93f0e
.long 0x3f0e0000,0x3f7b3f6d,0xbf0e250d,0xbf7bbf6d
.long 0x3f220000,0x3f623f7b,0xbf46bf80,0x3ef1be48
.long 0x3f350000,0x3f353f80,0x3f350000,0x3f353f80
.long 0x3f460000,0x3ef13f7b,0x3f223f80,0xbf62be48
.long 0x3f550000,0x3e483f6d,0xbf55250d,0xbe48bf6d
.long 0x3f620000,0xbdc93f55,0xbef1bf80,0x3f7f3f0e
.long 0x3f6d0000,0xbec43f35,0x3f6d0000,0xbec43f35
.long 0x3f750000,0xbf223f0e,0x3e953f80,0xbf46bf55
.long 0x3f7b0000,0xbf553ec4,0xbf7b250d,0x3f55bec4
.long 0x3f7f0000,0xbf753e48,0xbdc9bf80,0x3e953f7b
.long 0x0,0x0,0x0,0x0
.long 0x3ef13ec4,0x3f223f0e,0x3f623f6d,0x3f463f55
.long 0x3f553f35,0x3f7b3f6d,0xbf55bf35,0xbf7bbf6d
.long 0x3f7f3f6d,0x3f623f7b,0xbdc9bec4,0x3ef13e48
.long 0x3f6d3f80,0x3ec43f35,0x3f6d3f80,0x3ec43f35
.long 0x3f223f6d,0xbe953e48,0xbf46bec4,0xbf75bf7b
.long 0x3e483f35,0xbf55bec4,0xbe48bf35,0x3f553ec4
.long 0xbe953ec4,0xbf7fbf55,0x3f753f6d,0xbdc93f0e
.long 0xbf35250d,0xbf35bf80,0xbf35250d,0xbf35bf80
.long 0xbf75bec4,0xbdc9bf55,0xbe95bf6d,0x3f7f3f0e
.long 0xbf7bbf35,0x3f0ebec4,0x3f7b3f35,0xbf0e3ec4
.long 0xbf46bf6d,0x3f753e48,0xbf223ec4,0xbe95bf7b
.long 0xbec4bf80,0x3f6d3f35,0xbec4bf80,0x3f6d3f35
.long 0x3dc9bf6d,0x3ef13f7b,0x3f7f3ec4,0xbf623e48
.long 0x3f0ebf35,0xbe483f6d,0xbf0e3f35,0x3e48bf6d
.long 0x3f62bec4,0xbf463f0e,0xbef1bf6d,0x3f223f55
.long 0x0,0x0,0x0,0x0
.long 0x3f463f35,0x3f623f55,0x3f223f35,0x3ef13f0e
.long 0x3f7b3f80,0x3f553f6d,0xbf7bbf80,0xbf55bf6d
.long 0x3ef13f35,0xbdc93e48,0x3f623f35,0x3f7f3f7b
.long 0xbec4250d,0xbf6dbf35,0xbec4250d,0xbf6dbf35
.long 0xbf75bf35,0xbf46bf7b,0xbe95bf35,0x3f223e48
.long 0xbf55bf80,0x3e48bec4,0x3f553f80,0xbe483ec4
.long 0xbdc9bf35,0x3f753f0e,0xbf7fbf35,0xbe95bf55
.long 0x3f350000,0x3f353f80,0x3f350000,0x3f353f80
.long 0x3f7f3f35,0xbe953f0e,0xbdc93f35,0xbf75bf55
.long 0x3f0e3f80,0xbf7bbec4,0xbf0ebf80,0x3f7b3ec4
.long 0xbe953f35,0xbf22bf7b,0x3f753f35,0xbf463e48
.long 0xbf6d250d,0x3ec4bf35,0xbf6d250d,0x3ec4bf35
.long 0xbf62bf35,0x3f7f3e48,0x3ef1bf35,0x3dc93f7b
.long 0xbe48bf80,0x3f0e3f6d,0x3e483f80,0xbf0ebf6d
.long 0x3f22bf35,0xbef13f55,0xbf46bf35,0x3f623f0e
.long 0x0,0x0,0x0,0x0
.long 0x3f753f6d,0x3f7f3f7b,0x3e953ec4,0x3dc93e48
.long 0x3f0e3f35,0x3e483ec4,0xbf0ebf35,0xbe48bec4
.long 0xbf22bec4,0xbf75bf55,0x3f463f6d,0x3e953f0e
.long 0xbf6dbf80,0xbec4bf35,0xbf6dbf80,0xbec4bf35
.long 0x3dc9bec4,0x3f623f0e,0x3f7f3f6d,0x3ef13f55
.long 0x3f7b3f35,0x3f0e3f6d,0xbf7bbf35,0xbf0ebf6d
.long 0x3ef13f6d,0xbf46be48,0x3f623ec4,0x3f223f7b
.long 0xbf35250d,0xbf35bf80,0xbf35250d,0xbf35bf80
.long 0xbf62bf6d,0x3f22be48,0x3ef1bec4,0x3f463f7b
.long 0x3e48bf35,0x3f553f6d,0xbe483f35,0xbf55bf6d
.long 0x3f7f3ec4,0xbef13f0e,0xbdc9bf6d,0x3f623f55
.long 0x3ec43f80,0xbf6dbf35,0x3ec43f80,0xbf6dbf35
.long 0xbf463ec4,0x3e95bf55,0xbf22bf6d,0x3f753f0e
.long 0xbf55bf35,0x3f7b3ec4,0x3f553f35,0xbf7bbec4
.long 0x3e95bf6d,0xbdc93f7b,0xbf75bec4,0x3f7f3e48
.long 0x0,0x0,0x0,0x0
.long 0xbdc9250d,0xbe95be48,0xbf7fbf80,0xbf75bf7b
.long 0x3e480000,0x3f0e3ec4,0xbe48250d,0xbf0ebec4
.long 0xbe95250d,0xbf46bf0e,0x3f753f80,0x3f223f55
.long 0x3ec40000,0x3f6d3f35,0x3ec40000,0x3f6d3f35
.long 0xbef1250d,0xbf7fbf55,0xbf62bf80,0xbdc9bf0e
.long 0x3f0e0000,0x3f7b3f6d,0xbf0e250d,0xbf7bbf6d
.long 0xbf22250d,0xbf62bf7b,0x3f463f80,0xbef13e48
.long 0x3f350000,0x3f353f80,0x3f350000,0x3f353f80
.long 0xbf46250d,0xbef1bf7b,0xbf22bf80,0x3f623e48
.long 0x3f550000,0x3e483f6d,0xbf55250d,0xbe48bf6d
.long 0xbf62250d,0x3dc9bf55,0x3ef13f80,0xbf7fbf0e
.long 0x3f6d0000,0xbec43f35,0x3f6d0000,0xbec43f35
.long 0xbf75250d,0x3f22bf0e,0xbe95bf80,0x3f463f55
.long 0x3f7b0000,0xbf553ec4,0xbf7b250d,0x3f55bec4
.long 0xbf7f250d,0x3f75be48,0x3dc93f80,0xbe95bf7b
.long 0x0,0x0,0x0,0x0
.long 0xbef1bec4,0xbf22bf0e,0xbf62bf6d,0xbf46bf55
.long 0x3f553f35,0x3f7b3f6d,0xbf55bf35,0xbf7bbf6d
.long 0xbf7fbf6d,0xbf62bf7b,0x3dc93ec4,0xbef1be48
.long 0x3f6d3f80,0x3ec43f35,0x3f6d3f80,0x3ec43f35
.long 0xbf22bf6d,0x3e95be48,0x3f463ec4,0x3f753f7b
.long 0x3e483f35,0xbf55bec4,0xbe48bf35,0x3f553ec4
.long 0x3e95bec4,0x3f7f3f55,0xbf75bf6d,0x3dc9bf0e
.long 0xbf35250d,0xbf35bf80,0xbf35250d,0xbf35bf80
.long 0x3f753ec4,0x3dc93f55,0x3e953f6d,0xbf7fbf0e
.long 0xbf7bbf35,0x3f0ebec4,0x3f7b3f35,0xbf0e3ec4
.long 0x3f463f6d,0xbf75be48,0x3f22bec4,0x3e953f7b
.long 0xbec4bf80,0x3f6d3f35,0xbec4bf80,0x3f6d3f35
.long 0xbdc93f6d,0xbef1bf7b,0xbf7fbec4,0x3f62be48
.long 0x3f0ebf35,0xbe483f6d,0xbf0e3f35,0x3e48bf6d
.long 0xbf623ec4,0x3f46bf0e,0x3ef13f6d,0xbf22bf55
.long 0x0,0x0,0x0,0x0
.long 0xbf46bf35,0xbf62bf55,0xbf22bf35,0xbef1bf0e
.long 0x3f7b3f80,0x3f553f6d,0xbf7bbf80,0xbf55bf6d
.long 0xbef1bf35,0x3dc9be48,0xbf62bf35,0xbf7fbf7b
.long 0xbec4250d,0xbf6dbf35,0xbec4250d,0xbf6dbf35
.long 0x3f753f35,0x3f463f7b,0x3e953f35,0xbf22be48
.long 0xbf55bf80,0x3e48bec4,0x3f553f80,0xbe483ec4
.long 0x3dc93f35,0xbf75bf0e,0x3f7f3f35,0x3e953f55
.long 0x3f350000,0x3f353f80,0x3f350000,0x3f353f80
.long 0xbf7fbf35,0x3e95bf0e,0x3dc9bf35,0x3f753f55
.long 0x3f0e3f80,0xbf7bbec4,0xbf0ebf80,0x3f7b3ec4
.long 0x3e95bf35,0x3f223f7b,0xbf75bf35,0x3f46be48
.long 0xbf6d250d,0x3ec4bf35,0xbf6d250d,0x3ec4bf35
.long 0x3f623f35,0xbf7fbe48,0xbef13f35,0xbdc9bf7b
.long 0xbe48bf80,0x3f0e3f6d,0x3e483f80,0xbf0ebf6d
.long 0xbf223f35,0x3ef1bf55,0x3f463f35,0xbf62bf0e
.long 0x0,0x0,0x0,0x0
.long 0xbf75bf6d,0xbf7fbf7b,0xbe95bec4,0xbdc9be48
.long 0x3f0e3f35,0x3e483ec4,0xbf0ebf35,0xbe48bec4
.long 0x3f223ec4,0x3f753f55,0xbf46bf6d,0xbe95bf0e
.long 0xbf6dbf80,0xbec4bf35,0xbf6dbf80,0xbec4bf35
.long 0xbdc93ec4,0xbf62bf0e,0xbf7fbf6d,0xbef1bf55
.long 0x3f7b3f35,0x3f0e3f6d,0xbf7bbf35,0xbf0ebf6d
.long 0xbef1bf6d,0x3f463e48,0xbf62bec4,0xbf22bf7b
.long 0xbf35250d,0xbf35bf80,0xbf35250d,0xbf35bf80
.long 0x3f623f6d,0xbf223e48,0xbef13ec4,0xbf46bf7b
.long 0x3e48bf35,0x3f553f6d,0xbe483f35,0xbf55bf6d
.long 0xbf7fbec4,0x3ef1bf0e,0x3dc93f6d,0xbf62bf55
.long 0x3ec43f80,0xbf6dbf35,0x3ec43f80,0xbf6dbf35
.long 0x3f46bec4,0xbe953f55,0x3f223f6d,0xbf75bf0e
.long 0xbf55bf35,0x3f7b3ec4,0x3f553f35,0xbf7bbec4
.long 0xbe953f6d,0x3dc9bf7b,0x3f753ec4,0xbf7fbe48
.long 0x3f800000,0xbf80250d,0x3f800000,0xbf80250d
.long 0x3f7f0000,0xbf75be48,0xbdc93f80,0x3e95bf7b
.long 0x3f7b0000,0xbf55bec4,0xbf7b250d,0x3f553ec4
.long 0x3f750000,0xbf22bf0e,0x3e95bf80,0xbf463f55
.long 0x3f6d0000,0xbec4bf35,0x3f6d0000,0xbec4bf35
.long 0x3f620000,0xbdc9bf55,0xbef13f80,0x3f7fbf0e
.long 0x3f550000,0x3e48bf6d,0xbf55250d,0xbe483f6d
.long 0x3f460000,0x3ef1bf7b,0x3f22bf80,0xbf623e48
.long 0x3f350000,0x3f35bf80,0x3f350000,0x3f35bf80
.long 0x3f220000,0x3f62bf7b,0xbf463f80,0x3ef13e48
.long 0x3f0e0000,0x3f7bbf6d,0xbf0e250d,0xbf7b3f6d
.long 0x3ef10000,0x3f7fbf55,0x3f62bf80,0x3dc9bf0e
.long 0x3ec40000,0x3f6dbf35,0x3ec40000,0x3f6dbf35
.long 0x3e950000,0x3f46bf0e,0xbf753f80,0xbf223f55
.long 0x3e480000,0x3f0ebec4,0xbe48250d,0xbf0e3ec4
.long 0x3dc90000,0x3e95be48,0x3f7fbf80,0x3f75bf7b
.long 0x3f800000,0xbf80250d,0x3f800000,0xbf80250d
.long 0x3f623ec4,0xbf46bf0e,0xbef13f6d,0x3f22bf55
.long 0x3f0e3f35,0xbe48bf6d,0xbf0ebf35,0x3e483f6d
.long 0x3dc93f6d,0x3ef1bf7b,0x3f7fbec4,0xbf62be48
.long 0xbec43f80,0x3f6dbf35,0xbec43f80,0x3f6dbf35
.long 0xbf463f6d,0x3f75be48,0xbf22bec4,0xbe953f7b
.long 0xbf7b3f35,0x3f0e3ec4,0x3f7bbf35,0xbf0ebec4
.long 0xbf753ec4,0xbdc93f55,0xbe953f6d,0x3f7fbf0e
.long 0xbf35250d,0xbf353f80,0xbf35250d,0xbf353f80
.long 0xbe95bec4,0xbf7f3f55,0x3f75bf6d,0xbdc9bf0e
.long 0x3e48bf35,0xbf553ec4,0xbe483f35,0x3f55bec4
.long 0x3f22bf6d,0xbe95be48,0xbf463ec4,0xbf753f7b
.long 0x3f6dbf80,0x3ec4bf35,0x3f6dbf80,0x3ec4bf35
.long 0x3f7fbf6d,0x3f62bf7b,0xbdc93ec4,0x3ef1be48
.long 0x3f55bf35,0x3f7bbf6d,0xbf553f35,0xbf7b3f6d
.long 0x3ef1bec4,0x3f22bf0e,0x3f62bf6d,0x3f46bf55
.long 0x3f800000,0xbf80250d,0x3f800000,0xbf80250d
.long 0x3f223f35,0xbef1bf55,0xbf463f35,0x3f62bf0e
.long 0xbe483f80,0x3f0ebf6d,0x3e48bf80,0xbf0e3f6d
.long 0xbf623f35,0x3f7fbe48,0x3ef13f35,0x3dc9bf7b
.long 0xbf6d250d,0x3ec43f35,0xbf6d250d,0x3ec43f35
.long 0xbe95bf35,0xbf223f7b,0x3f75bf35,0xbf46be48
.long 0x3f0ebf80,0xbf7b3ec4,0xbf0e3f80,0x3f7bbec4
.long 0x3f7fbf35,0xbe95bf0e,0xbdc9bf35,0xbf753f55
.long 0x3f350000,0x3f35bf80,0x3f350000,0x3f35bf80
.long 0xbdc93f35,0x3f75bf0e,0xbf7f3f35,0xbe953f55
.long 0xbf553f80,0x3e483ec4,0x3f55bf80,0xbe48bec4
.long 0xbf753f35,0xbf463f7b,0xbe953f35,0x3f22be48
.long 0xbec4250d,0xbf6d3f35,0xbec4250d,0xbf6d3f35
.long 0x3ef1bf35,0xbdc9be48,0x3f62bf35,0x3f7fbf7b
.long 0x3f7bbf80,0x3f55bf6d,0xbf7b3f80,0xbf553f6d
.long 0x3f46bf35,0x3f62bf55,0x3f22bf35,0x3ef1bf0e
.long 0x3f800000,0xbf80250d,0x3f800000,0xbf80250d
.long 0x3e953f6d,0xbdc9bf7b,0xbf753ec4,0x3f7fbe48
.long 0xbf553f35,0x3f7bbec4,0x3f55bf35,0xbf7b3ec4
.long 0xbf46bec4,0x3e953f55,0xbf223f6d,0x3f75bf0e
.long 0x3ec4bf80,0xbf6d3f35,0x3ec4bf80,0xbf6d3f35
.long 0x3f7fbec4,0xbef1bf0e,0xbdc93f6d,0x3f62bf55
.long 0x3e483f35,0x3f55bf6d,0xbe48bf35,0xbf553f6d
.long 0xbf623f6d,0x3f223e48,0x3ef13ec4,0x3f46bf7b
.long 0xbf35250d,0xbf353f80,0xbf35250d,0xbf353f80
.long 0x3ef1bf6d,0xbf463e48,0x3f62bec4,0x3f22bf7b
.long 0x3f7bbf35,0x3f0ebf6d,0xbf7b3f35,0xbf0e3f6d
.long 0x3dc93ec4,0x3f62bf0e,0x3f7fbf6d,0x3ef1bf55
.long 0xbf6d3f80,0xbec43f35,0xbf6d3f80,0xbec43f35
.long 0xbf223ec4,0xbf753f55,0x3f46bf6d,0x3e95bf0e
.long 0x3f0ebf35,0x3e48bec4,0xbf0e3f35,0xbe483ec4
.long 0x3f75bf6d,0x3f7fbf7b,0x3e95bec4,0x3dc9be48
.long 0x3f800000,0xbf80250d,0x3f800000,0xbf80250d
.long 0xbf7f250d,0x3f753e48,0x3dc9bf80,0xbe953f7b
.long 0x3f7b0000,0xbf55bec4,0xbf7b250d,0x3f553ec4
.long 0xbf75250d,0x3f223f0e,0xbe953f80,0x3f46bf55
.long 0x3f6d0000,0xbec4bf35,0x3f6d0000,0xbec4bf35
.long 0xbf62250d,0x3dc93f55,0x3ef1bf80,0xbf7f3f0e
.long 0x3f550000,0x3e48bf6d,0xbf55250d,0xbe483f6d
.long 0xbf46250d,0xbef13f7b,0xbf223f80,0x3f62be48
.long 0x3f350000,0x3f35bf80,0x3f350000,0x3f35bf80
.long 0xbf22250d,0xbf623f7b,0x3f46bf80,0xbef1be48
.long 0x3f0e0000,0x3f7bbf6d,0xbf0e250d,0xbf7b3f6d
.long 0xbef1250d,0xbf7f3f55,0xbf623f80,0xbdc93f0e
.long 0x3ec40000,0x3f6dbf35,0x3ec40000,0x3f6dbf35
.long 0xbe95250d,0xbf463f0e,0x3f75bf80,0x3f22bf55
.long 0x3e480000,0x3f0ebec4,0xbe48250d,0xbf0e3ec4
.long 0xbdc9250d,0xbe953e48,0xbf7f3f80,0xbf753f7b
.long 0x3f800000,0xbf80250d,0x3f800000,0xbf80250d
.long 0xbf62bec4,0x3f463f0e,0x3ef1bf6d,0xbf223f55
.long 0x3f0e3f35,0xbe48bf6d,0xbf0ebf35,0x3e483f6d
.long 0xbdc9bf6d,0xbef13f7b,0xbf7f3ec4,0x3f623e48
.long 0xbec43f80,0x3f6dbf35,0xbec43f80,0x3f6dbf35
.long 0x3f46bf6d,0xbf753e48,0x3f223ec4,0x3e95bf7b
.long 0xbf7b3f35,0x3f0e3ec4,0x3f7bbf35,0xbf0ebec4
.long 0x3f75bec4,0x3dc9bf55,0x3e95bf6d,0xbf7f3f0e
.long 0xbf35250d,0xbf353f80,0xbf35250d,0xbf353f80
.long 0x3e953ec4,0x3f7fbf55,0xbf753f6d,0x3dc93f0e
.long 0x3e48bf35,0xbf553ec4,0xbe483f35,0x3f55bec4
.long 0xbf223f6d,0x3e953e48,0x3f46bec4,0x3f75bf7b
.long 0x3f6dbf80,0x3ec4bf35,0x3f6dbf80,0x3ec4bf35
.long 0xbf7f3f6d,0xbf623f7b,0x3dc9bec4,0xbef13e48
.long 0x3f55bf35,0x3f7bbf6d,0xbf553f35,0xbf7b3f6d
.long 0xbef13ec4,0xbf223f0e,0xbf623f6d,0xbf463f55
.long 0x3f800000,0xbf80250d,0x3f800000,0xbf80250d
.long 0xbf22bf35,0x3ef13f55,0x3f46bf35,0xbf623f0e
.long 0xbe483f80,0x3f0ebf6d,0x3e48bf80,0xbf0e3f6d
.long 0x3f62bf35,0xbf7f3e48,0xbef1bf35,0xbdc93f7b
.long 0xbf6d250d,0x3ec43f35,0xbf6d250d,0x3ec43f35
.long 0x3e953f35,0x3f22bf7b,0xbf753f35,0x3f463e48
.long 0x3f0ebf80,0xbf7b3ec4,0xbf0e3f80,0x3f7bbec4
.long 0xbf7f3f35,0x3e953f0e,0x3dc93f35,0x3f75bf55
.long 0x3f350000,0x3f35bf80,0x3f350000,0x3f35bf80
.long 0x3dc9bf35,0xbf753f0e,0x3f7fbf35,0x3e95bf55
.long 0xbf553f80,0x3e483ec4,0x3f55bf80,0xbe48bec4
.long 0x3f75bf35,0x3f46bf7b,0x3e95bf35,0xbf223e48
.long 0xbec4250d,0xbf6d3f35,0xbec4250d,0xbf6d3f35
.long 0xbef13f35,0x3dc93e48,0xbf623f35,0xbf7f3f7b
.long 0x3f7bbf80,0x3f55bf6d,0xbf7b3f80,0xbf553f6d
.long 0xbf463f35,0xbf623f55,0xbf223f35,0xbef13f0e
.long 0x3f800000,0xbf80250d,0x3f800000,0xbf80250d
.long 0xbe95bf6d,0x3dc93f7b,0x3f75bec4,0xbf7f3e48
.long 0xbf553f35,0x3f7bbec4,0x3f55bf35,0xbf7b3ec4
.long 0x3f463ec4,0xbe95bf55,0x3f22bf6d,0xbf753f0e
.long 0x3ec4bf80,0xbf6d3f35,0x3ec4bf80,0xbf6d3f35
.long 0xbf7f3ec4,0x3ef13f0e,0x3dc9bf6d,0xbf623f55
.long 0x3e483f35,0x3f55bf6d,0xbe48bf35,0xbf553f6d
.long 0x3f62bf6d,0xbf22be48,0xbef1bec4,0xbf463f7b
.long 0xbf35250d,0xbf353f80,0xbf35250d,0xbf353f80
.long 0xbef13f6d,0x3f46be48,0xbf623ec4,0xbf223f7b
.long 0x3f7bbf35,0x3f0ebf6d,0xbf7b3f35,0xbf0e3f6d
.long 0xbdc9bec4,0xbf623f0e,0xbf7f3f6d,0xbef13f55
.long 0xbf6d3f80,0xbec43f35,0xbf6d3f80,0xbec43f35
.long 0x3f22bec4,0x3f75bf55,0xbf463f6d,0xbe953f0e
.long 0x3f0ebf35,0x3e48bec4,0xbf0e3f35,0xbe483ec4
.long 0xbf753f6d,0xbf7f3f7b,0xbe953ec4,0xbdc93e48
.long 0x250d0000,0x250d0000,0x250d0000,0x250d0000
.long 0xbdc90000,0xbe953e48,0xbf7f3f80,0xbf753f7b
.long 0xbe480000,0xbf0e3ec4,0x3e48250d,0x3f0ebec4
.long 0xbe950000,0xbf463f0e,0x3f75bf80,0x3f22bf55
.long 0xbec40000,0xbf6d3f35,0xbec40000,0xbf6d3f35
.long 0xbef10000,0xbf7f3f55,0xbf623f80,0xbdc93f0e
.long 0xbf0e0000,0xbf7b3f6d,0x3f0e250d,0x3f7bbf6d
.long 0xbf220000,0xbf623f7b,0x3f46bf80,0xbef1be48
.long 0xbf350000,0xbf353f80,0xbf350000,0xbf353f80
.long 0xbf460000,0xbef13f7b,0xbf223f80,0x3f62be48
.long 0xbf550000,0xbe483f6d,0x3f55250d,0x3e48bf6d
.long 0xbf620000,0x3dc93f55,0x3ef1bf80,0xbf7f3f0e
.long 0xbf6d0000,0x3ec43f35,0xbf6d0000,0x3ec43f35
.long 0xbf750000,0x3f223f0e,0xbe953f80,0x3f46bf55
.long 0xbf7b0000,0x3f553ec4,0x3f7b250d,0xbf55bec4
.long 0xbf7f0000,0x3f753e48,0x3dc9bf80,0xbe953f7b
.long 0x250d0000,0x250d0000,0x250d0000,0x250d0000
.long 0xbef13ec4,0xbf223f0e,0xbf623f6d,0xbf463f55
.long 0xbf553f35,0xbf7b3f6d,0x3f55bf35,0x3f7bbf6d
.long 0xbf7f3f6d,0xbf623f7b,0x3dc9bec4,0xbef13e48
.long 0xbf6d3f80,0xbec43f35,0xbf6d3f80,0xbec43f35
.long 0xbf223f6d,0x3e953e48,0x3f46bec4,0x3f75bf7b
.long 0xbe483f35,0x3f55bec4,0x3e48bf35,0xbf553ec4
.long 0x3e953ec4,0x3f7fbf55,0xbf753f6d,0x3dc93f0e
.long 0x3f35250d,0x3f35bf80,0x3f35250d,0x3f35bf80
.long 0x3f75bec4,0x3dc9bf55,0x3e95bf6d,0xbf7f3f0e
.long 0x3f7bbf35,0xbf0ebec4,0xbf7b3f35,0x3f0e3ec4
.long 0x3f46bf6d,0xbf753e48,0x3f223ec4,0x3e95bf7b
.long 0x3ec4bf80,0xbf6d3f35,0x3ec4bf80,0xbf6d3f35
.long 0xbdc9bf6d,0xbef13f7b,0xbf7f3ec4,0x3f623e48
.long 0xbf0ebf35,0x3e483f6d,0x3f0e3f35,0xbe48bf6d
.long 0xbf62bec4,0x3f463f0e,0x3ef1bf6d,0xbf223f55
.long 0x250d0000,0x250d0000,0x250d0000,0x250d0000
.long 0xbf463f35,0xbf623f55,0xbf223f35,0xbef13f0e
.long 0xbf7b3f80,0xbf553f6d,0x3f7bbf80,0x3f55bf6d
.long 0xbef13f35,0x3dc93e48,0xbf623f35,0xbf7f3f7b
.long 0x3ec4250d,0x3f6dbf35,0x3ec4250d,0x3f6dbf35
.long 0x3f75bf35,0x3f46bf7b,0x3e95bf35,0xbf223e48
.long 0x3f55bf80,0xbe48bec4,0xbf553f80,0x3e483ec4
.long 0x3dc9bf35,0xbf753f0e,0x3f7fbf35,0x3e95bf55
.long 0xbf350000,0xbf353f80,0xbf350000,0xbf353f80
.long 0xbf7f3f35,0x3e953f0e,0x3dc93f35,0x3f75bf55
.long 0xbf0e3f80,0x3f7bbec4,0x3f0ebf80,0xbf7b3ec4
.long 0x3e953f35,0x3f22bf7b,0xbf753f35,0x3f463e48
.long 0x3f6d250d,0xbec4bf35,0x3f6d250d,0xbec4bf35
.long 0x3f62bf35,0xbf7f3e48,0xbef1bf35,0xbdc93f7b
.long 0x3e48bf80,0xbf0e3f6d,0xbe483f80,0x3f0ebf6d
.long 0xbf22bf35,0x3ef13f55,0x3f46bf35,0xbf623f0e
.long 0x250d0000,0x250d0000,0x250d0000,0x250d0000
.long 0xbf753f6d,0xbf7f3f7b,0xbe953ec4,0xbdc93e48
.long 0xbf0e3f35,0xbe483ec4,0x3f0ebf35,0x3e48bec4
.long 0x3f22bec4,0x3f75bf55,0xbf463f6d,0xbe953f0e
.long 0x3f6dbf80,0x3ec4bf35,0x3f6dbf80,0x3ec4bf35
.long 0xbdc9bec4,0xbf623f0e,0xbf7f3f6d,0xbef13f55
.long 0xbf7b3f35,0xbf0e3f6d,0x3f7bbf35,0x3f0ebf6d
.long 0xbef13f6d,0x3f46be48,0xbf623ec4,0xbf223f7b
.long 0x3f35250d,0x3f35bf80,0x3f35250d,0x3f35bf80
.long 0x3f62bf6d,0xbf22be48,0xbef1bec4,0xbf463f7b
.long 0xbe48bf35,0xbf553f6d,0x3e483f35,0x3f55bf6d
.long 0xbf7f3ec4,0x3ef13f0e,0x3dc9bf6d,0xbf623f55
.long 0xbec43f80,0x3f6dbf35,0xbec43f80,0x3f6dbf35
.long 0x3f463ec4,0xbe95bf55,0x3f22bf6d,0xbf753f0e
.long 0x3f55bf35,0xbf7b3ec4,0xbf553f35,0x3f7bbec4
.long 0xbe95bf6d,0x3dc93f7b,0x3f75bec4,0xbf7f3e48
.long 0x250d0000,0x250d0000,0x250d0000,0x250d0000
.long 0x3dc9250d,0x3e95be48,0x3f7fbf80,0x3f75bf7b
.long 0xbe480000,0xbf0e3ec4,0x3e48250d,0x3f0ebec4
.long 0x3e95250d,0x3f46bf0e,0xbf753f80,0xbf223f55
.long 0xbec40000,0xbf6d3f35,0xbec40000,0xbf6d3f35
.long 0x3ef1250d,0x3f7fbf55,0x3f62bf80,0x3dc9bf0e
.long 0xbf0e0000,0xbf7b3f6d,0x3f0e250d,0x3f7bbf6d
.long 0x3f22250d,0x3f62bf7b,0xbf463f80,0x3ef13e48
.long 0xbf350000,0xbf353f80,0xbf350000,0xbf353f80
.long 0x3f46250d,0x3ef1bf7b,0x3f22bf80,0xbf623e48
.long 0xbf550000,0xbe483f6d,0x3f55250d,0x3e48bf6d
.long 0x3f62250d,0xbdc9bf55,0xbef13f80,0x3f7fbf0e
.long 0xbf6d0000,0x3ec43f35,0xbf6d0000,0x3ec43f35
.long 0x3f75250d,0xbf22bf0e,0x3e95bf80,0xbf463f55
.long 0xbf7b0000,0x3f553ec4,0x3f7b250d,0xbf55bec4
.long 0x3f7f250d,0xbf75be48,0xbdc93f80,0x3e95bf7b
.long 0x250d0000,0x250d0000,0x250d0000,0x250d0000
.long 0x3ef1bec4,0x3f22bf0e,0x3f62bf6d,0x3f46bf55
.long 0xbf553f35,0xbf7b3f6d,0x3f55bf35,0x3f7bbf6d
.long 0x3f7fbf6d,0x3f62bf7b,0xbdc93ec4,0x3ef1be48
.long 0xbf6d3f80,0xbec43f35,0xbf6d3f80,0xbec43f35
.long 0x3f22bf6d,0xbe95be48,0xbf463ec4,0xbf753f7b
.long 0xbe483f35,0x3f55bec4,0x3e48bf35,0xbf553ec4
.long 0xbe95bec4,0xbf7f3f55,0x3f75bf6d,0xbdc9bf0e
.long 0x3f35250d,0x3f35bf80,0x3f35250d,0x3f35bf80
.long 0xbf753ec4,0xbdc93f55,0xbe953f6d,0x3f7fbf0e
.long 0x3f7bbf35,0xbf0ebec4,0xbf7b3f35,0x3f0e3ec4
.long 0xbf463f6d,0x3f75be48,0xbf22bec4,0xbe953f7b
.long 0x3ec4bf80,0xbf6d3f35,0x3ec4bf80,0xbf6d3f35
.long 0x3dc93f6d,0x3ef1bf7b,0x3f7fbec4,0xbf62be48
.long 0xbf0ebf35,0x3e483f6d,0x3f0e3f35,0xbe48bf6d
.long 0x3f623ec4,0xbf46bf0e,0xbef13f6d,0x3f22bf55
.long 0x250d0000,0x250d0000,0x250d0000,0x250d0000
.long 0x3f46bf35,0x3f62bf55,0x3f22bf35,0x3ef1bf0e
.long 0xbf7b3f80,0xbf553f6d,0x3f7bbf80,0x3f55bf6d
.long 0x3ef1bf35,0xbdc9be48,0x3f62bf35,0x3f7fbf7b
.long 0x3ec4250d,0x3f6dbf35,0x3ec4250d,0x3f6dbf35
.long 0xbf753f35,0xbf463f7b,0xbe953f35,0x3f22be48
.long 0x3f55bf80,0xbe48bec4,0xbf553f80,0x3e483ec4
.long 0xbdc93f35,0x3f75bf0e,0xbf7f3f35,0xbe953f55
.long 0xbf350000,0xbf353f80,0xbf350000,0xbf353f80
.long 0x3f7fbf35,0xbe95bf0e,0xbdc9bf35,0xbf753f55
.long 0xbf0e3f80,0x3f7bbec4,0x3f0ebf80,0xbf7b3ec4
.long 0xbe95bf35,0xbf223f7b,0x3f75bf35,0xbf46be48
.long 0x3f6d250d,0xbec4bf35,0x3f6d250d,0xbec4bf35
.long 0xbf623f35,0x3f7fbe48,0x3ef13f35,0x3dc9bf7b
.long 0x3e48bf80,0xbf0e3f6d,0xbe483f80,0x3f0ebf6d
.long 0x3f223f35,0xbef1bf55,0xbf463f35,0x3f62bf0e
.long 0x250d0000,0x250d0000,0x250d0000,0x250d0000
.long 0x3f75bf6d,0x3f7fbf7b,0x3e95bec4,0x3dc9be48
.long 0xbf0e3f35,0xbe483ec4,0x3f0ebf35,0x3e48bec4
.long 0xbf223ec4,0xbf753f55,0x3f46bf6d,0x3e95bf0e
.long 0x3f6dbf80,0x3ec4bf35,0x3f6dbf80,0x3ec4bf35
.long 0x3dc93ec4,0x3f62bf0e,0x3f7fbf6d,0x3ef1bf55
.long 0xbf7b3f35,0xbf0e3f6d,0x3f7bbf35,0x3f0ebf6d
.long 0x3ef1bf6d,0xbf463e48,0x3f62bec4,0x3f22bf7b
.long 0x3f35250d,0x3f35bf80,0x3f35250d,0x3f35bf80
.long 0xbf623f6d,0x3f223e48,0x3ef13ec4,0x3f46bf7b
.long 0xbe48bf35,0xbf553f6d,0x3e483f35,0x3f55bf6d
.long 0x3f7fbec4,0xbef1bf0e,0xbdc93f6d,0x3f62bf55
.long 0xbec43f80,0x3f6dbf35,0xbec43f80,0x3f6dbf35
.long 0xbf46bec4,0x3e953f55,0xbf223f6d,0x3f75bf0e
.long 0x3f55bf35,0xbf7b3ec4,0xbf553f35,0x3f7bbec4
.long 0x3e953f6d,0xbdc9bf7b,0xbf753ec4,0x3f7fbe48
.long 0xbf800000,0x3f80250d,0xbf800000,0x3f80250d
.long 0xbf7f0000,0x3f75be48,0x3dc93f80,0xbe95bf7b
.long 0xbf7b0000,0x3f55bec4,0x3f7b250d,0xbf553ec4
.long 0xbf750000,0x3f22bf0e,0xbe95bf80,0x3f463f55
.long 0xbf6d0000,0x3ec4bf35,0xbf6d0000,0x3ec4bf35
.long 0xbf620000,0x3dc9bf55,0x3ef13f80,0xbf7fbf0e
.long 0xbf550000,0xbe48bf6d,0x3f55250d,0x3e483f6d
.long 0xbf460000,0xbef1bf7b,0xbf22bf80,0x3f623e48
.long 0xbf350000,0xbf35bf80,0xbf350000,0xbf35bf80
.long 0xbf220000,0xbf62bf7b,0x3f463f80,0xbef13e48
.long 0xbf0e0000,0xbf7bbf6d,0x3f0e250d,0x3f7b3f6d
.long 0xbef10000,0xbf7fbf55,0xbf62bf80,0xbdc9bf0e
.long 0xbec40000,0xbf6dbf35,0xbec40000,0xbf6dbf35
.long 0xbe950000,0xbf46bf0e,0x3f753f80,0x3f223f55
.long 0xbe480000,0xbf0ebec4,0x3e48250d,0x3f0e3ec4
.long 0xbdc90000,0xbe95be48,0xbf7fbf80,0xbf75bf7b
.long 0xbf800000,0x3f80250d,0xbf800000,0x3f80250d
.long 0xbf623ec4,0x3f46bf0e,0x3ef13f6d,0xbf22bf55
.long 0xbf0e3f35,0x3e48bf6d,0x3f0ebf35,0xbe483f6d
.long 0xbdc93f6d,0xbef1bf7b,0xbf7fbec4,0x3f62be48
.long 0x3ec43f80,0xbf6dbf35,0x3ec43f80,0xbf6dbf35
.long 0x3f463f6d,0xbf75be48,0x3f22bec4,0x3e953f7b
.long 0x3f7b3f35,0xbf0e3ec4,0xbf7bbf35,0x3f0ebec4
.long 0x3f753ec4,0x3dc93f55,0x3e953f6d,0xbf7fbf0e
.long 0x3f35250d,0x3f353f80,0x3f35250d,0x3f353f80
.long 0x3e95bec4,0x3f7f3f55,0xbf75bf6d,0x3dc9bf0e
.long 0xbe48bf35,0x3f553ec4,0x3e483f35,0xbf55bec4
.long 0xbf22bf6d,0x3e95be48,0x3f463ec4,0x3f753f7b
.long 0xbf6dbf80,0xbec4bf35,0xbf6dbf80,0xbec4bf35
.long 0xbf7fbf6d,0xbf62bf7b,0x3dc93ec4,0xbef1be48
.long 0xbf55bf35,0xbf7bbf6d,0x3f553f35,0x3f7b3f6d
.long 0xbef1bec4,0xbf22bf0e,0xbf62bf6d,0xbf46bf55
.long 0xbf800000,0x3f80250d,0xbf800000,0x3f80250d
.long 0xbf223f35,0x3ef1bf55,0x3f463f35,0xbf62bf0e
.long 0x3e483f80,0xbf0ebf6d,0xbe48bf80,0x3f0e3f6d
.long 0x3f623f35,0xbf7fbe48,0xbef13f35,0xbdc9bf7b
.long 0x3f6d250d,0xbec43f35,0x3f6d250d,0xbec43f35
.long 0x3e95bf35,0x3f223f7b,0xbf75bf35,0x3f46be48
.long 0xbf0ebf80,0x3f7b3ec4,0x3f0e3f80,0xbf7bbec4
.long 0xbf7fbf35,0x3e95bf0e,0x3dc9bf35,0x3f753f55
.long 0xbf350000,0xbf35bf80,0xbf350000,0xbf35bf80
.long 0x3dc93f35,0xbf75bf0e,0x3f7f3f35,0x3e953f55
.long 0x3f553f80,0xbe483ec4,0xbf55bf80,0x3e48bec4
.long 0x3f753f35,0x3f463f7b,0x3e953f35,0xbf22be48
.long 0x3ec4250d,0x3f6d3f35,0x3ec4250d,0x3f6d3f35
.long 0xbef1bf35,0x3dc9be48,0xbf62bf35,0xbf7fbf7b
.long 0xbf7bbf80,0xbf55bf6d,0x3f7b3f80,0x3f553f6d
.long 0xbf46bf35,0xbf62bf55,0xbf22bf35,0xbef1bf0e
.long 0xbf800000,0x3f80250d,0xbf800000,0x3f80250d
.long 0xbe953f6d,0x3dc9bf7b,0x3f753ec4,0xbf7fbe48
.long 0x3f553f35,0xbf7bbec4,0xbf55bf35,0x3f7b3ec4
.long 0x3f46bec4,0xbe953f55,0x3f223f6d,0xbf75bf0e
.long 0xbec4bf80,0x3f6d3f35,0xbec4bf80,0x3f6d3f35
.long 0xbf7fbec4,0x3ef1bf0e,0x3dc93f6d,0xbf62bf55
.long 0xbe483f35,0xbf55bf6d,0x3e48bf35,0x3f553f6d
.long 0x3f623f6d,0xbf223e48,0xbef13ec4,0xbf46bf7b
.long 0x3f35250d,0x3f353f80,0x3f35250d,0x3f353f80
.long 0xbef1bf6d,0x3f463e48,0xbf62bec4,0xbf22bf7b
.long 0xbf7bbf35,0xbf0ebf6d,0x3f7b3f35,0x3f0e3f6d
.long 0xbdc93ec4,0xbf62bf0e,0xbf7fbf6d,0xbef1bf55
.long 0x3f6d3f80,0x3ec43f35,0x3f6d3f80,0x3ec43f35
.long 0x3f223ec4,0x3f753f55,0xbf46bf6d,0xbe95bf0e
.long 0xbf0ebf35,0xbe48bec4,0x3f0e3f35,0x3e483ec4
.long 0xbf75bf6d,0xbf7fbf7b,0xbe95bec4,0xbdc9be48
.long 0xbf800000,0x3f80250d,0xbf800000,0x3f80250d
.long 0x3f7f250d,0xbf753e48,0xbdc9bf80,0x3e953f7b
.long 0xbf7b0000,0x3f55bec4,0x3f7b250d,0xbf553ec4
.long 0x3f75250d,0xbf223f0e,0x3e953f80,0xbf46bf55
.long 0xbf6d0000,0x3ec4bf35,0xbf6d0000,0x3ec4bf35
.long 0x3f62250d,0xbdc93f55,0xbef1bf80,0x3f7f3f0e
.long 0xbf550000,0xbe48bf6d,0x3f55250d,0x3e483f6d
.long 0x3f46250d,0x3ef13f7b,0x3f223f80,0xbf62be48
.long 0xbf350000,0xbf35bf80,0xbf350000,0xbf35bf80
.long 0x3f22250d,0x3f623f7b,0xbf46bf80,0x3ef1be48
.long 0xbf0e0000,0xbf7bbf6d,0x3f0e250d,0x3f7b3f6d
.long 0x3ef1250d,0x3f7f3f55,0x3f623f80,0x3dc93f0e
.long 0xbec40000,0xbf6dbf35,0xbec40000,0xbf6dbf35
.long 0x3e95250d,0x3f463f0e,0xbf75bf80,0xbf22bf55
.long 0xbe480000,0xbf0ebec4,0x3e48250d,0x3f0e3ec4
.long 0x3dc9250d,0x3e953e48,0x3f7f3f80,0x3f753f7b
.long 0xbf800000,0x3f80250d,0xbf800000,0x3f80250d
.long 0x3f62bec4,0xbf463f0e,0xbef1bf6d,0x3f223f55
.long 0xbf0e3f35,0x3e48bf6d,0x3f0ebf35,0xbe483f6d
.long 0x3dc9bf6d,0x3ef13f7b,0x3f7f3ec4,0xbf623e48
.long 0x3ec43f80,0xbf6dbf35,0x3ec43f80,0xbf6dbf35
.long 0xbf46bf6d,0x3f753e48,0xbf223ec4,0xbe95bf7b
.long 0x3f7b3f35,0xbf0e3ec4,0xbf7bbf35,0x3f0ebec4
.long 0xbf75bec4,0xbdc9bf55,0xbe95bf6d,0x3f7f3f0e
.long 0x3f35250d,0x3f353f80,0x3f35250d,0x3f353f80
.long 0xbe953ec4,0xbf7fbf55,0x3f753f6d,0xbdc93f0e
.long 0xbe48bf35,0x3f553ec4,0x3e483f35,0xbf55bec4
.long 0x3f223f6d,0xbe953e48,0xbf46bec4,0xbf75bf7b
.long 0xbf6dbf80,0xbec4bf35,0xbf6dbf80,0xbec4bf35
.long 0x3f7f3f6d,0x3f623f7b,0xbdc9bec4,0x3ef13e48
.long 0xbf55bf35,0xbf7bbf6d,0x3f553f35,0x3f7b3f6d
.long 0x3ef13ec4,0x3f223f0e,0x3f623f6d,0x3f463f55
.long 0xbf800000,0x3f80250d,0xbf800000,0x3f80250d
.long 0x3f22bf35,0xbef13f55,0xbf46bf35,0x3f623f0e
.long 0x3e483f80,0xbf0ebf6d,0xbe48bf80,0x3f0e3f6d
.long 0xbf62bf35,0x3f7f3e48,0x3ef1bf35,0x3dc93f7b
.long 0x3f6d250d,0xbec43f35,0x3f6d250d,0xbec43f35
.long 0xbe953f35,0xbf22bf7b,0x3f753f35,0xbf463e48
.long 0xbf0ebf80,0x3f7b3ec4,0x3f0e3f80,0xbf7bbec4
.long 0x3f7f3f35,0xbe953f0e,0xbdc93f35,0xbf75bf55
.long 0xbf350000,0xbf35bf80,0xbf350000,0xbf35bf80
.long 0xbdc9bf35,0x3f753f0e,0xbf7fbf35,0xbe95bf55
.long 0x3f553f80,0xbe483ec4,0xbf55bf80,0x3e48bec4
.long 0xbf75bf35,0xbf46bf7b,0xbe95bf35,0x3f223e48
.long 0x3ec4250d,0x3f6d3f35,0x3ec4250d,0x3f6d3f35
.long 0x3ef13f35,0xbdc93e48,0x3f623f35,0x3f7f3f7b
.long 0xbf7bbf80,0xbf55bf6d,0x3f7b3f80,0x3f553f6d
.long 0x3f463f35,0x3f623f55,0x3f223f35,0x3ef13f0e
.long 0xbf800000,0x3f80250d,0xbf800000,0x3f80250d
.long 0x3e95bf6d,0xbdc93f7b,0xbf75bec4,0x3f7f3e48
.long 0x3f553f35,0xbf7bbec4,0xbf55bf35,0x3f7b3ec4
.long 0xbf463ec4,0x3e95bf55,0xbf22bf6d,0x3f753f0e
.long 0xbec4bf80,0x3f6d3f35,0xbec4bf80,0x3f6d3f35
.long 0x3f7f3ec4,0xbef13f0e,0xbdc9bf6d,0x3f623f55
.long 0xbe483f35,0xbf55bf6d,0x3e48bf35,0x3f553f6d
.long 0xbf62bf6d,0x3f22be48,0x3ef1bec4,0x3f463f7b
.long 0x3f35250d,0x3f353f80,0x3f35250d,0x3f353f80
.long 0x3ef13f6d,0xbf46be48,0x3f623ec4,0x3f223f7b
.long 0xbf7bbf35,0xbf0ebf6d,0x3f7b3f35,0x3f0e3f6d
.long 0x3dc9bec4,0x3f623f0e,0x3f7f3f6d,0x3ef13f55
.long 0x3f6d3f80,0x3ec43f35,0x3f6d3f80,0x3ec43f35
.long 0xbf22bec4,0xbf75bf55,0x3f463f6d,0x3e953f0e
.long 0xbf0ebf35,0xbe48bec4,0x3f0e3f35,0x3e483ec4
.long 0x3f753f6d,0x3f7f3f7b,0x3e953ec4,0x3dc93e48
.long 0x3f7f3f80,0x3f7c3f7e,0x3f273f31,0x3f133f1d
.long 0x3f7a3f7f,0x3f5f3f6f,0xbf58bf42,0xbf77bf6a
.long 0x3f6f3f7e,0x3f273f51,0xbecfbf1d,0x3d97be2f
.long 0x3f5f3f7c,0x3eb83f27,0x3f773f51,0x3f6a3f7f
.long 0x3f4a3f7a,0x3cc93ee6,0x3dfb3f09,0xbf31bea1
.long 0x3f313f77,0xbea13e60,0xbf80bf5f,0xbee6bf58
.long 0x3f133f73,0xbf1dbcc9,0x3e2fbee6,0x3f7e3f39
.long 0x3ee63f6f,0xbf58be89,0x3f733f6a,0xbe603efc
.long 0x3ea13f6a,0xbf7abefc,0xbee63eb8,0xbf58bf77
.long 0x3e2f3f65,0xbf7ebf31,0xbf51bf73,0x3f4abcc9
.long 0x3cc93f5f,0xbf65bf58,0x3f31be89,0x3ea13f7a
.long 0xbdfb3f58,0xbf31bf73,0x3f1d3f7a,0xbf80bee6
.long 0xbe893f51,0xbecfbf7f,0xbf5f3e2f,0x3eb8bf42
.long 0xbecf3f4a,0xbd97bf7c,0xbeb8bf7e,0x3f423f51
.long 0xbf093f42,0x3e89bf6a,0x3f7abd97,0xbf5f3eb8
.long 0xbf273f39,0x3f13bf4a,0x3d973f80,0xbe2fbf7e
.long 0x3f773f7a,0x3f6f3f73,0x3efc3f09,0x3ecf3ee6
.long 0x3f313f4a,0x3ee63f13,0xbf80bf7e,0xbf73bf7c
.long 0x3e603ee6,0xbe89bcc9,0x3f093ea1,0x3f5f3f39
.long 0xbea13cc9,0xbf58bf1d,0x3ee63f39,0xbe603dfb
.long 0xbf42becf,0xbf7cbf77,0xbf7fbf6f,0xbf13bf5f
.long 0xbf7cbf42,0xbf1dbf6f,0x3f133d97,0x3f7e3f6a
.long 0xbf6fbf77,0x3d97bf09,0x3ecf3f5f,0xbf42be60
.long 0xbf1dbf7c,0x3f393d97,0xbf7ebf51,0x3cc9bf27
.long 0xbdfbbf51,0x3f803f27,0x3f1dbe2f,0x3f393f7f
.long 0x3ecfbefc,0x3f423f7a,0x3eb83f77,0xbf7fbf09
.long 0x3f51bd97,0x3dfb3f6a,0xbf7cbf27,0x3f1dbeb8
.long 0x3f7f3eb8,0xbf133efc,0x3f27becf,0x3e2f3f77
.long 0x3f653f39,0xbf7abdfb,0x3ea13f80,0xbf58bf4a
.long 0x3f093f73,0xbf5fbf31,0xbf7abee6,0x3f77bcc9
.long 0x3cc93f7e,0xbea1bf7c,0x3f31bf1d,0xbee63f51
.long 0xbefc3f58,0x3ecfbf65,0x3e893f7a,0xbeb8bf73
.long 0x3f653f6a,0x3f583f5f,0x3ea13eb8,0x3e603e89
.long 0x3e2f3ea1,0xbdfb3cc9,0xbf51bf65,0xbf1dbf39
.long 0xbf31befc,0xbf73bf58,0x3f803f77,0x3f653f7a
.long 0xbf7ebf7a,0xbf31bf65,0xbf4abf09,0xbf80bf73
.long 0xbefcbf51,0x3eb8bd97,0x3e89be2f,0x3f6a3f27
.long 0x3ecfbdfb,0x3f7f3f51,0x3eb83f4a,0xbf27be2f
.long 0x3f7a3f27,0x3efc3f6a,0xbf58bf7f,0x3e89beb8
.long 0x3f423f80,0xbf133dfb,0x3f7f3f31,0x3e2f3f4a
.long 0xbd973f31,0xbf7cbf4a,0xbf42bcc9,0xbf13bf7e
.long 0xbf58bd97,0xbe89bf6f,0x3e60bf27,0x3f5f3f6a
.long 0xbf6fbf4a,0x3f42be2f,0x3ecf3f7e,0xbf7fbf13
.long 0xbe89bf7c,0x3f6a3f42,0xbf5fbf51,0x3f6f3d97
.long 0x3f1dbf09,0x3cc93f73,0x3f7e3e60,0xbf313ee6
.long 0x3f803e89,0xbf653e60,0xbf393efc,0x3ea1bf58
.long 0x3f133f65,0xbf4abf39,0x3e2fbf73,0x3dfb3f80
.long 0xbea13f6f,0x3e60bf77,0x3ee63f6a,0xbf09bf5f
.long 0x3f4a3f51,0x3f393f42,0x3dfb3e2f,0x3cc93d97
.long 0xbecfbe89,0xbf27bf09,0xbeb8befc,0xbd97be60
.long 0xbf7cbf7f,0xbf4abf6a,0x3f133f42,0x3dfb3eb8
.long 0xbd97becf,0x3f133e89,0xbf42bf6f,0xbe2fbefc
.long 0x3f733f39,0x3f583f7e,0x3f653f80,0x3e603f1d
.long 0x3f093f65,0xbefc3cc9,0xbf7abf73,0xbe89bf39
.long 0xbf31bdfb,0xbf65bf7c,0x3f803f4a,0x3ea13f51
.long 0xbf5fbf7a,0x3ecfbea1,0xbf77bf09,0xbeb8bf65
.long 0x3e89bf09,0x3f6f3f65,0x3f5f3e60,0x3ecf3f73
.long 0x3f803f1d,0xbea13f13,0xbf393dfb,0xbee6bf7c
.long 0x3e603f73,0xbf77bf39,0x3f09bee6,0x3efc3f80
.long 0xbf653cc9,0x3e60bf4a,0xbea13f39,0xbf09bf7e
.long 0xbf27bf6f,0x3f7c3efc,0x3d97bf6a,0x3f133f77
.long 0x3f13bf27,0xbdfb3f6f,0x3e2f3f7f,0xbf1dbf6a
.long 0x3f6f3efc,0xbf7fbe60,0xbecfbf77,0x3f273f58
.long 0xbdfb3f7c,0x3cc9bf7f,0x3f1d3f51,0xbf31bf42
.long 0xbd97bcc9,0xbe2fbdfb,0xbf42bf39,0xbf51bf4a
.long 0x3e603d97,0x3efc3eb8,0x3f093f27,0x3e893ecf
.long 0xbeb8bdfb,0xbf42bf13,0x3f6a3f4a,0x3f7f3f7c
.long 0x3efc3e2f,0x3f6f3f42,0xbe89bf13,0x3ecf3d97
.long 0xbf1dbe60,0xbf80bf65,0xbf7ebf58,0xbf39bf73
.long 0x3f393e89,0x3f733f7a,0xbcc93efc,0xbf65bf09
.long 0xbf51bea1,0xbf4abf80,0x3f7c3f65,0x3dfb3f31
.long 0x3f653eb8,0x3f093f77,0x3ea1becf,0x3f7a3f5f
.long 0xbf73becf,0xbe60bf5f,0xbf65bf6f,0x3f09be89
.long 0x3f7c3ee6,0xbdfb3f39,0xbf133ea1,0xbf1dbf80
.long 0xbf80befc,0x3ee6bf09,0x3f393f77,0xbf73be60
.long 0x3f7e3f09,0xbf393ea1,0x3f4abe60,0xbcc93f65
.long 0xbf77bf13,0x3f6abd97,0xbefcbf7c,0x3f6f3f27
.long 0x3f6a3f1d,0xbf7fbe2f,0xbf6f3dfb,0x3f27bf13
.long 0xbf58bf27,0x3f773ecf,0x3e603f7f,0xbefcbf6f
.long 0x3f423f31,0xbf51bf1d,0x3f7fbcc9,0xbf7c3dfb
.long 0xbe89be60,0xbeb8bea1,0xbf5fbf58,0xbf6abf65
.long 0x3f393f1d,0x3f653f51,0xbcc93dfb,0xbea1be2f
.long 0xbf7abf65,0xbf77bf80,0x3f583f73,0x3efc3f31
.long 0x3f733f80,0x3f093f4a,0x3f653f31,0x3f7a3f7e
.long 0xbf27bf6a,0x3e2fbe89,0x3d97beb8,0x3f513efc
.long 0x3e2f3f27,0xbf4abeb8,0xbf51bf7f,0x3dfbbecf
.long 0x3eb8be89,0x3f7f3f58,0xbf6abefc,0xbf27bf7a
.long 0xbf4abe2f,0xbf31bf7f,0xbdfb3f13,0xbf80bf42
.long 0x3f7e3f13,0x3cc93f42,0x3f4a3f7c,0xbf313d97
.long 0xbf6abf5f,0x3f27be60,0x3f6f3e89,0x3d973f58
.long 0x3f133f7f,0xbf7ebecf,0x3e2fbf42,0x3f4a3f6f
.long 0xbd97bf6f,0x3f513f5f,0xbf42bf6a,0x3f7c3e89
.long 0xbee63f31,0xbe60bf7e,0xbf73bcc9,0x3f09bf1d
.long 0x3f58bea1,0xbefc3f39,0xbe603f65,0xbe89bf80
.long 0xbf80bdfb,0x3f73be2f,0x3f393f4a,0xbf65bf13
.long 0x3f5f3f09,0xbf6abee6,0x3f77be60,0xbf6f3ea1
.long 0xbee6becf,0xbf09befc,0xbf73bf6f,0xbf7abf77
.long 0x3f7c3f73,0x3f7e3f80,0xbf13bee6,0xbf4abf31
.long 0xbf39bf5f,0xbea1bf09,0x3cc93e89,0xbee6be60
.long 0xbdfb3e60,0xbf39bee6,0x3f1d3f58,0xbcc93ea1
.long 0x3f5f3f13,0x3f6f3f7f,0x3f773f7c,0x3ecf3f42
.long 0xbf6abf7e,0xbd97bf13,0x3f6f3f1d,0x3f423f7c
.long 0x3e603f42,0xbf5fbecf,0x3f09bd97,0x3f773f6f
.long 0x3f27bcc9,0x3f513f7e,0xbd97bf39,0x3f7c3f1d
.long 0xbf7fbf39,0x3e2fbf1d,0xbf27bf80,0x3f513dfb
.long 0x3f093f7f,0xbf77beb8,0xbf7abf42,0x3efcbecf
.long 0x3eb8bf1d,0x3f273f7c,0xbf6abdfb,0x3d97bf51
.long 0xbf77be2f,0x3ecfbf27,0xbefc3f13,0xbeb8bf7f
.long 0x3f4a3f58,0xbf80bea1,0x3dfb3f7a,0xbf39bf65
.long 0x3cc9bf77,0x3ee63f7a,0x3f313f5f,0xbf73bf09
.long 0xbf513ee6,0x3f1dbf31,0x3f7c3ea1,0xbf7ebcc9
.long 0x3f733eb8,0xbf7abe89,0x3f65becf,0xbf583efc
.long 0xbf1dbf13,0xbf31bf27,0xbf7ebf7c,0xbf80bf7f
.long 0x3f6a3f77,0x3f423f58,0xbf6fbf5f,0xbf7fbf7a
.long 0x3e2fbd97,0x3f1d3ecf,0xbf51bf27,0xbf7ebf6f
.long 0xbf7fbf6a,0xbf51bf77,0xbf27beb8,0xbf7cbf5f
.long 0x3ea13f31,0xbf09bdfb,0xbee6bcc9,0xbf7abf4a
.long 0x3f583ee6,0x3f5f3f80,0xbe603ea1,0xbf77bf31
.long 0xbf39bf7e,0x3ee6be2f,0x3cc93f1d,0xbf73bf13
.long 0xbefc3e60,0xbf6abf73,0x3e893f58,0xbf6fbee6
.long 0x3f773f58,0xbeb83ee6,0x3efc3f7a,0xbf6abea1
.long 0x3cc9bf4a,0x3f733f51,0x3f313f7e,0xbf65be2f
.long 0xbf7abea1,0x3e89bf31,0x3f583f65,0xbf5fbcc9
.long 0x3ee63f80,0xbf7abf1d,0x3f733f31,0xbf583dfb
.long 0x3f42beb8,0xbe2f3f5f,0x3f7f3ecf,0xbf513e89
.long 0xbf51bf42,0x3f7e3eb8,0x3f7c3d97,0xbf4a3ecf
.long 0xbeb83f5f,0x3d97bf7a,0x3f6abe89,0xbf423f09
.long 0x3f7e3e2f,0xbf80bd97,0x3f4abf13,0xbf393f27
.long 0xbf423f31,0x3f51bf1d,0xbf7fbcc9,0x3f7c3dfb
.long 0xbf583f27,0x3f77becf,0x3e60bf7f,0xbefc3f6f
.long 0xbf6a3f1d,0x3f7fbe2f,0x3f6f3dfb,0xbf27bf13
.long 0xbf773f13,0x3f6a3d97,0xbefc3f7c,0x3f6fbf27
.long 0xbf7e3f09,0x3f393ea1,0xbf4abe60,0x3cc93f65
.long 0xbf803efc,0x3ee63f09,0x3f39bf77,0xbf733e60
.long 0xbf7c3ee6,0x3dfb3f39,0x3f133ea1,0x3f1dbf80
.long 0xbf733ecf,0xbe603f5f,0xbf653f6f,0x3f093e89
.long 0xbf653eb8,0xbf093f77,0xbea1becf,0xbf7a3f5f
.long 0xbf513ea1,0xbf4a3f80,0x3f7cbf65,0x3dfbbf31
.long 0xbf393e89,0xbf733f7a,0x3cc93efc,0x3f65bf09
.long 0xbf1d3e60,0xbf803f65,0xbf7e3f58,0xbf393f73
.long 0xbefc3e2f,0xbf6f3f42,0x3e89bf13,0xbecf3d97
.long 0xbeb83dfb,0xbf423f13,0x3f6abf4a,0x3f7fbf7c
.long 0xbe603d97,0xbefc3eb8,0xbf093f27,0xbe893ecf
.long 0xbd973cc9,0xbe2f3dfb,0xbf423f39,0xbf513f4a
.long 0xbf5f3f09,0x3f6abee6,0xbf77be60,0x3f6f3ea1
.long 0xbf803dfb,0x3f733e2f,0x3f39bf4a,0xbf653f13
.long 0xbf58bea1,0x3efc3f39,0x3e603f65,0x3e89bf80
.long 0xbee6bf31,0xbe603f7e,0xbf733cc9,0x3f093f1d
.long 0x3d97bf6f,0xbf513f5f,0x3f42bf6a,0xbf7c3e89
.long 0x3f13bf7f,0xbf7e3ecf,0x3e2f3f42,0x3f4abf6f
.long 0x3f6abf5f,0xbf27be60,0xbf6f3e89,0xbd973f58
.long 0x3f7ebf13,0x3cc9bf42,0x3f4abf7c,0xbf31bd97
.long 0x3f4abe2f,0x3f31bf7f,0x3dfb3f13,0x3f80bf42
.long 0x3eb83e89,0x3f7fbf58,0xbf6a3efc,0xbf273f7a
.long 0xbe2f3f27,0x3f4abeb8,0x3f51bf7f,0xbdfbbecf
.long 0xbf273f6a,0x3e2f3e89,0x3d973eb8,0x3f51befc
.long 0xbf733f80,0xbf093f4a,0xbf653f31,0xbf7a3f7e
.long 0xbf7a3f65,0xbf773f80,0x3f58bf73,0x3efcbf31
.long 0xbf393f1d,0xbf653f51,0x3cc93dfb,0x3ea1be2f
.long 0xbe893e60,0xbeb83ea1,0xbf5f3f58,0xbf6a3f65
.long 0xbf733eb8,0x3f7abe89,0xbf65becf,0x3f583efc
.long 0xbf51bee6,0x3f1d3f31,0x3f7cbea1,0xbf7e3cc9
.long 0xbcc9bf77,0xbee63f7a,0xbf313f5f,0x3f73bf09
.long 0x3f4abf58,0xbf803ea1,0x3dfbbf7a,0xbf393f65
.long 0x3f77be2f,0xbecfbf27,0x3efc3f13,0x3eb8bf7f
.long 0x3eb83f1d,0x3f27bf7c,0xbf6a3dfb,0x3d973f51
.long 0xbf093f7f,0x3f77beb8,0x3f7abf42,0xbefcbecf
.long 0xbf7f3f39,0x3e2f3f1d,0xbf273f80,0x3f51bdfb
.long 0xbf27bcc9,0xbf513f7e,0x3d97bf39,0xbf7c3f1d
.long 0x3e60bf42,0xbf5f3ecf,0x3f093d97,0x3f77bf6f
.long 0x3f6abf7e,0x3d97bf13,0xbf6f3f1d,0xbf423f7c
.long 0x3f5fbf13,0x3f6fbf7f,0x3f77bf7c,0x3ecfbf42
.long 0x3dfb3e60,0x3f39bee6,0xbf1d3f58,0x3cc93ea1
.long 0xbf393f5f,0xbea13f09,0x3cc9be89,0xbee63e60
.long 0xbf7c3f73,0xbf7e3f80,0x3f13bee6,0x3f4abf31
.long 0xbee63ecf,0xbf093efc,0xbf733f6f,0xbf7a3f77
.long 0xbf7e3e2f,0x3f80bd97,0xbf4abf13,0x3f393f27
.long 0xbeb8bf5f,0x3d973f7a,0x3f6a3e89,0xbf42bf09
.long 0x3f51bf42,0xbf7e3eb8,0xbf7c3d97,0x3f4a3ecf
.long 0x3f423eb8,0xbe2fbf5f,0x3f7fbecf,0xbf51be89
.long 0xbee63f80,0x3f7abf1d,0xbf733f31,0x3f583dfb
.long 0xbf7a3ea1,0x3e893f31,0x3f58bf65,0xbf5f3cc9
.long 0xbcc9bf4a,0xbf733f51,0xbf313f7e,0x3f65be2f
.long 0x3f77bf58,0xbeb8bee6,0x3efcbf7a,0xbf6a3ea1
.long 0x3efc3e60,0x3f6abf73,0xbe893f58,0x3f6fbee6
.long 0xbf393f7e,0x3ee63e2f,0x3cc9bf1d,0xbf733f13
.long 0xbf583ee6,0xbf5f3f80,0x3e603ea1,0x3f77bf31
.long 0x3ea1bf31,0xbf093dfb,0xbee63cc9,0xbf7a3f4a
.long 0x3f7fbf6a,0x3f51bf77,0x3f27beb8,0x3f7cbf5f
.long 0x3e2f3d97,0x3f1dbecf,0xbf513f27,0xbf7e3f6f
.long 0xbf6a3f77,0xbf423f58,0x3f6fbf5f,0x3f7fbf7a
.long 0xbf1d3f13,0xbf313f27,0xbf7e3f7c,0xbf803f7f
.long 0xbf27bf39,0x3f133f4a,0x3d97bf80,0xbe2f3f7e
.long 0x3f093f42,0xbe89bf6a,0xbf7abd97,0x3f5f3eb8
.long 0xbecfbf4a,0xbd973f7c,0xbeb83f7e,0x3f42bf51
.long 0x3e893f51,0x3ecfbf7f,0x3f5f3e2f,0xbeb8bf42
.long 0xbdfbbf58,0xbf313f73,0x3f1dbf7a,0xbf803ee6
.long 0xbcc93f5f,0x3f65bf58,0xbf31be89,0xbea13f7a
.long 0x3e2fbf65,0xbf7e3f31,0xbf513f73,0x3f4a3cc9
.long 0xbea13f6a,0x3f7abefc,0x3ee63eb8,0x3f58bf77
.long 0x3ee6bf6f,0xbf583e89,0x3f73bf6a,0xbe60befc
.long 0xbf133f73,0x3f1dbcc9,0xbe2fbee6,0xbf7e3f39
.long 0x3f31bf77,0xbea1be60,0xbf803f5f,0xbee63f58
.long 0xbf4a3f7a,0xbcc93ee6,0xbdfb3f09,0x3f31bea1
.long 0x3f5fbf7c,0x3eb8bf27,0x3f77bf51,0x3f6abf7f
.long 0xbf6f3f7e,0xbf273f51,0x3ecfbf1d,0xbd97be2f
.long 0x3f7abf7f,0x3f5fbf6f,0xbf583f42,0xbf773f6a
.long 0xbf7f3f80,0xbf7c3f7e,0xbf273f31,0xbf133f1d
.long 0xbefcbf58,0x3ecf3f65,0x3e89bf7a,0xbeb83f73
.long 0xbcc93f7e,0x3ea1bf7c,0xbf31bf1d,0x3ee63f51
.long 0x3f09bf73,0xbf5f3f31,0xbf7a3ee6,0x3f773cc9
.long 0xbf653f39,0x3f7abdfb,0xbea13f80,0x3f58bf4a
.long 0x3f7fbeb8,0xbf13befc,0x3f273ecf,0x3e2fbf77
.long 0xbf51bd97,0xbdfb3f6a,0x3f7cbf27,0xbf1dbeb8
.long 0x3ecf3efc,0x3f42bf7a,0x3eb8bf77,0xbf7f3f09
.long 0x3dfbbf51,0xbf803f27,0xbf1dbe2f,0xbf393f7f
.long 0xbf1d3f7c,0x3f39bd97,0xbf7e3f51,0x3cc93f27
.long 0x3f6fbf77,0xbd97bf09,0xbecf3f5f,0x3f42be60
.long 0xbf7c3f42,0xbf1d3f6f,0x3f13bd97,0x3f7ebf6a
.long 0x3f42becf,0x3f7cbf77,0x3f7fbf6f,0x3f13bf5f
.long 0xbea1bcc9,0xbf583f1d,0x3ee6bf39,0xbe60bdfb
.long 0xbe603ee6,0x3e89bcc9,0xbf093ea1,0xbf5f3f39
.long 0x3f31bf4a,0x3ee6bf13,0xbf803f7e,0xbf733f7c
.long 0xbf773f7a,0xbf6f3f73,0xbefc3f09,0xbecf3ee6
.long 0xbea1bf6f,0x3e603f77,0x3ee6bf6a,0xbf093f5f
.long 0xbf133f65,0x3f4abf39,0xbe2fbf73,0xbdfb3f80
.long 0x3f80be89,0xbf65be60,0xbf39befc,0x3ea13f58
.long 0xbf1dbf09,0xbcc93f73,0xbf7e3e60,0x3f313ee6
.long 0xbe893f7c,0x3f6abf42,0xbf5f3f51,0x3f6fbd97
.long 0x3f6fbf4a,0xbf42be2f,0xbecf3f7e,0x3f7fbf13
.long 0xbf583d97,0xbe893f6f,0x3e603f27,0x3f5fbf6a
.long 0x3d973f31,0x3f7cbf4a,0x3f42bcc9,0x3f13bf7e
.long 0x3f42bf80,0xbf13bdfb,0x3f7fbf31,0x3e2fbf4a
.long 0xbf7a3f27,0xbefc3f6a,0x3f58bf7f,0xbe89beb8
.long 0x3ecf3dfb,0x3f7fbf51,0x3eb8bf4a,0xbf273e2f
.long 0x3efcbf51,0xbeb8bd97,0xbe89be2f,0xbf6a3f27
.long 0xbf7e3f7a,0xbf313f65,0xbf4a3f09,0xbf803f73
.long 0x3f31befc,0x3f73bf58,0xbf803f77,0xbf653f7a
.long 0x3e2fbea1,0xbdfbbcc9,0xbf513f65,0xbf1d3f39
.long 0xbf653f6a,0xbf583f5f,0xbea13eb8,0xbe603e89
.long 0xbdfbbf7c,0x3cc93f7f,0x3f1dbf51,0xbf313f42
.long 0xbf6f3efc,0x3f7fbe60,0x3ecfbf77,0xbf273f58
.long 0x3f133f27,0xbdfbbf6f,0x3e2fbf7f,0xbf1d3f6a
.long 0x3f27bf6f,0xbf7c3efc,0xbd97bf6a,0xbf133f77
.long 0xbf65bcc9,0x3e603f4a,0xbea1bf39,0xbf093f7e
.long 0xbe603f73,0x3f77bf39,0xbf09bee6,0xbefc3f80
.long 0x3f80bf1d,0xbea1bf13,0xbf39bdfb,0xbee63f7c
.long 0xbe89bf09,0xbf6f3f65,0xbf5f3e60,0xbecf3f73
.long 0xbf5f3f7a,0x3ecf3ea1,0xbf773f09,0xbeb83f65
.long 0x3f31bdfb,0x3f65bf7c,0xbf803f4a,0xbea13f51
.long 0x3f09bf65,0xbefcbcc9,0xbf7a3f73,0xbe893f39
.long 0xbf733f39,0xbf583f7e,0xbf653f80,0xbe603f1d
.long 0xbd973ecf,0x3f13be89,0xbf423f6f,0xbe2f3efc
.long 0x3f7cbf7f,0x3f4abf6a,0xbf133f42,0xbdfb3eb8
.long 0xbecf3e89,0xbf273f09,0xbeb83efc,0xbd973e60
.long 0xbf4a3f51,0xbf393f42,0xbdfb3e2f,0xbcc93d97
.long 0x3d97bcc9,0x3e2fbdfb,0x3f42bf39,0x3f51bf4a
.long 0x3e60bd97,0x3efcbeb8,0x3f09bf27,0x3e89becf
.long 0x3eb8bdfb,0x3f42bf13,0xbf6a3f4a,0xbf7f3f7c
.long 0x3efcbe2f,0x3f6fbf42,0xbe893f13,0x3ecfbd97
.long 0x3f1dbe60,0x3f80bf65,0x3f7ebf58,0x3f39bf73
.long 0x3f39be89,0x3f73bf7a,0xbcc9befc,0xbf653f09
.long 0x3f51bea1,0x3f4abf80,0xbf7c3f65,0xbdfb3f31
.long 0x3f65beb8,0x3f09bf77,0x3ea13ecf,0x3f7abf5f
.long 0x3f73becf,0x3e60bf5f,0x3f65bf6f,0xbf09be89
.long 0x3f7cbee6,0xbdfbbf39,0xbf13bea1,0xbf1d3f80
.long 0x3f80befc,0xbee6bf09,0xbf393f77,0x3f73be60
.long 0x3f7ebf09,0xbf39bea1,0x3f4a3e60,0xbcc9bf65
.long 0x3f77bf13,0xbf6abd97,0x3efcbf7c,0xbf6f3f27
.long 0x3f6abf1d,0xbf7f3e2f,0xbf6fbdfb,0x3f273f13
.long 0x3f58bf27,0xbf773ecf,0xbe603f7f,0x3efcbf6f
.long 0x3f42bf31,0xbf513f1d,0x3f7f3cc9,0xbf7cbdfb
.long 0x3e89be60,0x3eb8bea1,0x3f5fbf58,0x3f6abf65
.long 0x3f39bf1d,0x3f65bf51,0xbcc9bdfb,0xbea13e2f
.long 0x3f7abf65,0x3f77bf80,0xbf583f73,0xbefc3f31
.long 0x3f73bf80,0x3f09bf4a,0x3f65bf31,0x3f7abf7e
.long 0x3f27bf6a,0xbe2fbe89,0xbd97beb8,0xbf513efc
.long 0x3e2fbf27,0xbf4a3eb8,0xbf513f7f,0x3dfb3ecf
.long 0xbeb8be89,0xbf7f3f58,0x3f6abefc,0x3f27bf7a
.long 0xbf4a3e2f,0xbf313f7f,0xbdfbbf13,0xbf803f42
.long 0xbf7e3f13,0xbcc93f42,0xbf4a3f7c,0x3f313d97
.long 0xbf6a3f5f,0x3f273e60,0x3f6fbe89,0x3d97bf58
.long 0xbf133f7f,0x3f7ebecf,0xbe2fbf42,0xbf4a3f6f
.long 0xbd973f6f,0x3f51bf5f,0xbf423f6a,0x3f7cbe89
.long 0x3ee63f31,0x3e60bf7e,0x3f73bcc9,0xbf09bf1d
.long 0x3f583ea1,0xbefcbf39,0xbe60bf65,0xbe893f80
.long 0x3f80bdfb,0xbf73be2f,0xbf393f4a,0x3f65bf13
.long 0x3f5fbf09,0xbf6a3ee6,0x3f773e60,0xbf6fbea1
.long 0x3ee6becf,0x3f09befc,0x3f73bf6f,0x3f7abf77
.long 0x3f7cbf73,0x3f7ebf80,0xbf133ee6,0xbf4a3f31
.long 0x3f39bf5f,0x3ea1bf09,0xbcc93e89,0x3ee6be60
.long 0xbdfbbe60,0xbf393ee6,0x3f1dbf58,0xbcc9bea1
.long 0xbf5f3f13,0xbf6f3f7f,0xbf773f7c,0xbecf3f42
.long 0xbf6a3f7e,0xbd973f13,0x3f6fbf1d,0x3f42bf7c
.long 0xbe603f42,0x3f5fbecf,0xbf09bd97,0xbf773f6f
.long 0x3f273cc9,0x3f51bf7e,0xbd973f39,0x3f7cbf1d
.long 0x3f7fbf39,0xbe2fbf1d,0x3f27bf80,0xbf513dfb
.long 0x3f09bf7f,0xbf773eb8,0xbf7a3f42,0x3efc3ecf
.long 0xbeb8bf1d,0xbf273f7c,0x3f6abdfb,0xbd97bf51
.long 0xbf773e2f,0x3ecf3f27,0xbefcbf13,0xbeb83f7f
.long 0xbf4a3f58,0x3f80bea1,0xbdfb3f7a,0x3f39bf65
.long 0x3cc93f77,0x3ee6bf7a,0x3f31bf5f,0xbf733f09
.long 0x3f513ee6,0xbf1dbf31,0xbf7c3ea1,0x3f7ebcc9
.long 0x3f73beb8,0xbf7a3e89,0x3f653ecf,0xbf58befc
.long 0x3f1dbf13,0x3f31bf27,0x3f7ebf7c,0x3f80bf7f
.long 0x3f6abf77,0x3f42bf58,0xbf6f3f5f,0xbf7f3f7a
.long 0xbe2fbd97,0xbf1d3ecf,0x3f51bf27,0x3f7ebf6f
.long 0xbf7f3f6a,0xbf513f77,0xbf273eb8,0xbf7c3f5f
.long 0xbea13f31,0x3f09bdfb,0x3ee6bcc9,0x3f7abf4a
.long 0x3f58bee6,0x3f5fbf80,0xbe60bea1,0xbf773f31
.long 0x3f39bf7e,0xbee6be2f,0xbcc93f1d,0x3f73bf13
.long 0xbefcbe60,0xbf6a3f73,0x3e89bf58,0xbf6f3ee6
.long 0xbf773f58,0x3eb83ee6,0xbefc3f7a,0x3f6abea1
.long 0x3cc93f4a,0x3f73bf51,0x3f31bf7e,0xbf653e2f
.long 0x3f7abea1,0xbe89bf31,0xbf583f65,0x3f5fbcc9
.long 0x3ee6bf80,0xbf7a3f1d,0x3f73bf31,0xbf58bdfb
.long 0xbf42beb8,0x3e2f3f5f,0xbf7f3ecf,0x3f513e89
.long 0xbf513f42,0x3f7ebeb8,0x3f7cbd97,0xbf4abecf
.long 0x3eb83f5f,0xbd97bf7a,0xbf6abe89,0x3f423f09
.long 0x3f7ebe2f,0xbf803d97,0x3f4a3f13,0xbf39bf27
.long 0x3f7fbf80,0x3f7cbf7e,0x3f27bf31,0x3f13bf1d
.long 0xbf7a3f7f,0xbf5f3f6f,0x3f58bf42,0x3f77bf6a
.long 0x3f6fbf7e,0x3f27bf51,0xbecf3f1d,0x3d973e2f
.long 0xbf5f3f7c,0xbeb83f27,0xbf773f51,0xbf6a3f7f
.long 0x3f4abf7a,0x3cc9bee6,0x3dfbbf09,0xbf313ea1
.long 0xbf313f77,0x3ea13e60,0x3f80bf5f,0x3ee6bf58
.long 0x3f13bf73,0xbf1d3cc9,0x3e2f3ee6,0x3f7ebf39
.long 0xbee63f6f,0x3f58be89,0xbf733f6a,0x3e603efc
.long 0x3ea1bf6a,0xbf7a3efc,0xbee6beb8,0xbf583f77
.long 0xbe2f3f65,0x3f7ebf31,0x3f51bf73,0xbf4abcc9
.long 0x3cc9bf5f,0xbf653f58,0x3f313e89,0x3ea1bf7a
.long 0x3dfb3f58,0x3f31bf73,0xbf1d3f7a,0x3f80bee6
.long 0xbe89bf51,0xbecf3f7f,0xbf5fbe2f,0x3eb83f42
.long 0x3ecf3f4a,0x3d97bf7c,0x3eb8bf7e,0xbf423f51
.long 0xbf09bf42,0x3e893f6a,0x3f7a3d97,0xbf5fbeb8
.long 0x3f273f39,0xbf13bf4a,0xbd973f80,0x3e2fbf7e
.long 0x3f77bf7a,0x3f6fbf73,0x3efcbf09,0x3ecfbee6
.long 0xbf313f4a,0xbee63f13,0x3f80bf7e,0x3f73bf7c
.long 0x3e60bee6,0xbe893cc9,0x3f09bea1,0x3f5fbf39
.long 0x3ea13cc9,0x3f58bf1d,0xbee63f39,0x3e603dfb
.long 0xbf423ecf,0xbf7c3f77,0xbf7f3f6f,0xbf133f5f
.long 0x3f7cbf42,0x3f1dbf6f,0xbf133d97,0xbf7e3f6a
.long 0xbf6f3f77,0x3d973f09,0x3ecfbf5f,0xbf423e60
.long 0x3f1dbf7c,0xbf393d97,0x3f7ebf51,0xbcc9bf27
.long 0xbdfb3f51,0x3f80bf27,0x3f1d3e2f,0x3f39bf7f
.long 0xbecfbefc,0xbf423f7a,0xbeb83f77,0x3f7fbf09
.long 0x3f513d97,0x3dfbbf6a,0xbf7c3f27,0x3f1d3eb8
.long 0xbf7f3eb8,0x3f133efc,0xbf27becf,0xbe2f3f77
.long 0x3f65bf39,0xbf7a3dfb,0x3ea1bf80,0xbf583f4a
.long 0xbf093f73,0x3f5fbf31,0x3f7abee6,0xbf77bcc9
.long 0x3cc9bf7e,0xbea13f7c,0x3f313f1d,0xbee6bf51
.long 0x3efc3f58,0xbecfbf65,0xbe893f7a,0x3eb8bf73
.long 0x3f65bf6a,0x3f58bf5f,0x3ea1beb8,0x3e60be89
.long 0xbe2f3ea1,0x3dfb3cc9,0x3f51bf65,0x3f1dbf39
.long 0xbf313efc,0xbf733f58,0x3f80bf77,0x3f65bf7a
.long 0x3f7ebf7a,0x3f31bf65,0x3f4abf09,0x3f80bf73
.long 0xbefc3f51,0x3eb83d97,0x3e893e2f,0x3f6abf27
.long 0xbecfbdfb,0xbf7f3f51,0xbeb83f4a,0x3f27be2f
.long 0x3f7abf27,0x3efcbf6a,0xbf583f7f,0x3e893eb8
.long 0xbf423f80,0x3f133dfb,0xbf7f3f31,0xbe2f3f4a
.long 0xbd97bf31,0xbf7c3f4a,0xbf423cc9,0xbf133f7e
.long 0x3f58bd97,0x3e89bf6f,0xbe60bf27,0xbf5f3f6a
.long 0xbf6f3f4a,0x3f423e2f,0x3ecfbf7e,0xbf7f3f13
.long 0x3e89bf7c,0xbf6a3f42,0x3f5fbf51,0xbf6f3d97
.long 0x3f1d3f09,0x3cc9bf73,0x3f7ebe60,0xbf31bee6
.long 0xbf803e89,0x3f653e60,0x3f393efc,0xbea1bf58
.long 0x3f13bf65,0xbf4a3f39,0x3e2f3f73,0x3dfbbf80
.long 0x3ea13f6f,0xbe60bf77,0xbee63f6a,0x3f09bf5f
.long 0x3f4abf51,0x3f39bf42,0x3dfbbe2f,0x3cc9bd97
.long 0x3ecfbe89,0x3f27bf09,0x3eb8befc,0x3d97be60
.long 0xbf7c3f7f,0xbf4a3f6a,0x3f13bf42,0x3dfbbeb8
.long 0x3d97becf,0xbf133e89,0x3f42bf6f,0x3e2fbefc
.long 0x3f73bf39,0x3f58bf7e,0x3f65bf80,0x3e60bf1d
.long 0xbf093f65,0x3efc3cc9,0x3f7abf73,0x3e89bf39
.long 0xbf313dfb,0xbf653f7c,0x3f80bf4a,0x3ea1bf51
.long 0x3f5fbf7a,0xbecfbea1,0x3f77bf09,0x3eb8bf65
.long 0x3e893f09,0x3f6fbf65,0x3f5fbe60,0x3ecfbf73
.long 0xbf803f1d,0x3ea13f13,0x3f393dfb,0x3ee6bf7c
.long 0x3e60bf73,0xbf773f39,0x3f093ee6,0x3efcbf80
.long 0x3f653cc9,0xbe60bf4a,0x3ea13f39,0x3f09bf7e
.long 0xbf273f6f,0x3f7cbefc,0x3d973f6a,0x3f13bf77
.long 0xbf13bf27,0x3dfb3f6f,0xbe2f3f7f,0x3f1dbf6a
.long 0x3f6fbefc,0xbf7f3e60,0xbecf3f77,0x3f27bf58
.long 0x3dfb3f7c,0xbcc9bf7f,0xbf1d3f51,0x3f31bf42
.long 0x3f27bf39,0xbf133f4a,0xbd97bf80,0x3e2f3f7e
.long 0x3f09bf42,0xbe893f6a,0xbf7a3d97,0x3f5fbeb8
.long 0x3ecfbf4a,0x3d973f7c,0x3eb83f7e,0xbf42bf51
.long 0x3e89bf51,0x3ecf3f7f,0x3f5fbe2f,0xbeb83f42
.long 0x3dfbbf58,0x3f313f73,0xbf1dbf7a,0x3f803ee6
.long 0xbcc9bf5f,0x3f653f58,0xbf313e89,0xbea1bf7a
.long 0xbe2fbf65,0x3f7e3f31,0x3f513f73,0xbf4a3cc9
.long 0xbea1bf6a,0x3f7a3efc,0x3ee6beb8,0x3f583f77
.long 0xbee6bf6f,0x3f583e89,0xbf73bf6a,0x3e60befc
.long 0xbf13bf73,0x3f1d3cc9,0xbe2f3ee6,0xbf7ebf39
.long 0xbf31bf77,0x3ea1be60,0x3f803f5f,0x3ee63f58
.long 0xbf4abf7a,0xbcc9bee6,0xbdfbbf09,0x3f313ea1
.long 0xbf5fbf7c,0xbeb8bf27,0xbf77bf51,0xbf6abf7f
.long 0xbf6fbf7e,0xbf27bf51,0x3ecf3f1d,0xbd973e2f
.long 0xbf7abf7f,0xbf5fbf6f,0x3f583f42,0x3f773f6a
.long 0xbf7fbf80,0xbf7cbf7e,0xbf27bf31,0xbf13bf1d
.long 0x3efcbf58,0xbecf3f65,0xbe89bf7a,0x3eb83f73
.long 0xbcc9bf7e,0x3ea13f7c,0xbf313f1d,0x3ee6bf51
.long 0xbf09bf73,0x3f5f3f31,0x3f7a3ee6,0xbf773cc9
.long 0xbf65bf39,0x3f7a3dfb,0xbea1bf80,0x3f583f4a
.long 0xbf7fbeb8,0x3f13befc,0xbf273ecf,0xbe2fbf77
.long 0xbf513d97,0xbdfbbf6a,0x3f7c3f27,0xbf1d3eb8
.long 0xbecf3efc,0xbf42bf7a,0xbeb8bf77,0x3f7f3f09
.long 0x3dfb3f51,0xbf80bf27,0xbf1d3e2f,0xbf39bf7f
.long 0x3f1d3f7c,0xbf39bd97,0x3f7e3f51,0xbcc93f27
.long 0x3f6f3f77,0xbd973f09,0xbecfbf5f,0x3f423e60
.long 0x3f7c3f42,0x3f1d3f6f,0xbf13bd97,0xbf7ebf6a
.long 0x3f423ecf,0x3f7c3f77,0x3f7f3f6f,0x3f133f5f
.long 0x3ea1bcc9,0x3f583f1d,0xbee6bf39,0x3e60bdfb
.long 0xbe60bee6,0x3e893cc9,0xbf09bea1,0xbf5fbf39
.long 0xbf31bf4a,0xbee6bf13,0x3f803f7e,0x3f733f7c
.long 0xbf77bf7a,0xbf6fbf73,0xbefcbf09,0xbecfbee6
.long 0x3ea1bf6f,0xbe603f77,0xbee6bf6a,0x3f093f5f
.long 0xbf13bf65,0x3f4a3f39,0xbe2f3f73,0xbdfbbf80
.long 0xbf80be89,0x3f65be60,0x3f39befc,0xbea13f58
.long 0xbf1d3f09,0xbcc9bf73,0xbf7ebe60,0x3f31bee6
.long 0x3e893f7c,0xbf6abf42,0x3f5f3f51,0xbf6fbd97
.long 0x3f6f3f4a,0xbf423e2f,0xbecfbf7e,0x3f7f3f13
.long 0x3f583d97,0x3e893f6f,0xbe603f27,0xbf5fbf6a
.long 0x3d97bf31,0x3f7c3f4a,0x3f423cc9,0x3f133f7e
.long 0xbf42bf80,0x3f13bdfb,0xbf7fbf31,0xbe2fbf4a
.long 0xbf7abf27,0xbefcbf6a,0x3f583f7f,0xbe893eb8
.long 0xbecf3dfb,0xbf7fbf51,0xbeb8bf4a,0x3f273e2f
.long 0x3efc3f51,0xbeb83d97,0xbe893e2f,0xbf6abf27
.long 0x3f7e3f7a,0x3f313f65,0x3f4a3f09,0x3f803f73
.long 0x3f313efc,0x3f733f58,0xbf80bf77,0xbf65bf7a
.long 0xbe2fbea1,0x3dfbbcc9,0x3f513f65,0x3f1d3f39
.long 0xbf65bf6a,0xbf58bf5f,0xbea1beb8,0xbe60be89
.long 0x3dfbbf7c,0xbcc93f7f,0xbf1dbf51,0x3f313f42
.long 0xbf6fbefc,0x3f7f3e60,0x3ecf3f77,0xbf27bf58
.long 0xbf133f27,0x3dfbbf6f,0xbe2fbf7f,0x3f1d3f6a
.long 0x3f273f6f,0xbf7cbefc,0xbd973f6a,0xbf13bf77
.long 0x3f65bcc9,0xbe603f4a,0x3ea1bf39,0x3f093f7e
.long 0xbe60bf73,0x3f773f39,0xbf093ee6,0xbefcbf80
.long 0xbf80bf1d,0x3ea1bf13,0x3f39bdfb,0x3ee63f7c
.long 0xbe893f09,0xbf6fbf65,0xbf5fbe60,0xbecfbf73
.long 0x3f5f3f7a,0xbecf3ea1,0x3f773f09,0x3eb83f65
.long 0x3f313dfb,0x3f653f7c,0xbf80bf4a,0xbea1bf51
.long 0xbf09bf65,0x3efcbcc9,0x3f7a3f73,0x3e893f39
.long 0xbf73bf39,0xbf58bf7e,0xbf65bf80,0xbe60bf1d
.long 0x3d973ecf,0xbf13be89,0x3f423f6f,0x3e2f3efc
.long 0x3f7c3f7f,0x3f4a3f6a,0xbf13bf42,0xbdfbbeb8
.long 0x3ecf3e89,0x3f273f09,0x3eb83efc,0x3d973e60
.long 0xbf4abf51,0xbf39bf42,0xbdfbbe2f,0xbcc9bd97
.long 0xbf42bf31,0x3f513f1d,0xbf7f3cc9,0x3f7cbdfb
.long 0x3f583f27,0xbf77becf,0xbe60bf7f,0x3efc3f6f
.long 0xbf6abf1d,0x3f7f3e2f,0x3f6fbdfb,0xbf273f13
.long 0x3f773f13,0xbf6a3d97,0x3efc3f7c,0xbf6fbf27
.long 0xbf7ebf09,0x3f39bea1,0xbf4a3e60,0x3cc9bf65
.long 0x3f803efc,0xbee63f09,0xbf39bf77,0x3f733e60
.long 0xbf7cbee6,0x3dfbbf39,0x3f13bea1,0x3f1d3f80
.long 0x3f733ecf,0x3e603f5f,0x3f653f6f,0xbf093e89
.long 0xbf65beb8,0xbf09bf77,0xbea13ecf,0xbf7abf5f
.long 0x3f513ea1,0x3f4a3f80,0xbf7cbf65,0xbdfbbf31
.long 0xbf39be89,0xbf73bf7a,0x3cc9befc,0x3f653f09
.long 0x3f1d3e60,0x3f803f65,0x3f7e3f58,0x3f393f73
.long 0xbefcbe2f,0xbf6fbf42,0x3e893f13,0xbecfbd97
.long 0x3eb83dfb,0x3f423f13,0xbf6abf4a,0xbf7fbf7c
.long 0xbe60bd97,0xbefcbeb8,0xbf09bf27,0xbe89becf
.long 0x3d973cc9,0x3e2f3dfb,0x3f423f39,0x3f513f4a
.long 0xbf5fbf09,0x3f6a3ee6,0xbf773e60,0x3f6fbea1
.long 0x3f803dfb,0xbf733e2f,0xbf39bf4a,0x3f653f13
.long 0xbf583ea1,0x3efcbf39,0x3e60bf65,0x3e893f80
.long 0x3ee6bf31,0x3e603f7e,0x3f733cc9,0xbf093f1d
.long 0x3d973f6f,0xbf51bf5f,0x3f423f6a,0xbf7cbe89
.long 0xbf13bf7f,0x3f7e3ecf,0xbe2f3f42,0xbf4abf6f
.long 0x3f6a3f5f,0xbf273e60,0xbf6fbe89,0xbd97bf58
.long 0xbf7ebf13,0xbcc9bf42,0xbf4abf7c,0x3f31bd97
.long 0x3f4a3e2f,0x3f313f7f,0x3dfbbf13,0x3f803f42
.long 0xbeb83e89,0xbf7fbf58,0x3f6a3efc,0x3f273f7a
.long 0xbe2fbf27,0x3f4a3eb8,0x3f513f7f,0xbdfb3ecf
.long 0x3f273f6a,0xbe2f3e89,0xbd973eb8,0xbf51befc
.long 0xbf73bf80,0xbf09bf4a,0xbf65bf31,0xbf7abf7e
.long 0x3f7a3f65,0x3f773f80,0xbf58bf73,0xbefcbf31
.long 0xbf39bf1d,0xbf65bf51,0x3cc9bdfb,0x3ea13e2f
.long 0x3e893e60,0x3eb83ea1,0x3f5f3f58,0x3f6a3f65
.long 0xbf73beb8,0x3f7a3e89,0xbf653ecf,0x3f58befc
.long 0x3f51bee6,0xbf1d3f31,0xbf7cbea1,0x3f7e3cc9
.long 0xbcc93f77,0xbee6bf7a,0xbf31bf5f,0x3f733f09
.long 0xbf4abf58,0x3f803ea1,0xbdfbbf7a,0x3f393f65
.long 0x3f773e2f,0xbecf3f27,0x3efcbf13,0x3eb83f7f
.long 0xbeb83f1d,0xbf27bf7c,0x3f6a3dfb,0xbd973f51
.long 0xbf09bf7f,0x3f773eb8,0x3f7a3f42,0xbefc3ecf
.long 0x3f7f3f39,0xbe2f3f1d,0x3f273f80,0xbf51bdfb
.long 0xbf273cc9,0xbf51bf7e,0x3d973f39,0xbf7cbf1d
.long 0xbe60bf42,0x3f5f3ecf,0xbf093d97,0xbf77bf6f
.long 0x3f6a3f7e,0x3d973f13,0xbf6fbf1d,0xbf42bf7c
.long 0xbf5fbf13,0xbf6fbf7f,0xbf77bf7c,0xbecfbf42
.long 0x3dfbbe60,0x3f393ee6,0xbf1dbf58,0x3cc9bea1
.long 0x3f393f5f,0x3ea13f09,0xbcc9be89,0x3ee63e60
.long 0xbf7cbf73,0xbf7ebf80,0x3f133ee6,0x3f4a3f31
.long 0x3ee63ecf,0x3f093efc,0x3f733f6f,0x3f7a3f77
.long 0xbf7ebe2f,0x3f803d97,0xbf4a3f13,0x3f39bf27
.long 0x3eb8bf5f,0xbd973f7a,0xbf6a3e89,0x3f42bf09
.long 0x3f513f42,0xbf7ebeb8,0xbf7cbd97,0x3f4abecf
.long 0xbf423eb8,0x3e2fbf5f,0xbf7fbecf,0x3f51be89
.long 0xbee6bf80,0x3f7a3f1d,0xbf73bf31,0x3f58bdfb
.long 0x3f7a3ea1,0xbe893f31,0xbf58bf65,0x3f5f3cc9
.long 0xbcc93f4a,0xbf73bf51,0xbf31bf7e,0x3f653e2f
.long 0xbf77bf58,0x3eb8bee6,0xbefcbf7a,0x3f6a3ea1
.long 0x3efcbe60,0x3f6a3f73,0xbe89bf58,0x3f6f3ee6
.long 0x3f393f7e,0xbee63e2f,0xbcc9bf1d,0x3f733f13
.long 0xbf58bee6,0xbf5fbf80,0x3e60bea1,0x3f773f31
.long 0xbea1bf31,0x3f093dfb,0x3ee63cc9,0x3f7a3f4a
.long 0x3f7f3f6a,0x3f513f77,0x3f273eb8,0x3f7c3f5f
.long 0xbe2f3d97,0xbf1dbecf,0x3f513f27,0x3f7e3f6f
.long 0xbf6abf77,0xbf42bf58,0x3f6f3f5f,0x3f7f3f7a
.long 0x3f1d3f13,0x3f313f27,0x3f7e3f7c,0x3f803f7f
.long 0x3d973cc9,0x3e2f3dfb,0x3f423f39,0x3f513f4a
.long 0x3e603d97,0x3efc3eb8,0x3f093f27,0x3e893ecf
.long 0x3eb83dfb,0x3f423f13,0xbf6abf4a,0xbf7fbf7c
.long 0x3efc3e2f,0x3f6f3f42,0xbe89bf13,0x3ecf3d97
.long 0x3f1d3e60,0x3f803f65,0x3f7e3f58,0x3f393f73
.long 0x3f393e89,0x3f733f7a,0xbcc93efc,0xbf65bf09
.long 0x3f513ea1,0x3f4a3f80,0xbf7cbf65,0xbdfbbf31
.long 0x3f653eb8,0x3f093f77,0x3ea1becf,0x3f7a3f5f
.long 0x3f733ecf,0x3e603f5f,0x3f653f6f,0xbf093e89
.long 0x3f7c3ee6,0xbdfb3f39,0xbf133ea1,0xbf1dbf80
.long 0x3f803efc,0xbee63f09,0xbf39bf77,0x3f733e60
.long 0x3f7e3f09,0xbf393ea1,0x3f4abe60,0xbcc93f65
.long 0x3f773f13,0xbf6a3d97,0x3efc3f7c,0xbf6fbf27
.long 0x3f6a3f1d,0xbf7fbe2f,0xbf6f3dfb,0x3f27bf13
.long 0x3f583f27,0xbf77becf,0xbe60bf7f,0x3efc3f6f
.long 0x3f423f31,0xbf51bf1d,0x3f7fbcc9,0xbf7c3dfb
.long 0x3e893e60,0x3eb83ea1,0x3f5f3f58,0x3f6a3f65
.long 0x3f393f1d,0x3f653f51,0xbcc93dfb,0xbea1be2f
.long 0x3f7a3f65,0x3f773f80,0xbf58bf73,0xbefcbf31
.long 0x3f733f80,0x3f093f4a,0x3f653f31,0x3f7a3f7e
.long 0x3f273f6a,0xbe2f3e89,0xbd973eb8,0xbf51befc
.long 0x3e2f3f27,0xbf4abeb8,0xbf51bf7f,0x3dfbbecf
.long 0xbeb83e89,0xbf7fbf58,0x3f6a3efc,0x3f273f7a
.long 0xbf4abe2f,0xbf31bf7f,0xbdfb3f13,0xbf80bf42
.long 0xbf7ebf13,0xbcc9bf42,0xbf4abf7c,0x3f31bd97
.long 0xbf6abf5f,0x3f27be60,0x3f6f3e89,0x3d973f58
.long 0xbf13bf7f,0x3f7e3ecf,0xbe2f3f42,0xbf4abf6f
.long 0xbd97bf6f,0x3f513f5f,0xbf42bf6a,0x3f7c3e89
.long 0x3ee6bf31,0x3e603f7e,0x3f733cc9,0xbf093f1d
.long 0x3f58bea1,0xbefc3f39,0xbe603f65,0xbe89bf80
.long 0x3f803dfb,0xbf733e2f,0xbf39bf4a,0x3f653f13
.long 0x3f5f3f09,0xbf6abee6,0x3f77be60,0xbf6f3ea1
.long 0x3ee63ecf,0x3f093efc,0x3f733f6f,0x3f7a3f77
.long 0x3f7c3f73,0x3f7e3f80,0xbf13bee6,0xbf4abf31
.long 0x3f393f5f,0x3ea13f09,0xbcc9be89,0x3ee63e60
.long 0xbdfb3e60,0xbf39bee6,0x3f1d3f58,0xbcc93ea1
.long 0xbf5fbf13,0xbf6fbf7f,0xbf77bf7c,0xbecfbf42
.long 0xbf6abf7e,0xbd97bf13,0x3f6f3f1d,0x3f423f7c
.long 0xbe60bf42,0x3f5f3ecf,0xbf093d97,0xbf77bf6f
.long 0x3f27bcc9,0x3f513f7e,0xbd97bf39,0x3f7c3f1d
.long 0x3f7f3f39,0xbe2f3f1d,0x3f273f80,0xbf51bdfb
.long 0x3f093f7f,0xbf77beb8,0xbf7abf42,0x3efcbecf
.long 0xbeb83f1d,0xbf27bf7c,0x3f6a3dfb,0xbd973f51
.long 0xbf77be2f,0x3ecfbf27,0xbefc3f13,0xbeb8bf7f
.long 0xbf4abf58,0x3f803ea1,0xbdfbbf7a,0x3f393f65
.long 0x3cc9bf77,0x3ee63f7a,0x3f313f5f,0xbf73bf09
.long 0x3f51bee6,0xbf1d3f31,0xbf7cbea1,0x3f7e3cc9
.long 0x3f733eb8,0xbf7abe89,0x3f65becf,0xbf583efc
.long 0x3f1d3f13,0x3f313f27,0x3f7e3f7c,0x3f803f7f
.long 0x3f6a3f77,0x3f423f58,0xbf6fbf5f,0xbf7fbf7a
.long 0xbe2f3d97,0xbf1dbecf,0x3f513f27,0x3f7e3f6f
.long 0xbf7fbf6a,0xbf51bf77,0xbf27beb8,0xbf7cbf5f
.long 0xbea1bf31,0x3f093dfb,0x3ee63cc9,0x3f7a3f4a
.long 0x3f583ee6,0x3f5f3f80,0xbe603ea1,0xbf77bf31
.long 0x3f393f7e,0xbee63e2f,0xbcc9bf1d,0x3f733f13
.long 0xbefc3e60,0xbf6abf73,0x3e893f58,0xbf6fbee6
.long 0xbf77bf58,0x3eb8bee6,0xbefcbf7a,0x3f6a3ea1
.long 0x3cc9bf4a,0x3f733f51,0x3f313f7e,0xbf65be2f
.long 0x3f7a3ea1,0xbe893f31,0xbf58bf65,0x3f5f3cc9
.long 0x3ee63f80,0xbf7abf1d,0x3f733f31,0xbf583dfb
.long 0xbf423eb8,0x3e2fbf5f,0xbf7fbecf,0x3f51be89
.long 0xbf51bf42,0x3f7e3eb8,0x3f7c3d97,0xbf4a3ecf
.long 0x3eb8bf5f,0xbd973f7a,0xbf6a3e89,0x3f42bf09
.long 0x3f7e3e2f,0xbf80bd97,0x3f4abf13,0xbf393f27
.long 0x3f7f3f80,0x3f7c3f7e,0x3f273f31,0x3f133f1d
.long 0xbf7abf7f,0xbf5fbf6f,0x3f583f42,0x3f773f6a
.long 0x3f6f3f7e,0x3f273f51,0xbecfbf1d,0x3d97be2f
.long 0xbf5fbf7c,0xbeb8bf27,0xbf77bf51,0xbf6abf7f
.long 0x3f4a3f7a,0x3cc93ee6,0x3dfb3f09,0xbf31bea1
.long 0xbf31bf77,0x3ea1be60,0x3f803f5f,0x3ee63f58
.long 0x3f133f73,0xbf1dbcc9,0x3e2fbee6,0x3f7e3f39
.long 0xbee6bf6f,0x3f583e89,0xbf73bf6a,0x3e60befc
.long 0x3ea13f6a,0xbf7abefc,0xbee63eb8,0xbf58bf77
.long 0xbe2fbf65,0x3f7e3f31,0x3f513f73,0xbf4a3cc9
.long 0x3cc93f5f,0xbf65bf58,0x3f31be89,0x3ea13f7a
.long 0x3dfbbf58,0x3f313f73,0xbf1dbf7a,0x3f803ee6
.long 0xbe893f51,0xbecfbf7f,0xbf5f3e2f,0x3eb8bf42
.long 0x3ecfbf4a,0x3d973f7c,0x3eb83f7e,0xbf42bf51
.long 0xbf093f42,0x3e89bf6a,0x3f7abd97,0xbf5f3eb8
.long 0x3f27bf39,0xbf133f4a,0xbd97bf80,0x3e2f3f7e
.long 0x3f773f7a,0x3f6f3f73,0x3efc3f09,0x3ecf3ee6
.long 0xbf31bf4a,0xbee6bf13,0x3f803f7e,0x3f733f7c
.long 0x3e603ee6,0xbe89bcc9,0x3f093ea1,0x3f5f3f39
.long 0x3ea1bcc9,0x3f583f1d,0xbee6bf39,0x3e60bdfb
.long 0xbf42becf,0xbf7cbf77,0xbf7fbf6f,0xbf13bf5f
.long 0x3f7c3f42,0x3f1d3f6f,0xbf13bd97,0xbf7ebf6a
.long 0xbf6fbf77,0x3d97bf09,0x3ecf3f5f,0xbf42be60
.long 0x3f1d3f7c,0xbf39bd97,0x3f7e3f51,0xbcc93f27
.long 0xbdfbbf51,0x3f803f27,0x3f1dbe2f,0x3f393f7f
.long 0xbecf3efc,0xbf42bf7a,0xbeb8bf77,0x3f7f3f09
.long 0x3f51bd97,0x3dfb3f6a,0xbf7cbf27,0x3f1dbeb8
.long 0xbf7fbeb8,0x3f13befc,0xbf273ecf,0xbe2fbf77
.long 0x3f653f39,0xbf7abdfb,0x3ea13f80,0xbf58bf4a
.long 0xbf09bf73,0x3f5f3f31,0x3f7a3ee6,0xbf773cc9
.long 0x3cc93f7e,0xbea1bf7c,0x3f31bf1d,0xbee63f51
.long 0x3efcbf58,0xbecf3f65,0xbe89bf7a,0x3eb83f73
.long 0x3f653f6a,0x3f583f5f,0x3ea13eb8,0x3e603e89
.long 0xbe2fbea1,0x3dfbbcc9,0x3f513f65,0x3f1d3f39
.long 0xbf31befc,0xbf73bf58,0x3f803f77,0x3f653f7a
.long 0x3f7e3f7a,0x3f313f65,0x3f4a3f09,0x3f803f73
.long 0xbefcbf51,0x3eb8bd97,0x3e89be2f,0x3f6a3f27
.long 0xbecf3dfb,0xbf7fbf51,0xbeb8bf4a,0x3f273e2f
.long 0x3f7a3f27,0x3efc3f6a,0xbf58bf7f,0x3e89beb8
.long 0xbf42bf80,0x3f13bdfb,0xbf7fbf31,0xbe2fbf4a
.long 0xbd973f31,0xbf7cbf4a,0xbf42bcc9,0xbf13bf7e
.long 0x3f583d97,0x3e893f6f,0xbe603f27,0xbf5fbf6a
.long 0xbf6fbf4a,0x3f42be2f,0x3ecf3f7e,0xbf7fbf13
.long 0x3e893f7c,0xbf6abf42,0x3f5f3f51,0xbf6fbd97
.long 0x3f1dbf09,0x3cc93f73,0x3f7e3e60,0xbf313ee6
.long 0xbf80be89,0x3f65be60,0x3f39befc,0xbea13f58
.long 0x3f133f65,0xbf4abf39,0x3e2fbf73,0x3dfb3f80
.long 0x3ea1bf6f,0xbe603f77,0xbee6bf6a,0x3f093f5f
.long 0x3f4a3f51,0x3f393f42,0x3dfb3e2f,0x3cc93d97
.long 0x3ecf3e89,0x3f273f09,0x3eb83efc,0x3d973e60
.long 0xbf7cbf7f,0xbf4abf6a,0x3f133f42,0x3dfb3eb8
.long 0x3d973ecf,0xbf13be89,0x3f423f6f,0x3e2f3efc
.long 0x3f733f39,0x3f583f7e,0x3f653f80,0x3e603f1d
.long 0xbf09bf65,0x3efcbcc9,0x3f7a3f73,0x3e893f39
.long 0xbf31bdfb,0xbf65bf7c,0x3f803f4a,0x3ea13f51
.long 0x3f5f3f7a,0xbecf3ea1,0x3f773f09,0x3eb83f65
.long 0x3e89bf09,0x3f6f3f65,0x3f5f3e60,0x3ecf3f73
.long 0xbf80bf1d,0x3ea1bf13,0x3f39bdfb,0x3ee63f7c
.long 0x3e603f73,0xbf77bf39,0x3f09bee6,0x3efc3f80
.long 0x3f65bcc9,0xbe603f4a,0x3ea1bf39,0x3f093f7e
.long 0xbf27bf6f,0x3f7c3efc,0x3d97bf6a,0x3f133f77
.long 0xbf133f27,0x3dfbbf6f,0xbe2fbf7f,0x3f1d3f6a
.long 0x3f6f3efc,0xbf7fbe60,0xbecfbf77,0x3f273f58
.long 0x3dfbbf7c,0xbcc93f7f,0xbf1dbf51,0x3f313f42
.long 0x3f273f39,0xbf13bf4a,0xbd973f80,0x3e2fbf7e
.long 0x3f093f42,0xbe89bf6a,0xbf7abd97,0x3f5f3eb8
.long 0x3ecf3f4a,0x3d97bf7c,0x3eb8bf7e,0xbf423f51
.long 0x3e893f51,0x3ecfbf7f,0x3f5f3e2f,0xbeb8bf42
.long 0x3dfb3f58,0x3f31bf73,0xbf1d3f7a,0x3f80bee6
.long 0xbcc93f5f,0x3f65bf58,0xbf31be89,0xbea13f7a
.long 0xbe2f3f65,0x3f7ebf31,0x3f51bf73,0xbf4abcc9
.long 0xbea13f6a,0x3f7abefc,0x3ee63eb8,0x3f58bf77
.long 0xbee63f6f,0x3f58be89,0xbf733f6a,0x3e603efc
.long 0xbf133f73,0x3f1dbcc9,0xbe2fbee6,0xbf7e3f39
.long 0xbf313f77,0x3ea13e60,0x3f80bf5f,0x3ee6bf58
.long 0xbf4a3f7a,0xbcc93ee6,0xbdfb3f09,0x3f31bea1
.long 0xbf5f3f7c,0xbeb83f27,0xbf773f51,0xbf6a3f7f
.long 0xbf6f3f7e,0xbf273f51,0x3ecfbf1d,0xbd97be2f
.long 0xbf7a3f7f,0xbf5f3f6f,0x3f58bf42,0x3f77bf6a
.long 0xbf7f3f80,0xbf7c3f7e,0xbf273f31,0xbf133f1d
.long 0x3efc3f58,0xbecfbf65,0xbe893f7a,0x3eb8bf73
.long 0xbcc93f7e,0x3ea1bf7c,0xbf31bf1d,0x3ee63f51
.long 0xbf093f73,0x3f5fbf31,0x3f7abee6,0xbf77bcc9
.long 0xbf653f39,0x3f7abdfb,0xbea13f80,0x3f58bf4a
.long 0xbf7f3eb8,0x3f133efc,0xbf27becf,0xbe2f3f77
.long 0xbf51bd97,0xbdfb3f6a,0x3f7cbf27,0xbf1dbeb8
.long 0xbecfbefc,0xbf423f7a,0xbeb83f77,0x3f7fbf09
.long 0x3dfbbf51,0xbf803f27,0xbf1dbe2f,0xbf393f7f
.long 0x3f1dbf7c,0xbf393d97,0x3f7ebf51,0xbcc9bf27
.long 0x3f6fbf77,0xbd97bf09,0xbecf3f5f,0x3f42be60
.long 0x3f7cbf42,0x3f1dbf6f,0xbf133d97,0xbf7e3f6a
.long 0x3f42becf,0x3f7cbf77,0x3f7fbf6f,0x3f13bf5f
.long 0x3ea13cc9,0x3f58bf1d,0xbee63f39,0x3e603dfb
.long 0xbe603ee6,0x3e89bcc9,0xbf093ea1,0xbf5f3f39
.long 0xbf313f4a,0xbee63f13,0x3f80bf7e,0x3f73bf7c
.long 0xbf773f7a,0xbf6f3f73,0xbefc3f09,0xbecf3ee6
.long 0x3ea13f6f,0xbe60bf77,0xbee63f6a,0x3f09bf5f
.long 0xbf133f65,0x3f4abf39,0xbe2fbf73,0xbdfb3f80
.long 0xbf803e89,0x3f653e60,0x3f393efc,0xbea1bf58
.long 0xbf1dbf09,0xbcc93f73,0xbf7e3e60,0x3f313ee6
.long 0x3e89bf7c,0xbf6a3f42,0x3f5fbf51,0xbf6f3d97
.long 0x3f6fbf4a,0xbf42be2f,0xbecf3f7e,0x3f7fbf13
.long 0x3f58bd97,0x3e89bf6f,0xbe60bf27,0xbf5f3f6a
.long 0x3d973f31,0x3f7cbf4a,0x3f42bcc9,0x3f13bf7e
.long 0xbf423f80,0x3f133dfb,0xbf7f3f31,0xbe2f3f4a
.long 0xbf7a3f27,0xbefc3f6a,0x3f58bf7f,0xbe89beb8
.long 0xbecfbdfb,0xbf7f3f51,0xbeb83f4a,0x3f27be2f
.long 0x3efcbf51,0xbeb8bd97,0xbe89be2f,0xbf6a3f27
.long 0x3f7ebf7a,0x3f31bf65,0x3f4abf09,0x3f80bf73
.long 0x3f31befc,0x3f73bf58,0xbf803f77,0xbf653f7a
.long 0xbe2f3ea1,0x3dfb3cc9,0x3f51bf65,0x3f1dbf39
.long 0xbf653f6a,0xbf583f5f,0xbea13eb8,0xbe603e89
.long 0x3dfb3f7c,0xbcc9bf7f,0xbf1d3f51,0x3f31bf42
.long 0xbf6f3efc,0x3f7fbe60,0x3ecfbf77,0xbf273f58
.long 0xbf13bf27,0x3dfb3f6f,0xbe2f3f7f,0x3f1dbf6a
.long 0x3f27bf6f,0xbf7c3efc,0xbd97bf6a,0xbf133f77
.long 0x3f653cc9,0xbe60bf4a,0x3ea13f39,0x3f09bf7e
.long 0xbe603f73,0x3f77bf39,0xbf09bee6,0xbefc3f80
.long 0xbf803f1d,0x3ea13f13,0x3f393dfb,0x3ee6bf7c
.long 0xbe89bf09,0xbf6f3f65,0xbf5f3e60,0xbecf3f73
.long 0x3f5fbf7a,0xbecfbea1,0x3f77bf09,0x3eb8bf65
.long 0x3f31bdfb,0x3f65bf7c,0xbf803f4a,0xbea13f51
.long 0xbf093f65,0x3efc3cc9,0x3f7abf73,0x3e89bf39
.long 0xbf733f39,0xbf583f7e,0xbf653f80,0xbe603f1d
.long 0x3d97becf,0xbf133e89,0x3f42bf6f,0x3e2fbefc
.long 0x3f7cbf7f,0x3f4abf6a,0xbf133f42,0xbdfb3eb8
.long 0x3ecfbe89,0x3f27bf09,0x3eb8befc,0x3d97be60
.long 0xbf4a3f51,0xbf393f42,0xbdfb3e2f,0xbcc93d97
.long 0xbf423f31,0x3f51bf1d,0xbf7fbcc9,0x3f7c3dfb
.long 0x3f58bf27,0xbf773ecf,0xbe603f7f,0x3efcbf6f
.long 0xbf6a3f1d,0x3f7fbe2f,0x3f6f3dfb,0xbf27bf13
.long 0x3f77bf13,0xbf6abd97,0x3efcbf7c,0xbf6f3f27
.long 0xbf7e3f09,0x3f393ea1,0xbf4abe60,0x3cc93f65
.long 0x3f80befc,0xbee6bf09,0xbf393f77,0x3f73be60
.long 0xbf7c3ee6,0x3dfb3f39,0x3f133ea1,0x3f1dbf80
.long 0x3f73becf,0x3e60bf5f,0x3f65bf6f,0xbf09be89
.long 0xbf653eb8,0xbf093f77,0xbea1becf,0xbf7a3f5f
.long 0x3f51bea1,0x3f4abf80,0xbf7c3f65,0xbdfb3f31
.long 0xbf393e89,0xbf733f7a,0x3cc93efc,0x3f65bf09
.long 0x3f1dbe60,0x3f80bf65,0x3f7ebf58,0x3f39bf73
.long 0xbefc3e2f,0xbf6f3f42,0x3e89bf13,0xbecf3d97
.long 0x3eb8bdfb,0x3f42bf13,0xbf6a3f4a,0xbf7f3f7c
.long 0xbe603d97,0xbefc3eb8,0xbf093f27,0xbe893ecf
.long 0x3d97bcc9,0x3e2fbdfb,0x3f42bf39,0x3f51bf4a
.long 0xbf5f3f09,0x3f6abee6,0xbf77be60,0x3f6f3ea1
.long 0x3f80bdfb,0xbf73be2f,0xbf393f4a,0x3f65bf13
.long 0xbf58bea1,0x3efc3f39,0x3e603f65,0x3e89bf80
.long 0x3ee63f31,0x3e60bf7e,0x3f73bcc9,0xbf09bf1d
.long 0x3d97bf6f,0xbf513f5f,0x3f42bf6a,0xbf7c3e89
.long 0xbf133f7f,0x3f7ebecf,0xbe2fbf42,0xbf4a3f6f
.long 0x3f6abf5f,0xbf27be60,0xbf6f3e89,0xbd973f58
.long 0xbf7e3f13,0xbcc93f42,0xbf4a3f7c,0x3f313d97
.long 0x3f4abe2f,0x3f31bf7f,0x3dfb3f13,0x3f80bf42
.long 0xbeb8be89,0xbf7f3f58,0x3f6abefc,0x3f27bf7a
.long 0xbe2f3f27,0x3f4abeb8,0x3f51bf7f,0xbdfbbecf
.long 0x3f27bf6a,0xbe2fbe89,0xbd97beb8,0xbf513efc
.long 0xbf733f80,0xbf093f4a,0xbf653f31,0xbf7a3f7e
.long 0x3f7abf65,0x3f77bf80,0xbf583f73,0xbefc3f31
.long 0xbf393f1d,0xbf653f51,0x3cc93dfb,0x3ea1be2f
.long 0x3e89be60,0x3eb8bea1,0x3f5fbf58,0x3f6abf65
.long 0xbf733eb8,0x3f7abe89,0xbf65becf,0x3f583efc
.long 0x3f513ee6,0xbf1dbf31,0xbf7c3ea1,0x3f7ebcc9
.long 0xbcc9bf77,0xbee63f7a,0xbf313f5f,0x3f73bf09
.long 0xbf4a3f58,0x3f80bea1,0xbdfb3f7a,0x3f39bf65
.long 0x3f77be2f,0xbecfbf27,0x3efc3f13,0x3eb8bf7f
.long 0xbeb8bf1d,0xbf273f7c,0x3f6abdfb,0xbd97bf51
.long 0xbf093f7f,0x3f77beb8,0x3f7abf42,0xbefcbecf
.long 0x3f7fbf39,0xbe2fbf1d,0x3f27bf80,0xbf513dfb
.long 0xbf27bcc9,0xbf513f7e,0x3d97bf39,0xbf7c3f1d
.long 0xbe603f42,0x3f5fbecf,0xbf09bd97,0xbf773f6f
.long 0x3f6abf7e,0x3d97bf13,0xbf6f3f1d,0xbf423f7c
.long 0xbf5f3f13,0xbf6f3f7f,0xbf773f7c,0xbecf3f42
.long 0x3dfb3e60,0x3f39bee6,0xbf1d3f58,0x3cc93ea1
.long 0x3f39bf5f,0x3ea1bf09,0xbcc93e89,0x3ee6be60
.long 0xbf7c3f73,0xbf7e3f80,0x3f13bee6,0x3f4abf31
.long 0x3ee6becf,0x3f09befc,0x3f73bf6f,0x3f7abf77
.long 0xbf7e3e2f,0x3f80bd97,0xbf4abf13,0x3f393f27
.long 0x3eb83f5f,0xbd97bf7a,0xbf6abe89,0x3f423f09
.long 0x3f51bf42,0xbf7e3eb8,0xbf7c3d97,0x3f4a3ecf
.long 0xbf42beb8,0x3e2f3f5f,0xbf7f3ecf,0x3f513e89
.long 0xbee63f80,0x3f7abf1d,0xbf733f31,0x3f583dfb
.long 0x3f7abea1,0xbe89bf31,0xbf583f65,0x3f5fbcc9
.long 0xbcc9bf4a,0xbf733f51,0xbf313f7e,0x3f65be2f
.long 0xbf773f58,0x3eb83ee6,0xbefc3f7a,0x3f6abea1
.long 0x3efc3e60,0x3f6abf73,0xbe893f58,0x3f6fbee6
.long 0x3f39bf7e,0xbee6be2f,0xbcc93f1d,0x3f73bf13
.long 0xbf583ee6,0xbf5f3f80,0x3e603ea1,0x3f77bf31
.long 0xbea13f31,0x3f09bdfb,0x3ee6bcc9,0x3f7abf4a
.long 0x3f7fbf6a,0x3f51bf77,0x3f27beb8,0x3f7cbf5f
.long 0xbe2fbd97,0xbf1d3ecf,0x3f51bf27,0x3f7ebf6f
.long 0xbf6a3f77,0xbf423f58,0x3f6fbf5f,0x3f7fbf7a
.long 0x3f1dbf13,0x3f31bf27,0x3f7ebf7c,0x3f80bf7f
.long 0xbf7f3f80,0xbf7c3f7e,0xbf273f31,0xbf133f1d
.long 0xbf7a3f7f,0xbf5f3f6f,0x3f58bf42,0x3f77bf6a
.long 0xbf6f3f7e,0xbf273f51,0x3ecfbf1d,0xbd97be2f
.long 0xbf5f3f7c,0xbeb83f27,0xbf773f51,0xbf6a3f7f
.long 0xbf4a3f7a,0xbcc93ee6,0xbdfb3f09,0x3f31bea1
.long 0xbf313f77,0x3ea13e60,0x3f80bf5f,0x3ee6bf58
.long 0xbf133f73,0x3f1dbcc9,0xbe2fbee6,0xbf7e3f39
.long 0xbee63f6f,0x3f58be89,0xbf733f6a,0x3e603efc
.long 0xbea13f6a,0x3f7abefc,0x3ee63eb8,0x3f58bf77
.long 0xbe2f3f65,0x3f7ebf31,0x3f51bf73,0xbf4abcc9
.long 0xbcc93f5f,0x3f65bf58,0xbf31be89,0xbea13f7a
.long 0x3dfb3f58,0x3f31bf73,0xbf1d3f7a,0x3f80bee6
.long 0x3e893f51,0x3ecfbf7f,0x3f5f3e2f,0xbeb8bf42
.long 0x3ecf3f4a,0x3d97bf7c,0x3eb8bf7e,0xbf423f51
.long 0x3f093f42,0xbe89bf6a,0xbf7abd97,0x3f5f3eb8
.long 0x3f273f39,0xbf13bf4a,0xbd973f80,0x3e2fbf7e
.long 0xbf773f7a,0xbf6f3f73,0xbefc3f09,0xbecf3ee6
.long 0xbf313f4a,0xbee63f13,0x3f80bf7e,0x3f73bf7c
.long 0xbe603ee6,0x3e89bcc9,0xbf093ea1,0xbf5f3f39
.long 0x3ea13cc9,0x3f58bf1d,0xbee63f39,0x3e603dfb
.long 0x3f42becf,0x3f7cbf77,0x3f7fbf6f,0x3f13bf5f
.long 0x3f7cbf42,0x3f1dbf6f,0xbf133d97,0xbf7e3f6a
.long 0x3f6fbf77,0xbd97bf09,0xbecf3f5f,0x3f42be60
.long 0x3f1dbf7c,0xbf393d97,0x3f7ebf51,0xbcc9bf27
.long 0x3dfbbf51,0xbf803f27,0xbf1dbe2f,0xbf393f7f
.long 0xbecfbefc,0xbf423f7a,0xbeb83f77,0x3f7fbf09
.long 0xbf51bd97,0xbdfb3f6a,0x3f7cbf27,0xbf1dbeb8
.long 0xbf7f3eb8,0x3f133efc,0xbf27becf,0xbe2f3f77
.long 0xbf653f39,0x3f7abdfb,0xbea13f80,0x3f58bf4a
.long 0xbf093f73,0x3f5fbf31,0x3f7abee6,0xbf77bcc9
.long 0xbcc93f7e,0x3ea1bf7c,0xbf31bf1d,0x3ee63f51
.long 0x3efc3f58,0xbecfbf65,0xbe893f7a,0x3eb8bf73
.long 0xbf653f6a,0xbf583f5f,0xbea13eb8,0xbe603e89
.long 0xbe2f3ea1,0x3dfb3cc9,0x3f51bf65,0x3f1dbf39
.long 0x3f31befc,0x3f73bf58,0xbf803f77,0xbf653f7a
.long 0x3f7ebf7a,0x3f31bf65,0x3f4abf09,0x3f80bf73
.long 0x3efcbf51,0xbeb8bd97,0xbe89be2f,0xbf6a3f27
.long 0xbecfbdfb,0xbf7f3f51,0xbeb83f4a,0x3f27be2f
.long 0xbf7a3f27,0xbefc3f6a,0x3f58bf7f,0xbe89beb8
.long 0xbf423f80,0x3f133dfb,0xbf7f3f31,0xbe2f3f4a
.long 0x3d973f31,0x3f7cbf4a,0x3f42bcc9,0x3f13bf7e
.long 0x3f58bd97,0x3e89bf6f,0xbe60bf27,0xbf5f3f6a
.long 0x3f6fbf4a,0xbf42be2f,0xbecf3f7e,0x3f7fbf13
.long 0x3e89bf7c,0xbf6a3f42,0x3f5fbf51,0xbf6f3d97
.long 0xbf1dbf09,0xbcc93f73,0xbf7e3e60,0x3f313ee6
.long 0xbf803e89,0x3f653e60,0x3f393efc,0xbea1bf58
.long 0xbf133f65,0x3f4abf39,0xbe2fbf73,0xbdfb3f80
.long 0x3ea13f6f,0xbe60bf77,0xbee63f6a,0x3f09bf5f
.long 0xbf4a3f51,0xbf393f42,0xbdfb3e2f,0xbcc93d97
.long 0x3ecfbe89,0x3f27bf09,0x3eb8befc,0x3d97be60
.long 0x3f7cbf7f,0x3f4abf6a,0xbf133f42,0xbdfb3eb8
.long 0x3d97becf,0xbf133e89,0x3f42bf6f,0x3e2fbefc
.long 0xbf733f39,0xbf583f7e,0xbf653f80,0xbe603f1d
.long 0xbf093f65,0x3efc3cc9,0x3f7abf73,0x3e89bf39
.long 0x3f31bdfb,0x3f65bf7c,0xbf803f4a,0xbea13f51
.long 0x3f5fbf7a,0xbecfbea1,0x3f77bf09,0x3eb8bf65
.long 0xbe89bf09,0xbf6f3f65,0xbf5f3e60,0xbecf3f73
.long 0xbf803f1d,0x3ea13f13,0x3f393dfb,0x3ee6bf7c
.long 0xbe603f73,0x3f77bf39,0xbf09bee6,0xbefc3f80
.long 0x3f653cc9,0xbe60bf4a,0x3ea13f39,0x3f09bf7e
.long 0x3f27bf6f,0xbf7c3efc,0xbd97bf6a,0xbf133f77
.long 0xbf13bf27,0x3dfb3f6f,0xbe2f3f7f,0x3f1dbf6a
.long 0xbf6f3efc,0x3f7fbe60,0x3ecfbf77,0xbf273f58
.long 0x3dfb3f7c,0xbcc9bf7f,0xbf1d3f51,0x3f31bf42
.long 0x3d97bcc9,0x3e2fbdfb,0x3f42bf39,0x3f51bf4a
.long 0xbe603d97,0xbefc3eb8,0xbf093f27,0xbe893ecf
.long 0x3eb8bdfb,0x3f42bf13,0xbf6a3f4a,0xbf7f3f7c
.long 0xbefc3e2f,0xbf6f3f42,0x3e89bf13,0xbecf3d97
.long 0x3f1dbe60,0x3f80bf65,0x3f7ebf58,0x3f39bf73
.long 0xbf393e89,0xbf733f7a,0x3cc93efc,0x3f65bf09
.long 0x3f51bea1,0x3f4abf80,0xbf7c3f65,0xbdfb3f31
.long 0xbf653eb8,0xbf093f77,0xbea1becf,0xbf7a3f5f
.long 0x3f73becf,0x3e60bf5f,0x3f65bf6f,0xbf09be89
.long 0xbf7c3ee6,0x3dfb3f39,0x3f133ea1,0x3f1dbf80
.long 0x3f80befc,0xbee6bf09,0xbf393f77,0x3f73be60
.long 0xbf7e3f09,0x3f393ea1,0xbf4abe60,0x3cc93f65
.long 0x3f77bf13,0xbf6abd97,0x3efcbf7c,0xbf6f3f27
.long 0xbf6a3f1d,0x3f7fbe2f,0x3f6f3dfb,0xbf27bf13
.long 0x3f58bf27,0xbf773ecf,0xbe603f7f,0x3efcbf6f
.long 0xbf423f31,0x3f51bf1d,0xbf7fbcc9,0x3f7c3dfb
.long 0x3e89be60,0x3eb8bea1,0x3f5fbf58,0x3f6abf65
.long 0xbf393f1d,0xbf653f51,0x3cc93dfb,0x3ea1be2f
.long 0x3f7abf65,0x3f77bf80,0xbf583f73,0xbefc3f31
.long 0xbf733f80,0xbf093f4a,0xbf653f31,0xbf7a3f7e
.long 0x3f27bf6a,0xbe2fbe89,0xbd97beb8,0xbf513efc
.long 0xbe2f3f27,0x3f4abeb8,0x3f51bf7f,0xbdfbbecf
.long 0xbeb8be89,0xbf7f3f58,0x3f6abefc,0x3f27bf7a
.long 0x3f4abe2f,0x3f31bf7f,0x3dfb3f13,0x3f80bf42
.long 0xbf7e3f13,0xbcc93f42,0xbf4a3f7c,0x3f313d97
.long 0x3f6abf5f,0xbf27be60,0xbf6f3e89,0xbd973f58
.long 0xbf133f7f,0x3f7ebecf,0xbe2fbf42,0xbf4a3f6f
.long 0x3d97bf6f,0xbf513f5f,0x3f42bf6a,0xbf7c3e89
.long 0x3ee63f31,0x3e60bf7e,0x3f73bcc9,0xbf09bf1d
.long 0xbf58bea1,0x3efc3f39,0x3e603f65,0x3e89bf80
.long 0x3f80bdfb,0xbf73be2f,0xbf393f4a,0x3f65bf13
.long 0xbf5f3f09,0x3f6abee6,0xbf77be60,0x3f6f3ea1
.long 0x3ee6becf,0x3f09befc,0x3f73bf6f,0x3f7abf77
.long 0xbf7c3f73,0xbf7e3f80,0x3f13bee6,0x3f4abf31
.long 0x3f39bf5f,0x3ea1bf09,0xbcc93e89,0x3ee6be60
.long 0x3dfb3e60,0x3f39bee6,0xbf1d3f58,0x3cc93ea1
.long 0xbf5f3f13,0xbf6f3f7f,0xbf773f7c,0xbecf3f42
.long 0x3f6abf7e,0x3d97bf13,0xbf6f3f1d,0xbf423f7c
.long 0xbe603f42,0x3f5fbecf,0xbf09bd97,0xbf773f6f
.long 0xbf27bcc9,0xbf513f7e,0x3d97bf39,0xbf7c3f1d
.long 0x3f7fbf39,0xbe2fbf1d,0x3f27bf80,0xbf513dfb
.long 0xbf093f7f,0x3f77beb8,0x3f7abf42,0xbefcbecf
.long 0xbeb8bf1d,0xbf273f7c,0x3f6abdfb,0xbd97bf51
.long 0x3f77be2f,0xbecfbf27,0x3efc3f13,0x3eb8bf7f
.long 0xbf4a3f58,0x3f80bea1,0xbdfb3f7a,0x3f39bf65
.long 0xbcc9bf77,0xbee63f7a,0xbf313f5f,0x3f73bf09
.long 0x3f513ee6,0xbf1dbf31,0xbf7c3ea1,0x3f7ebcc9
.long 0xbf733eb8,0x3f7abe89,0xbf65becf,0x3f583efc
.long 0x3f1dbf13,0x3f31bf27,0x3f7ebf7c,0x3f80bf7f
.long 0xbf6a3f77,0xbf423f58,0x3f6fbf5f,0x3f7fbf7a
.long 0xbe2fbd97,0xbf1d3ecf,0x3f51bf27,0x3f7ebf6f
.long 0x3f7fbf6a,0x3f51bf77,0x3f27beb8,0x3f7cbf5f
.long 0xbea13f31,0x3f09bdfb,0x3ee6bcc9,0x3f7abf4a
.long 0xbf583ee6,0xbf5f3f80,0x3e603ea1,0x3f77bf31
.long 0x3f39bf7e,0xbee6be2f,0xbcc93f1d,0x3f73bf13
.long 0x3efc3e60,0x3f6abf73,0xbe893f58,0x3f6fbee6
.long 0xbf773f58,0x3eb83ee6,0xbefc3f7a,0x3f6abea1
.long 0xbcc9bf4a,0xbf733f51,0xbf313f7e,0x3f65be2f
.long 0x3f7abea1,0xbe89bf31,0xbf583f65,0x3f5fbcc9
.long 0xbee63f80,0x3f7abf1d,0xbf733f31,0x3f583dfb
.long 0xbf42beb8,0x3e2f3f5f,0xbf7f3ecf,0x3f513e89
.long 0x3f51bf42,0xbf7e3eb8,0xbf7c3d97,0x3f4a3ecf
.long 0x3eb83f5f,0xbd97bf7a,0xbf6abe89,0x3f423f09
.long 0xbf7e3e2f,0x3f80bd97,0xbf4abf13,0x3f393f27
.long 0x3f423f31,0xbf51bf1d,0x3f7fbcc9,0xbf7c3dfb
.long 0x3f583f27,0xbf77becf,0xbe60bf7f,0x3efc3f6f
.long 0x3f6a3f1d,0xbf7fbe2f,0xbf6f3dfb,0x3f27bf13
.long 0x3f773f13,0xbf6a3d97,0x3efc3f7c,0xbf6fbf27
.long 0x3f7e3f09,0xbf393ea1,0x3f4abe60,0xbcc93f65
.long 0x3f803efc,0xbee63f09,0xbf39bf77,0x3f733e60
.long 0x3f7c3ee6,0xbdfb3f39,0xbf133ea1,0xbf1dbf80
.long 0x3f733ecf,0x3e603f5f,0x3f653f6f,0xbf093e89
.long 0x3f653eb8,0x3f093f77,0x3ea1becf,0x3f7a3f5f
.long 0x3f513ea1,0x3f4a3f80,0xbf7cbf65,0xbdfbbf31
.long 0x3f393e89,0x3f733f7a,0xbcc93efc,0xbf65bf09
.long 0x3f1d3e60,0x3f803f65,0x3f7e3f58,0x3f393f73
.long 0x3efc3e2f,0x3f6f3f42,0xbe89bf13,0x3ecf3d97
.long 0x3eb83dfb,0x3f423f13,0xbf6abf4a,0xbf7fbf7c
.long 0x3e603d97,0x3efc3eb8,0x3f093f27,0x3e893ecf
.long 0x3d973cc9,0x3e2f3dfb,0x3f423f39,0x3f513f4a
.long 0x3f5f3f09,0xbf6abee6,0x3f77be60,0xbf6f3ea1
.long 0x3f803dfb,0xbf733e2f,0xbf39bf4a,0x3f653f13
.long 0x3f58bea1,0xbefc3f39,0xbe603f65,0xbe89bf80
.long 0x3ee6bf31,0x3e603f7e,0x3f733cc9,0xbf093f1d
.long 0xbd97bf6f,0x3f513f5f,0xbf42bf6a,0x3f7c3e89
.long 0xbf13bf7f,0x3f7e3ecf,0xbe2f3f42,0xbf4abf6f
.long 0xbf6abf5f,0x3f27be60,0x3f6f3e89,0x3d973f58
.long 0xbf7ebf13,0xbcc9bf42,0xbf4abf7c,0x3f31bd97
.long 0xbf4abe2f,0xbf31bf7f,0xbdfb3f13,0xbf80bf42
.long 0xbeb83e89,0xbf7fbf58,0x3f6a3efc,0x3f273f7a
.long 0x3e2f3f27,0xbf4abeb8,0xbf51bf7f,0x3dfbbecf
.long 0x3f273f6a,0xbe2f3e89,0xbd973eb8,0xbf51befc
.long 0x3f733f80,0x3f093f4a,0x3f653f31,0x3f7a3f7e
.long 0x3f7a3f65,0x3f773f80,0xbf58bf73,0xbefcbf31
.long 0x3f393f1d,0x3f653f51,0xbcc93dfb,0xbea1be2f
.long 0x3e893e60,0x3eb83ea1,0x3f5f3f58,0x3f6a3f65
.long 0x3f733eb8,0xbf7abe89,0x3f65becf,0xbf583efc
.long 0x3f51bee6,0xbf1d3f31,0xbf7cbea1,0x3f7e3cc9
.long 0x3cc9bf77,0x3ee63f7a,0x3f313f5f,0xbf73bf09
.long 0xbf4abf58,0x3f803ea1,0xbdfbbf7a,0x3f393f65
.long 0xbf77be2f,0x3ecfbf27,0xbefc3f13,0xbeb8bf7f
.long 0xbeb83f1d,0xbf27bf7c,0x3f6a3dfb,0xbd973f51
.long 0x3f093f7f,0xbf77beb8,0xbf7abf42,0x3efcbecf
.long 0x3f7f3f39,0xbe2f3f1d,0x3f273f80,0xbf51bdfb
.long 0x3f27bcc9,0x3f513f7e,0xbd97bf39,0x3f7c3f1d
.long 0xbe60bf42,0x3f5f3ecf,0xbf093d97,0xbf77bf6f
.long 0xbf6abf7e,0xbd97bf13,0x3f6f3f1d,0x3f423f7c
.long 0xbf5fbf13,0xbf6fbf7f,0xbf77bf7c,0xbecfbf42
.long 0xbdfb3e60,0xbf39bee6,0x3f1d3f58,0xbcc93ea1
.long 0x3f393f5f,0x3ea13f09,0xbcc9be89,0x3ee63e60
.long 0x3f7c3f73,0x3f7e3f80,0xbf13bee6,0xbf4abf31
.long 0x3ee63ecf,0x3f093efc,0x3f733f6f,0x3f7a3f77
.long 0x3f7e3e2f,0xbf80bd97,0x3f4abf13,0xbf393f27
.long 0x3eb8bf5f,0xbd973f7a,0xbf6a3e89,0x3f42bf09
.long 0xbf51bf42,0x3f7e3eb8,0x3f7c3d97,0xbf4a3ecf
.long 0xbf423eb8,0x3e2fbf5f,0xbf7fbecf,0x3f51be89
.long 0x3ee63f80,0xbf7abf1d,0x3f733f31,0xbf583dfb
.long 0x3f7a3ea1,0xbe893f31,0xbf58bf65,0x3f5f3cc9
.long 0x3cc9bf4a,0x3f733f51,0x3f313f7e,0xbf65be2f
.long 0xbf77bf58,0x3eb8bee6,0xbefcbf7a,0x3f6a3ea1
.long 0xbefc3e60,0xbf6abf73,0x3e893f58,0xbf6fbee6
.long 0x3f393f7e,0xbee63e2f,0xbcc9bf1d,0x3f733f13
.long 0x3f583ee6,0x3f5f3f80,0xbe603ea1,0xbf77bf31
.long 0xbea1bf31,0x3f093dfb,0x3ee63cc9,0x3f7a3f4a
.long 0xbf7fbf6a,0xbf51bf77,0xbf27beb8,0xbf7cbf5f
.long 0xbe2f3d97,0xbf1dbecf,0x3f513f27,0x3f7e3f6f
.long 0x3f6a3f77,0x3f423f58,0xbf6fbf5f,0xbf7fbf7a
.long 0x3f1d3f13,0x3f313f27,0x3f7e3f7c,0x3f803f7f
.long 0x3f27bf39,0xbf133f4a,0xbd97bf80,0x3e2f3f7e
.long 0xbf093f42,0x3e89bf6a,0x3f7abd97,0xbf5f3eb8
.long 0x3ecfbf4a,0x3d973f7c,0x3eb83f7e,0xbf42bf51
.long 0xbe893f51,0xbecfbf7f,0xbf5f3e2f,0x3eb8bf42
.long 0x3dfbbf58,0x3f313f73,0xbf1dbf7a,0x3f803ee6
.long 0x3cc93f5f,0xbf65bf58,0x3f31be89,0x3ea13f7a
.long 0xbe2fbf65,0x3f7e3f31,0x3f513f73,0xbf4a3cc9
.long 0x3ea13f6a,0xbf7abefc,0xbee63eb8,0xbf58bf77
.long 0xbee6bf6f,0x3f583e89,0xbf73bf6a,0x3e60befc
.long 0x3f133f73,0xbf1dbcc9,0x3e2fbee6,0x3f7e3f39
.long 0xbf31bf77,0x3ea1be60,0x3f803f5f,0x3ee63f58
.long 0x3f4a3f7a,0x3cc93ee6,0x3dfb3f09,0xbf31bea1
.long 0xbf5fbf7c,0xbeb8bf27,0xbf77bf51,0xbf6abf7f
.long 0x3f6f3f7e,0x3f273f51,0xbecfbf1d,0x3d97be2f
.long 0xbf7abf7f,0xbf5fbf6f,0x3f583f42,0x3f773f6a
.long 0x3f7f3f80,0x3f7c3f7e,0x3f273f31,0x3f133f1d
.long 0x3efcbf58,0xbecf3f65,0xbe89bf7a,0x3eb83f73
.long 0x3cc93f7e,0xbea1bf7c,0x3f31bf1d,0xbee63f51
.long 0xbf09bf73,0x3f5f3f31,0x3f7a3ee6,0xbf773cc9
.long 0x3f653f39,0xbf7abdfb,0x3ea13f80,0xbf58bf4a
.long 0xbf7fbeb8,0x3f13befc,0xbf273ecf,0xbe2fbf77
.long 0x3f51bd97,0x3dfb3f6a,0xbf7cbf27,0x3f1dbeb8
.long 0xbecf3efc,0xbf42bf7a,0xbeb8bf77,0x3f7f3f09
.long 0xbdfbbf51,0x3f803f27,0x3f1dbe2f,0x3f393f7f
.long 0x3f1d3f7c,0xbf39bd97,0x3f7e3f51,0xbcc93f27
.long 0xbf6fbf77,0x3d97bf09,0x3ecf3f5f,0xbf42be60
.long 0x3f7c3f42,0x3f1d3f6f,0xbf13bd97,0xbf7ebf6a
.long 0xbf42becf,0xbf7cbf77,0xbf7fbf6f,0xbf13bf5f
.long 0x3ea1bcc9,0x3f583f1d,0xbee6bf39,0x3e60bdfb
.long 0x3e603ee6,0xbe89bcc9,0x3f093ea1,0x3f5f3f39
.long 0xbf31bf4a,0xbee6bf13,0x3f803f7e,0x3f733f7c
.long 0x3f773f7a,0x3f6f3f73,0x3efc3f09,0x3ecf3ee6
.long 0x3ea1bf6f,0xbe603f77,0xbee6bf6a,0x3f093f5f
.long 0x3f133f65,0xbf4abf39,0x3e2fbf73,0x3dfb3f80
.long 0xbf80be89,0x3f65be60,0x3f39befc,0xbea13f58
.long 0x3f1dbf09,0x3cc93f73,0x3f7e3e60,0xbf313ee6
.long 0x3e893f7c,0xbf6abf42,0x3f5f3f51,0xbf6fbd97
.long 0xbf6fbf4a,0x3f42be2f,0x3ecf3f7e,0xbf7fbf13
.long 0x3f583d97,0x3e893f6f,0xbe603f27,0xbf5fbf6a
.long 0xbd973f31,0xbf7cbf4a,0xbf42bcc9,0xbf13bf7e
.long 0xbf42bf80,0x3f13bdfb,0xbf7fbf31,0xbe2fbf4a
.long 0x3f7a3f27,0x3efc3f6a,0xbf58bf7f,0x3e89beb8
.long 0xbecf3dfb,0xbf7fbf51,0xbeb8bf4a,0x3f273e2f
.long 0xbefcbf51,0x3eb8bd97,0x3e89be2f,0x3f6a3f27
.long 0x3f7e3f7a,0x3f313f65,0x3f4a3f09,0x3f803f73
.long 0xbf31befc,0xbf73bf58,0x3f803f77,0x3f653f7a
.long 0xbe2fbea1,0x3dfbbcc9,0x3f513f65,0x3f1d3f39
.long 0x3f653f6a,0x3f583f5f,0x3ea13eb8,0x3e603e89
.long 0x3dfbbf7c,0xbcc93f7f,0xbf1dbf51,0x3f313f42
.long 0x3f6f3efc,0xbf7fbe60,0xbecfbf77,0x3f273f58
.long 0xbf133f27,0x3dfbbf6f,0xbe2fbf7f,0x3f1d3f6a
.long 0xbf27bf6f,0x3f7c3efc,0x3d97bf6a,0x3f133f77
.long 0x3f65bcc9,0xbe603f4a,0x3ea1bf39,0x3f093f7e
.long 0x3e603f73,0xbf77bf39,0x3f09bee6,0x3efc3f80
.long 0xbf80bf1d,0x3ea1bf13,0x3f39bdfb,0x3ee63f7c
.long 0x3e89bf09,0x3f6f3f65,0x3f5f3e60,0x3ecf3f73
.long 0x3f5f3f7a,0xbecf3ea1,0x3f773f09,0x3eb83f65
.long 0xbf31bdfb,0xbf65bf7c,0x3f803f4a,0x3ea13f51
.long 0xbf09bf65,0x3efcbcc9,0x3f7a3f73,0x3e893f39
.long 0x3f733f39,0x3f583f7e,0x3f653f80,0x3e603f1d
.long 0x3d973ecf,0xbf13be89,0x3f423f6f,0x3e2f3efc
.long 0xbf7cbf7f,0xbf4abf6a,0x3f133f42,0x3dfb3eb8
.long 0x3ecf3e89,0x3f273f09,0x3eb83efc,0x3d973e60
.long 0x3f4a3f51,0x3f393f42,0x3dfb3e2f,0x3cc93d97
.size L_dft, 32768
.p2align 8
.type L_tab,@object
L_tab:
.long 0,32,0,0x60000,0x1a000,0xe00000,0xe00400,0x1000000,0x1000400,0x100000,0x60000,0x100000,0x40600000,0x40000280,0x3e800000,79,16,15,0x20000,0x40000,0,11,0,1,0,0xffffffff,0,0x20000,0x100000,0x600000,0xe00000,0
.long 0,32,3,0x60000,0x1a008,0xe00800,0xe0f000,0x1000800,0x1000c00,0x100c00,0x68000,0x104000,0x40600a00,0x40000280,0x3e800000,79,16,15,0x22000,0x40080,16,10,0,1,0,0,0xffffffff,0x20800,0x101000,0x600b00,0xe0f000,0
.long 0,32,6,0x60000,0x1a010,0xe0f400,0xe0f800,0x1001000,0x103c000,0x101800,0x70000,0x120000,0x600000,0x40000280,0x3e800000,79,16,15,0x24000,0x40100,0,11,0,2,0,0xffffffff,0,0x21000,0x102000,0x601600,0xe1e000,16384
.long 0,32,9,0x60000,0x1a018,0xe1e000,0xe1e400,0x103c400,0x103c800,0x102400,0x78000,0x124000,0x600a00,640,0x3e800000,79,16,15,0x26000,0x40180,16,10,0,2,0,0,0xffffffff,0x21800,0x103000,0x602100,0xe2d000,16384
.long 0,32,0,0x60400,0x1a000,0xe1e800,0xe2d000,0x103cc00,0x103d000,0x120000,0x60400,0x100800,0x406b0000,0x40000280,0x3f000000,63,63,63,0x20400,0x40200,2,10,0,1,1,0xffffffff,0xffffffff,0x24000,0x120000,0x616000,0xe00000,0
.long 0,32,3,0x60400,0x1a008,0xe2d400,0xe2d800,0x1078000,0x1078400,0x120c00,0x68400,0x104800,0x406b0b00,0x40000280,0x3f000000,63,63,63,0x22400,0x40280,322,10,0,1,1,0xffffffff,0xffffffff,0x24800,0x121000,0x616b00,0xe0f000,0
.long 0,32,6,0x60400,0x1a010,0xe3c000,0xe3c400,0x1078800,0x1078c00,0x121800,0x70400,0x120800,0x6b0000,0x40000280,0x3f000000,63,63,63,0x24400,0x40300,2,10,0,2,1,0xffffffff,0xffffffff,0x25000,0x122000,0x617600,0xe1e000,16384
.long 0,32,9,0x60400,0x1a018,0xe3c800,0xe4b000,0x1079000,0x10b4000,0x122400,0x78400,0x124800,0x6b0b00,640,0x3f000000,63,63,63,0x26400,0x40380,322,10,0,2,1,0xffffffff,0xffffffff,0x25800,0x123000,0x618100,0xe2d000,16384
.long 0,32,0,0x68800,0x1a000,0xe4b400,0xe4b800,0x10b4400,0x10b4800,0x140000,0x60800,0x101000,0x40760000,0x40000280,0x3f000000,63,63,63,0x20800,0x40400,4,10,0,1,1,0xffffffff,0xffffffff,0x28000,0x140000,0x62c000,0xe00000,0
.long 0,32,3,0x68800,0x1a008,0xe5a000,0xe5a400,0x10b4c00,0x10b5000,0x140c00,0x68800,0x105000,0x40760b00,0x40000280,0x3f000000,63,63,63,0x22800,0x40480,324,10,0,1,1,0xffffffff,0xffffffff,0x28800,0x141000,0x62cb00,0xe0f000,0
.long 0,32,6,0x68800,0x1a010,0xe5a800,0xe69000,0x10f0000,0x10f0400,0x141800,0x70800,0x121000,0x760000,0x40000280,0x3f000000,63,63,63,0x24800,0x40500,4,10,0,2,1,0xffffffff,0xffffffff,0x29000,0x142000,0x62d600,0xe1e000,16384
.long 0,32,9,0x68800,0x1a018,0xe69400,0xe69800,0x10f0800,0x10f0c00,0x142400,0x78800,0x125000,0x760b00,640,0x3f000000,63,63,63,0x26800,0x40580,324,10,0,2,1,0xffffffff,0xffffffff,0x29800,0x143000,0x62e100,0xe2d000,16384
.long 0,32,0,0x68c00,0x1a000,0xe78000,0xe78400,0x10f1000,0x112c000,0x160000,0x60c00,0x101800,0x40810000,0x40000280,0x3f000000,63,63,63,0x20c00,0x40600,6,10,0,1,1,0xffffffff,0xffffffff,0x2c000,0x160000,0x642000,0xe00000,0
.long 0,32,3,0x68c00,0x1a008,0xe78800,0xe87000,0x112c400,0x112c800,0x160c00,0x68c00,0x105800,0x40810b00,0x40000280,0x3f000000,63,63,63,0x22c00,0x40680,326,10,0,1,1,0xffffffff,0xffffffff,0x2c800,0x161000,0x642b00,0xe0f000,0
.long 0,32,6,0x68c00,0x1a010,0xe87400,0xe87800,0x112cc00,0x112d000,0x161800,0x70c00,0x121800,0x810000,0x40000280,0x3f000000,63,63,63,0x24c00,0x40700,6,10,0,2,1,0xffffffff,0xffffffff,0x2d000,0x162000,0x643600,0xe1e000,16384
.long 0,32,9,0x68c00,0x1a018,0xe96000,0xe96400,0x1168000,0x1168400,0x162400,0x78c00,0x125800,0x810b00,640,0x3f000000,63,63,63,0x26c00,0x40780,326,10,0,2,1,0xffffffff,0xffffffff,0x2d800,0x163000,0x644100,0xe2d000,16384
.long 0,32,0,0x71000,0x1a000,0xe96800,0xea5000,0x1168800,0x1168c00,0x180000,0x61000,0x102000,0x40601600,0x40000280,0x3e800000,63,63,63,0x21000,0x40800,8,10,0,1,1,0xffffffff,0xffffffff,0x30000,0x180000,0x658000,0xe00000,0
.long 0,32,3,0x71000,0x1a008,0xea5400,0xea5800,0x1169000,0x11a4000,0x180c00,0x69000,0x106000,0x40602000,0x40000280,0x3e800000,63,63,63,0x23000,0x40880,328,10,0,1,1,0xffffffff,0xffffffff,0x30800,0x181000,0x658b00,0xe0f000,0
.long 0,32,6,0x71000,0x1a010,0xeb4000,0xeb4400,0x11a4400,0x11a4800,0x181800,0x71000,0x122000,0x601600,0x40000280,0x3e800000,63,63,63,0x25000,0x40900,8,10,0,2,1,0xffffffff,0xffffffff,0x31000,0x182000,0x659600,0xe1e000,16384
.long 0,32,9,0x71000,0x1a018,0xeb4800,0xec3000,0x11a4c00,0x11a5000,0x182400,0x79000,0x126000,0x602000,640,0x3e800000,63,63,63,0x27000,0x40980,328,10,0,2,1,0xffffffff,0xffffffff,0x31800,0x183000,0x65a100,0xe2d000,16384
.long 0,32,0,0x71400,0x1a000,0xec3400,0xec3800,0x1001400,0x1001800,0x1a0000,0x61400,0x102800,0x40810000,0x40000280,0x3f000000,63,63,63,0x21400,0x40a00,10,10,0,1,1,0xffffffff,0xffffffff,0x34000,0x1a0000,0x66e000,0xe00000,0
.long 0,32,3,0x71400,0x1a008,0xed2000,0xed2400,0x1001c00,0x1002000,0x1a0c00,0x69400,0x106800,0x40810b00,0x40000280,0x3f000000,63,63,63,0x23400,0x40a80,330,10,0,1,1,0xffffffff,0xffffffff,0x34800,0x1a1000,0x66eb00,0xe0f000,0
.long 0,32,6,0x71400,0x1a010,0xed2800,0xee1000,0x1002400,0x103d400,0x1a1800,0x71400,0x122800,0x40810000,0x40000280,0x3f000000,63,63,63,0x25400,0x40b00,10,10,0,2,1,0xffffffff,0xffffffff,0x35000,0x1a2000,0x66f600,0xe1e000,16384
.long 0,32,9,0x71400,0x1a018,0xee1400,0xee1800,0x103d800,0x103dc00,0x1a2400,0x79400,0x126800,0x40810b00,0x40000280,0x3f000000,63,63,63,0x27400,0x40b80,330,10,0,2,1,0xffffffff,0xffffffff,0x35800,0x1a3000,0x670100,0xe2d000,16384
.long 0,32,0,0x79800,0x1a000,0xef0000,0xef0400,0x103e000,0x103e400,0x1c0000,0x61800,0x103000,0x40760000,0x40000280,0x3f000000,63,63,63,0x21800,0x40c00,12,10,0,1,1,0xffffffff,0xffffffff,0x38000,0x1c0000,0x684000,0xe00000,0
.long 0,32,3,0x79800,0x1a008,0xef0800,0xeff000,0x1079400,0x1079800,0x1c0c00,0x69800,0x107000,0x40760b00,0x40000280,0x3f000000,63,63,63,0x23800,0x40c80,332,10,0,1,1,0xffffffff,0xffffffff,0x38800,0x1c1000,0x684b00,0xe0f000,0
.long 0,32,6,0x79800,0x1a010,0xeff400,0xeff800,0x1079c00,0x107a000,0x1c1800,0x71800,0x123000,0x40760000,0x40000280,0x3f000000,63,63,63,0x25800,0x40d00,12,10,0,2,1,0xffffffff,0xffffffff,0x39000,0x1c2000,0x685600,0xe1e000,16384
.long 0,32,9,0x79800,0x1a018,0xf0e000,0xf0e400,0x107a400,0x10b5400,0x1c2400,0x79800,0x127000,0x40760b00,0x40000280,0x3f000000,63,63,63,0x27800,0x40d80,332,10,0,2,1,0xffffffff,0xffffffff,0x39800,0x1c3000,0x686100,0xe2d000,16384
.long 0,32,0,0x79c00,0x1a000,0xf0e800,0xf1d000,0x10b5800,0x10b5c00,0x1e0000,0x61c00,0x103800,0x406b0000,0x40000280,0x3f000000,63,63,63,0x21c00,0x40e00,14,10,0,1,1,0xffffffff,0xffffffff,0x3c000,0x1e0000,0x69a000,0xe00000,0
.long 0,32,3,0x79c00,0x1a008,0xf1d400,0xf1d800,0x10b6000,0x10b6400,0x1e0c00,0x69c00,0x107800,0x406b0b00,0x40000280,0x3f000000,63,63,63,0x23c00,0x40e80,334,10,0,1,1,0xffffffff,0xffffffff,0x3c800,0x1e1000,0x69ab00,0xe0f000,0
.long 0,32,6,0x79c00,0x1a010,0xf2c000,0xf2c400,0x10f1400,0x10f1800,0x1e1800,0x71c00,0x123800,0x406b0000,0x40000280,0x3f000000,63,63,63,0x25c00,0x40f00,14,10,0,2,1,0xffffffff,0xffffffff,0x3d000,0x1e2000,0x69b600,0xe1e000,16384
.long 0,32,9,0x79c00,0x1a018,0xf2c800,0xf3b000,0x10f1c00,0x10f2000,0x1e2400,0x79c00,0x127800,0x406b0b00,0x40000280,0x3f000000,63,63,63,0x27c00,0x40f80,334,10,0,2,1,0xffffffff,0xffffffff,0x3d800,0x1e3000,0x69c100,0xe2d000,16384
.long 0,32,12,0x60000,0x1a000,0xf3b400,0xf3b800,0x10f2400,0x112d400,0x104000,0x60080,0x140000,0x40600000,0x40000280,0x3e800000,79,16,15,0x28000,0x41000,1,10,0,1,1,0xffffffff,0xffffffff,0x22000,0x104000,0x602c00,0xe3c000,0
.long 0,32,15,0x60000,0x1a008,0xf4a000,0xf4a400,0x112d800,0x112dc00,0x104c00,0x68080,0x144000,0x40600a00,0x40000280,0x3e800000,79,16,15,0x2a000,0x41080,321,10,0,1,1,0xffffffff,0xffffffff,0x22800,0x105000,0x603700,0xe4b000,0
.long 0,32,18,0x60000,0x1a010,0xf4a800,0xf59000,0x112e000,0x112e400,0x105800,0x70080,0x160000,0x40600000,0x40000280,0x3e800000,79,16,15,0x2c000,0x41100,1,10,0,2,1,0xffffffff,0xffffffff,0x23000,0x106000,0x604200,0xe5a000,16384
.long 0,32,21,0x60000,0x1a018,0xf59400,0xf59800,0x1169400,0x1169800,0x106400,0x78080,0x164000,0x40600a00,0x40000280,0x3e800000,79,16,15,0x2e000,0x41180,321,10,0,2,1,0xffffffff,0xffffffff,0x23800,0x107000,0x604d00,0xe69000,16384
.long 0,32,12,0x60400,0x1a000,0xf68000,0xf68400,0x1169c00,0x116a000,0x124000,0x60480,0x140800,0x406b0000,0x40000280,0x3f000000,63,63,63,0x28400,0x41200,3,10,0,1,1,0xffffffff,0xffffffff,0x26000,0x124000,0x618c00,0xe3c000,0
.long 0,32,15,0x60400,0x1a008,0xf68800,0xf77000,0x116a400,0x11a5400,0x124c00,0x68480,0x144800,0x406b0b00,0x40000280,0x3f000000,63,63,63,0x2a400,0x41280,323,10,0,1,1,0xffffffff,0xffffffff,0x26800,0x125000,0x619700,0xe4b000,0
.long 0,32,18,0x60400,0x1a010,0xf77400,0xf77800,0x11a5800,0x11a5c00,0x125800,0x70480,0x160800,0x406b0000,0x40000280,0x3f000000,63,63,63,0x2c400,0x41300,3,10,0,2,1,0xffffffff,0xffffffff,0x27000,0x126000,0x61a200,0xe5a000,16384
.long 0,32,21,0x60400,0x1a018,0xf86000,0xf86400,0x11a6000,0x11a6400,0x126400,0x78480,0x164800,0x406b0b00,0x40000280,0x3f000000,63,63,63,0x2e400,0x41380,323,10,0,2,1,0xffffffff,0xffffffff,0x27800,0x127000,0x61ad00,0xe69000,16384
.long 0,32,12,0x68800,0x1a000,0xf86800,0xf95000,0x1002800,0x1002c00,0x144000,0x60880,0x141000,0x40760000,0x40000280,0x3f000000,63,63,63,0x28800,0x41400,5,10,0,1,1,0xffffffff,0xffffffff,0x2a000,0x144000,0x62ec00,0xe3c000,0
.long 0,32,15,0x68800,0x1a008,0xf95400,0xf95800,0x1003000,0x1003400,0x144c00,0x68880,0x145000,0x40760b00,0x40000280,0x3f000000,63,63,63,0x2a800,0x41480,325,10,0,1,1,0xffffffff,0xffffffff,0x2a800,0x145000,0x62f700,0xe4b000,0
.long 0,32,18,0x68800,0x1a010,0xfa4000,0xfa4400,0x1003800,0x103e800,0x145800,0x70880,0x161000,0x40760000,0x40000280,0x3f000000,63,63,63,0x2c800,0x41500,5,10,0,2,1,0xffffffff,0xffffffff,0x2b000,0x146000,0x630200,0xe5a000,16384
.long 0,32,21,0x68800,0x1a018,0xfa4800,0xfb3000,0x103ec00,0x103f000,0x146400,0x78880,0x165000,0x40760b00,0x40000280,0x3f000000,63,63,63,0x2e800,0x41580,325,10,0,2,1,0xffffffff,0xffffffff,0x2b800,0x147000,0x630d00,0xe69000,16384
.long 0,32,12,0x68c00,0x1a000,0xfb3400,0xfb3800,0x103f400,0x103f800,0x164000,0x60c80,0x141800,0x40810000,0x40000280,0x3f000000,63,63,63,0x28c00,0x41600,7,10,0,1,1,0xffffffff,0xffffffff,0x2e000,0x164000,0x644c00,0xe3c000,0
.long 0,32,15,0x68c00,0x1a008,0xfc2000,0xfc2400,0x107a800,0x107ac00,0x164c00,0x68c80,0x145800,0x40810b00,0x40000280,0x3f000000,63,63,63,0x2ac00,0x41680,327,10,0,1,1,0xffffffff,0xffffffff,0x2e800,0x165000,0x645700,0xe4b000,0
.long 0,32,18,0x68c00,0x1a010,0xfc2800,0xfd1000,0x107b000,0x107b400,0x165800,0x70c80,0x161800,0x40810000,0x40000280,0x3f000000,63,63,63,0x2cc00,0x41700,7,10,0,2,1,0xffffffff,0xffffffff,0x2f000,0x166000,0x646200,0xe5a000,16384
.long 0,32,21,0x68c00,0x1a018,0xfd1400,0xfd1800,0x107b800,0x10b6800,0x166400,0x78c80,0x165800,0x40810b00,0x40000280,0x3f000000,63,63,63,0x2ec00,0x41780,327,10,0,2,1,0xffffffff,0xffffffff,0x2f800,0x167000,0x646d00,0xe69000,16384
.long 0,32,12,0x71000,0x1a000,0xe00c00,0xe01000,0x10b6c00,0x10b7000,0x184000,0x61080,0x142000,0x40601600,0x40000280,0x3e800000,63,63,63,0x29000,0x41800,9,10,0,1,1,0xffffffff,0xffffffff,0x32000,0x184000,0x65ac00,0xe3c000,0
.long 0,32,15,0x71000,0x1a008,0xe01400,0xe0fc00,0x10b7400,0x10b7800,0x184c00,0x69080,0x146000,0x40602000,0x40000280,0x3e800000,63,63,63,0x2b000,0x41880,329,10,0,1,1,0xffffffff,0xffffffff,0x32800,0x185000,0x65b700,0xe4b000,0
.long 0,32,18,0x71000,0x1a010,0xe10000,0xe10400,0x10f2800,0x10f2c00,0x185800,0x71080,0x162000,0x40601600,0x40000280,0x3e800000,63,63,63,0x2d000,0x41900,9,10,0,2,1,0xffffffff,0xffffffff,0x33000,0x186000,0x65c200,0xe5a000,16384
.long 0,32,21,0x71000,0x1a018,0xe1ec00,0xe1f000,0x10f3000,0x10f3400,0x186400,0x79080,0x166000,0x40602000,0x40000280,0x3e800000,63,63,63,0x2f000,0x41980,329,10,0,2,1,0xffffffff,0xffffffff,0x33800,0x187000,0x65cd00,0xe69000,16384
.long 0,32,12,0x71400,0x1a000,0xe1f400,0xe2dc00,0x10f3800,0x112e800,0x1a4000,0x61480,0x142800,0x40810000,0x40000280,0x3f000000,63,63,63,0x29400,0x41a00,11,10,0,1,1,0xffffffff,0xffffffff,0x36000,0x1a4000,0x670c00,0xe3c000,0
.long 0,32,15,0x71400,0x1a008,0xe2e000,0xe2e400,0x112ec00,0x112f000,0x1a4c00,0x69480,0x146800,0x40810b00,0x40000280,0x3f000000,63,63,63,0x2b400,0x41a80,331,10,0,1,1,0xffffffff,0xffffffff,0x36800,0x1a5000,0x671700,0xe4b000,0
.long 0,32,18,0x71400,0x1a010,0xe3cc00,0xe3d000,0x112f400,0x112f800,0x1a5800,0x71480,0x162800,0x40810000,0x40000280,0x3f000000,63,63,63,0x2d400,0x41b00,11,10,0,2,1,0xffffffff,0xffffffff,0x37000,0x1a6000,0x672200,0xe5a000,16384
.long 0,32,21,0x71400,0x1a018,0xe3d400,0xe4bc00,0x116a800,0x116ac00,0x1a6400,0x79480,0x166800,0x40810b00,0x40000280,0x3f000000,63,63,63,0x2f400,0x41b80,331,10,0,2,1,0xffffffff,0xffffffff,0x37800,0x1a7000,0x672d00,0xe69000,16384
.long 0,32,12,0x79800,0x1a000,0xe4c000,0xe4c400,0x116b000,0x116b400,0x1c4000,0x61880,0x143000,0x40760000,0x40000280,0x3f000000,63,63,63,0x29800,0x41c00,13,10,0,1,1,0xffffffff,0xffffffff,0x3a000,0x1c4000,0x686c00,0xe3c000,0
.long 0,32,15,0x79800,0x1a008,0xe5ac00,0xe5b000,0x116b800,0x11a6800,0x1c4c00,0x69880,0x147000,0x40760b00,0x40000280,0x3f000000,63,63,63,0x2b800,0x41c80,333,10,0,1,1,0xffffffff,0xffffffff,0x3a800,0x1c5000,0x687700,0xe4b000,0
.long 0,32,18,0x79800,0x1a010,0xe5b400,0xe69c00,0x11a6c00,0x11a7000,0x1c5800,0x71880,0x163000,0x40760000,0x40000280,0x3f000000,63,63,63,0x2d800,0x41d00,13,10,0,2,1,0xffffffff,0xffffffff,0x3b000,0x1c6000,0x688200,0xe5a000,16384
.long 0,32,21,0x79800,0x1a018,0xe6a000,0xe6a400,0x11a7400,0x11a7800,0x1c6400,0x79880,0x167000,0x40760b00,0x40000280,0x3f000000,63,63,63,0x2f800,0x41d80,333,10,0,2,1,0xffffffff,0xffffffff,0x3b800,0x1c7000,0x688d00,0xe69000,16384
.long 0,32,12,0x79c00,0x1a000,0xe78c00,0xe79000,0x1003c00,0x1004000,0x1e4000,0x61c80,0x143800,0x406b0000,0x40000280,0x3f000000,63,63,63,0x29c00,0x41e00,15,10,0,1,1,0xffffffff,0xffffffff,0x3e000,0x1e4000,0x69cc00,0xe3c000,0
.long 0,32,15,0x79c00,0x1a008,0xe79400,0xe87c00,0x1004400,0x1004800,0x1e4c00,0x69c80,0x147800,0x406b0b00,0x40000280,0x3f000000,63,63,63,0x2bc00,0x41e80,335,10,0,1,1,0xffffffff,0xffffffff,0x3e800,0x1e5000,0x69d700,0xe4b000,0
.long 0,32,18,0x79c00,0x1a010,0xe88000,0xe88400,0x1004c00,0x103fc00,0x1e5800,0x71c80,0x163800,0x406b0000,0x40000280,0x3f000000,63,63,63,0x2dc00,0x41f00,15,10,0,2,1,0xffffffff,0xffffffff,0x3f000,0x1e6000,0x69e200,0xe5a000,16384
.long 0,32,21,0x79c00,0x1a018,0xe96c00,0xe97000,0x1040000,0x1040400,0x1e6400,0x79c80,0x167800,0x406b0b00,0x40000280,0x3f000000,63,63,63,0x2fc00,0x41f80,335,10,0,2,1,0xffffffff,0xffffffff,0x3f800,0x1e7000,0x69ed00,0xe69000,16384
.long 2,62,24,0x60000,0x1a000,0xe97400,0xea5c00,0x1040800,0x1040c00,0x108000,0x60100,0x180000,0x40600000,0x40000280,0x3e800000,79,16,15,0x30000,0x42000,0,10,0xbe800000,3,0,0xffffffff,0,0x20000,0x108000,0x605800,0xe78000,0
.long 2,62,27,0x60000,0x1a008,0xea6000,0xea6400,0x107bc00,0x107c000,0x108c00,0x68100,0x184000,0x40600a00,0x40000280,0x3e800000,79,16,15,0x32000,0x42080,320,10,0xbe800000,3,0,0xffffffff,0,0x20800,0x109000,0x606300,0xe87000,0
.long 2,62,30,0x60000,0x1a010,0xeb4c00,0xeb5000,0x107c400,0x107c800,0x109800,0x70100,0x1a0000,0x40600000,0x40000280,0x3e800000,79,16,15,0x34000,0x42100,16,10,0xbe800000,3,0,0,0xffffffff,0x21000,0x10a000,0x606e00,0xe96000,0
.long 2,62,33,0x60000,0x1a018,0xeb5400,0xec3c00,0x107cc00,0x10b7c00,0x10a400,0x78100,0x1a4000,0x40600a00,0x40000280,0x3e800000,79,16,15,0x36000,0x42180,336,10,0xbe800000,3,0,0,0xffffffff,0x21800,0x10b000,0x607900,0xea5000,0
.long 2,62,24,0x60400,0x1a000,0xec4000,0xec4400,0x10b8000,0x10b8400,0x128000,0x60500,0x180800,0x406b0000,0x40000280,0x3f000000,63,63,63,0x30400,0x42200,2,10,0xbe800000,3,1,0xffffffff,0xffffffff,0x24000,0x128000,0x61b800,0xe78000,0
.long 2,62,27,0x60400,0x1a008,0xed2c00,0xed3000,0x10b8800,0x10b8c00,0x128c00,0x68500,0x184800,0x406b0b00,0x40000280,0x3f000000,63,63,63,0x32400,0x42280,322,10,0xbe800000,3,1,0xffffffff,0xffffffff,0x24800,0x129000,0x61c300,0xe87000,0
.long 2,62,30,0x60400,0x1a010,0xed3400,0xee1c00,0x10f3c00,0x10f4000,0x129800,0x70500,0x1a0800,0x406b0000,0x40000280,0x3f000000,63,63,63,0x34400,0x42300,30,10,0xbe800000,3,0x80008000,0xffffffff,0xffffffff,0x25000,0x12a000,0x61ce00,0xe96000,0
.long 2,62,33,0x60400,0x1a018,0xee2000,0xee2400,0x10f4400,0x10f4800,0x12a400,0x78500,0x1a4800,0x406b0b00,0x40000280,0x3f000000,63,63,63,0x36400,0x42380,350,10,0xbe800000,3,0x80008000,0xffffffff,0xffffffff,0x25800,0x12b000,0x61d900,0xea5000,0
.long 2,62,24,0x68800,0x1a000,0xef0c00,0xef1000,0x10f4c00,0x112fc00,0x148000,0x60900,0x181000,0x40760000,0x40000280,0x3f000000,63,63,63,0x30800,0x42400,4,10,0xbe800000,3,1,0xffffffff,0xffffffff,0x28000,0x148000,0x631800,0xe78000,0
.long 2,62,27,0x68800,0x1a008,0xef1400,0xeffc00,0x1130000,0x1130400,0x148c00,0x68900,0x185000,0x40760b00,0x40000280,0x3f000000,63,63,63,0x32800,0x42480,324,10,0xbe800000,3,1,0xffffffff,0xffffffff,0x28800,0x149000,0x632300,0xe87000,0
.long 2,62,30,0x68800,0x1a010,0xf00000,0xf00400,0x1130800,0x1130c00,0x149800,0x70900,0x1a1000,0x40760000,0x40000280,0x3f000000,63,63,63,0x34800,0x42500,28,10,0xbe800000,3,0x80008000,0xffffffff,0xffffffff,0x29000,0x14a000,0x632e00,0xe96000,0
.long 2,62,33,0x68800,0x1a018,0xf0ec00,0xf0f000,0x116bc00,0x116c000,0x14a400,0x78900,0x1a5000,0x40760b00,0x40000280,0x3f000000,63,63,63,0x36800,0x42580,348,10,0xbe800000,3,0x80008000,0xffffffff,0xffffffff,0x29800,0x14b000,0x633900,0xea5000,0
.long 2,62,24,0x68c00,0x1a000,0xf0f400,0xf1dc00,0x116c400,0x116c800,0x168000,0x60d00,0x181800,0x40810000,0x40000280,0x3f000000,63,63,63,0x30c00,0x42600,6,10,0xbe800000,3,1,0xffffffff,0xffffffff,0x2c000,0x168000,0x647800,0xe78000,0
.long 2,62,27,0x68c00,0x1a008,0xf1e000,0xf1e400,0x116cc00,0x11a7c00,0x168c00,0x68d00,0x185800,0x40810b00,0x40000280,0x3f000000,63,63,63,0x32c00,0x42680,326,10,0xbe800000,3,1,0xffffffff,0xffffffff,0x2c800,0x169000,0x648300,0xe87000,0
.long 2,62,30,0x68c00,0x1a010,0xf2cc00,0xf2d000,0x11a8000,0x11a8400,0x169800,0x70d00,0x1a1800,0x40810000,0x40000280,0x3f000000,63,63,63,0x34c00,0x42700,26,10,0xbe800000,3,0x80008000,0xffffffff,0xffffffff,0x2d000,0x16a000,0x648e00,0xe96000,0
.long 2,62,33,0x68c00,0x1a018,0xf2d400,0xf3bc00,0x11a8800,0x11a8c00,0x16a400,0x78d00,0x1a5800,0x40810b00,0x40000280,0x3f000000,63,63,63,0x36c00,0x42780,346,10,0xbe800000,3,0x80008000,0xffffffff,0xffffffff,0x2d800,0x16b000,0x649900,0xea5000,0
.long 2,62,24,0x71000,0x1a000,0xf3c000,0xf3c400,0x1005000,0x1005400,0x188000,0x61100,0x182000,0x40601600,0x40000280,0x3e800000,63,63,63,0x31000,0x42800,8,10,0xbe800000,3,1,0xffffffff,0xffffffff,0x30000,0x188000,0x65d800,0xe78000,0
.long 2,62,27,0x71000,0x1a008,0xf4ac00,0xf4b000,0x1005800,0x1005c00,0x188c00,0x69100,0x186000,0x40602000,0x40000280,0x3e800000,63,63,63,0x33000,0x42880,328,10,0xbe800000,3,1,0xffffffff,0xffffffff,0x30800,0x189000,0x65e300,0xe87000,0
.long 2,62,30,0x71000,0x1a010,0xf4b400,0xf59c00,0x1006000,0x1041000,0x189800,0x71100,0x1a2000,0x40601600,0x40000280,0x3e800000,63,63,63,0x35000,0x42900,24,10,0xbe800000,3,0x80008000,0xffffffff,0xffffffff,0x31000,0x18a000,0x65ee00,0xe96000,0
.long 2,62,33,0x71000,0x1a018,0xf5a000,0xf5a400,0x1041400,0x1041800,0x18a400,0x79100,0x1a6000,0x40602000,0x40000280,0x3e800000,63,63,63,0x37000,0x42980,344,10,0xbe800000,3,0x80008000,0xffffffff,0xffffffff,0x31800,0x18b000,0x65f900,0xea5000,0
.long 2,62,24,0x71400,0x1a000,0xf68c00,0xf69000,0x1041c00,0x1042000,0x1a8000,0x61500,0x182800,0x40810000,0x40000280,0x3f000000,63,63,63,0x31400,0x42a00,10,10,0xbe800000,3,1,0xffffffff,0xffffffff,0x34000,0x1a8000,0x673800,0xe78000,0
.long 2,62,27,0x71400,0x1a008,0xf69400,0xf77c00,0x107d000,0x107d400,0x1a8c00,0x69500,0x186800,0x40810b00,0x40000280,0x3f000000,63,63,63,0x33400,0x42a80,330,10,0xbe800000,3,1,0xffffffff,0xffffffff,0x34800,0x1a9000,0x674300,0xe87000,0
.long 2,62,30,0x71400,0x1a010,0xf78000,0xf78400,0x107d800,0x107dc00,0x1a9800,0x71500,0x1a2800,0x40810000,0x40000280,0x3f000000,63,63,63,0x35400,0x42b00,22,10,0xbe800000,3,0x80008000,0xffffffff,0xffffffff,0x35000,0x1aa000,0x674e00,0xe96000,0
.long 2,62,33,0x71400,0x1a018,0xf86c00,0xf87000,0x107e000,0x10b9000,0x1aa400,0x79500,0x1a6800,0x40810b00,0x40000280,0x3f000000,63,63,63,0x37400,0x42b80,342,10,0xbe800000,3,0x80008000,0xffffffff,0xffffffff,0x35800,0x1ab000,0x675900,0xea5000,0
.long 2,62,24,0x79800,0x1a000,0xf87400,0xf95c00,0x10b9400,0x10b9800,0x1c8000,0x61900,0x183000,0x40760000,0x40000280,0x3f000000,63,63,63,0x31800,0x42c00,12,10,0xbe800000,3,1,0xffffffff,0xffffffff,0x38000,0x1c8000,0x689800,0xe78000,0
.long 2,62,27,0x79800,0x1a008,0xf96000,0xf96400,0x10b9c00,0x10ba000,0x1c8c00,0x69900,0x187000,0x40760b00,0x40000280,0x3f000000,63,63,63,0x33800,0x42c80,332,10,0xbe800000,3,1,0xffffffff,0xffffffff,0x38800,0x1c9000,0x68a300,0xe87000,0
.long 2,62,30,0x79800,0x1a010,0xfa4c00,0xfa5000,0x10f5000,0x10f5400,0x1c9800,0x71900,0x1a3000,0x40760000,0x40000280,0x3f000000,63,63,63,0x35800,0x42d00,20,10,0xbe800000,3,0x80008000,0xffffffff,0xffffffff,0x39000,0x1ca000,0x68ae00,0xe96000,0
.long 2,62,33,0x79800,0x1a018,0xfa5400,0xfb3c00,0x10f5800,0x10f5c00,0x1ca400,0x79900,0x1a7000,0x40760b00,0x40000280,0x3f000000,63,63,63,0x37800,0x42d80,340,10,0xbe800000,3,0x80008000,0xffffffff,0xffffffff,0x39800,0x1cb000,0x68b900,0xea5000,0
.long 2,62,24,0x79c00,0x1a000,0xfb4000,0xfb4400,0x10f6000,0x1131000,0x1e8000,0x61d00,0x183800,0x406b0000,0x40000280,0x3f000000,63,63,63,0x31c00,0x42e00,14,10,0xbe800000,3,1,0xffffffff,0xffffffff,0x3c000,0x1e8000,0x69f800,0xe78000,0
.long 2,62,27,0x79c00,0x1a008,0xfc2c00,0xfc3000,0x1131400,0x1131800,0x1e8c00,0x69d00,0x187800,0x406b0b00,0x40000280,0x3f000000,63,63,63,0x33c00,0x42e80,334,10,0xbe800000,3,1,0xffffffff,0xffffffff,0x3c800,0x1e9000,0x6a0300,0xe87000,0
.long 2,62,30,0x79c00,0x1a010,0xfc3400,0xfd1c00,0x1131c00,0x1132000,0x1e9800,0x71d00,0x1a3800,0x406b0000,0x40000280,0x3f000000,63,63,63,0x35c00,0x42f00,18,10,0xbe800000,3,0x80008000,0xffffffff,0xffffffff,0x3d000,0x1ea000,0x6a0e00,0xe96000,0
.long 2,62,33,0x79c00,0x1a018,0xfd2000,0xfd2400,0x116d000,0x116d400,0x1ea400,0x79d00,0x1a7800,0x406b0b00,0x40000280,0x3f000000,63,63,63,0x37c00,0x42f80,338,10,0xbe800000,3,0x80008000,0xffffffff,0xffffffff,0x3d800,0x1eb000,0x6a1900,0xea5000,0
.long 2,62,36,0x60000,0x1a000,0xe01800,0xe01c00,0x116d800,0x116dc00,0x10c000,0x60180,0x1c0000,0x40600000,0x40000280,0x3e800000,79,16,15,0x38000,0x43000,1,10,0xbe800000,3,1,0xffffffff,0xffffffff,0x22000,0x10c000,0x608400,0xeb4000,0
.long 2,62,39,0x60000,0x1a008,0xe02000,0xe10800,0x116e000,0x11a9000,0x10cc00,0x68180,0x1c4000,0x40600a00,0x40000280,0x3e800000,79,16,15,0x3a000,0x43080,321,10,0xbe800000,3,1,0xffffffff,0xffffffff,0x22800,0x10d000,0x608f00,0xec3000,0
.long 2,62,42,0x60000,0x1a010,0xe10c00,0xe11000,0x11a9400,0x11a9800,0x10d800,0x70180,0x1e0000,0x40600000,0x40000280,0x3e800000,79,16,15,0x3c000,0x43100,31,10,0xbe800000,3,0x80008000,0xffffffff,0xffffffff,0x23000,0x10e000,0x609a00,0xed2000,0
.long 2,62,45,0x60000,0x1a018,0xe1f800,0xe1fc00,0x11a9c00,0x11aa000,0x10e400,0x78180,0x1e4000,0x40600a00,0x40000280,0x3e800000,79,16,15,0x3e000,0x43180,351,10,0xbe800000,3,0x80008000,0xffffffff,0xffffffff,0x23800,0x10f000,0x60a500,0xee1000,0
.long 2,62,36,0x60400,0x1a000,0xe20000,0xe2e800,0x1006400,0x1006800,0x12c000,0x60580,0x1c0800,0x406b0000,0x40000280,0x3f000000,63,63,63,0x38400,0x43200,3,10,0xbe800000,3,1,0xffffffff,0xffffffff,0x26000,0x12c000,0x61e400,0xeb4000,0
.long 2,62,39,0x60400,0x1a008,0xe2ec00,0xe2f000,0x1006c00,0x1007000,0x12cc00,0x68580,0x1c4800,0x406b0b00,0x40000280,0x3f000000,63,63,63,0x3a400,0x43280,323,10,0xbe800000,3,1,0xffffffff,0xffffffff,0x26800,0x12d000,0x61ef00,0xec3000,0
.long 2,62,42,0x60400,0x1a010,0xe3d800,0xe3dc00,0x1007400,0x1042400,0x12d800,0x70580,0x1e0800,0x406b0000,0x40000280,0x3f000000,63,63,63,0x3c400,0x43300,29,10,0xbe800000,3,0x80008000,0xffffffff,0xffffffff,0x27000,0x12e000,0x61fa00,0xed2000,0
.long 2,62,45,0x60400,0x1a018,0xe3e000,0xe4c800,0x1042800,0x1042c00,0x12e400,0x78580,0x1e4800,0x406b0b00,0x40000280,0x3f000000,63,63,63,0x3e400,0x43380,349,10,0xbe800000,3,0x80008000,0xffffffff,0xffffffff,0x27800,0x12f000,0x620500,0xee1000,0
.long 2,62,36,0x68800,0x1a000,0xe4cc00,0xe4d000,0x1043000,0x1043400,0x14c000,0x60980,0x1c1000,0x40760000,0x40000280,0x3f000000,63,63,63,0x38800,0x43400,5,10,0xbe800000,3,1,0xffffffff,0xffffffff,0x2a000,0x14c000,0x634400,0xeb4000,0
.long 2,62,39,0x68800,0x1a008,0xe5b800,0xe5bc00,0x107e400,0x107e800,0x14cc00,0x68980,0x1c5000,0x40760b00,0x40000280,0x3f000000,63,63,63,0x3a800,0x43480,325,10,0xbe800000,3,1,0xffffffff,0xffffffff,0x2a800,0x14d000,0x634f00,0xec3000,0
.long 2,62,42,0x68800,0x1a010,0xe5c000,0xe6a800,0x107ec00,0x107f000,0x14d800,0x70980,0x1e1000,0x40760000,0x40000280,0x3f000000,63,63,63,0x3c800,0x43500,27,10,0xbe800000,3,0x80008000,0xffffffff,0xffffffff,0x2b000,0x14e000,0x635a00,0xed2000,0
.long 2,62,45,0x68800,0x1a018,0xe6ac00,0xe6b000,0x107f400,0x10ba400,0x14e400,0x78980,0x1e5000,0x40760b00,0x40000280,0x3f000000,63,63,63,0x3e800,0x43580,347,10,0xbe800000,3,0x80008000,0xffffffff,0xffffffff,0x2b800,0x14f000,0x636500,0xee1000,0
.long 2,62,36,0x68c00,0x1a000,0xe79800,0xe79c00,0x10ba800,0x10bac00,0x16c000,0x60d80,0x1c1800,0x40810000,0x40000280,0x3f000000,63,63,63,0x38c00,0x43600,7,10,0xbe800000,3,1,0xffffffff,0xffffffff,0x2e000,0x16c000,0x64a400,0xeb4000,0
.long 2,62,39,0x68c00,0x1a008,0xe7a000,0xe88800,0x10bb000,0x10bb400,0x16cc00,0x68d80,0x1c5800,0x40810b00,0x40000280,0x3f000000,63,63,63,0x3ac00,0x43680,327,10,0xbe800000,3,1,0xffffffff,0xffffffff,0x2e800,0x16d000,0x64af00,0xec3000,0
.long 2,62,42,0x68c00,0x1a010,0xe88c00,0xe89000,0x10f6400,0x10f6800,0x16d800,0x70d80,0x1e1800,0x40810000,0x40000280,0x3f000000,63,63,63,0x3cc00,0x43700,25,10,0xbe800000,3,0x80008000,0xffffffff,0xffffffff,0x2f000,0x16e000,0x64ba00,0xed2000,0
.long 2,62,45,0x68c00,0x1a018,0xe97800,0xe97c00,0x10f6c00,0x10f7000,0x16e400,0x78d80,0x1e5800,0x40810b00,0x40000280,0x3f000000,63,63,63,0x3ec00,0x43780,345,10,0xbe800000,3,0x80008000,0xffffffff,0xffffffff,0x2f800,0x16f000,0x64c500,0xee1000,0
.long 2,62,36,0x71000,0x1a000,0xe98000,0xea6800,0x10f7400,0x1132400,0x18c000,0x61180,0x1c2000,0x40601600,0x40000280,0x3e800000,63,63,63,0x39000,0x43800,9,10,0xbe800000,3,1,0xffffffff,0xffffffff,0x32000,0x18c000,0x660400,0xeb4000,0
.long 2,62,39,0x71000,0x1a008,0xea6c00,0xea7000,0x1132800,0x1132c00,0x18cc00,0x69180,0x1c6000,0x40602000,0x40000280,0x3e800000,63,63,63,0x3b000,0x43880,329,10,0xbe800000,3,1,0xffffffff,0xffffffff,0x32800,0x18d000,0x660f00,0xec3000,0
.long 2,62,42,0x71000,0x1a010,0xeb5800,0xeb5c00,0x1133000,0x1133400,0x18d800,0x71180,0x1e2000,0x40601600,0x40000280,0x3e800000,63,63,63,0x3d000,0x43900,23,10,0xbe800000,3,0x80008000,0xffffffff,0xffffffff,0x33000,0x18e000,0x661a00,0xed2000,0
.long 2,62,45,0x71000,0x1a018,0xeb6000,0xec4800,0x116e400,0x116e800,0x18e400,0x79180,0x1e6000,0x40602000,0x40000280,0x3e800000,63,63,63,0x3f000,0x43980,343,10,0xbe800000,3,0x80008000,0xffffffff,0xffffffff,0x33800,0x18f000,0x662500,0xee1000,0
.long 2,62,36,0x71400,0x1a000,0xec4c00,0xec5000,0x116ec00,0x116f000,0x1ac000,0x61580,0x1c2800,0x40810000,0x40000280,0x3f000000,63,63,63,0x39400,0x43a00,11,10,0xbe800000,3,1,0xffffffff,0xffffffff,0x36000,0x1ac000,0x676400,0xeb4000,0
.long 2,62,39,0x71400,0x1a008,0xed3800,0xed3c00,0x116f400,0x11aa400,0x1acc00,0x69580,0x1c6800,0x40810b00,0x40000280,0x3f000000,63,63,63,0x3b400,0x43a80,331,10,0xbe800000,3,1,0xffffffff,0xffffffff,0x36800,0x1ad000,0x676f00,0xec3000,0
.long 2,62,42,0x71400,0x1a010,0xed4000,0xee2800,0x11aa800,0x11aac00,0x1ad800,0x71580,0x1e2800,0x40810000,0x40000280,0x3f000000,63,63,63,0x3d400,0x43b00,21,10,0xbe800000,3,0x80008000,0xffffffff,0xffffffff,0x37000,0x1ae000,0x677a00,0xed2000,0
.long 2,62,45,0x71400,0x1a018,0xee2c00,0xee3000,0x11ab000,0x11ab400,0x1ae400,0x79580,0x1e6800,0x40810b00,0x40000280,0x3f000000,63,63,63,0x3f400,0x43b80,341,10,0xbe800000,3,0x80008000,0xffffffff,0xffffffff,0x37800,0x1af000,0x678500,0xee1000,0
.long 2,62,36,0x79800,0x1a000,0xef1800,0xef1c00,0x1007800,0x1007c00,0x1cc000,0x61980,0x1c3000,0x40760000,0x40000280,0x3f000000,63,63,63,0x39800,0x43c00,13,10,0xbe800000,3,1,0xffffffff,0xffffffff,0x3a000,0x1cc000,0x68c400,0xeb4000,0
.long 2,62,39,0x79800,0x1a008,0xef2000,0xf00800,0x1008000,0x1008400,0x1ccc00,0x69980,0x1c7000,0x40760b00,0x40000280,0x3f000000,63,63,63,0x3b800,0x43c80,333,10,0xbe800000,3,1,0xffffffff,0xffffffff,0x3a800,0x1cd000,0x68cf00,0xec3000,0
.long 2,62,42,0x79800,0x1a010,0xf00c00,0xf01000,0x1008800,0x1043800,0x1cd800,0x71980,0x1e3000,0x40760000,0x40000280,0x3f000000,63,63,63,0x3d800,0x43d00,19,10,0xbe800000,3,0x80008000,0xffffffff,0xffffffff,0x3b000,0x1ce000,0x68da00,0xed2000,0
.long 2,62,45,0x79800,0x1a018,0xf0f800,0xf0fc00,0x1043c00,0x1044000,0x1ce400,0x79980,0x1e7000,0x40760b00,0x40000280,0x3f000000,63,63,63,0x3f800,0x43d80,339,10,0xbe800000,3,0x80008000,0xffffffff,0xffffffff,0x3b800,0x1cf000,0x68e500,0xee1000,0
.long 2,62,36,0x79c00,0x1a000,0xf10000,0xf1e800,0x1044400,0x1044800,0x1ec000,0x61d80,0x1c3800,0x406b0000,0x40000280,0x3f000000,63,63,63,0x39c00,0x43e00,15,10,0xbe800000,3,1,0xffffffff,0xffffffff,0x3e000,0x1ec000,0x6a2400,0xeb4000,0
.long 2,62,39,0x79c00,0x1a008,0xf1ec00,0xf1f000,0x107f800,0x107fc00,0x1ecc00,0x69d80,0x1c7800,0x406b0b00,0x40000280,0x3f000000,63,63,63,0x3bc00,0x43e80,335,10,0xbe800000,3,1,0xffffffff,0xffffffff,0x3e800,0x1ed000,0x6a2f00,0xec3000,0
.long 2,62,42,0x79c00,0x1a010,0xf2d800,0xf2dc00,0x1080000,0x1080400,0x1ed800,0x71d80,0x1e3800,0x406b0000,0x40000280,0x3f000000,63,63,63,0x3dc00,0x43f00,17,10,0xbe800000,3,0x80008000,0xffffffff,0xffffffff,0x3f000,0x1ee000,0x6a3a00,0xed2000,0
.long 2,62,45,0x79c00,0x1a018,0xf2e000,0xf3c800,0x1080800,0x10bb800,0x1ee400,0x79d80,0x1e7800,0x406b0b00,0x40000280,0x3f000000,63,63,63,0x3fc00,0x43f80,337,10,0xbe800000,3,0x80008000,0xffffffff,0xffffffff,0x3f800,0x1ef000,0x6a4500,0xee1000,0
.long 4,60,48,0x60000,0x1a000,0xf3cc00,0xf3d000,0x10bbc00,0x10bc000,0x110000,0x60200,0x100100,0x40600000,0x40000280,0x3e800000,79,16,15,0x20080,0x44000,0,10,0xbe800000,3,0,0xffffffff,0,0x20000,0x110000,0x60b000,0xef0000,0
.long 4,60,51,0x60000,0x1a008,0xf4b800,0xf4bc00,0x10bc400,0x10bc800,0x110c00,0x68200,0x104100,0x40600a00,0x40000280,0x3e800000,79,16,15,0x22080,0x44080,320,10,0xbe800000,3,0,0xffffffff,0,0x20800,0x111000,0x60bb00,0xeff000,0
.long 4,60,54,0x60000,0x1a010,0xf4c000,0xf5a800,0x10f7800,0x10f7c00,0x111800,0x70200,0x120100,0x40600000,0x40000280,0x3e800000,79,16,15,0x24080,0x44100,16,10,0xbe800000,3,0,0,0xffffffff,0x21000,0x112000,0x60c600,0xf0e000,0
.long 4,60,57,0x60000,0x1a018,0xf5ac00,0xf5b000,0x10f8000,0x10f8400,0x112400,0x78200,0x124100,0x40600a00,0x40000280,0x3e800000,79,16,15,0x26080,0x44180,336,10,0xbe800000,3,0,0,0xffffffff,0x21800,0x113000,0x60d100,0xf1d000,0
.long 4,60,48,0x60400,0x1a000,0xf69800,0xf69c00,0x10f8800,0x1133800,0x130000,0x60600,0x100900,0x406b0000,0x40000280,0x3f000000,63,63,63,0x20480,0x44200,2,10,0xbe800000,3,1,0xffffffff,0xffffffff,0x24000,0x130000,0x621000,0xef0000,0
.long 4,60,51,0x60400,0x1a008,0xf6a000,0xf78800,0x1133c00,0x1134000,0x130c00,0x68600,0x104900,0x406b0b00,0x40000280,0x3f000000,63,63,63,0x22480,0x44280,322,10,0xbe800000,3,1,0xffffffff,0xffffffff,0x24800,0x131000,0x621b00,0xeff000,0
.long 4,60,54,0x60400,0x1a010,0xf78c00,0xf79000,0x1134400,0x1134800,0x131800,0x70600,0x120900,0x406b0000,0x40000280,0x3f000000,63,63,63,0x24480,0x44300,30,10,0xbe800000,3,0x80008000,0xffffffff,0xffffffff,0x25000,0x132000,0x622600,0xf0e000,0
.long 4,60,57,0x60400,0x1a018,0xf87800,0xf87c00,0x116f800,0x116fc00,0x132400,0x78600,0x124900,0x406b0b00,0x40000280,0x3f000000,63,63,63,0x26480,0x44380,350,10,0xbe800000,3,0x80008000,0xffffffff,0xffffffff,0x25800,0x133000,0x623100,0xf1d000,0
.long 4,60,48,0x68800,0x1a000,0xf88000,0xf96800,0x1170000,0x1170400,0x150000,0x60a00,0x101100,0x40760000,0x40000280,0x3f000000,63,63,63,0x20880,0x44400,4,10,0xbe800000,3,1,0xffffffff,0xffffffff,0x28000,0x150000,0x637000,0xef0000,0
.long 4,60,51,0x68800,0x1a008,0xf96c00,0xf97000,0x1170800,0x11ab800,0x150c00,0x68a00,0x105100,0x40760b00,0x40000280,0x3f000000,63,63,63,0x22880,0x44480,324,10,0xbe800000,3,1,0xffffffff,0xffffffff,0x28800,0x151000,0x637b00,0xeff000,0
.long 4,60,54,0x68800,0x1a010,0xfa5800,0xfa5c00,0x11abc00,0x11ac000,0x151800,0x70a00,0x121100,0x40760000,0x40000280,0x3f000000,63,63,63,0x24880,0x44500,28,10,0xbe800000,3,0x80008000,0xffffffff,0xffffffff,0x29000,0x152000,0x638600,0xf0e000,0
.long 4,60,57,0x68800,0x1a018,0xfa6000,0xfb4800,0x11ac400,0x11ac800,0x152400,0x78a00,0x125100,0x40760b00,0x40000280,0x3f000000,63,63,63,0x26880,0x44580,348,10,0xbe800000,3,0x80008000,0xffffffff,0xffffffff,0x29800,0x153000,0x639100,0xf1d000,0
.long 4,60,48,0x68c00,0x1a000,0xfb4c00,0xfb5000,0x1008c00,0x1009000,0x170000,0x60e00,0x101900,0x40810000,0x40000280,0x3f000000,63,63,63,0x20c80,0x44600,6,10,0xbe800000,3,1,0xffffffff,0xffffffff,0x2c000,0x170000,0x64d000,0xef0000,0
.long 4,60,51,0x68c00,0x1a008,0xfc3800,0xfc3c00,0x1009400,0x1009800,0x170c00,0x68e00,0x105900,0x40810b00,0x40000280,0x3f000000,63,63,63,0x22c80,0x44680,326,10,0xbe800000,3,1,0xffffffff,0xffffffff,0x2c800,0x171000,0x64db00,0xeff000,0
.long 4,60,54,0x68c00,0x1a010,0xfc4000,0xfd2800,0x1009c00,0x1044c00,0x171800,0x70e00,0x121900,0x40810000,0x40000280,0x3f000000,63,63,63,0x24c80,0x44700,26,10,0xbe800000,3,0x80008000,0xffffffff,0xffffffff,0x2d000,0x172000,0x64e600,0xf0e000,0
.long 4,60,57,0x68c00,0x1a018,0xfd2c00,0xfd3000,0x1045000,0x1045400,0x172400,0x78e00,0x125900,0x40810b00,0x40000280,0x3f000000,63,63,63,0x26c80,0x44780,346,10,0xbe800000,3,0x80008000,0xffffffff,0xffffffff,0x2d800,0x173000,0x64f100,0xf1d000,0
.long 4,60,48,0x71000,0x1a000,0xe02400,0xe02800,0x1045800,0x1045c00,0x190000,0x61200,0x102100,0x40601600,0x40000280,0x3e800000,63,63,63,0x21080,0x44800,8,10,0xbe800000,3,1,0xffffffff,0xffffffff,0x30000,0x190000,0x663000,0xef0000,0
.long 4,60,51,0x71000,0x1a008,0xe02c00,0xe11400,0x1080c00,0x1081000,0x190c00,0x69200,0x106100,0x40602000,0x40000280,0x3e800000,63,63,63,0x23080,0x44880,328,10,0xbe800000,3,1,0xffffffff,0xffffffff,0x30800,0x191000,0x663b00,0xeff000,0
.long 4,60,54,0x71000,0x1a010,0xe11800,0xe11c00,0x1081400,0x1081800,0x191800,0x71200,0x122100,0x40601600,0x40000280,0x3e800000,63,63,63,0x25080,0x44900,24,10,0xbe800000,3,0x80008000,0xffffffff,0xffffffff,0x31000,0x192000,0x664600,0xf0e000,0
.long 4,60,57,0x71000,0x1a018,0xe20400,0xe20800,0x1081c00,0x10bcc00,0x192400,0x79200,0x126100,0x40602000,0x40000280,0x3e800000,63,63,63,0x27080,0x44980,344,10,0xbe800000,3,0x80008000,0xffffffff,0xffffffff,0x31800,0x193000,0x665100,0xf1d000,0
.long 4,60,48,0x71400,0x1a000,0xe20c00,0xe2f400,0x10bd000,0x10bd400,0x1b0000,0x61600,0x102900,0x40810000,0x40000280,0x3f000000,63,63,63,0x21480,0x44a00,10,10,0xbe800000,3,1,0xffffffff,0xffffffff,0x34000,0x1b0000,0x679000,0xef0000,0
.long 4,60,51,0x71400,0x1a008,0xe2f800,0xe2fc00,0x10bd800,0x10bdc00,0x1b0c00,0x69600,0x106900,0x40810b00,0x40000280,0x3f000000,63,63,63,0x23480,0x44a80,330,10,0xbe800000,3,1,0xffffffff,0xffffffff,0x34800,0x1b1000,0x679b00,0xeff000,0
.long 4,60,54,0x71400,0x1a010,0xe3e400,0xe3e800,0x10f8c00,0x10f9000,0x1b1800,0x71600,0x122900,0x40810000,0x40000280,0x3f000000,63,63,63,0x25480,0x44b00,22,10,0xbe800000,3,0x80008000,0xffffffff,0xffffffff,0x35000,0x1b2000,0x67a600,0xf0e000,0
.long 4,60,57,0x71400,0x1a018,0xe3ec00,0xe4d400,0x10f9400,0x10f9800,0x1b2400,0x79600,0x126900,0x40810b00,0x40000280,0x3f000000,63,63,63,0x27480,0x44b80,342,10,0xbe800000,3,0x80008000,0xffffffff,0xffffffff,0x35800,0x1b3000,0x67b100,0xf1d000,0
.long 4,60,48,0x79800,0x1a000,0xe4d800,0xe4dc00,0x10f9c00,0x1134c00,0x1d0000,0x61a00,0x103100,0x40760000,0x40000280,0x3f000000,63,63,63,0x21880,0x44c00,12,10,0xbe800000,3,1,0xffffffff,0xffffffff,0x38000,0x1d0000,0x68f000,0xef0000,0
.long 4,60,51,0x79800,0x1a008,0xe5c400,0xe5c800,0x1135000,0x1135400,0x1d0c00,0x69a00,0x107100,0x40760b00,0x40000280,0x3f000000,63,63,63,0x23880,0x44c80,332,10,0xbe800000,3,1,0xffffffff,0xffffffff,0x38800,0x1d1000,0x68fb00,0xeff000,0
.long 4,60,54,0x79800,0x1a010,0xe5cc00,0xe6b400,0x1135800,0x1135c00,0x1d1800,0x71a00,0x123100,0x40760000,0x40000280,0x3f000000,63,63,63,0x25880,0x44d00,20,10,0xbe800000,3,0x80008000,0xffffffff,0xffffffff,0x39000,0x1d2000,0x690600,0xf0e000,0
.long 4,60,57,0x79800,0x1a018,0xe6b800,0xe6bc00,0x1170c00,0x1171000,0x1d2400,0x79a00,0x127100,0x40760b00,0x40000280,0x3f000000,63,63,63,0x27880,0x44d80,340,10,0xbe800000,3,0x80008000,0xffffffff,0xffffffff,0x39800,0x1d3000,0x691100,0xf1d000,0
.long 4,60,48,0x79c00,0x1a000,0xe7a400,0xe7a800,0x1171400,0x1171800,0x1f0000,0x61e00,0x103900,0x406b0000,0x40000280,0x3f000000,63,63,63,0x21c80,0x44e00,14,10,0xbe800000,3,1,0xffffffff,0xffffffff,0x3c000,0x1f0000,0x6a5000,0xef0000,0
.long 4,60,51,0x79c00,0x1a008,0xe7ac00,0xe89400,0x1171c00,0x11acc00,0x1f0c00,0x69e00,0x107900,0x406b0b00,0x40000280,0x3f000000,63,63,63,0x23c80,0x44e80,334,10,0xbe800000,3,1,0xffffffff,0xffffffff,0x3c800,0x1f1000,0x6a5b00,0xeff000,0
.long 4,60,54,0x79c00,0x1a010,0xe89800,0xe89c00,0x11ad000,0x11ad400,0x1f1800,0x71e00,0x123900,0x406b0000,0x40000280,0x3f000000,63,63,63,0x25c80,0x44f00,18,10,0xbe800000,3,0x80008000,0xffffffff,0xffffffff,0x3d000,0x1f2000,0x6a6600,0xf0e000,0
.long 4,60,57,0x79c00,0x1a018,0xe98400,0xe98800,0x11ad800,0x11adc00,0x1f2400,0x79e00,0x127900,0x406b0b00,0x40000280,0x3f000000,63,63,63,0x27c80,0x44f80,338,10,0xbe800000,3,0x80008000,0xffffffff,0xffffffff,0x3d800,0x1f3000,0x6a7100,0xf1d000,0
.long 4,60,60,0x60000,0x1a000,0xe98c00,0xea7400,0x100a000,0x100a400,0x114000,0x60280,0x140100,0x40600000,0x40000280,0x3e800000,79,16,15,0x28080,0x45000,1,10,0xbe800000,3,1,0xffffffff,0xffffffff,0x22000,0x114000,0x60dc00,0xf2c000,0
.long 4,60,63,0x60000,0x1a008,0xea7800,0xea7c00,0x100a800,0x100ac00,0x114c00,0x68280,0x144100,0x40600a00,0x40000280,0x3e800000,79,16,15,0x2a080,0x45080,321,10,0xbe800000,3,1,0xffffffff,0xffffffff,0x22800,0x115000,0x60e700,0xf3b000,0
.long 4,60,66,0x60000,0x1a010,0xeb6400,0xeb6800,0x100b000,0x1046000,0x115800,0x70280,0x160100,0x40600000,0x40000280,0x3e800000,79,16,15,0x2c080,0x45100,31,10,0xbe800000,3,0x80008000,0xffffffff,0xffffffff,0x23000,0x116000,0x60f200,0xf4a000,0
.long 4,60,69,0x60000,0x1a018,0xeb6c00,0xec5400,0x1046400,0x1046800,0x116400,0x78280,0x164100,0x40600a00,0x40000280,0x3e800000,79,16,15,0x2e080,0x45180,351,10,0xbe800000,3,0x80008000,0xffffffff,0xffffffff,0x23800,0x117000,0x60fd00,0xf59000,0
.long 4,60,60,0x60400,0x1a000,0xec5800,0xec5c00,0x1046c00,0x1047000,0x134000,0x60680,0x140900,0x406b0000,0x40000280,0x3f000000,63,63,63,0x28480,0x45200,3,10,0xbe800000,3,1,0xffffffff,0xffffffff,0x26000,0x134000,0x623c00,0xf2c000,0
.long 4,60,63,0x60400,0x1a008,0xed4400,0xed4800,0x1082000,0x1082400,0x134c00,0x68680,0x144900,0x406b0b00,0x40000280,0x3f000000,63,63,63,0x2a480,0x45280,323,10,0xbe800000,3,1,0xffffffff,0xffffffff,0x26800,0x135000,0x624700,0xf3b000,0
.long 4,60,66,0x60400,0x1a010,0xed4c00,0xee3400,0x1082800,0x1082c00,0x135800,0x70680,0x160900,0x406b0000,0x40000280,0x3f000000,63,63,63,0x2c480,0x45300,29,10,0xbe800000,3,0x80008000,0xffffffff,0xffffffff,0x27000,0x136000,0x625200,0xf4a000,0
.long 4,60,69,0x60400,0x1a018,0xee3800,0xee3c00,0x1083000,0x10be000,0x136400,0x78680,0x164900,0x406b0b00,0x40000280,0x3f000000,63,63,63,0x2e480,0x45380,349,10,0xbe800000,3,0x80008000,0xffffffff,0xffffffff,0x27800,0x137000,0x625d00,0xf59000,0
.long 4,60,60,0x68800,0x1a000,0xef2400,0xef2800,0x10be400,0x10be800,0x154000,0x60a80,0x141100,0x40760000,0x40000280,0x3f000000,63,63,63,0x28880,0x45400,5,10,0xbe800000,3,1,0xffffffff,0xffffffff,0x2a000,0x154000,0x639c00,0xf2c000,0
.long 4,60,63,0x68800,0x1a008,0xef2c00,0xf01400,0x10bec00,0x10bf000,0x154c00,0x68a80,0x145100,0x40760b00,0x40000280,0x3f000000,63,63,63,0x2a880,0x45480,325,10,0xbe800000,3,1,0xffffffff,0xffffffff,0x2a800,0x155000,0x63a700,0xf3b000,0
.long 4,60,66,0x68800,0x1a010,0xf01800,0xf01c00,0x10fa000,0x10fa400,0x155800,0x70a80,0x161100,0x40760000,0x40000280,0x3f000000,63,63,63,0x2c880,0x45500,27,10,0xbe800000,3,0x80008000,0xffffffff,0xffffffff,0x2b000,0x156000,0x63b200,0xf4a000,0
.long 4,60,69,0x68800,0x1a018,0xf10400,0xf10800,0x10fa800,0x10fac00,0x156400,0x78a80,0x165100,0x40760b00,0x40000280,0x3f000000,63,63,63,0x2e880,0x45580,347,10,0xbe800000,3,0x80008000,0xffffffff,0xffffffff,0x2b800,0x157000,0x63bd00,0xf59000,0
.long 4,60,60,0x68c00,0x1a000,0xf10c00,0xf1f400,0x10fb000,0x1136000,0x174000,0x60e80,0x141900,0x40810000,0x40000280,0x3f000000,63,63,63,0x28c80,0x45600,7,10,0xbe800000,3,1,0xffffffff,0xffffffff,0x2e000,0x174000,0x64fc00,0xf2c000,0
.long 4,60,63,0x68c00,0x1a008,0xf1f800,0xf1fc00,0x1136400,0x1136800,0x174c00,0x68e80,0x145900,0x40810b00,0x40000280,0x3f000000,63,63,63,0x2ac80,0x45680,327,10,0xbe800000,3,1,0xffffffff,0xffffffff,0x2e800,0x175000,0x650700,0xf3b000,0
.long 4,60,66,0x68c00,0x1a010,0xf2e400,0xf2e800,0x1136c00,0x1137000,0x175800,0x70e80,0x161900,0x40810000,0x40000280,0x3f000000,63,63,63,0x2cc80,0x45700,25,10,0xbe800000,3,0x80008000,0xffffffff,0xffffffff,0x2f000,0x176000,0x651200,0xf4a000,0
.long 4,60,69,0x68c00,0x1a018,0xf2ec00,0xf3d400,0x1172000,0x1172400,0x176400,0x78e80,0x165900,0x40810b00,0x40000280,0x3f000000,63,63,63,0x2ec80,0x45780,345,10,0xbe800000,3,0x80008000,0xffffffff,0xffffffff,0x2f800,0x177000,0x651d00,0xf59000,0
.long 4,60,60,0x71000,0x1a000,0xf3d800,0xf3dc00,0x1172800,0x1172c00,0x194000,0x61280,0x142100,0x40601600,0x40000280,0x3e800000,63,63,63,0x29080,0x45800,9,10,0xbe800000,3,1,0xffffffff,0xffffffff,0x32000,0x194000,0x665c00,0xf2c000,0
.long 4,60,63,0x71000,0x1a008,0xf4c400,0xf4c800,0x1173000,0x11ae000,0x194c00,0x69280,0x146100,0x40602000,0x40000280,0x3e800000,63,63,63,0x2b080,0x45880,329,10,0xbe800000,3,1,0xffffffff,0xffffffff,0x32800,0x195000,0x666700,0xf3b000,0
.long 4,60,66,0x71000,0x1a010,0xf4cc00,0xf5b400,0x11ae400,0x11ae800,0x195800,0x71280,0x162100,0x40601600,0x40000280,0x3e800000,63,63,63,0x2d080,0x45900,23,10,0xbe800000,3,0x80008000,0xffffffff,0xffffffff,0x33000,0x196000,0x667200,0xf4a000,0
.long 4,60,69,0x71000,0x1a018,0xf5b800,0xf5bc00,0x11aec00,0x11af000,0x196400,0x79280,0x166100,0x40602000,0x40000280,0x3e800000,63,63,63,0x2f080,0x45980,343,10,0xbe800000,3,0x80008000,0xffffffff,0xffffffff,0x33800,0x197000,0x667d00,0xf59000,0
.long 4,60,60,0x71400,0x1a000,0xf6a400,0xf6a800,0x100b400,0x100b800,0x1b4000,0x61680,0x142900,0x40810000,0x40000280,0x3f000000,63,63,63,0x29480,0x45a00,11,10,0xbe800000,3,1,0xffffffff,0xffffffff,0x36000,0x1b4000,0x67bc00,0xf2c000,0
.long 4,60,63,0x71400,0x1a008,0xf6ac00,0xf79400,0x100bc00,0x100c000,0x1b4c00,0x69680,0x146900,0x40810b00,0x40000280,0x3f000000,63,63,63,0x2b480,0x45a80,331,10,0xbe800000,3,1,0xffffffff,0xffffffff,0x36800,0x1b5000,0x67c700,0xf3b000,0
.long 4,60,66,0x71400,0x1a010,0xf79800,0xf79c00,0x100c400,0x1047400,0x1b5800,0x71680,0x162900,0x40810000,0x40000280,0x3f000000,63,63,63,0x2d480,0x45b00,21,10,0xbe800000,3,0x80008000,0xffffffff,0xffffffff,0x37000,0x1b6000,0x67d200,0xf4a000,0
.long 4,60,69,0x71400,0x1a018,0xf88400,0xf88800,0x1047800,0x1047c00,0x1b6400,0x79680,0x166900,0x40810b00,0x40000280,0x3f000000,63,63,63,0x2f480,0x45b80,341,10,0xbe800000,3,0x80008000,0xffffffff,0xffffffff,0x37800,0x1b7000,0x67dd00,0xf59000,0
.long 4,60,60,0x79800,0x1a000,0xf88c00,0xf97400,0x1048000,0x1048400,0x1d4000,0x61a80,0x143100,0x40760000,0x40000280,0x3f000000,63,63,63,0x29880,0x45c00,13,10,0xbe800000,3,1,0xffffffff,0xffffffff,0x3a000,0x1d4000,0x691c00,0xf2c000,0
.long 4,60,63,0x79800,0x1a008,0xf97800,0xf97c00,0x1083400,0x1083800,0x1d4c00,0x69a80,0x147100,0x40760b00,0x40000280,0x3f000000,63,63,63,0x2b880,0x45c80,333,10,0xbe800000,3,1,0xffffffff,0xffffffff,0x3a800,0x1d5000,0x692700,0xf3b000,0
.long 4,60,66,0x79800,0x1a010,0xfa6400,0xfa6800,0x1083c00,0x1084000,0x1d5800,0x71a80,0x163100,0x40760000,0x40000280,0x3f000000,63,63,63,0x2d880,0x45d00,19,10,0xbe800000,3,0x80008000,0xffffffff,0xffffffff,0x3b000,0x1d6000,0x693200,0xf4a000,0
.long 4,60,69,0x79800,0x1a018,0xfa6c00,0xfb5400,0x1084400,0x10bf400,0x1d6400,0x79a80,0x167100,0x40760b00,0x40000280,0x3f000000,63,63,63,0x2f880,0x45d80,339,10,0xbe800000,3,0x80008000,0xffffffff,0xffffffff,0x3b800,0x1d7000,0x693d00,0xf59000,0
.long 4,60,60,0x79c00,0x1a000,0xfb5800,0xfb5c00,0x10bf800,0x10bfc00,0x1f4000,0x61e80,0x143900,0x406b0000,0x40000280,0x3f000000,63,63,63,0x29c80,0x45e00,15,10,0xbe800000,3,1,0xffffffff,0xffffffff,0x3e000,0x1f4000,0x6a7c00,0xf2c000,0
.long 4,60,63,0x79c00,0x1a008,0xfc4400,0xfc4800,0x10c0000,0x10c0400,0x1f4c00,0x69e80,0x147900,0x406b0b00,0x40000280,0x3f000000,63,63,63,0x2bc80,0x45e80,335,10,0xbe800000,3,1,0xffffffff,0xffffffff,0x3e800,0x1f5000,0x6a8700,0xf3b000,0
.long 4,60,66,0x79c00,0x1a010,0xfc4c00,0xfd3400,0x10fb400,0x10fb800,0x1f5800,0x71e80,0x163900,0x406b0000,0x40000280,0x3f000000,63,63,63,0x2dc80,0x45f00,17,10,0xbe800000,3,0x80008000,0xffffffff,0xffffffff,0x3f000,0x1f6000,0x6a9200,0xf4a000,0
.long 4,60,69,0x79c00,0x1a018,0xfd3800,0xfd3c00,0x10fbc00,0x10fc000,0x1f6400,0x79e80,0x167900,0x406b0b00,0x40000280,0x3f000000,63,63,63,0x2fc80,0x45f80,337,10,0xbe800000,3,0x80008000,0xffffffff,0xffffffff,0x3f800,0x1f7000,0x6a9d00,0xf59000,0
.long 6,58,72,0x60000,0x1a000,0xe03000,0xe03400,0x10fc400,0x1137400,0x118000,0x60300,0x180100,0x40600000,0x40000280,0x3e800000,79,16,15,0x30080,0x46000,0,10,0xbe800000,3,0,0xffffffff,0,0x20000,0x118000,0x610800,0xf68000,0
.long 6,58,75,0x60000,0x1a008,0xe03800,0xe12000,0x1137800,0x1137c00,0x118c00,0x68300,0x184100,0x40600a00,0x40000280,0x3e800000,79,16,15,0x32080,0x46080,320,10,0xbe800000,3,0,0xffffffff,0,0x20800,0x119000,0x611300,0xf77000,0
.long 6,58,78,0x60000,0x1a010,0xe12400,0xe12800,0x1138000,0x1138400,0x119800,0x70300,0x1a0100,0x40600000,0x40000280,0x3e800000,79,16,15,0x34080,0x46100,16,10,0xbe800000,3,0,0,0xffffffff,0x21000,0x11a000,0x611e00,0xf86000,0
.long 6,58,81,0x60000,0x1a018,0xe21000,0xe21400,0x1173400,0x1173800,0x11a400,0x78300,0x1a4100,0x40600a00,0x40000280,0x3e800000,79,16,15,0x36080,0x46180,336,10,0xbe800000,3,0,0,0xffffffff,0x21800,0x11b000,0x612900,0xf95000,0
.long 6,58,72,0x60400,0x1a000,0xe21800,0xe30000,0x1173c00,0x1174000,0x138000,0x60700,0x180900,0x406b0000,0x40000280,0x3f000000,63,63,63,0x30480,0x46200,2,10,0xbe800000,3,1,0xffffffff,0xffffffff,0x24000,0x138000,0x626800,0xf68000,0
.long 6,58,75,0x60400,0x1a008,0xe30400,0xe30800,0x1174400,0x11af400,0x138c00,0x68700,0x184900,0x406b0b00,0x40000280,0x3f000000,63,63,63,0x32480,0x46280,322,10,0xbe800000,3,1,0xffffffff,0xffffffff,0x24800,0x139000,0x627300,0xf77000,0
.long 6,58,78,0x60400,0x1a010,0xe3f000,0xe3f400,0x11af800,0x11afc00,0x139800,0x70700,0x1a0900,0x406b0000,0x40000280,0x3f000000,63,63,63,0x34480,0x46300,30,10,0xbe800000,3,0x80008000,0xffffffff,0xffffffff,0x25000,0x13a000,0x627e00,0xf86000,0
.long 6,58,81,0x60400,0x1a018,0xe3f800,0xe4e000,0x11b0000,0x11b0400,0x13a400,0x78700,0x1a4900,0x406b0b00,0x40000280,0x3f000000,63,63,63,0x36480,0x46380,350,10,0xbe800000,3,0x80008000,0xffffffff,0xffffffff,0x25800,0x13b000,0x628900,0xf95000,0
.long 6,58,72,0x68800,0x1a000,0xe4e400,0xe4e800,0x100c800,0x100cc00,0x158000,0x60b00,0x181100,0x40760000,0x40000280,0x3f000000,63,63,63,0x30880,0x46400,4,10,0xbe800000,3,1,0xffffffff,0xffffffff,0x28000,0x158000,0x63c800,0xf68000,0
.long 6,58,75,0x68800,0x1a008,0xe5d000,0xe5d400,0x100d000,0x100d400,0x158c00,0x68b00,0x185100,0x40760b00,0x40000280,0x3f000000,63,63,63,0x32880,0x46480,324,10,0xbe800000,3,1,0xffffffff,0xffffffff,0x28800,0x159000,0x63d300,0xf77000,0
.long 6,58,78,0x68800,0x1a010,0xe5d800,0xe6c000,0x100d800,0x1048800,0x159800,0x70b00,0x1a1100,0x40760000,0x40000280,0x3f000000,63,63,63,0x34880,0x46500,28,10,0xbe800000,3,0x80008000,0xffffffff,0xffffffff,0x29000,0x15a000,0x63de00,0xf86000,0
.long 6,58,81,0x68800,0x1a018,0xe6c400,0xe6c800,0x1048c00,0x1049000,0x15a400,0x78b00,0x1a5100,0x40760b00,0x40000280,0x3f000000,63,63,63,0x36880,0x46580,348,10,0xbe800000,3,0x80008000,0xffffffff,0xffffffff,0x29800,0x15b000,0x63e900,0xf95000,0
.long 6,58,72,0x68c00,0x1a000,0xe7b000,0xe7b400,0x1049400,0x1049800,0x178000,0x60f00,0x181900,0x40810000,0x40000280,0x3f000000,63,63,63,0x30c80,0x46600,6,10,0xbe800000,3,1,0xffffffff,0xffffffff,0x2c000,0x178000,0x652800,0xf68000,0
.long 6,58,75,0x68c00,0x1a008,0xe7b800,0xe8a000,0x1084800,0x1084c00,0x178c00,0x68f00,0x185900,0x40810b00,0x40000280,0x3f000000,63,63,63,0x32c80,0x46680,326,10,0xbe800000,3,1,0xffffffff,0xffffffff,0x2c800,0x179000,0x653300,0xf77000,0
.long 6,58,78,0x68c00,0x1a010,0xe8a400,0xe8a800,0x1085000,0x1085400,0x179800,0x70f00,0x1a1900,0x40810000,0x40000280,0x3f000000,63,63,63,0x34c80,0x46700,26,10,0xbe800000,3,0x80008000,0xffffffff,0xffffffff,0x2d000,0x17a000,0x653e00,0xf86000,0
.long 6,58,81,0x68c00,0x1a018,0xe99000,0xe99400,0x1085800,0x10c0800,0x17a400,0x78f00,0x1a5900,0x40810b00,0x40000280,0x3f000000,63,63,63,0x36c80,0x46780,346,10,0xbe800000,3,0x80008000,0xffffffff,0xffffffff,0x2d800,0x17b000,0x654900,0xf95000,0
.long 6,58,72,0x71000,0x1a000,0xe99800,0xea8000,0x10c0c00,0x10c1000,0x198000,0x61300,0x182100,0x40601600,0x40000280,0x3e800000,63,63,63,0x31080,0x46800,8,10,0xbe800000,3,1,0xffffffff,0xffffffff,0x30000,0x198000,0x668800,0xf68000,0
.long 6,58,75,0x71000,0x1a008,0xea8400,0xea8800,0x10c1400,0x10c1800,0x198c00,0x69300,0x186100,0x40602000,0x40000280,0x3e800000,63,63,63,0x33080,0x46880,328,10,0xbe800000,3,1,0xffffffff,0xffffffff,0x30800,0x199000,0x669300,0xf77000,0
.long 6,58,78,0x71000,0x1a010,0xeb7000,0xeb7400,0x10fc800,0x10fcc00,0x199800,0x71300,0x1a2100,0x40601600,0x40000280,0x3e800000,63,63,63,0x35080,0x46900,24,10,0xbe800000,3,0x80008000,0xffffffff,0xffffffff,0x31000,0x19a000,0x669e00,0xf86000,0
.long 6,58,81,0x71000,0x1a018,0xeb7800,0xec6000,0x10fd000,0x10fd400,0x19a400,0x79300,0x1a6100,0x40602000,0x40000280,0x3e800000,63,63,63,0x37080,0x46980,344,10,0xbe800000,3,0x80008000,0xffffffff,0xffffffff,0x31800,0x19b000,0x66a900,0xf95000,0
.long 6,58,72,0x71400,0x1a000,0xec6400,0xec6800,0x10fd800,0x1138800,0x1b8000,0x61700,0x182900,0x40810000,0x40000280,0x3f000000,63,63,63,0x31480,0x46a00,10,10,0xbe800000,3,1,0xffffffff,0xffffffff,0x34000,0x1b8000,0x67e800,0xf68000,0
.long 6,58,75,0x71400,0x1a008,0xed5000,0xed5400,0x1138c00,0x1139000,0x1b8c00,0x69700,0x186900,0x40810b00,0x40000280,0x3f000000,63,63,63,0x33480,0x46a80,330,10,0xbe800000,3,1,0xffffffff,0xffffffff,0x34800,0x1b9000,0x67f300,0xf77000,0
.long 6,58,78,0x71400,0x1a010,0xed5800,0xee4000,0x1139400,0x1139800,0x1b9800,0x71700,0x1a2900,0x40810000,0x40000280,0x3f000000,63,63,63,0x35480,0x46b00,22,10,0xbe800000,3,0x80008000,0xffffffff,0xffffffff,0x35000,0x1ba000,0x67fe00,0xf86000,0
.long 6,58,81,0x71400,0x1a018,0xee4400,0xee4800,0x1174800,0x1174c00,0x1ba400,0x79700,0x1a6900,0x40810b00,0x40000280,0x3f000000,63,63,63,0x37480,0x46b80,342,10,0xbe800000,3,0x80008000,0xffffffff,0xffffffff,0x35800,0x1bb000,0x680900,0xf95000,0
.long 6,58,72,0x79800,0x1a000,0xef3000,0xef3400,0x1175000,0x1175400,0x1d8000,0x61b00,0x183100,0x40760000,0x40000280,0x3f000000,63,63,63,0x31880,0x46c00,12,10,0xbe800000,3,1,0xffffffff,0xffffffff,0x38000,0x1d8000,0x694800,0xf68000,0
.long 6,58,75,0x79800,0x1a008,0xef3800,0xf02000,0x1175800,0x11b0800,0x1d8c00,0x69b00,0x187100,0x40760b00,0x40000280,0x3f000000,63,63,63,0x33880,0x46c80,332,10,0xbe800000,3,1,0xffffffff,0xffffffff,0x38800,0x1d9000,0x695300,0xf77000,0
.long 6,58,78,0x79800,0x1a010,0xf02400,0xf02800,0x11b0c00,0x11b1000,0x1d9800,0x71b00,0x1a3100,0x40760000,0x40000280,0x3f000000,63,63,63,0x35880,0x46d00,20,10,0xbe800000,3,0x80008000,0xffffffff,0xffffffff,0x39000,0x1da000,0x695e00,0xf86000,0
.long 6,58,81,0x79800,0x1a018,0xf11000,0xf11400,0x11b1400,0x11b1800,0x1da400,0x79b00,0x1a7100,0x40760b00,0x40000280,0x3f000000,63,63,63,0x37880,0x46d80,340,10,0xbe800000,3,0x80008000,0xffffffff,0xffffffff,0x39800,0x1db000,0x696900,0xf95000,0
.long 6,58,72,0x79c00,0x1a000,0xf11800,0xf20000,0x100dc00,0x100e000,0x1f8000,0x61f00,0x183900,0x406b0000,0x40000280,0x3f000000,63,63,63,0x31c80,0x46e00,14,10,0xbe800000,3,1,0xffffffff,0xffffffff,0x3c000,0x1f8000,0x6aa800,0xf68000,0
.long 6,58,75,0x79c00,0x1a008,0xf20400,0xf20800,0x100e400,0x100e800,0x1f8c00,0x69f00,0x187900,0x406b0b00,0x40000280,0x3f000000,63,63,63,0x33c80,0x46e80,334,10,0xbe800000,3,1,0xffffffff,0xffffffff,0x3c800,0x1f9000,0x6ab300,0xf77000,0
.long 6,58,78,0x79c00,0x1a010,0xf2f000,0xf2f400,0x100ec00,0x1049c00,0x1f9800,0x71f00,0x1a3900,0x406b0000,0x40000280,0x3f000000,63,63,63,0x35c80,0x46f00,18,10,0xbe800000,3,0x80008000,0xffffffff,0xffffffff,0x3d000,0x1fa000,0x6abe00,0xf86000,0
.long 6,58,81,0x79c00,0x1a018,0xf2f800,0xf3e000,0x104a000,0x104a400,0x1fa400,0x79f00,0x1a7900,0x406b0b00,0x40000280,0x3f000000,63,63,63,0x37c80,0x46f80,338,10,0xbe800000,3,0x80008000,0xffffffff,0xffffffff,0x3d800,0x1fb000,0x6ac900,0xf95000,0
.long 6,58,84,0x60000,0x1a000,0xf3e400,0xf3e800,0x104a800,0x104ac00,0x11c000,0x60380,0x1c0100,0x40600000,0x40000280,0x3e800000,79,16,15,0x38080,0x47000,1,10,0xbe800000,3,1,0xffffffff,0xffffffff,0x22000,0x11c000,0x613400,0xfa4000,0
.long 6,58,87,0x60000,0x1a008,0xf4d000,0xf4d400,0x1085c00,0x1086000,0x11cc00,0x68380,0x1c4100,0x40600a00,0x40000280,0x3e800000,79,16,15,0x3a080,0x47080,321,10,0xbe800000,3,1,0xffffffff,0xffffffff,0x22800,0x11d000,0x613f00,0xfb3000,0
.long 6,58,90,0x60000,0x1a010,0xf4d800,0xf5c000,0x1086400,0x1086800,0x11d800,0x70380,0x1e0100,0x40600000,0x40000280,0x3e800000,79,16,15,0x3c080,0x47100,31,10,0xbe800000,3,0x80008000,0xffffffff,0xffffffff,0x23000,0x11e000,0x614a00,0xfc2000,0
.long 6,58,93,0x60000,0x1a018,0xf5c400,0xf5c800,0x1086c00,0x10c1c00,0x11e400,0x78380,0x1e4100,0x40600a00,0x40000280,0x3e800000,79,16,15,0x3e080,0x47180,351,10,0xbe800000,3,0x80008000,0xffffffff,0xffffffff,0x23800,0x11f000,0x615500,0xfd1000,0
.long 6,58,84,0x60400,0x1a000,0xf6b000,0xf6b400,0x10c2000,0x10c2400,0x13c000,0x60780,0x1c0900,0x406b0000,0x40000280,0x3f000000,63,63,63,0x38480,0x47200,3,10,0xbe800000,3,1,0xffffffff,0xffffffff,0x26000,0x13c000,0x629400,0xfa4000,0
.long 6,58,87,0x60400,0x1a008,0xf6b800,0xf7a000,0x10c2800,0x10c2c00,0x13cc00,0x68780,0x1c4900,0x406b0b00,0x40000280,0x3f000000,63,63,63,0x3a480,0x47280,323,10,0xbe800000,3,1,0xffffffff,0xffffffff,0x26800,0x13d000,0x629f00,0xfb3000,0
.long 6,58,90,0x60400,0x1a010,0xf7a400,0xf7a800,0x10fdc00,0x10fe000,0x13d800,0x70780,0x1e0900,0x406b0000,0x40000280,0x3f000000,63,63,63,0x3c480,0x47300,29,10,0xbe800000,3,0x80008000,0xffffffff,0xffffffff,0x27000,0x13e000,0x62aa00,0xfc2000,0
.long 6,58,93,0x60400,0x1a018,0xf89000,0xf89400,0x10fe400,0x10fe800,0x13e400,0x78780,0x1e4900,0x406b0b00,0x40000280,0x3f000000,63,63,63,0x3e480,0x47380,349,10,0xbe800000,3,0x80008000,0xffffffff,0xffffffff,0x27800,0x13f000,0x62b500,0xfd1000,0
.long 6,58,84,0x68800,0x1a000,0xf89800,0xf98000,0x10fec00,0x1139c00,0x15c000,0x60b80,0x1c1100,0x40760000,0x40000280,0x3f000000,63,63,63,0x38880,0x47400,5,10,0xbe800000,3,1,0xffffffff,0xffffffff,0x2a000,0x15c000,0x63f400,0xfa4000,0
.long 6,58,87,0x68800,0x1a008,0xf98400,0xf98800,0x113a000,0x113a400,0x15cc00,0x68b80,0x1c5100,0x40760b00,0x40000280,0x3f000000,63,63,63,0x3a880,0x47480,325,10,0xbe800000,3,1,0xffffffff,0xffffffff,0x2a800,0x15d000,0x63ff00,0xfb3000,0
.long 6,58,90,0x68800,0x1a010,0xfa7000,0xfa7400,0x113a800,0x113ac00,0x15d800,0x70b80,0x1e1100,0x40760000,0x40000280,0x3f000000,63,63,63,0x3c880,0x47500,27,10,0xbe800000,3,0x80008000,0xffffffff,0xffffffff,0x2b000,0x15e000,0x640a00,0xfc2000,0
.long 6,58,93,0x68800,0x1a018,0xfa7800,0xfb6000,0x1175c00,0x1176000,0x15e400,0x78b80,0x1e5100,0x40760b00,0x40000280,0x3f000000,63,63,63,0x3e880,0x47580,347,10,0xbe800000,3,0x80008000,0xffffffff,0xffffffff,0x2b800,0x15f000,0x641500,0xfd1000,0
.long 6,58,84,0x68c00,0x1a000,0xfb6400,0xfb6800,0x1176400,0x1176800,0x17c000,0x60f80,0x1c1900,0x40810000,0x40000280,0x3f000000,63,63,63,0x38c80,0x47600,7,10,0xbe800000,3,1,0xffffffff,0xffffffff,0x2e000,0x17c000,0x655400,0xfa4000,0
.long 6,58,87,0x68c00,0x1a008,0xfc5000,0xfc5400,0x1176c00,0x11b1c00,0x17cc00,0x68f80,0x1c5900,0x40810b00,0x40000280,0x3f000000,63,63,63,0x3ac80,0x47680,327,10,0xbe800000,3,1,0xffffffff,0xffffffff,0x2e800,0x17d000,0x655f00,0xfb3000,0
.long 6,58,90,0x68c00,0x1a010,0xfc5800,0xfd4000,0x11b2000,0x11b2400,0x17d800,0x70f80,0x1e1900,0x40810000,0x40000280,0x3f000000,63,63,63,0x3cc80,0x47700,25,10,0xbe800000,3,0x80008000,0xffffffff,0xffffffff,0x2f000,0x17e000,0x656a00,0xfc2000,0
.long 6,58,93,0x68c00,0x1a018,0xfd4400,0xfd4800,0x11b2800,0x11b2c00,0x17e400,0x78f80,0x1e5900,0x40810b00,0x40000280,0x3f000000,63,63,63,0x3ec80,0x47780,345,10,0xbe800000,3,0x80008000,0xffffffff,0xffffffff,0x2f800,0x17f000,0x657500,0xfd1000,0
.long 6,58,84,0x71000,0x1a000,0xe03c00,0xe04000,0x100f000,0x100f400,0x19c000,0x61380,0x1c2100,0x40601600,0x40000280,0x3e800000,63,63,63,0x39080,0x47800,9,10,0xbe800000,3,1,0xffffffff,0xffffffff,0x32000,0x19c000,0x66b400,0xfa4000,0
.long 6,58,87,0x71000,0x1a008,0xe04400,0xe12c00,0x100f800,0x100fc00,0x19cc00,0x69380,0x1c6100,0x40602000,0x40000280,0x3e800000,63,63,63,0x3b080,0x47880,329,10,0xbe800000,3,1,0xffffffff,0xffffffff,0x32800,0x19d000,0x66bf00,0xfb3000,0
.long 6,58,90,0x71000,0x1a010,0xe13000,0xe13400,0x1010000,0x104b000,0x19d800,0x71380,0x1e2100,0x40601600,0x40000280,0x3e800000,63,63,63,0x3d080,0x47900,23,10,0xbe800000,3,0x80008000,0xffffffff,0xffffffff,0x33000,0x19e000,0x66ca00,0xfc2000,0
.long 6,58,93,0x71000,0x1a018,0xe21c00,0xe22000,0x104b400,0x104b800,0x19e400,0x79380,0x1e6100,0x40602000,0x40000280,0x3e800000,63,63,63,0x3f080,0x47980,343,10,0xbe800000,3,0x80008000,0xffffffff,0xffffffff,0x33800,0x19f000,0x66d500,0xfd1000,0
.long 6,58,84,0x71400,0x1a000,0xe22400,0xe30c00,0x104bc00,0x104c000,0x1bc000,0x61780,0x1c2900,0x40810000,0x40000280,0x3f000000,63,63,63,0x39480,0x47a00,11,10,0xbe800000,3,1,0xffffffff,0xffffffff,0x36000,0x1bc000,0x681400,0xfa4000,0
.long 6,58,87,0x71400,0x1a008,0xe31000,0xe31400,0x1087000,0x1087400,0x1bcc00,0x69780,0x1c6900,0x40810b00,0x40000280,0x3f000000,63,63,63,0x3b480,0x47a80,331,10,0xbe800000,3,1,0xffffffff,0xffffffff,0x36800,0x1bd000,0x681f00,0xfb3000,0
.long 6,58,90,0x71400,0x1a010,0xe3fc00,0xe40000,0x1087800,0x1087c00,0x1bd800,0x71780,0x1e2900,0x40810000,0x40000280,0x3f000000,63,63,63,0x3d480,0x47b00,21,10,0xbe800000,3,0x80008000,0xffffffff,0xffffffff,0x37000,0x1be000,0x682a00,0xfc2000,0
.long 6,58,93,0x71400,0x1a018,0xe40400,0xe4ec00,0x1088000,0x10c3000,0x1be400,0x79780,0x1e6900,0x40810b00,0x40000280,0x3f000000,63,63,63,0x3f480,0x47b80,341,10,0xbe800000,3,0x80008000,0xffffffff,0xffffffff,0x37800,0x1bf000,0x683500,0xfd1000,0
.long 6,58,84,0x79800,0x1a000,0xe4f000,0xe4f400,0x10c3400,0x10c3800,0x1dc000,0x61b80,0x1c3100,0x40760000,0x40000280,0x3f000000,63,63,63,0x39880,0x47c00,13,10,0xbe800000,3,1,0xffffffff,0xffffffff,0x3a000,0x1dc000,0x697400,0xfa4000,0
.long 6,58,87,0x79800,0x1a008,0xe5dc00,0xe5e000,0x10c3c00,0x10c4000,0x1dcc00,0x69b80,0x1c7100,0x40760b00,0x40000280,0x3f000000,63,63,63,0x3b880,0x47c80,333,10,0xbe800000,3,1,0xffffffff,0xffffffff,0x3a800,0x1dd000,0x697f00,0xfb3000,0
.long 6,58,90,0x79800,0x1a010,0xe5e400,0xe6cc00,0x10ff000,0x10ff400,0x1dd800,0x71b80,0x1e3100,0x40760000,0x40000280,0x3f000000,63,63,63,0x3d880,0x47d00,19,10,0xbe800000,3,0x80008000,0xffffffff,0xffffffff,0x3b000,0x1de000,0x698a00,0xfc2000,0
.long 6,58,93,0x79800,0x1a018,0xe6d000,0xe6d400,0x10ff800,0x10ffc00,0x1de400,0x79b80,0x1e7100,0x40760b00,0x40000280,0x3f000000,63,63,63,0x3f880,0x47d80,339,10,0xbe800000,3,0x80008000,0xffffffff,0xffffffff,0x3b800,0x1df000,0x699500,0xfd1000,0
.long 6,58,84,0x79c00,0x1a000,0xe7bc00,0xe7c000,0x1100000,0x113b000,0x1fc000,0x61f80,0x1c3900,0x406b0000,0x40000280,0x3f000000,63,63,63,0x39c80,0x47e00,15,10,0xbe800000,3,1,0xffffffff,0xffffffff,0x3e000,0x1fc000,0x6ad400,0xfa4000,0
.long 6,58,87,0x79c00,0x1a008,0xe7c400,0xe8ac00,0x113b400,0x113b800,0x1fcc00,0x69f80,0x1c7900,0x406b0b00,0x40000280,0x3f000000,63,63,63,0x3bc80,0x47e80,335,10,0xbe800000,3,1,0xffffffff,0xffffffff,0x3e800,0x1fd000,0x6adf00,0xfb3000,0
.long 6,58,90,0x79c00,0x1a010,0xe8b000,0xe8b400,0x113bc00,0x113c000,0x1fd800,0x71f80,0x1e3900,0x406b0000,0x40000280,0x3f000000,63,63,63,0x3dc80,0x47f00,17,10,0xbe800000,3,0x80008000,0xffffffff,0xffffffff,0x3f000,0x1fe000,0x6aea00,0xfc2000,0
.long 6,58,93,0x79c00,0x1a018,0xe99c00,0xe9a000,0x1177000,0x1177400,0x1fe400,0x79f80,0x1e7900,0x406b0b00,0x40000280,0x3f000000,63,63,63,0x3fc80,0x47f80,337,10,0xbe800000,3,0x80008000,0xffffffff,0xffffffff,0x3f800,0x1ff000,0x6af500,0xfd1000,0
.long 8,56,0,0x62000,0x1a002,0xe9a400,0xea8c00,0x1177800,0x1177c00,0x200000,0x62000,0x100200,0x40605800,0x40000280,0x3f000000,63,63,63,0x20100,0x48000,0,10,0xbe800000,3,0,0xffffffff,0,0x20000,0x200000,0x6b0000,0xe00000,0
.long 8,56,3,0x62000,0x1a00a,0xea9000,0xea9400,0x1178000,0x11b3000,0x200c00,0x6a000,0x104200,0x40606300,0x40000280,0x3f000000,63,63,63,0x22100,0x48080,320,10,0xbe800000,3,0,0xffffffff,0,0x20800,0x201000,0x6b0b00,0xe0f000,0
.long 8,56,6,0x62000,0x1a012,0xeb7c00,0xeb8000,0x11b3400,0x11b3800,0x201800,0x72000,0x120200,0x605800,0x40000280,0x3f000000,63,63,63,0x24100,0x48100,16,10,0xbe800000,3,0,0,0xffffffff,0x21000,0x202000,0x6b1600,0xe1e000,0
.long 8,56,9,0x62000,0x1a01a,0xeb8400,0xec6c00,0x11b3c00,0x11b4000,0x202400,0x7a000,0x124200,0x606300,640,0x3f000000,63,63,63,0x26100,0x48180,336,10,0xbe800000,3,0,0,0xffffffff,0x21800,0x203000,0x6b2100,0xe2d000,0
.long 8,56,0,0x62400,0x1a002,0xec7000,0xec7400,0x1010400,0x1010800,0x220000,0x62400,0x100a00,0x406b5800,0x40000280,0x3f000000,63,63,63,0x20500,0x48200,2,10,0xbe800000,3,1,0xffffffff,0xffffffff,0x24000,0x220000,0x6c6000,0xe00000,0
.long 8,56,3,0x62400,0x1a00a,0xed5c00,0xed6000,0x1010c00,0x1011000,0x220c00,0x6a400,0x104a00,0x406b6300,0x40000280,0x3f000000,63,63,63,0x22500,0x48280,322,10,0xbe800000,3,1,0xffffffff,0xffffffff,0x24800,0x221000,0x6c6b00,0xe0f000,0
.long 8,56,6,0x62400,0x1a012,0xed6400,0xee4c00,0x1011400,0x104c400,0x221800,0x72400,0x120a00,0x6b5800,0x40000280,0x3f000000,63,63,63,0x24500,0x48300,30,10,0xbe800000,3,0x80008000,0xffffffff,0xffffffff,0x25000,0x222000,0x6c7600,0xe1e000,0
.long 8,56,9,0x62400,0x1a01a,0xee5000,0xee5400,0x104c800,0x104cc00,0x222400,0x7a400,0x124a00,0x6b6300,640,0x3f000000,63,63,63,0x26500,0x48380,350,10,0xbe800000,3,0x80008000,0xffffffff,0xffffffff,0x25800,0x223000,0x6c8100,0xe2d000,0
.long 8,56,0,0x6a800,0x1a002,0xef3c00,0xef4000,0x104d000,0x104d400,0x240000,0x62800,0x101200,0x40765800,0x40000280,0x3f000000,63,63,63,0x20900,0x48400,4,10,0xbe800000,3,1,0xffffffff,0xffffffff,0x28000,0x240000,0x6dc000,0xe00000,0
.long 8,56,3,0x6a800,0x1a00a,0xef4400,0xf02c00,0x1088400,0x1088800,0x240c00,0x6a800,0x105200,0x40766300,0x40000280,0x3f000000,63,63,63,0x22900,0x48480,324,10,0xbe800000,3,1,0xffffffff,0xffffffff,0x28800,0x241000,0x6dcb00,0xe0f000,0
.long 8,56,6,0x6a800,0x1a012,0xf03000,0xf03400,0x1088c00,0x1089000,0x241800,0x72800,0x121200,0x765800,0x40000280,0x3f000000,63,63,63,0x24900,0x48500,28,10,0xbe800000,3,0x80008000,0xffffffff,0xffffffff,0x29000,0x242000,0x6dd600,0xe1e000,0
.long 8,56,9,0x6a800,0x1a01a,0xf11c00,0xf12000,0x1089400,0x10c4400,0x242400,0x7a800,0x125200,0x766300,640,0x3f000000,63,63,63,0x26900,0x48580,348,10,0xbe800000,3,0x80008000,0xffffffff,0xffffffff,0x29800,0x243000,0x6de100,0xe2d000,0
.long 8,56,0,0x6ac00,0x1a002,0xf12400,0xf20c00,0x10c4800,0x10c4c00,0x260000,0x62c00,0x101a00,0x40815800,0x40000280,0x3f000000,63,63,63,0x20d00,0x48600,6,10,0xbe800000,3,1,0xffffffff,0xffffffff,0x2c000,0x260000,0x6f2000,0xe00000,0
.long 8,56,3,0x6ac00,0x1a00a,0xf21000,0xf21400,0x10c5000,0x10c5400,0x260c00,0x6ac00,0x105a00,0x40816300,0x40000280,0x3f000000,63,63,63,0x22d00,0x48680,326,10,0xbe800000,3,1,0xffffffff,0xffffffff,0x2c800,0x261000,0x6f2b00,0xe0f000,0
.long 8,56,6,0x6ac00,0x1a012,0xf2fc00,0xf30000,0x1100400,0x1100800,0x261800,0x72c00,0x121a00,0x815800,0x40000280,0x3f000000,63,63,63,0x24d00,0x48700,26,10,0xbe800000,3,0x80008000,0xffffffff,0xffffffff,0x2d000,0x262000,0x6f3600,0xe1e000,0
.long 8,56,9,0x6ac00,0x1a01a,0xf30400,0xf3ec00,0x1100c00,0x1101000,0x262400,0x7ac00,0x125a00,0x816300,640,0x3f000000,63,63,63,0x26d00,0x48780,346,10,0xbe800000,3,0x80008000,0xffffffff,0xffffffff,0x2d800,0x263000,0x6f4100,0xe2d000,0
.long 8,56,0,0x73000,0x1a002,0xf3f000,0xf3f400,0x1101400,0x113c400,0x280000,0x63000,0x102200,0x40820800,0x40000280,0x3f000000,63,63,63,0x21100,0x48800,8,10,0xbe800000,3,1,0xffffffff,0xffffffff,0x30000,0x280000,0x708000,0xe00000,0
.long 8,56,3,0x73000,0x1a00a,0xf4dc00,0xf4e000,0x113c800,0x113cc00,0x280c00,0x6b000,0x106200,0x40821300,0x40000280,0x3f000000,63,63,63,0x23100,0x48880,328,10,0xbe800000,3,1,0xffffffff,0xffffffff,0x30800,0x281000,0x708b00,0xe0f000,0
.long 8,56,6,0x73000,0x1a012,0xf4e400,0xf5cc00,0x113d000,0x113d400,0x281800,0x73000,0x122200,0x40820800,0x40000280,0x3f000000,63,63,63,0x25100,0x48900,24,10,0xbe800000,3,0x80008000,0xffffffff,0xffffffff,0x31000,0x282000,0x709600,0xe1e000,0
.long 8,56,9,0x73000,0x1a01a,0xf5d000,0xf5d400,0x1178400,0x1178800,0x282400,0x7b000,0x126200,0x40821300,0x40000280,0x3f000000,63,63,63,0x27100,0x48980,344,10,0xbe800000,3,0x80008000,0xffffffff,0xffffffff,0x31800,0x283000,0x70a100,0xe2d000,0
.long 8,56,0,0x73400,0x1a002,0xf6bc00,0xf6c000,0x1178c00,0x1179000,0x2a0000,0x63400,0x102a00,0x40770800,0x40000280,0x3f000000,63,63,63,0x21500,0x48a00,10,10,0xbe800000,3,1,0xffffffff,0xffffffff,0x34000,0x2a0000,0x71e000,0xe00000,0
.long 8,56,3,0x73400,0x1a00a,0xf6c400,0xf7ac00,0x1179400,0x11b4400,0x2a0c00,0x6b400,0x106a00,0x40771300,0x40000280,0x3f000000,63,63,63,0x23500,0x48a80,330,10,0xbe800000,3,1,0xffffffff,0xffffffff,0x34800,0x2a1000,0x71eb00,0xe0f000,0
.long 8,56,6,0x73400,0x1a012,0xf7b000,0xf7b400,0x11b4800,0x11b4c00,0x2a1800,0x73400,0x122a00,0x40770800,0x40000280,0x3f000000,63,63,63,0x25500,0x48b00,22,10,0xbe800000,3,0x80008000,0xffffffff,0xffffffff,0x35000,0x2a2000,0x71f600,0xe1e000,0
.long 8,56,9,0x73400,0x1a01a,0xf89c00,0xf8a000,0x11b5000,0x11b5400,0x2a2400,0x7b400,0x126a00,0x40771300,0x40000280,0x3f000000,63,63,63,0x27500,0x48b80,342,10,0xbe800000,3,0x80008000,0xffffffff,0xffffffff,0x35800,0x2a3000,0x720100,0xe2d000,0
.long 8,56,0,0x7b800,0x1a002,0xf8a400,0xf98c00,0x1011800,0x1011c00,0x2c0000,0x63800,0x103200,0x406c0800,0x40000280,0x3f000000,63,63,63,0x21900,0x48c00,12,10,0xbe800000,3,1,0xffffffff,0xffffffff,0x38000,0x2c0000,0x734000,0xe00000,0
.long 8,56,3,0x7b800,0x1a00a,0xf99000,0xf99400,0x1012000,0x1012400,0x2c0c00,0x6b800,0x107200,0x406c1300,0x40000280,0x3f000000,63,63,63,0x23900,0x48c80,332,10,0xbe800000,3,1,0xffffffff,0xffffffff,0x38800,0x2c1000,0x734b00,0xe0f000,0
.long 8,56,6,0x7b800,0x1a012,0xfa7c00,0xfa8000,0x1012800,0x104d800,0x2c1800,0x73800,0x123200,0x406c0800,0x40000280,0x3f000000,63,63,63,0x25900,0x48d00,20,10,0xbe800000,3,0x80008000,0xffffffff,0xffffffff,0x39000,0x2c2000,0x735600,0xe1e000,0
.long 8,56,9,0x7b800,0x1a01a,0xfa8400,0xfb6c00,0x104dc00,0x104e000,0x2c2400,0x7b800,0x127200,0x406c1300,0x40000280,0x3f000000,63,63,63,0x27900,0x48d80,340,10,0xbe800000,3,0x80008000,0xffffffff,0xffffffff,0x39800,0x2c3000,0x736100,0xe2d000,0
.long 8,56,0,0x7bc00,0x1a002,0xfb7000,0xfb7400,0x104e400,0x104e800,0x2e0000,0x63c00,0x103a00,0x40610800,0x40000280,0x3f000000,63,63,63,0x21d00,0x48e00,14,10,0xbe800000,3,1,0xffffffff,0xffffffff,0x3c000,0x2e0000,0x74a000,0xe00000,0
.long 8,56,3,0x7bc00,0x1a00a,0xfc5c00,0xfc6000,0x1089800,0x1089c00,0x2e0c00,0x6bc00,0x107a00,0x40611300,0x40000280,0x3f000000,63,63,63,0x23d00,0x48e80,334,10,0xbe800000,3,1,0xffffffff,0xffffffff,0x3c800,0x2e1000,0x74ab00,0xe0f000,0
.long 8,56,6,0x7bc00,0x1a012,0xfc6400,0xfd4c00,0x108a000,0x108a400,0x2e1800,0x73c00,0x123a00,0x40610800,0x40000280,0x3f000000,63,63,63,0x25d00,0x48f00,18,10,0xbe800000,3,0x80008000,0xffffffff,0xffffffff,0x3d000,0x2e2000,0x74b600,0xe1e000,0
.long 8,56,9,0x7bc00,0x1a01a,0xfd5000,0xfd5400,0x108a800,0x10c5800,0x2e2400,0x7bc00,0x127a00,0x40611300,0x40000280,0x3f000000,63,63,63,0x27d00,0x48f80,338,10,0xbe800000,3,0x80008000,0xffffffff,0xffffffff,0x3d800,0x2e3000,0x74c100,0xe2d000,0
.long 8,56,12,0x62000,0x1a002,0xe04800,0xe04c00,0x10c5c00,0x10c6000,0x204000,0x62080,0x140200,0x40605800,0x40000280,0x3f000000,63,63,63,0x28100,0x49000,1,10,0xbe800000,3,1,0xffffffff,0xffffffff,0x22000,0x204000,0x6b2c00,0xe3c000,0
.long 8,56,15,0x62000,0x1a00a,0xe05000,0xe13800,0x10c6400,0x10c6800,0x204c00,0x6a080,0x144200,0x40606300,0x40000280,0x3f000000,63,63,63,0x2a100,0x49080,321,10,0xbe800000,3,1,0xffffffff,0xffffffff,0x22800,0x205000,0x6b3700,0xe4b000,0
.long 8,56,18,0x62000,0x1a012,0xe13c00,0xe14000,0x1101800,0x1101c00,0x205800,0x72080,0x160200,0x40605800,0x40000280,0x3f000000,63,63,63,0x2c100,0x49100,31,10,0xbe800000,3,0x80008000,0xffffffff,0xffffffff,0x23000,0x206000,0x6b4200,0xe5a000,0
.long 8,56,21,0x62000,0x1a01a,0xe22800,0xe22c00,0x1102000,0x1102400,0x206400,0x7a080,0x164200,0x40606300,0x40000280,0x3f000000,63,63,63,0x2e100,0x49180,351,10,0xbe800000,3,0x80008000,0xffffffff,0xffffffff,0x23800,0x207000,0x6b4d00,0xe69000,0
.long 8,56,12,0x62400,0x1a002,0xe23000,0xe31800,0x1102800,0x113d800,0x224000,0x62480,0x140a00,0x406b5800,0x40000280,0x3f000000,63,63,63,0x28500,0x49200,3,10,0xbe800000,3,1,0xffffffff,0xffffffff,0x26000,0x224000,0x6c8c00,0xe3c000,0
.long 8,56,15,0x62400,0x1a00a,0xe31c00,0xe32000,0x113dc00,0x113e000,0x224c00,0x6a480,0x144a00,0x406b6300,0x40000280,0x3f000000,63,63,63,0x2a500,0x49280,323,10,0xbe800000,3,1,0xffffffff,0xffffffff,0x26800,0x225000,0x6c9700,0xe4b000,0
.long 8,56,18,0x62400,0x1a012,0xe40800,0xe40c00,0x113e400,0x113e800,0x225800,0x72480,0x160a00,0x406b5800,0x40000280,0x3f000000,63,63,63,0x2c500,0x49300,29,10,0xbe800000,3,0x80008000,0xffffffff,0xffffffff,0x27000,0x226000,0x6ca200,0xe5a000,0
.long 8,56,21,0x62400,0x1a01a,0xe41000,0xe4f800,0x1179800,0x1179c00,0x226400,0x7a480,0x164a00,0x406b6300,0x40000280,0x3f000000,63,63,63,0x2e500,0x49380,349,10,0xbe800000,3,0x80008000,0xffffffff,0xffffffff,0x27800,0x227000,0x6cad00,0xe69000,0
.long 8,56,12,0x6a800,0x1a002,0xe4fc00,0xe50000,0x117a000,0x117a400,0x244000,0x62880,0x141200,0x40765800,0x40000280,0x3f000000,63,63,63,0x28900,0x49400,5,10,0xbe800000,3,1,0xffffffff,0xffffffff,0x2a000,0x244000,0x6dec00,0xe3c000,0
.long 8,56,15,0x6a800,0x1a00a,0xe5e800,0xe5ec00,0x117a800,0x11b5800,0x244c00,0x6a880,0x145200,0x40766300,0x40000280,0x3f000000,63,63,63,0x2a900,0x49480,325,10,0xbe800000,3,1,0xffffffff,0xffffffff,0x2a800,0x245000,0x6df700,0xe4b000,0
.long 8,56,18,0x6a800,0x1a012,0xe5f000,0xe6d800,0x11b5c00,0x11b6000,0x245800,0x72880,0x161200,0x40765800,0x40000280,0x3f000000,63,63,63,0x2c900,0x49500,27,10,0xbe800000,3,0x80008000,0xffffffff,0xffffffff,0x2b000,0x246000,0x6e0200,0xe5a000,0
.long 8,56,21,0x6a800,0x1a01a,0xe6dc00,0xe6e000,0x11b6400,0x11b6800,0x246400,0x7a880,0x165200,0x40766300,0x40000280,0x3f000000,63,63,63,0x2e900,0x49580,347,10,0xbe800000,3,0x80008000,0xffffffff,0xffffffff,0x2b800,0x247000,0x6e0d00,0xe69000,0
.long 8,56,12,0x6ac00,0x1a002,0xe7c800,0xe7cc00,0x1012c00,0x1013000,0x264000,0x62c80,0x141a00,0x40815800,0x40000280,0x3f000000,63,63,63,0x28d00,0x49600,7,10,0xbe800000,3,1,0xffffffff,0xffffffff,0x2e000,0x264000,0x6f4c00,0xe3c000,0
.long 8,56,15,0x6ac00,0x1a00a,0xe7d000,0xe8b800,0x1013400,0x1013800,0x264c00,0x6ac80,0x145a00,0x40816300,0x40000280,0x3f000000,63,63,63,0x2ad00,0x49680,327,10,0xbe800000,3,1,0xffffffff,0xffffffff,0x2e800,0x265000,0x6f5700,0xe4b000,0
.long 8,56,18,0x6ac00,0x1a012,0xe8bc00,0xe8c000,0x1013c00,0x104ec00,0x265800,0x72c80,0x161a00,0x40815800,0x40000280,0x3f000000,63,63,63,0x2cd00,0x49700,25,10,0xbe800000,3,0x80008000,0xffffffff,0xffffffff,0x2f000,0x266000,0x6f6200,0xe5a000,0
.long 8,56,21,0x6ac00,0x1a01a,0xe9a800,0xe9ac00,0x104f000,0x104f400,0x266400,0x7ac80,0x165a00,0x40816300,0x40000280,0x3f000000,63,63,63,0x2ed00,0x49780,345,10,0xbe800000,3,0x80008000,0xffffffff,0xffffffff,0x2f800,0x267000,0x6f6d00,0xe69000,0
.long 8,56,12,0x73000,0x1a002,0xe9b000,0xea9800,0x104f800,0x104fc00,0x284000,0x63080,0x142200,0x40820800,0x40000280,0x3f000000,63,63,63,0x29100,0x49800,9,10,0xbe800000,3,1,0xffffffff,0xffffffff,0x32000,0x284000,0x70ac00,0xe3c000,0
.long 8,56,15,0x73000,0x1a00a,0xea9c00,0xeaa000,0x108ac00,0x108b000,0x284c00,0x6b080,0x146200,0x40821300,0x40000280,0x3f000000,63,63,63,0x2b100,0x49880,329,10,0xbe800000,3,1,0xffffffff,0xffffffff,0x32800,0x285000,0x70b700,0xe4b000,0
.long 8,56,18,0x73000,0x1a012,0xeb8800,0xeb8c00,0x108b400,0x108b800,0x285800,0x73080,0x162200,0x40820800,0x40000280,0x3f000000,63,63,63,0x2d100,0x49900,23,10,0xbe800000,3,0x80008000,0xffffffff,0xffffffff,0x33000,0x286000,0x70c200,0xe5a000,0
.long 8,56,21,0x73000,0x1a01a,0xeb9000,0xec7800,0x108bc00,0x10c6c00,0x286400,0x7b080,0x166200,0x40821300,0x40000280,0x3f000000,63,63,63,0x2f100,0x49980,343,10,0xbe800000,3,0x80008000,0xffffffff,0xffffffff,0x33800,0x287000,0x70cd00,0xe69000,0
.long 8,56,12,0x73400,0x1a002,0xec7c00,0xec8000,0x10c7000,0x10c7400,0x2a4000,0x63480,0x142a00,0x40770800,0x40000280,0x3f000000,63,63,63,0x29500,0x49a00,11,10,0xbe800000,3,1,0xffffffff,0xffffffff,0x36000,0x2a4000,0x720c00,0xe3c000,0
.long 8,56,15,0x73400,0x1a00a,0xed6800,0xed6c00,0x10c7800,0x10c7c00,0x2a4c00,0x6b480,0x146a00,0x40771300,0x40000280,0x3f000000,63,63,63,0x2b500,0x49a80,331,10,0xbe800000,3,1,0xffffffff,0xffffffff,0x36800,0x2a5000,0x721700,0xe4b000,0
.long 8,56,18,0x73400,0x1a012,0xed7000,0xee5800,0x1102c00,0x1103000,0x2a5800,0x73480,0x162a00,0x40770800,0x40000280,0x3f000000,63,63,63,0x2d500,0x49b00,21,10,0xbe800000,3,0x80008000,0xffffffff,0xffffffff,0x37000,0x2a6000,0x722200,0xe5a000,0
.long 8,56,21,0x73400,0x1a01a,0xee5c00,0xee6000,0x1103400,0x1103800,0x2a6400,0x7b480,0x166a00,0x40771300,0x40000280,0x3f000000,63,63,63,0x2f500,0x49b80,341,10,0xbe800000,3,0x80008000,0xffffffff,0xffffffff,0x37800,0x2a7000,0x722d00,0xe69000,0
.long 8,56,12,0x7b800,0x1a002,0xef4800,0xef4c00,0x1103c00,0x113ec00,0x2c4000,0x63880,0x143200,0x406c0800,0x40000280,0x3f000000,63,63,63,0x29900,0x49c00,13,10,0xbe800000,3,1,0xffffffff,0xffffffff,0x3a000,0x2c4000,0x736c00,0xe3c000,0
.long 8,56,15,0x7b800,0x1a00a,0xef5000,0xf03800,0x113f000,0x113f400,0x2c4c00,0x6b880,0x147200,0x406c1300,0x40000280,0x3f000000,63,63,63,0x2b900,0x49c80,333,10,0xbe800000,3,1,0xffffffff,0xffffffff,0x3a800,0x2c5000,0x737700,0xe4b000,0
.long 8,56,18,0x7b800,0x1a012,0xf03c00,0xf04000,0x113f800,0x113fc00,0x2c5800,0x73880,0x163200,0x406c0800,0x40000280,0x3f000000,63,63,63,0x2d900,0x49d00,19,10,0xbe800000,3,0x80008000,0xffffffff,0xffffffff,0x3b000,0x2c6000,0x738200,0xe5a000,0
.long 8,56,21,0x7b800,0x1a01a,0xf12800,0xf12c00,0x117ac00,0x117b000,0x2c6400,0x7b880,0x167200,0x406c1300,0x40000280,0x3f000000,63,63,63,0x2f900,0x49d80,339,10,0xbe800000,3,0x80008000,0xffffffff,0xffffffff,0x3b800,0x2c7000,0x738d00,0xe69000,0
.long 8,56,12,0x7bc00,0x1a002,0xf13000,0xf21800,0x117b400,0x117b800,0x2e4000,0x63c80,0x143a00,0x40610800,0x40000280,0x3f000000,63,63,63,0x29d00,0x49e00,15,10,0xbe800000,3,1,0xffffffff,0xffffffff,0x3e000,0x2e4000,0x74cc00,0xe3c000,0
.long 8,56,15,0x7bc00,0x1a00a,0xf21c00,0xf22000,0x117bc00,0x11b6c00,0x2e4c00,0x6bc80,0x147a00,0x40611300,0x40000280,0x3f000000,63,63,63,0x2bd00,0x49e80,335,10,0xbe800000,3,1,0xffffffff,0xffffffff,0x3e800,0x2e5000,0x74d700,0xe4b000,0
.long 8,56,18,0x7bc00,0x1a012,0xf30800,0xf30c00,0x11b7000,0x11b7400,0x2e5800,0x73c80,0x163a00,0x40610800,0x40000280,0x3f000000,63,63,63,0x2dd00,0x49f00,17,10,0xbe800000,3,0x80008000,0xffffffff,0xffffffff,0x3f000,0x2e6000,0x74e200,0xe5a000,0
.long 8,56,21,0x7bc00,0x1a01a,0xf31000,0xf3f800,0x11b7800,0x11b7c00,0x2e6400,0x7bc80,0x167a00,0x40611300,0x40000280,0x3f000000,63,63,63,0x2fd00,0x49f80,337,10,0xbe800000,3,0x80008000,0xffffffff,0xffffffff,0x3f800,0x2e7000,0x74ed00,0xe69000,0
.long 10,54,24,0x62000,0x1a002,0xf3fc00,0xf40000,0x1014000,0x1014400,0x208000,0x62100,0x180200,0x40605800,0x40000280,0x3f000000,63,63,63,0x30100,0x4a000,0,10,0xbe800000,3,0,0xffffffff,0,0x20000,0x208000,0x6b5800,0xe78000,0
.long 10,54,27,0x62000,0x1a00a,0xf4e800,0xf4ec00,0x1014800,0x1014c00,0x208c00,0x6a100,0x184200,0x40606300,0x40000280,0x3f000000,63,63,63,0x32100,0x4a080,320,10,0xbe800000,3,0,0xffffffff,0,0x20800,0x209000,0x6b6300,0xe87000,0
.long 10,54,30,0x62000,0x1a012,0xf4f000,0xf5d800,0x1015000,0x1050000,0x209800,0x72100,0x1a0200,0x40605800,0x40000280,0x3f000000,63,63,63,0x34100,0x4a100,16,10,0xbe800000,3,0,0,0xffffffff,0x21000,0x20a000,0x6b6e00,0xe96000,0
.long 10,54,33,0x62000,0x1a01a,0xf5dc00,0xf5e000,0x1050400,0x1050800,0x20a400,0x7a100,0x1a4200,0x40606300,0x40000280,0x3f000000,63,63,63,0x36100,0x4a180,336,10,0xbe800000,3,0,0,0xffffffff,0x21800,0x20b000,0x6b7900,0xea5000,0
.long 10,54,24,0x62400,0x1a002,0xf6c800,0xf6cc00,0x1050c00,0x1051000,0x228000,0x62500,0x180a00,0x406b5800,0x40000280,0x3f000000,63,63,63,0x30500,0x4a200,2,10,0xbe800000,3,1,0xffffffff,0xffffffff,0x24000,0x228000,0x6cb800,0xe78000,0
.long 10,54,27,0x62400,0x1a00a,0xf6d000,0xf7b800,0x108c000,0x108c400,0x228c00,0x6a500,0x184a00,0x406b6300,0x40000280,0x3f000000,63,63,63,0x32500,0x4a280,322,10,0xbe800000,3,1,0xffffffff,0xffffffff,0x24800,0x229000,0x6cc300,0xe87000,0
.long 10,54,30,0x62400,0x1a012,0xf7bc00,0xf7c000,0x108c800,0x108cc00,0x229800,0x72500,0x1a0a00,0x406b5800,0x40000280,0x3f000000,63,63,63,0x34500,0x4a300,30,10,0xbe800000,3,0x80008000,0xffffffff,0xffffffff,0x25000,0x22a000,0x6cce00,0xe96000,0
.long 10,54,33,0x62400,0x1a01a,0xf8a800,0xf8ac00,0x108d000,0x10c8000,0x22a400,0x7a500,0x1a4a00,0x406b6300,0x40000280,0x3f000000,63,63,63,0x36500,0x4a380,350,10,0xbe800000,3,0x80008000,0xffffffff,0xffffffff,0x25800,0x22b000,0x6cd900,0xea5000,0
.long 10,54,24,0x6a800,0x1a002,0xf8b000,0xf99800,0x10c8400,0x10c8800,0x248000,0x62900,0x181200,0x40765800,0x40000280,0x3f000000,63,63,63,0x30900,0x4a400,4,10,0xbe800000,3,1,0xffffffff,0xffffffff,0x28000,0x248000,0x6e1800,0xe78000,0
.long 10,54,27,0x6a800,0x1a00a,0xf99c00,0xf9a000,0x10c8c00,0x10c9000,0x248c00,0x6a900,0x185200,0x40766300,0x40000280,0x3f000000,63,63,63,0x32900,0x4a480,324,10,0xbe800000,3,1,0xffffffff,0xffffffff,0x28800,0x249000,0x6e2300,0xe87000,0
.long 10,54,30,0x6a800,0x1a012,0xfa8800,0xfa8c00,0x1104000,0x1104400,0x249800,0x72900,0x1a1200,0x40765800,0x40000280,0x3f000000,63,63,63,0x34900,0x4a500,28,10,0xbe800000,3,0x80008000,0xffffffff,0xffffffff,0x29000,0x24a000,0x6e2e00,0xe96000,0
.long 10,54,33,0x6a800,0x1a01a,0xfa9000,0xfb7800,0x1104800,0x1104c00,0x24a400,0x7a900,0x1a5200,0x40766300,0x40000280,0x3f000000,63,63,63,0x36900,0x4a580,348,10,0xbe800000,3,0x80008000,0xffffffff,0xffffffff,0x29800,0x24b000,0x6e3900,0xea5000,0
.long 10,54,24,0x6ac00,0x1a002,0xfb7c00,0xfb8000,0x1105000,0x1140000,0x268000,0x62d00,0x181a00,0x40815800,0x40000280,0x3f000000,63,63,63,0x30d00,0x4a600,6,10,0xbe800000,3,1,0xffffffff,0xffffffff,0x2c000,0x268000,0x6f7800,0xe78000,0
.long 10,54,27,0x6ac00,0x1a00a,0xfc6800,0xfc6c00,0x1140400,0x1140800,0x268c00,0x6ad00,0x185a00,0x40816300,0x40000280,0x3f000000,63,63,63,0x32d00,0x4a680,326,10,0xbe800000,3,1,0xffffffff,0xffffffff,0x2c800,0x269000,0x6f8300,0xe87000,0
.long 10,54,30,0x6ac00,0x1a012,0xfc7000,0xfd5800,0x1140c00,0x1141000,0x269800,0x72d00,0x1a1a00,0x40815800,0x40000280,0x3f000000,63,63,63,0x34d00,0x4a700,26,10,0xbe800000,3,0x80008000,0xffffffff,0xffffffff,0x2d000,0x26a000,0x6f8e00,0xe96000,0
.long 10,54,33,0x6ac00,0x1a01a,0xfd5c00,0xfd6000,0x117c000,0x117c400,0x26a400,0x7ad00,0x1a5a00,0x40816300,0x40000280,0x3f000000,63,63,63,0x36d00,0x4a780,346,10,0xbe800000,3,0x80008000,0xffffffff,0xffffffff,0x2d800,0x26b000,0x6f9900,0xea5000,0
.long 10,54,24,0x73000,0x1a002,0xe05400,0xe05800,0x117c800,0x117cc00,0x288000,0x63100,0x182200,0x40820800,0x40000280,0x3f000000,63,63,63,0x31100,0x4a800,8,10,0xbe800000,3,1,0xffffffff,0xffffffff,0x30000,0x288000,0x70d800,0xe78000,0
.long 10,54,27,0x73000,0x1a00a,0xe05c00,0xe14400,0x117d000,0x11b8000,0x288c00,0x6b100,0x186200,0x40821300,0x40000280,0x3f000000,63,63,63,0x33100,0x4a880,328,10,0xbe800000,3,1,0xffffffff,0xffffffff,0x30800,0x289000,0x70e300,0xe87000,0
.long 10,54,30,0x73000,0x1a012,0xe14800,0xe14c00,0x11b8400,0x11b8800,0x289800,0x73100,0x1a2200,0x40820800,0x40000280,0x3f000000,63,63,63,0x35100,0x4a900,24,10,0xbe800000,3,0x80008000,0xffffffff,0xffffffff,0x31000,0x28a000,0x70ee00,0xe96000,0
.long 10,54,33,0x73000,0x1a01a,0xe23400,0xe23800,0x11b8c00,0x11b9000,0x28a400,0x7b100,0x1a6200,0x40821300,0x40000280,0x3f000000,63,63,63,0x37100,0x4a980,344,10,0xbe800000,3,0x80008000,0xffffffff,0xffffffff,0x31800,0x28b000,0x70f900,0xea5000,0
.long 10,54,24,0x73400,0x1a002,0xe23c00,0xe32400,0x1015400,0x1015800,0x2a8000,0x63500,0x182a00,0x40770800,0x40000280,0x3f000000,63,63,63,0x31500,0x4aa00,10,10,0xbe800000,3,1,0xffffffff,0xffffffff,0x34000,0x2a8000,0x723800,0xe78000,0
.long 10,54,27,0x73400,0x1a00a,0xe32800,0xe32c00,0x1015c00,0x1016000,0x2a8c00,0x6b500,0x186a00,0x40771300,0x40000280,0x3f000000,63,63,63,0x33500,0x4aa80,330,10,0xbe800000,3,1,0xffffffff,0xffffffff,0x34800,0x2a9000,0x724300,0xe87000,0
.long 10,54,30,0x73400,0x1a012,0xe41400,0xe41800,0x1016400,0x1051400,0x2a9800,0x73500,0x1a2a00,0x40770800,0x40000280,0x3f000000,63,63,63,0x35500,0x4ab00,22,10,0xbe800000,3,0x80008000,0xffffffff,0xffffffff,0x35000,0x2aa000,0x724e00,0xe96000,0
.long 10,54,33,0x73400,0x1a01a,0xe41c00,0xe50400,0x1051800,0x1051c00,0x2aa400,0x7b500,0x1a6a00,0x40771300,0x40000280,0x3f000000,63,63,63,0x37500,0x4ab80,342,10,0xbe800000,3,0x80008000,0xffffffff,0xffffffff,0x35800,0x2ab000,0x725900,0xea5000,0
.long 10,54,24,0x7b800,0x1a002,0xe50800,0xe50c00,0x1052000,0x1052400,0x2c8000,0x63900,0x183200,0x406c0800,0x40000280,0x3f000000,63,63,63,0x31900,0x4ac00,12,10,0xbe800000,3,1,0xffffffff,0xffffffff,0x38000,0x2c8000,0x739800,0xe78000,0
.long 10,54,27,0x7b800,0x1a00a,0xe5f400,0xe5f800,0x108d400,0x108d800,0x2c8c00,0x6b900,0x187200,0x406c1300,0x40000280,0x3f000000,63,63,63,0x33900,0x4ac80,332,10,0xbe800000,3,1,0xffffffff,0xffffffff,0x38800,0x2c9000,0x73a300,0xe87000,0
.long 10,54,30,0x7b800,0x1a012,0xe5fc00,0xe6e400,0x108dc00,0x108e000,0x2c9800,0x73900,0x1a3200,0x406c0800,0x40000280,0x3f000000,63,63,63,0x35900,0x4ad00,20,10,0xbe800000,3,0x80008000,0xffffffff,0xffffffff,0x39000,0x2ca000,0x73ae00,0xe96000,0
.long 10,54,33,0x7b800,0x1a01a,0xe6e800,0xe6ec00,0x108e400,0x10c9400,0x2ca400,0x7b900,0x1a7200,0x406c1300,0x40000280,0x3f000000,63,63,63,0x37900,0x4ad80,340,10,0xbe800000,3,0x80008000,0xffffffff,0xffffffff,0x39800,0x2cb000,0x73b900,0xea5000,0
.long 10,54,24,0x7bc00,0x1a002,0xe7d400,0xe7d800,0x10c9800,0x10c9c00,0x2e8000,0x63d00,0x183a00,0x40610800,0x40000280,0x3f000000,63,63,63,0x31d00,0x4ae00,14,10,0xbe800000,3,1,0xffffffff,0xffffffff,0x3c000,0x2e8000,0x74f800,0xe78000,0
.long 10,54,27,0x7bc00,0x1a00a,0xe7dc00,0xe8c400,0x10ca000,0x10ca400,0x2e8c00,0x6bd00,0x187a00,0x40611300,0x40000280,0x3f000000,63,63,63,0x33d00,0x4ae80,334,10,0xbe800000,3,1,0xffffffff,0xffffffff,0x3c800,0x2e9000,0x750300,0xe87000,0
.long 10,54,30,0x7bc00,0x1a012,0xe8c800,0xe8cc00,0x1105400,0x1105800,0x2e9800,0x73d00,0x1a3a00,0x40610800,0x40000280,0x3f000000,63,63,63,0x35d00,0x4af00,18,10,0xbe800000,3,0x80008000,0xffffffff,0xffffffff,0x3d000,0x2ea000,0x750e00,0xe96000,0
.long 10,54,33,0x7bc00,0x1a01a,0xe9b400,0xe9b800,0x1105c00,0x1106000,0x2ea400,0x7bd00,0x1a7a00,0x40611300,0x40000280,0x3f000000,63,63,63,0x37d00,0x4af80,338,10,0xbe800000,3,0x80008000,0xffffffff,0xffffffff,0x3d800,0x2eb000,0x751900,0xea5000,0
.long 10,54,36,0x62000,0x1a002,0xe9bc00,0xeaa400,0x1106400,0x1141400,0x20c000,0x62180,0x1c0200,0x40605800,0x40000280,0x3f000000,63,63,63,0x38100,0x4b000,1,10,0xbe800000,3,1,0xffffffff,0xffffffff,0x22000,0x20c000,0x6b8400,0xeb4000,0
.long 10,54,39,0x62000,0x1a00a,0xeaa800,0xeaac00,0x1141800,0x1141c00,0x20cc00,0x6a180,0x1c4200,0x40606300,0x40000280,0x3f000000,63,63,63,0x3a100,0x4b080,321,10,0xbe800000,3,1,0xffffffff,0xffffffff,0x22800,0x20d000,0x6b8f00,0xec3000,0
.long 10,54,42,0x62000,0x1a012,0xeb9400,0xeb9800,0x1142000,0x1142400,0x20d800,0x72180,0x1e0200,0x40605800,0x40000280,0x3f000000,63,63,63,0x3c100,0x4b100,31,10,0xbe800000,3,0x80008000,0xffffffff,0xffffffff,0x23000,0x20e000,0x6b9a00,0xed2000,0
.long 10,54,45,0x62000,0x1a01a,0xeb9c00,0xec8400,0x117d400,0x117d800,0x20e400,0x7a180,0x1e4200,0x40606300,0x40000280,0x3f000000,63,63,63,0x3e100,0x4b180,351,10,0xbe800000,3,0x80008000,0xffffffff,0xffffffff,0x23800,0x20f000,0x6ba500,0xee1000,0
.long 10,54,36,0x62400,0x1a002,0xec8800,0xec8c00,0x117dc00,0x117e000,0x22c000,0x62580,0x1c0a00,0x406b5800,0x40000280,0x3f000000,63,63,63,0x38500,0x4b200,3,10,0xbe800000,3,1,0xffffffff,0xffffffff,0x26000,0x22c000,0x6ce400,0xeb4000,0
.long 10,54,39,0x62400,0x1a00a,0xed7400,0xed7800,0x117e400,0x11b9400,0x22cc00,0x6a580,0x1c4a00,0x406b6300,0x40000280,0x3f000000,63,63,63,0x3a500,0x4b280,323,10,0xbe800000,3,1,0xffffffff,0xffffffff,0x26800,0x22d000,0x6cef00,0xec3000,0
.long 10,54,42,0x62400,0x1a012,0xed7c00,0xee6400,0x11b9800,0x11b9c00,0x22d800,0x72580,0x1e0a00,0x406b5800,0x40000280,0x3f000000,63,63,63,0x3c500,0x4b300,29,10,0xbe800000,3,0x80008000,0xffffffff,0xffffffff,0x27000,0x22e000,0x6cfa00,0xed2000,0
.long 10,54,45,0x62400,0x1a01a,0xee6800,0xee6c00,0x11ba000,0x11ba400,0x22e400,0x7a580,0x1e4a00,0x406b6300,0x40000280,0x3f000000,63,63,63,0x3e500,0x4b380,349,10,0xbe800000,3,0x80008000,0xffffffff,0xffffffff,0x27800,0x22f000,0x6d0500,0xee1000,0
.long 10,54,36,0x6a800,0x1a002,0xef5400,0xef5800,0x1016800,0x1016c00,0x24c000,0x62980,0x1c1200,0x40765800,0x40000280,0x3f000000,63,63,63,0x38900,0x4b400,5,10,0xbe800000,3,1,0xffffffff,0xffffffff,0x2a000,0x24c000,0x6e4400,0xeb4000,0
.long 10,54,39,0x6a800,0x1a00a,0xef5c00,0xf04400,0x1017000,0x1017400,0x24cc00,0x6a980,0x1c5200,0x40766300,0x40000280,0x3f000000,63,63,63,0x3a900,0x4b480,325,10,0xbe800000,3,1,0xffffffff,0xffffffff,0x2a800,0x24d000,0x6e4f00,0xec3000,0
.long 10,54,42,0x6a800,0x1a012,0xf04800,0xf04c00,0x1017800,0x1052800,0x24d800,0x72980,0x1e1200,0x40765800,0x40000280,0x3f000000,63,63,63,0x3c900,0x4b500,27,10,0xbe800000,3,0x80008000,0xffffffff,0xffffffff,0x2b000,0x24e000,0x6e5a00,0xed2000,0
.long 10,54,45,0x6a800,0x1a01a,0xf13400,0xf13800,0x1052c00,0x1053000,0x24e400,0x7a980,0x1e5200,0x40766300,0x40000280,0x3f000000,63,63,63,0x3e900,0x4b580,347,10,0xbe800000,3,0x80008000,0xffffffff,0xffffffff,0x2b800,0x24f000,0x6e6500,0xee1000,0
.long 10,54,36,0x6ac00,0x1a002,0xf13c00,0xf22400,0x1053400,0x1053800,0x26c000,0x62d80,0x1c1a00,0x40815800,0x40000280,0x3f000000,63,63,63,0x38d00,0x4b600,7,10,0xbe800000,3,1,0xffffffff,0xffffffff,0x2e000,0x26c000,0x6fa400,0xeb4000,0
.long 10,54,39,0x6ac00,0x1a00a,0xf22800,0xf22c00,0x108e800,0x108ec00,0x26cc00,0x6ad80,0x1c5a00,0x40816300,0x40000280,0x3f000000,63,63,63,0x3ad00,0x4b680,327,10,0xbe800000,3,1,0xffffffff,0xffffffff,0x2e800,0x26d000,0x6faf00,0xec3000,0
.long 10,54,42,0x6ac00,0x1a012,0xf31400,0xf31800,0x108f000,0x108f400,0x26d800,0x72d80,0x1e1a00,0x40815800,0x40000280,0x3f000000,63,63,63,0x3cd00,0x4b700,25,10,0xbe800000,3,0x80008000,0xffffffff,0xffffffff,0x2f000,0x26e000,0x6fba00,0xed2000,0
.long 10,54,45,0x6ac00,0x1a01a,0xf31c00,0xf40400,0x108f800,0x10ca800,0x26e400,0x7ad80,0x1e5a00,0x40816300,0x40000280,0x3f000000,63,63,63,0x3ed00,0x4b780,345,10,0xbe800000,3,0x80008000,0xffffffff,0xffffffff,0x2f800,0x26f000,0x6fc500,0xee1000,0
.long 10,54,36,0x73000,0x1a002,0xf40800,0xf40c00,0x10cac00,0x10cb000,0x28c000,0x63180,0x1c2200,0x40820800,0x40000280,0x3f000000,63,63,63,0x39100,0x4b800,9,10,0xbe800000,3,1,0xffffffff,0xffffffff,0x32000,0x28c000,0x710400,0xeb4000,0
.long 10,54,39,0x73000,0x1a00a,0xf4f400,0xf4f800,0x10cb400,0x10cb800,0x28cc00,0x6b180,0x1c6200,0x40821300,0x40000280,0x3f000000,63,63,63,0x3b100,0x4b880,329,10,0xbe800000,3,1,0xffffffff,0xffffffff,0x32800,0x28d000,0x710f00,0xec3000,0
.long 10,54,42,0x73000,0x1a012,0xf4fc00,0xf5e400,0x1106800,0x1106c00,0x28d800,0x73180,0x1e2200,0x40820800,0x40000280,0x3f000000,63,63,63,0x3d100,0x4b900,23,10,0xbe800000,3,0x80008000,0xffffffff,0xffffffff,0x33000,0x28e000,0x711a00,0xed2000,0
.long 10,54,45,0x73000,0x1a01a,0xf5e800,0xf5ec00,0x1107000,0x1107400,0x28e400,0x7b180,0x1e6200,0x40821300,0x40000280,0x3f000000,63,63,63,0x3f100,0x4b980,343,10,0xbe800000,3,0x80008000,0xffffffff,0xffffffff,0x33800,0x28f000,0x712500,0xee1000,0
.long 10,54,36,0x73400,0x1a002,0xf6d400,0xf6d800,0x1107800,0x1142800,0x2ac000,0x63580,0x1c2a00,0x40770800,0x40000280,0x3f000000,63,63,63,0x39500,0x4ba00,11,10,0xbe800000,3,1,0xffffffff,0xffffffff,0x36000,0x2ac000,0x726400,0xeb4000,0
.long 10,54,39,0x73400,0x1a00a,0xf6dc00,0xf7c400,0x1142c00,0x1143000,0x2acc00,0x6b580,0x1c6a00,0x40771300,0x40000280,0x3f000000,63,63,63,0x3b500,0x4ba80,331,10,0xbe800000,3,1,0xffffffff,0xffffffff,0x36800,0x2ad000,0x726f00,0xec3000,0
.long 10,54,42,0x73400,0x1a012,0xf7c800,0xf7cc00,0x1143400,0x1143800,0x2ad800,0x73580,0x1e2a00,0x40770800,0x40000280,0x3f000000,63,63,63,0x3d500,0x4bb00,21,10,0xbe800000,3,0x80008000,0xffffffff,0xffffffff,0x37000,0x2ae000,0x727a00,0xed2000,0
.long 10,54,45,0x73400,0x1a01a,0xf8b400,0xf8b800,0x117e800,0x117ec00,0x2ae400,0x7b580,0x1e6a00,0x40771300,0x40000280,0x3f000000,63,63,63,0x3f500,0x4bb80,341,10,0xbe800000,3,0x80008000,0xffffffff,0xffffffff,0x37800,0x2af000,0x728500,0xee1000,0
.long 10,54,36,0x7b800,0x1a002,0xf8bc00,0xf9a400,0x117f000,0x117f400,0x2cc000,0x63980,0x1c3200,0x406c0800,0x40000280,0x3f000000,63,63,63,0x39900,0x4bc00,13,10,0xbe800000,3,1,0xffffffff,0xffffffff,0x3a000,0x2cc000,0x73c400,0xeb4000,0
.long 10,54,39,0x7b800,0x1a00a,0xf9a800,0xf9ac00,0x117f800,0x11ba800,0x2ccc00,0x6b980,0x1c7200,0x406c1300,0x40000280,0x3f000000,63,63,63,0x3b900,0x4bc80,333,10,0xbe800000,3,1,0xffffffff,0xffffffff,0x3a800,0x2cd000,0x73cf00,0xec3000,0
.long 10,54,42,0x7b800,0x1a012,0xfa9400,0xfa9800,0x11bac00,0x11bb000,0x2cd800,0x73980,0x1e3200,0x406c0800,0x40000280,0x3f000000,63,63,63,0x3d900,0x4bd00,19,10,0xbe800000,3,0x80008000,0xffffffff,0xffffffff,0x3b000,0x2ce000,0x73da00,0xed2000,0
.long 10,54,45,0x7b800,0x1a01a,0xfa9c00,0xfb8400,0x11bb400,0x11bb800,0x2ce400,0x7b980,0x1e7200,0x406c1300,0x40000280,0x3f000000,63,63,63,0x3f900,0x4bd80,339,10,0xbe800000,3,0x80008000,0xffffffff,0xffffffff,0x3b800,0x2cf000,0x73e500,0xee1000,0
.long 10,54,36,0x7bc00,0x1a002,0xfb8800,0xfb8c00,0x1017c00,0x1018000,0x2ec000,0x63d80,0x1c3a00,0x40610800,0x40000280,0x3f000000,63,63,63,0x39d00,0x4be00,15,10,0xbe800000,3,1,0xffffffff,0xffffffff,0x3e000,0x2ec000,0x752400,0xeb4000,0
.long 10,54,39,0x7bc00,0x1a00a,0xfc7400,0xfc7800,0x1018400,0x1018800,0x2ecc00,0x6bd80,0x1c7a00,0x40611300,0x40000280,0x3f000000,63,63,63,0x3bd00,0x4be80,335,10,0xbe800000,3,1,0xffffffff,0xffffffff,0x3e800,0x2ed000,0x752f00,0xec3000,0
.long 10,54,42,0x7bc00,0x1a012,0xfc7c00,0xfd6400,0x1018c00,0x1053c00,0x2ed800,0x73d80,0x1e3a00,0x40610800,0x40000280,0x3f000000,63,63,63,0x3dd00,0x4bf00,17,10,0xbe800000,3,0x80008000,0xffffffff,0xffffffff,0x3f000,0x2ee000,0x753a00,0xed2000,0
.long 10,54,45,0x7bc00,0x1a01a,0xfd6800,0xfd6c00,0x1054000,0x1054400,0x2ee400,0x7bd80,0x1e7a00,0x40611300,0x40000280,0x3f000000,63,63,63,0x3fd00,0x4bf80,337,10,0xbe800000,3,0x80008000,0xffffffff,0xffffffff,0x3f800,0x2ef000,0x754500,0xee1000,0
.long 12,52,48,0x62000,0x1a002,0xe06000,0xe06400,0x1054800,0x1054c00,0x210000,0x62200,0x100300,0x40605800,0x40000280,0x3f000000,63,63,63,0x20180,0x4c000,0,10,0xbe800000,3,0,0xffffffff,0,0x20000,0x210000,0x6bb000,0xef0000,0
.long 12,52,51,0x62000,0x1a00a,0xe06800,0xe15000,0x108fc00,0x1090000,0x210c00,0x6a200,0x104300,0x40606300,0x40000280,0x3f000000,63,63,63,0x22180,0x4c080,320,10,0xbe800000,3,0,0xffffffff,0,0x20800,0x211000,0x6bbb00,0xeff000,0
.long 12,52,54,0x62000,0x1a012,0xe15400,0xe15800,0x1090400,0x1090800,0x211800,0x72200,0x120300,0x40605800,0x40000280,0x3f000000,63,63,63,0x24180,0x4c100,16,10,0xbe800000,3,0,0,0xffffffff,0x21000,0x212000,0x6bc600,0xf0e000,0
.long 12,52,57,0x62000,0x1a01a,0xe24000,0xe24400,0x1090c00,0x10cbc00,0x212400,0x7a200,0x124300,0x40606300,0x40000280,0x3f000000,63,63,63,0x26180,0x4c180,336,10,0xbe800000,3,0,0,0xffffffff,0x21800,0x213000,0x6bd100,0xf1d000,0
.long 12,52,48,0x62400,0x1a002,0xe24800,0xe33000,0x10cc000,0x10cc400,0x230000,0x62600,0x100b00,0x406b5800,0x40000280,0x3f000000,63,63,63,0x20580,0x4c200,2,10,0xbe800000,3,1,0xffffffff,0xffffffff,0x24000,0x230000,0x6d1000,0xef0000,0
.long 12,52,51,0x62400,0x1a00a,0xe33400,0xe33800,0x10cc800,0x10ccc00,0x230c00,0x6a600,0x104b00,0x406b6300,0x40000280,0x3f000000,63,63,63,0x22580,0x4c280,322,10,0xbe800000,3,1,0xffffffff,0xffffffff,0x24800,0x231000,0x6d1b00,0xeff000,0
.long 12,52,54,0x62400,0x1a012,0xe42000,0xe42400,0x1107c00,0x1108000,0x231800,0x72600,0x120b00,0x406b5800,0x40000280,0x3f000000,63,63,63,0x24580,0x4c300,30,10,0xbe800000,3,0x80008000,0xffffffff,0xffffffff,0x25000,0x232000,0x6d2600,0xf0e000,0
.long 12,52,57,0x62400,0x1a01a,0xe42800,0xe51000,0x1108400,0x1108800,0x232400,0x7a600,0x124b00,0x406b6300,0x40000280,0x3f000000,63,63,63,0x26580,0x4c380,350,10,0xbe800000,3,0x80008000,0xffffffff,0xffffffff,0x25800,0x233000,0x6d3100,0xf1d000,0
.long 12,52,48,0x6a800,0x1a002,0xe51400,0xe51800,0x1108c00,0x1143c00,0x250000,0x62a00,0x101300,0x40765800,0x40000280,0x3f000000,63,63,63,0x20980,0x4c400,4,10,0xbe800000,3,1,0xffffffff,0xffffffff,0x28000,0x250000,0x6e7000,0xef0000,0
.long 12,52,51,0x6a800,0x1a00a,0xe60000,0xe60400,0x1144000,0x1144400,0x250c00,0x6aa00,0x105300,0x40766300,0x40000280,0x3f000000,63,63,63,0x22980,0x4c480,324,10,0xbe800000,3,1,0xffffffff,0xffffffff,0x28800,0x251000,0x6e7b00,0xeff000,0
.long 12,52,54,0x6a800,0x1a012,0xe60800,0xe6f000,0x1144800,0x1144c00,0x251800,0x72a00,0x121300,0x40765800,0x40000280,0x3f000000,63,63,63,0x24980,0x4c500,28,10,0xbe800000,3,0x80008000,0xffffffff,0xffffffff,0x29000,0x252000,0x6e8600,0xf0e000,0
.long 12,52,57,0x6a800,0x1a01a,0xe6f400,0xe6f800,0x117fc00,0x1180000,0x252400,0x7aa00,0x125300,0x40766300,0x40000280,0x3f000000,63,63,63,0x26980,0x4c580,348,10,0xbe800000,3,0x80008000,0xffffffff,0xffffffff,0x29800,0x253000,0x6e9100,0xf1d000,0
.long 12,52,48,0x6ac00,0x1a002,0xe7e000,0xe7e400,0x1180400,0x1180800,0x270000,0x62e00,0x101b00,0x40815800,0x40000280,0x3f000000,63,63,63,0x20d80,0x4c600,6,10,0xbe800000,3,1,0xffffffff,0xffffffff,0x2c000,0x270000,0x6fd000,0xef0000,0
.long 12,52,51,0x6ac00,0x1a00a,0xe7e800,0xe8d000,0x1180c00,0x11bbc00,0x270c00,0x6ae00,0x105b00,0x40816300,0x40000280,0x3f000000,63,63,63,0x22d80,0x4c680,326,10,0xbe800000,3,1,0xffffffff,0xffffffff,0x2c800,0x271000,0x6fdb00,0xeff000,0
.long 12,52,54,0x6ac00,0x1a012,0xe8d400,0xe8d800,0x11bc000,0x11bc400,0x271800,0x72e00,0x121b00,0x40815800,0x40000280,0x3f000000,63,63,63,0x24d80,0x4c700,26,10,0xbe800000,3,0x80008000,0xffffffff,0xffffffff,0x2d000,0x272000,0x6fe600,0xf0e000,0
.long 12,52,57,0x6ac00,0x1a01a,0xe9c000,0xe9c400,0x11bc800,0x11bcc00,0x272400,0x7ae00,0x125b00,0x40816300,0x40000280,0x3f000000,63,63,63,0x26d80,0x4c780,346,10,0xbe800000,3,0x80008000,0xffffffff,0xffffffff,0x2d800,0x273000,0x6ff100,0xf1d000,0
.long 12,52,48,0x73000,0x1a002,0xe9c800,0xeab000,0x1019000,0x1019400,0x290000,0x63200,0x102300,0x40820800,0x40000280,0x3f000000,63,63,63,0x21180,0x4c800,8,10,0xbe800000,3,1,0xffffffff,0xffffffff,0x30000,0x290000,0x713000,0xef0000,0
.long 12,52,51,0x73000,0x1a00a,0xeab400,0xeab800,0x1019800,0x1019c00,0x290c00,0x6b200,0x106300,0x40821300,0x40000280,0x3f000000,63,63,63,0x23180,0x4c880,328,10,0xbe800000,3,1,0xffffffff,0xffffffff,0x30800,0x291000,0x713b00,0xeff000,0
.long 12,52,54,0x73000,0x1a012,0xeba000,0xeba400,0x101a000,0x1055000,0x291800,0x73200,0x122300,0x40820800,0x40000280,0x3f000000,63,63,63,0x25180,0x4c900,24,10,0xbe800000,3,0x80008000,0xffffffff,0xffffffff,0x31000,0x292000,0x714600,0xf0e000,0
.long 12,52,57,0x73000,0x1a01a,0xeba800,0xec9000,0x1055400,0x1055800,0x292400,0x7b200,0x126300,0x40821300,0x40000280,0x3f000000,63,63,63,0x27180,0x4c980,344,10,0xbe800000,3,0x80008000,0xffffffff,0xffffffff,0x31800,0x293000,0x715100,0xf1d000,0
.long 12,52,48,0x73400,0x1a002,0xec9400,0xec9800,0x1055c00,0x1056000,0x2b0000,0x63600,0x102b00,0x40770800,0x40000280,0x3f000000,63,63,63,0x21580,0x4ca00,10,10,0xbe800000,3,1,0xffffffff,0xffffffff,0x34000,0x2b0000,0x729000,0xef0000,0
.long 12,52,51,0x73400,0x1a00a,0xed8000,0xed8400,0x1091000,0x1091400,0x2b0c00,0x6b600,0x106b00,0x40771300,0x40000280,0x3f000000,63,63,63,0x23580,0x4ca80,330,10,0xbe800000,3,1,0xffffffff,0xffffffff,0x34800,0x2b1000,0x729b00,0xeff000,0
.long 12,52,54,0x73400,0x1a012,0xed8800,0xee7000,0x1091800,0x1091c00,0x2b1800,0x73600,0x122b00,0x40770800,0x40000280,0x3f000000,63,63,63,0x25580,0x4cb00,22,10,0xbe800000,3,0x80008000,0xffffffff,0xffffffff,0x35000,0x2b2000,0x72a600,0xf0e000,0
.long 12,52,57,0x73400,0x1a01a,0xee7400,0xee7800,0x1092000,0x10cd000,0x2b2400,0x7b600,0x126b00,0x40771300,0x40000280,0x3f000000,63,63,63,0x27580,0x4cb80,342,10,0xbe800000,3,0x80008000,0xffffffff,0xffffffff,0x35800,0x2b3000,0x72b100,0xf1d000,0
.long 12,52,48,0x7b800,0x1a002,0xef6000,0xef6400,0x10cd400,0x10cd800,0x2d0000,0x63a00,0x103300,0x406c0800,0x40000280,0x3f000000,63,63,63,0x21980,0x4cc00,12,10,0xbe800000,3,1,0xffffffff,0xffffffff,0x38000,0x2d0000,0x73f000,0xef0000,0
.long 12,52,51,0x7b800,0x1a00a,0xef6800,0xf05000,0x10cdc00,0x10ce000,0x2d0c00,0x6ba00,0x107300,0x406c1300,0x40000280,0x3f000000,63,63,63,0x23980,0x4cc80,332,10,0xbe800000,3,1,0xffffffff,0xffffffff,0x38800,0x2d1000,0x73fb00,0xeff000,0
.long 12,52,54,0x7b800,0x1a012,0xf05400,0xf05800,0x1109000,0x1109400,0x2d1800,0x73a00,0x123300,0x406c0800,0x40000280,0x3f000000,63,63,63,0x25980,0x4cd00,20,10,0xbe800000,3,0x80008000,0xffffffff,0xffffffff,0x39000,0x2d2000,0x740600,0xf0e000,0
.long 12,52,57,0x7b800,0x1a01a,0xf14000,0xf14400,0x1109800,0x1109c00,0x2d2400,0x7ba00,0x127300,0x406c1300,0x40000280,0x3f000000,63,63,63,0x27980,0x4cd80,340,10,0xbe800000,3,0x80008000,0xffffffff,0xffffffff,0x39800,0x2d3000,0x741100,0xf1d000,0
.long 12,52,48,0x7bc00,0x1a002,0xf14800,0xf23000,0x110a000,0x1145000,0x2f0000,0x63e00,0x103b00,0x40610800,0x40000280,0x3f000000,63,63,63,0x21d80,0x4ce00,14,10,0xbe800000,3,1,0xffffffff,0xffffffff,0x3c000,0x2f0000,0x755000,0xef0000,0
.long 12,52,51,0x7bc00,0x1a00a,0xf23400,0xf23800,0x1145400,0x1145800,0x2f0c00,0x6be00,0x107b00,0x40611300,0x40000280,0x3f000000,63,63,63,0x23d80,0x4ce80,334,10,0xbe800000,3,1,0xffffffff,0xffffffff,0x3c800,0x2f1000,0x755b00,0xeff000,0
.long 12,52,54,0x7bc00,0x1a012,0xf32000,0xf32400,0x1145c00,0x1146000,0x2f1800,0x73e00,0x123b00,0x40610800,0x40000280,0x3f000000,63,63,63,0x25d80,0x4cf00,18,10,0xbe800000,3,0x80008000,0xffffffff,0xffffffff,0x3d000,0x2f2000,0x756600,0xf0e000,0
.long 12,52,57,0x7bc00,0x1a01a,0xf32800,0xf41000,0x1181000,0x1181400,0x2f2400,0x7be00,0x127b00,0x40611300,0x40000280,0x3f000000,63,63,63,0x27d80,0x4cf80,338,10,0xbe800000,3,0x80008000,0xffffffff,0xffffffff,0x3d800,0x2f3000,0x757100,0xf1d000,0
.long 12,52,60,0x62000,0x1a002,0xf41400,0xf41800,0x1181800,0x1181c00,0x214000,0x62280,0x140300,0x40605800,0x40000280,0x3f000000,63,63,63,0x28180,0x4d000,1,10,0xbe800000,3,1,0xffffffff,0xffffffff,0x22000,0x214000,0x6bdc00,0xf2c000,0
.long 12,52,63,0x62000,0x1a00a,0xf50000,0xf50400,0x1182000,0x11bd000,0x214c00,0x6a280,0x144300,0x40606300,0x40000280,0x3f000000,63,63,63,0x2a180,0x4d080,321,10,0xbe800000,3,1,0xffffffff,0xffffffff,0x22800,0x215000,0x6be700,0xf3b000,0
.long 12,52,66,0x62000,0x1a012,0xf50800,0xf5f000,0x11bd400,0x11bd800,0x215800,0x72280,0x160300,0x40605800,0x40000280,0x3f000000,63,63,63,0x2c180,0x4d100,31,10,0xbe800000,3,0x80008000,0xffffffff,0xffffffff,0x23000,0x216000,0x6bf200,0xf4a000,0
.long 12,52,69,0x62000,0x1a01a,0xf5f400,0xf5f800,0x11bdc00,0x11be000,0x216400,0x7a280,0x164300,0x40606300,0x40000280,0x3f000000,63,63,63,0x2e180,0x4d180,351,10,0xbe800000,3,0x80008000,0xffffffff,0xffffffff,0x23800,0x217000,0x6bfd00,0xf59000,0
.long 12,52,60,0x62400,0x1a002,0xf6e000,0xf6e400,0x101a400,0x101a800,0x234000,0x62680,0x140b00,0x406b5800,0x40000280,0x3f000000,63,63,63,0x28580,0x4d200,3,10,0xbe800000,3,1,0xffffffff,0xffffffff,0x26000,0x234000,0x6d3c00,0xf2c000,0
.long 12,52,63,0x62400,0x1a00a,0xf6e800,0xf7d000,0x101ac00,0x101b000,0x234c00,0x6a680,0x144b00,0x406b6300,0x40000280,0x3f000000,63,63,63,0x2a580,0x4d280,323,10,0xbe800000,3,1,0xffffffff,0xffffffff,0x26800,0x235000,0x6d4700,0xf3b000,0
.long 12,52,66,0x62400,0x1a012,0xf7d400,0xf7d800,0x101b400,0x1056400,0x235800,0x72680,0x160b00,0x406b5800,0x40000280,0x3f000000,63,63,63,0x2c580,0x4d300,29,10,0xbe800000,3,0x80008000,0xffffffff,0xffffffff,0x27000,0x236000,0x6d5200,0xf4a000,0
.long 12,52,69,0x62400,0x1a01a,0xf8c000,0xf8c400,0x1056800,0x1056c00,0x236400,0x7a680,0x164b00,0x406b6300,0x40000280,0x3f000000,63,63,63,0x2e580,0x4d380,349,10,0xbe800000,3,0x80008000,0xffffffff,0xffffffff,0x27800,0x237000,0x6d5d00,0xf59000,0
.long 12,52,60,0x6a800,0x1a002,0xf8c800,0xf9b000,0x1057000,0x1057400,0x254000,0x62a80,0x141300,0x40765800,0x40000280,0x3f000000,63,63,63,0x28980,0x4d400,5,10,0xbe800000,3,1,0xffffffff,0xffffffff,0x2a000,0x254000,0x6e9c00,0xf2c000,0
.long 12,52,63,0x6a800,0x1a00a,0xf9b400,0xf9b800,0x1092400,0x1092800,0x254c00,0x6aa80,0x145300,0x40766300,0x40000280,0x3f000000,63,63,63,0x2a980,0x4d480,325,10,0xbe800000,3,1,0xffffffff,0xffffffff,0x2a800,0x255000,0x6ea700,0xf3b000,0
.long 12,52,66,0x6a800,0x1a012,0xfaa000,0xfaa400,0x1092c00,0x1093000,0x255800,0x72a80,0x161300,0x40765800,0x40000280,0x3f000000,63,63,63,0x2c980,0x4d500,27,10,0xbe800000,3,0x80008000,0xffffffff,0xffffffff,0x2b000,0x256000,0x6eb200,0xf4a000,0
.long 12,52,69,0x6a800,0x1a01a,0xfaa800,0xfb9000,0x1093400,0x10ce400,0x256400,0x7aa80,0x165300,0x40766300,0x40000280,0x3f000000,63,63,63,0x2e980,0x4d580,347,10,0xbe800000,3,0x80008000,0xffffffff,0xffffffff,0x2b800,0x257000,0x6ebd00,0xf59000,0
.long 12,52,60,0x6ac00,0x1a002,0xfb9400,0xfb9800,0x10ce800,0x10cec00,0x274000,0x62e80,0x141b00,0x40815800,0x40000280,0x3f000000,63,63,63,0x28d80,0x4d600,7,10,0xbe800000,3,1,0xffffffff,0xffffffff,0x2e000,0x274000,0x6ffc00,0xf2c000,0
.long 12,52,63,0x6ac00,0x1a00a,0xfc8000,0xfc8400,0x10cf000,0x10cf400,0x274c00,0x6ae80,0x145b00,0x40816300,0x40000280,0x3f000000,63,63,63,0x2ad80,0x4d680,327,10,0xbe800000,3,1,0xffffffff,0xffffffff,0x2e800,0x275000,0x700700,0xf3b000,0
.long 12,52,66,0x6ac00,0x1a012,0xfc8800,0xfd7000,0x110a400,0x110a800,0x275800,0x72e80,0x161b00,0x40815800,0x40000280,0x3f000000,63,63,63,0x2cd80,0x4d700,25,10,0xbe800000,3,0x80008000,0xffffffff,0xffffffff,0x2f000,0x276000,0x701200,0xf4a000,0
.long 12,52,69,0x6ac00,0x1a01a,0xfd7400,0xfd7800,0x110ac00,0x110b000,0x276400,0x7ae80,0x165b00,0x40816300,0x40000280,0x3f000000,63,63,63,0x2ed80,0x4d780,345,10,0xbe800000,3,0x80008000,0xffffffff,0xffffffff,0x2f800,0x277000,0x701d00,0xf59000,0
.long 12,52,60,0x73000,0x1a002,0xe06c00,0xe07000,0x110b400,0x1146400,0x294000,0x63280,0x142300,0x40820800,0x40000280,0x3f000000,63,63,63,0x29180,0x4d800,9,10,0xbe800000,3,1,0xffffffff,0xffffffff,0x32000,0x294000,0x715c00,0xf2c000,0
.long 12,52,63,0x73000,0x1a00a,0xe07400,0xe15c00,0x1146800,0x1146c00,0x294c00,0x6b280,0x146300,0x40821300,0x40000280,0x3f000000,63,63,63,0x2b180,0x4d880,329,10,0xbe800000,3,1,0xffffffff,0xffffffff,0x32800,0x295000,0x716700,0xf3b000,0
.long 12,52,66,0x73000,0x1a012,0xe16000,0xe16400,0x1147000,0x1147400,0x295800,0x73280,0x162300,0x40820800,0x40000280,0x3f000000,63,63,63,0x2d180,0x4d900,23,10,0xbe800000,3,0x80008000,0xffffffff,0xffffffff,0x33000,0x296000,0x717200,0xf4a000,0
.long 12,52,69,0x73000,0x1a01a,0xe24c00,0xe25000,0x1182400,0x1182800,0x296400,0x7b280,0x166300,0x40821300,0x40000280,0x3f000000,63,63,63,0x2f180,0x4d980,343,10,0xbe800000,3,0x80008000,0xffffffff,0xffffffff,0x33800,0x297000,0x717d00,0xf59000,0
.long 12,52,60,0x73400,0x1a002,0xe25400,0xe33c00,0x1182c00,0x1183000,0x2b4000,0x63680,0x142b00,0x40770800,0x40000280,0x3f000000,63,63,63,0x29580,0x4da00,11,10,0xbe800000,3,1,0xffffffff,0xffffffff,0x36000,0x2b4000,0x72bc00,0xf2c000,0
.long 12,52,63,0x73400,0x1a00a,0xe34000,0xe34400,0x1183400,0x11be400,0x2b4c00,0x6b680,0x146b00,0x40771300,0x40000280,0x3f000000,63,63,63,0x2b580,0x4da80,331,10,0xbe800000,3,1,0xffffffff,0xffffffff,0x36800,0x2b5000,0x72c700,0xf3b000,0
.long 12,52,66,0x73400,0x1a012,0xe42c00,0xe43000,0x11be800,0x11bec00,0x2b5800,0x73680,0x162b00,0x40770800,0x40000280,0x3f000000,63,63,63,0x2d580,0x4db00,21,10,0xbe800000,3,0x80008000,0xffffffff,0xffffffff,0x37000,0x2b6000,0x72d200,0xf4a000,0
.long 12,52,69,0x73400,0x1a01a,0xe43400,0xe51c00,0x11bf000,0x11bf400,0x2b6400,0x7b680,0x166b00,0x40771300,0x40000280,0x3f000000,63,63,63,0x2f580,0x4db80,341,10,0xbe800000,3,0x80008000,0xffffffff,0xffffffff,0x37800,0x2b7000,0x72dd00,0xf59000,0
.long 12,52,60,0x7b800,0x1a002,0xe52000,0xe52400,0x101b800,0x101bc00,0x2d4000,0x63a80,0x143300,0x406c0800,0x40000280,0x3f000000,63,63,63,0x29980,0x4dc00,13,10,0xbe800000,3,1,0xffffffff,0xffffffff,0x3a000,0x2d4000,0x741c00,0xf2c000,0
.long 12,52,63,0x7b800,0x1a00a,0xe60c00,0xe61000,0x101c000,0x101c400,0x2d4c00,0x6ba80,0x147300,0x406c1300,0x40000280,0x3f000000,63,63,63,0x2b980,0x4dc80,333,10,0xbe800000,3,1,0xffffffff,0xffffffff,0x3a800,0x2d5000,0x742700,0xf3b000,0
.long 12,52,66,0x7b800,0x1a012,0xe61400,0xe6fc00,0x101c800,0x1057800,0x2d5800,0x73a80,0x163300,0x406c0800,0x40000280,0x3f000000,63,63,63,0x2d980,0x4dd00,19,10,0xbe800000,3,0x80008000,0xffffffff,0xffffffff,0x3b000,0x2d6000,0x743200,0xf4a000,0
.long 12,52,69,0x7b800,0x1a01a,0xe70000,0xe70400,0x1057c00,0x1058000,0x2d6400,0x7ba80,0x167300,0x406c1300,0x40000280,0x3f000000,63,63,63,0x2f980,0x4dd80,339,10,0xbe800000,3,0x80008000,0xffffffff,0xffffffff,0x3b800,0x2d7000,0x743d00,0xf59000,0
.long 12,52,60,0x7bc00,0x1a002,0xe7ec00,0xe7f000,0x1058400,0x1058800,0x2f4000,0x63e80,0x143b00,0x40610800,0x40000280,0x3f000000,63,63,63,0x29d80,0x4de00,15,10,0xbe800000,3,1,0xffffffff,0xffffffff,0x3e000,0x2f4000,0x757c00,0xf2c000,0
.long 12,52,63,0x7bc00,0x1a00a,0xe7f400,0xe8dc00,0x1093800,0x1093c00,0x2f4c00,0x6be80,0x147b00,0x40611300,0x40000280,0x3f000000,63,63,63,0x2bd80,0x4de80,335,10,0xbe800000,3,1,0xffffffff,0xffffffff,0x3e800,0x2f5000,0x758700,0xf3b000,0
.long 12,52,66,0x7bc00,0x1a012,0xe8e000,0xe8e400,0x1094000,0x1094400,0x2f5800,0x73e80,0x163b00,0x40610800,0x40000280,0x3f000000,63,63,63,0x2dd80,0x4df00,17,10,0xbe800000,3,0x80008000,0xffffffff,0xffffffff,0x3f000,0x2f6000,0x759200,0xf4a000,0
.long 12,52,69,0x7bc00,0x1a01a,0xe9cc00,0xe9d000,0x1094800,0x10cf800,0x2f6400,0x7be80,0x167b00,0x40611300,0x40000280,0x3f000000,63,63,63,0x2fd80,0x4df80,337,10,0xbe800000,3,0x80008000,0xffffffff,0xffffffff,0x3f800,0x2f7000,0x759d00,0xf59000,0
.long 14,50,72,0x62000,0x1a002,0xe9d400,0xeabc00,0x10cfc00,0x10d0000,0x218000,0x62300,0x180300,0x40605800,0x40000280,0x3f000000,63,63,63,0x30180,0x4e000,0,10,0xbe800000,3,0,0xffffffff,0,0x20000,0x218000,0x6c0800,0xf68000,0
.long 14,50,75,0x62000,0x1a00a,0xeac000,0xeac400,0x10d0400,0x10d0800,0x218c00,0x6a300,0x184300,0x40606300,0x40000280,0x3f000000,63,63,63,0x32180,0x4e080,320,10,0xbe800000,3,0,0xffffffff,0,0x20800,0x219000,0x6c1300,0xf77000,0
.long 14,50,78,0x62000,0x1a012,0xebac00,0xebb000,0x110b800,0x110bc00,0x219800,0x72300,0x1a0300,0x40605800,0x40000280,0x3f000000,63,63,63,0x34180,0x4e100,16,10,0xbe800000,3,0,0,0xffffffff,0x21000,0x21a000,0x6c1e00,0xf86000,0
.long 14,50,81,0x62000,0x1a01a,0xebb400,0xec9c00,0x110c000,0x110c400,0x21a400,0x7a300,0x1a4300,0x40606300,0x40000280,0x3f000000,63,63,63,0x36180,0x4e180,336,10,0xbe800000,3,0,0,0xffffffff,0x21800,0x21b000,0x6c2900,0xf95000,0
.long 14,50,72,0x62400,0x1a002,0xeca000,0xeca400,0x110c800,0x1147800,0x238000,0x62700,0x180b00,0x406b5800,0x40000280,0x3f000000,63,63,63,0x30580,0x4e200,2,10,0xbe800000,3,1,0xffffffff,0xffffffff,0x24000,0x238000,0x6d6800,0xf68000,0
.long 14,50,75,0x62400,0x1a00a,0xed8c00,0xed9000,0x1147c00,0x1148000,0x238c00,0x6a700,0x184b00,0x406b6300,0x40000280,0x3f000000,63,63,63,0x32580,0x4e280,322,10,0xbe800000,3,1,0xffffffff,0xffffffff,0x24800,0x239000,0x6d7300,0xf77000,0
.long 14,50,78,0x62400,0x1a012,0xed9400,0xee7c00,0x1148400,0x1148800,0x239800,0x72700,0x1a0b00,0x406b5800,0x40000280,0x3f000000,63,63,63,0x34580,0x4e300,30,10,0xbe800000,3,0x80008000,0xffffffff,0xffffffff,0x25000,0x23a000,0x6d7e00,0xf86000,0
.long 14,50,81,0x62400,0x1a01a,0xee8000,0xee8400,0x1183800,0x1183c00,0x23a400,0x7a700,0x1a4b00,0x406b6300,0x40000280,0x3f000000,63,63,63,0x36580,0x4e380,350,10,0xbe800000,3,0x80008000,0xffffffff,0xffffffff,0x25800,0x23b000,0x6d8900,0xf95000,0
.long 14,50,72,0x6a800,0x1a002,0xef6c00,0xef7000,0x1184000,0x1184400,0x258000,0x62b00,0x181300,0x40765800,0x40000280,0x3f000000,63,63,63,0x30980,0x4e400,4,10,0xbe800000,3,1,0xffffffff,0xffffffff,0x28000,0x258000,0x6ec800,0xf68000,0
.long 14,50,75,0x6a800,0x1a00a,0xef7400,0xf05c00,0x1184800,0x11bf800,0x258c00,0x6ab00,0x185300,0x40766300,0x40000280,0x3f000000,63,63,63,0x32980,0x4e480,324,10,0xbe800000,3,1,0xffffffff,0xffffffff,0x28800,0x259000,0x6ed300,0xf77000,0
.long 14,50,78,0x6a800,0x1a012,0xf06000,0xf06400,0x11bfc00,0x11c0000,0x259800,0x72b00,0x1a1300,0x40765800,0x40000280,0x3f000000,63,63,63,0x34980,0x4e500,28,10,0xbe800000,3,0x80008000,0xffffffff,0xffffffff,0x29000,0x25a000,0x6ede00,0xf86000,0
.long 14,50,81,0x6a800,0x1a01a,0xf14c00,0xf15000,0x11c0400,0x11c0800,0x25a400,0x7ab00,0x1a5300,0x40766300,0x40000280,0x3f000000,63,63,63,0x36980,0x4e580,348,10,0xbe800000,3,0x80008000,0xffffffff,0xffffffff,0x29800,0x25b000,0x6ee900,0xf95000,0
.long 14,50,72,0x6ac00,0x1a002,0xf15400,0xf23c00,0x101cc00,0x101d000,0x278000,0x62f00,0x181b00,0x40815800,0x40000280,0x3f000000,63,63,63,0x30d80,0x4e600,6,10,0xbe800000,3,1,0xffffffff,0xffffffff,0x2c000,0x278000,0x702800,0xf68000,0
.long 14,50,75,0x6ac00,0x1a00a,0xf24000,0xf24400,0x101d400,0x101d800,0x278c00,0x6af00,0x185b00,0x40816300,0x40000280,0x3f000000,63,63,63,0x32d80,0x4e680,326,10,0xbe800000,3,1,0xffffffff,0xffffffff,0x2c800,0x279000,0x703300,0xf77000,0
.long 14,50,78,0x6ac00,0x1a012,0xf32c00,0xf33000,0x101dc00,0x1058c00,0x279800,0x72f00,0x1a1b00,0x40815800,0x40000280,0x3f000000,63,63,63,0x34d80,0x4e700,26,10,0xbe800000,3,0x80008000,0xffffffff,0xffffffff,0x2d000,0x27a000,0x703e00,0xf86000,0
.long 14,50,81,0x6ac00,0x1a01a,0xf33400,0xf41c00,0x1059000,0x1059400,0x27a400,0x7af00,0x1a5b00,0x40816300,0x40000280,0x3f000000,63,63,63,0x36d80,0x4e780,346,10,0xbe800000,3,0x80008000,0xffffffff,0xffffffff,0x2d800,0x27b000,0x704900,0xf95000,0
.long 14,50,72,0x73000,0x1a002,0xf42000,0xf42400,0x1059800,0x1059c00,0x298000,0x63300,0x182300,0x40820800,0x40000280,0x3f000000,63,63,63,0x31180,0x4e800,8,10,0xbe800000,3,1,0xffffffff,0xffffffff,0x30000,0x298000,0x718800,0xf68000,0
.long 14,50,75,0x73000,0x1a00a,0xf50c00,0xf51000,0x1094c00,0x1095000,0x298c00,0x6b300,0x186300,0x40821300,0x40000280,0x3f000000,63,63,63,0x33180,0x4e880,328,10,0xbe800000,3,1,0xffffffff,0xffffffff,0x30800,0x299000,0x719300,0xf77000,0
.long 14,50,78,0x73000,0x1a012,0xf51400,0xf5fc00,0x1095400,0x1095800,0x299800,0x73300,0x1a2300,0x40820800,0x40000280,0x3f000000,63,63,63,0x35180,0x4e900,24,10,0xbe800000,3,0x80008000,0xffffffff,0xffffffff,0x31000,0x29a000,0x719e00,0xf86000,0
.long 14,50,81,0x73000,0x1a01a,0xf60000,0xf60400,0x1095c00,0x10d0c00,0x29a400,0x7b300,0x1a6300,0x40821300,0x40000280,0x3f000000,63,63,63,0x37180,0x4e980,344,10,0xbe800000,3,0x80008000,0xffffffff,0xffffffff,0x31800,0x29b000,0x71a900,0xf95000,0
.long 14,50,72,0x73400,0x1a002,0xf6ec00,0xf6f000,0x10d1000,0x10d1400,0x2b8000,0x63700,0x182b00,0x40770800,0x40000280,0x3f000000,63,63,63,0x31580,0x4ea00,10,10,0xbe800000,3,1,0xffffffff,0xffffffff,0x34000,0x2b8000,0x72e800,0xf68000,0
.long 14,50,75,0x73400,0x1a00a,0xf6f400,0xf7dc00,0x10d1800,0x10d1c00,0x2b8c00,0x6b700,0x186b00,0x40771300,0x40000280,0x3f000000,63,63,63,0x33580,0x4ea80,330,10,0xbe800000,3,1,0xffffffff,0xffffffff,0x34800,0x2b9000,0x72f300,0xf77000,0
.long 14,50,78,0x73400,0x1a012,0xf7e000,0xf7e400,0x110cc00,0x110d000,0x2b9800,0x73700,0x1a2b00,0x40770800,0x40000280,0x3f000000,63,63,63,0x35580,0x4eb00,22,10,0xbe800000,3,0x80008000,0xffffffff,0xffffffff,0x35000,0x2ba000,0x72fe00,0xf86000,0
.long 14,50,81,0x73400,0x1a01a,0xf8cc00,0xf8d000,0x110d400,0x110d800,0x2ba400,0x7b700,0x1a6b00,0x40771300,0x40000280,0x3f000000,63,63,63,0x37580,0x4eb80,342,10,0xbe800000,3,0x80008000,0xffffffff,0xffffffff,0x35800,0x2bb000,0x730900,0xf95000,0
.long 14,50,72,0x7b800,0x1a002,0xf8d400,0xf9bc00,0x110dc00,0x1148c00,0x2d8000,0x63b00,0x183300,0x406c0800,0x40000280,0x3f000000,63,63,63,0x31980,0x4ec00,12,10,0xbe800000,3,1,0xffffffff,0xffffffff,0x38000,0x2d8000,0x744800,0xf68000,0
.long 14,50,75,0x7b800,0x1a00a,0xf9c000,0xf9c400,0x1149000,0x1149400,0x2d8c00,0x6bb00,0x187300,0x406c1300,0x40000280,0x3f000000,63,63,63,0x33980,0x4ec80,332,10,0xbe800000,3,1,0xffffffff,0xffffffff,0x38800,0x2d9000,0x745300,0xf77000,0
.long 14,50,78,0x7b800,0x1a012,0xfaac00,0xfab000,0x1149800,0x1149c00,0x2d9800,0x73b00,0x1a3300,0x406c0800,0x40000280,0x3f000000,63,63,63,0x35980,0x4ed00,20,10,0xbe800000,3,0x80008000,0xffffffff,0xffffffff,0x39000,0x2da000,0x745e00,0xf86000,0
.long 14,50,81,0x7b800,0x1a01a,0xfab400,0xfb9c00,0x1184c00,0x1185000,0x2da400,0x7bb00,0x1a7300,0x406c1300,0x40000280,0x3f000000,63,63,63,0x37980,0x4ed80,340,10,0xbe800000,3,0x80008000,0xffffffff,0xffffffff,0x39800,0x2db000,0x746900,0xf95000,0
.long 14,50,72,0x7bc00,0x1a002,0xfba000,0xfba400,0x1185400,0x1185800,0x2f8000,0x63f00,0x183b00,0x40610800,0x40000280,0x3f000000,63,63,63,0x31d80,0x4ee00,14,10,0xbe800000,3,1,0xffffffff,0xffffffff,0x3c000,0x2f8000,0x75a800,0xf68000,0
.long 14,50,75,0x7bc00,0x1a00a,0xfc8c00,0xfc9000,0x1185c00,0x11c0c00,0x2f8c00,0x6bf00,0x187b00,0x40611300,0x40000280,0x3f000000,63,63,63,0x33d80,0x4ee80,334,10,0xbe800000,3,1,0xffffffff,0xffffffff,0x3c800,0x2f9000,0x75b300,0xf77000,0
.long 14,50,78,0x7bc00,0x1a012,0xfc9400,0xfd7c00,0x11c1000,0x11c1400,0x2f9800,0x73f00,0x1a3b00,0x40610800,0x40000280,0x3f000000,63,63,63,0x35d80,0x4ef00,18,10,0xbe800000,3,0x80008000,0xffffffff,0xffffffff,0x3d000,0x2fa000,0x75be00,0xf86000,0
.long 14,50,81,0x7bc00,0x1a01a,0xfd8000,0xfd8400,0x11c1800,0x11c1c00,0x2fa400,0x7bf00,0x1a7b00,0x40611300,0x40000280,0x3f000000,63,63,63,0x37d80,0x4ef80,338,10,0xbe800000,3,0x80008000,0xffffffff,0xffffffff,0x3d800,0x2fb000,0x75c900,0xf95000,0
.long 14,50,84,0x62000,0x1a002,0xe07800,0xe07c00,0x101e000,0x101e400,0x21c000,0x62380,0x1c0300,0x40605800,0x40000280,0x3f000000,63,63,63,0x38180,0x4f000,1,10,0xbe800000,3,1,0xffffffff,0xffffffff,0x22000,0x21c000,0x6c3400,0xfa4000,0
.long 14,50,87,0x62000,0x1a00a,0xe08000,0xe16800,0x101e800,0x101ec00,0x21cc00,0x6a380,0x1c4300,0x40606300,0x40000280,0x3f000000,63,63,63,0x3a180,0x4f080,321,10,0xbe800000,3,1,0xffffffff,0xffffffff,0x22800,0x21d000,0x6c3f00,0xfb3000,0
.long 14,50,90,0x62000,0x1a012,0xe16c00,0xe17000,0x101f000,0x105a000,0x21d800,0x72380,0x1e0300,0x40605800,0x40000280,0x3f000000,63,63,63,0x3c180,0x4f100,31,10,0xbe800000,3,0x80008000,0xffffffff,0xffffffff,0x23000,0x21e000,0x6c4a00,0xfc2000,0
.long 14,50,93,0x62000,0x1a01a,0xe25800,0xe25c00,0x105a400,0x105a800,0x21e400,0x7a380,0x1e4300,0x40606300,0x40000280,0x3f000000,63,63,63,0x3e180,0x4f180,351,10,0xbe800000,3,0x80008000,0xffffffff,0xffffffff,0x23800,0x21f000,0x6c5500,0xfd1000,0
.long 14,50,84,0x62400,0x1a002,0xe26000,0xe34800,0x105ac00,0x105b000,0x23c000,0x62780,0x1c0b00,0x406b5800,0x40000280,0x3f000000,63,63,63,0x38580,0x4f200,3,10,0xbe800000,3,1,0xffffffff,0xffffffff,0x26000,0x23c000,0x6d9400,0xfa4000,0
.long 14,50,87,0x62400,0x1a00a,0xe34c00,0xe35000,0x1096000,0x1096400,0x23cc00,0x6a780,0x1c4b00,0x406b6300,0x40000280,0x3f000000,63,63,63,0x3a580,0x4f280,323,10,0xbe800000,3,1,0xffffffff,0xffffffff,0x26800,0x23d000,0x6d9f00,0xfb3000,0
.long 14,50,90,0x62400,0x1a012,0xe43800,0xe43c00,0x1096800,0x1096c00,0x23d800,0x72780,0x1e0b00,0x406b5800,0x40000280,0x3f000000,63,63,63,0x3c580,0x4f300,29,10,0xbe800000,3,0x80008000,0xffffffff,0xffffffff,0x27000,0x23e000,0x6daa00,0xfc2000,0
.long 14,50,93,0x62400,0x1a01a,0xe44000,0xe52800,0x1097000,0x10d2000,0x23e400,0x7a780,0x1e4b00,0x406b6300,0x40000280,0x3f000000,63,63,63,0x3e580,0x4f380,349,10,0xbe800000,3,0x80008000,0xffffffff,0xffffffff,0x27800,0x23f000,0x6db500,0xfd1000,0
.long 14,50,84,0x6a800,0x1a002,0xe52c00,0xe53000,0x10d2400,0x10d2800,0x25c000,0x62b80,0x1c1300,0x40765800,0x40000280,0x3f000000,63,63,63,0x38980,0x4f400,5,10,0xbe800000,3,1,0xffffffff,0xffffffff,0x2a000,0x25c000,0x6ef400,0xfa4000,0
.long 14,50,87,0x6a800,0x1a00a,0xe61800,0xe61c00,0x10d2c00,0x10d3000,0x25cc00,0x6ab80,0x1c5300,0x40766300,0x40000280,0x3f000000,63,63,63,0x3a980,0x4f480,325,10,0xbe800000,3,1,0xffffffff,0xffffffff,0x2a800,0x25d000,0x6eff00,0xfb3000,0
.long 14,50,90,0x6a800,0x1a012,0xe62000,0xe70800,0x110e000,0x110e400,0x25d800,0x72b80,0x1e1300,0x40765800,0x40000280,0x3f000000,63,63,63,0x3c980,0x4f500,27,10,0xbe800000,3,0x80008000,0xffffffff,0xffffffff,0x2b000,0x25e000,0x6f0a00,0xfc2000,0
.long 14,50,93,0x6a800,0x1a01a,0xe70c00,0xe71000,0x110e800,0x110ec00,0x25e400,0x7ab80,0x1e5300,0x40766300,0x40000280,0x3f000000,63,63,63,0x3e980,0x4f580,347,10,0xbe800000,3,0x80008000,0xffffffff,0xffffffff,0x2b800,0x25f000,0x6f1500,0xfd1000,0
.long 14,50,84,0x6ac00,0x1a002,0xe7f800,0xe7fc00,0x110f000,0x114a000,0x27c000,0x62f80,0x1c1b00,0x40815800,0x40000280,0x3f000000,63,63,63,0x38d80,0x4f600,7,10,0xbe800000,3,1,0xffffffff,0xffffffff,0x2e000,0x27c000,0x705400,0xfa4000,0
.long 14,50,87,0x6ac00,0x1a00a,0xe80000,0xe8e800,0x114a400,0x114a800,0x27cc00,0x6af80,0x1c5b00,0x40816300,0x40000280,0x3f000000,63,63,63,0x3ad80,0x4f680,327,10,0xbe800000,3,1,0xffffffff,0xffffffff,0x2e800,0x27d000,0x705f00,0xfb3000,0
.long 14,50,90,0x6ac00,0x1a012,0xe8ec00,0xe8f000,0x114ac00,0x114b000,0x27d800,0x72f80,0x1e1b00,0x40815800,0x40000280,0x3f000000,63,63,63,0x3cd80,0x4f700,25,10,0xbe800000,3,0x80008000,0xffffffff,0xffffffff,0x2f000,0x27e000,0x706a00,0xfc2000,0
.long 14,50,93,0x6ac00,0x1a01a,0xe9d800,0xe9dc00,0x1186000,0x1186400,0x27e400,0x7af80,0x1e5b00,0x40816300,0x40000280,0x3f000000,63,63,63,0x3ed80,0x4f780,345,10,0xbe800000,3,0x80008000,0xffffffff,0xffffffff,0x2f800,0x27f000,0x707500,0xfd1000,0
.long 14,50,84,0x73000,0x1a002,0xe9e000,0xeac800,0x1186800,0x1186c00,0x29c000,0x63380,0x1c2300,0x40820800,0x40000280,0x3f000000,63,63,63,0x39180,0x4f800,9,10,0xbe800000,3,1,0xffffffff,0xffffffff,0x32000,0x29c000,0x71b400,0xfa4000,0
.long 14,50,87,0x73000,0x1a00a,0xeacc00,0xead000,0x1187000,0x11c2000,0x29cc00,0x6b380,0x1c6300,0x40821300,0x40000280,0x3f000000,63,63,63,0x3b180,0x4f880,329,10,0xbe800000,3,1,0xffffffff,0xffffffff,0x32800,0x29d000,0x71bf00,0xfb3000,0
.long 14,50,90,0x73000,0x1a012,0xebb800,0xebbc00,0x11c2400,0x11c2800,0x29d800,0x73380,0x1e2300,0x40820800,0x40000280,0x3f000000,63,63,63,0x3d180,0x4f900,23,10,0xbe800000,3,0x80008000,0xffffffff,0xffffffff,0x33000,0x29e000,0x71ca00,0xfc2000,0
.long 14,50,93,0x73000,0x1a01a,0xebc000,0xeca800,0x11c2c00,0x11c3000,0x29e400,0x7b380,0x1e6300,0x40821300,0x40000280,0x3f000000,63,63,63,0x3f180,0x4f980,343,10,0xbe800000,3,0x80008000,0xffffffff,0xffffffff,0x33800,0x29f000,0x71d500,0xfd1000,0
.long 14,50,84,0x73400,0x1a002,0xecac00,0xecb000,0x101f400,0x101f800,0x2bc000,0x63780,0x1c2b00,0x40770800,0x40000280,0x3f000000,63,63,63,0x39580,0x4fa00,11,10,0xbe800000,3,1,0xffffffff,0xffffffff,0x36000,0x2bc000,0x731400,0xfa4000,0
.long 14,50,87,0x73400,0x1a00a,0xed9800,0xed9c00,0x101fc00,0x1020000,0x2bcc00,0x6b780,0x1c6b00,0x40771300,0x40000280,0x3f000000,63,63,63,0x3b580,0x4fa80,331,10,0xbe800000,3,1,0xffffffff,0xffffffff,0x36800,0x2bd000,0x731f00,0xfb3000,0
.long 14,50,90,0x73400,0x1a012,0xeda000,0xee8800,0x1020400,0x105b400,0x2bd800,0x73780,0x1e2b00,0x40770800,0x40000280,0x3f000000,63,63,63,0x3d580,0x4fb00,21,10,0xbe800000,3,0x80008000,0xffffffff,0xffffffff,0x37000,0x2be000,0x732a00,0xfc2000,0
.long 14,50,93,0x73400,0x1a01a,0xee8c00,0xee9000,0x105b800,0x105bc00,0x2be400,0x7b780,0x1e6b00,0x40771300,0x40000280,0x3f000000,63,63,63,0x3f580,0x4fb80,341,10,0xbe800000,3,0x80008000,0xffffffff,0xffffffff,0x37800,0x2bf000,0x733500,0xfd1000,0
.long 14,50,84,0x7b800,0x1a002,0xef7800,0xef7c00,0x105c000,0x105c400,0x2dc000,0x63b80,0x1c3300,0x406c0800,0x40000280,0x3f000000,63,63,63,0x39980,0x4fc00,13,10,0xbe800000,3,1,0xffffffff,0xffffffff,0x3a000,0x2dc000,0x747400,0xfa4000,0
.long 14,50,87,0x7b800,0x1a00a,0xef8000,0xf06800,0x1097400,0x1097800,0x2dcc00,0x6bb80,0x1c7300,0x406c1300,0x40000280,0x3f000000,63,63,63,0x3b980,0x4fc80,333,10,0xbe800000,3,1,0xffffffff,0xffffffff,0x3a800,0x2dd000,0x747f00,0xfb3000,0
.long 14,50,90,0x7b800,0x1a012,0xf06c00,0xf07000,0x1097c00,0x1098000,0x2dd800,0x73b80,0x1e3300,0x406c0800,0x40000280,0x3f000000,63,63,63,0x3d980,0x4fd00,19,10,0xbe800000,3,0x80008000,0xffffffff,0xffffffff,0x3b000,0x2de000,0x748a00,0xfc2000,0
.long 14,50,93,0x7b800,0x1a01a,0xf15800,0xf15c00,0x1098400,0x10d3400,0x2de400,0x7bb80,0x1e7300,0x406c1300,0x40000280,0x3f000000,63,63,63,0x3f980,0x4fd80,339,10,0xbe800000,3,0x80008000,0xffffffff,0xffffffff,0x3b800,0x2df000,0x749500,0xfd1000,0
.long 14,50,84,0x7bc00,0x1a002,0xf16000,0xf24800,0x10d3800,0x10d3c00,0x2fc000,0x63f80,0x1c3b00,0x40610800,0x40000280,0x3f000000,63,63,63,0x39d80,0x4fe00,15,10,0xbe800000,3,1,0xffffffff,0xffffffff,0x3e000,0x2fc000,0x75d400,0xfa4000,0
.long 14,50,87,0x7bc00,0x1a00a,0xf24c00,0xf25000,0x10d4000,0x10d4400,0x2fcc00,0x6bf80,0x1c7b00,0x40611300,0x40000280,0x3f000000,63,63,63,0x3bd80,0x4fe80,335,10,0xbe800000,3,1,0xffffffff,0xffffffff,0x3e800,0x2fd000,0x75df00,0xfb3000,0
.long 14,50,90,0x7bc00,0x1a012,0xf33800,0xf33c00,0x110f400,0x110f800,0x2fd800,0x73f80,0x1e3b00,0x40610800,0x40000280,0x3f000000,63,63,63,0x3dd80,0x4ff00,17,10,0xbe800000,3,0x80008000,0xffffffff,0xffffffff,0x3f000,0x2fe000,0x75ea00,0xfc2000,0
.long 14,50,93,0x7bc00,0x1a01a,0xf34000,0xf42800,0x110fc00,0x1110000,0x2fe400,0x7bf80,0x1e7b00,0x40611300,0x40000280,0x3f000000,63,63,63,0x3fd80,0x4ff80,337,10,0xbe800000,3,0x80008000,0xffffffff,0xffffffff,0x3f800,0x2ff000,0x75f500,0xfd1000,0
.long 16,48,0,0x64000,0x1a000,0xf42c00,0xf43000,0x1110400,0x114b400,0x300000,0x64000,0x100400,0x4060b000,0x40000280,0x3f000000,63,63,63,0x20200,0x50000,0,10,0xbe800000,3,0,0xffffffff,0,0x20000,0x300000,0x760000,0xe00000,0
.long 16,48,3,0x64000,0x1a008,0xf51800,0xf51c00,0x114b800,0x114bc00,0x300c00,0x6c000,0x104400,0x4060bb00,0x40000280,0x3f000000,63,63,63,0x22200,0x50080,320,10,0xbe800000,3,0,0xffffffff,0,0x20800,0x301000,0x760b00,0xe0f000,0
.long 16,48,6,0x64000,0x1a010,0xf52000,0xf60800,0x114c000,0x114c400,0x301800,0x74000,0x120400,0x60b000,0x40000280,0x3f000000,63,63,63,0x24200,0x50100,16,10,0xbe800000,3,0,0,0xffffffff,0x21000,0x302000,0x761600,0xe1e000,0
.long 16,48,9,0x64000,0x1a018,0xf60c00,0xf61000,0x1187400,0x1187800,0x302400,0x7c000,0x124400,0x60bb00,640,0x3f000000,63,63,63,0x26200,0x50180,336,10,0xbe800000,3,0,0,0xffffffff,0x21800,0x303000,0x762100,0xe2d000,0
.long 16,48,0,0x64400,0x1a000,0xf6f800,0xf6fc00,0x1187c00,0x1188000,0x320000,0x64400,0x100c00,0x406bb000,0x40000280,0x3f000000,63,63,63,0x20600,0x50200,2,10,0xbe800000,3,1,0xffffffff,0xffffffff,0x24000,0x320000,0x776000,0xe00000,0
.long 16,48,3,0x64400,0x1a008,0xf70000,0xf7e800,0x1188400,0x11c3400,0x320c00,0x6c400,0x104c00,0x406bbb00,0x40000280,0x3f000000,63,63,63,0x22600,0x50280,322,10,0xbe800000,3,1,0xffffffff,0xffffffff,0x24800,0x321000,0x776b00,0xe0f000,0
.long 16,48,6,0x64400,0x1a010,0xf7ec00,0xf7f000,0x11c3800,0x11c3c00,0x321800,0x74400,0x120c00,0x6bb000,0x40000280,0x3f000000,63,63,63,0x24600,0x50300,30,10,0xbe800000,3,0x80008000,0xffffffff,0xffffffff,0x25000,0x322000,0x777600,0xe1e000,0
.long 16,48,9,0x64400,0x1a018,0xf8d800,0xf8dc00,0x11c4000,0x11c4400,0x322400,0x7c400,0x124c00,0x6bbb00,640,0x3f000000,63,63,63,0x26600,0x50380,350,10,0xbe800000,3,0x80008000,0xffffffff,0xffffffff,0x25800,0x323000,0x778100,0xe2d000,0
.long 16,48,0,0x6c800,0x1a000,0xf8e000,0xf9c800,0x1020800,0x1020c00,0x340000,0x64800,0x101400,0x4076b000,0x40000280,0x3f000000,63,63,63,0x20a00,0x50400,4,10,0xbe800000,3,1,0xffffffff,0xffffffff,0x28000,0x340000,0x78c000,0xe00000,0
.long 16,48,3,0x6c800,0x1a008,0xf9cc00,0xf9d000,0x1021000,0x1021400,0x340c00,0x6c800,0x105400,0x4076bb00,0x40000280,0x3f000000,63,63,63,0x22a00,0x50480,324,10,0xbe800000,3,1,0xffffffff,0xffffffff,0x28800,0x341000,0x78cb00,0xe0f000,0
.long 16,48,6,0x6c800,0x1a010,0xfab800,0xfabc00,0x1021800,0x105c800,0x341800,0x74800,0x121400,0x76b000,0x40000280,0x3f000000,63,63,63,0x24a00,0x50500,28,10,0xbe800000,3,0x80008000,0xffffffff,0xffffffff,0x29000,0x342000,0x78d600,0xe1e000,0
.long 16,48,9,0x6c800,0x1a018,0xfac000,0xfba800,0x105cc00,0x105d000,0x342400,0x7c800,0x125400,0x76bb00,640,0x3f000000,63,63,63,0x26a00,0x50580,348,10,0xbe800000,3,0x80008000,0xffffffff,0xffffffff,0x29800,0x343000,0x78e100,0xe2d000,0
.long 16,48,0,0x6cc00,0x1a000,0xfbac00,0xfbb000,0x105d400,0x105d800,0x360000,0x64c00,0x101c00,0x4081b000,0x40000280,0x3f000000,63,63,63,0x20e00,0x50600,6,10,0xbe800000,3,1,0xffffffff,0xffffffff,0x2c000,0x360000,0x7a2000,0xe00000,0
.long 16,48,3,0x6cc00,0x1a008,0xfc9800,0xfc9c00,0x1098800,0x1098c00,0x360c00,0x6cc00,0x105c00,0x4081bb00,0x40000280,0x3f000000,63,63,63,0x22e00,0x50680,326,10,0xbe800000,3,1,0xffffffff,0xffffffff,0x2c800,0x361000,0x7a2b00,0xe0f000,0
.long 16,48,6,0x6cc00,0x1a010,0xfca000,0xfd8800,0x1099000,0x1099400,0x361800,0x74c00,0x121c00,0x81b000,0x40000280,0x3f000000,63,63,63,0x24e00,0x50700,26,10,0xbe800000,3,0x80008000,0xffffffff,0xffffffff,0x2d000,0x362000,0x7a3600,0xe1e000,0
.long 16,48,9,0x6cc00,0x1a018,0xfd8c00,0xfd9000,0x1099800,0x10d4800,0x362400,0x7cc00,0x125c00,0x81bb00,640,0x3f000000,63,63,63,0x26e00,0x50780,346,10,0xbe800000,3,0x80008000,0xffffffff,0xffffffff,0x2d800,0x363000,0x7a4100,0xe2d000,0
.long 16,48,0,0x75000,0x1a000,0xe08400,0xe08800,0x10d4c00,0x10d5000,0x380000,0x65000,0x102400,0x4081b000,0x40000280,0x3f000000,63,63,63,0x21200,0x50800,8,10,0xbe800000,3,1,0xffffffff,0xffffffff,0x30000,0x380000,0x7b8000,0xe00000,0
.long 16,48,3,0x75000,0x1a008,0xe08c00,0xe17400,0x10d5400,0x10d5800,0x380c00,0x6d000,0x106400,0x4081bb00,0x40000280,0x3f000000,63,63,63,0x23200,0x50880,328,10,0xbe800000,3,1,0xffffffff,0xffffffff,0x30800,0x381000,0x7b8b00,0xe0f000,0
.long 16,48,6,0x75000,0x1a010,0xe17800,0xe17c00,0x1110800,0x1110c00,0x381800,0x75000,0x122400,0x4081b000,0x40000280,0x3f000000,63,63,63,0x25200,0x50900,24,10,0xbe800000,3,0x80008000,0xffffffff,0xffffffff,0x31000,0x382000,0x7b9600,0xe1e000,0
.long 16,48,9,0x75000,0x1a018,0xe26400,0xe26800,0x1111000,0x1111400,0x382400,0x7d000,0x126400,0x4081bb00,0x40000280,0x3f000000,63,63,63,0x27200,0x50980,344,10,0xbe800000,3,0x80008000,0xffffffff,0xffffffff,0x31800,0x383000,0x7ba100,0xe2d000,0
.long 16,48,0,0x75400,0x1a000,0xe26c00,0xe35400,0x1111800,0x114c800,0x3a0000,0x65400,0x102c00,0x4076b000,0x40000280,0x3f000000,63,63,63,0x21600,0x50a00,10,10,0xbe800000,3,1,0xffffffff,0xffffffff,0x34000,0x3a0000,0x7ce000,0xe00000,0
.long 16,48,3,0x75400,0x1a008,0xe35800,0xe35c00,0x114cc00,0x114d000,0x3a0c00,0x6d400,0x106c00,0x4076bb00,0x40000280,0x3f000000,63,63,63,0x23600,0x50a80,330,10,0xbe800000,3,1,0xffffffff,0xffffffff,0x34800,0x3a1000,0x7ceb00,0xe0f000,0
.long 16,48,6,0x75400,0x1a010,0xe44400,0xe44800,0x114d400,0x114d800,0x3a1800,0x75400,0x122c00,0x4076b000,0x40000280,0x3f000000,63,63,63,0x25600,0x50b00,22,10,0xbe800000,3,0x80008000,0xffffffff,0xffffffff,0x35000,0x3a2000,0x7cf600,0xe1e000,0
.long 16,48,9,0x75400,0x1a018,0xe44c00,0xe53400,0x1188800,0x1188c00,0x3a2400,0x7d400,0x126c00,0x4076bb00,0x40000280,0x3f000000,63,63,63,0x27600,0x50b80,342,10,0xbe800000,3,0x80008000,0xffffffff,0xffffffff,0x35800,0x3a3000,0x7d0100,0xe2d000,0
.long 16,48,0,0x7d800,0x1a000,0xe53800,0xe53c00,0x1189000,0x1189400,0x3c0000,0x65800,0x103400,0x406bb000,0x40000280,0x3f000000,63,63,63,0x21a00,0x50c00,12,10,0xbe800000,3,1,0xffffffff,0xffffffff,0x38000,0x3c0000,0x7e4000,0xe00000,0
.long 16,48,3,0x7d800,0x1a008,0xe62400,0xe62800,0x1189800,0x11c4800,0x3c0c00,0x6d800,0x107400,0x406bbb00,0x40000280,0x3f000000,63,63,63,0x23a00,0x50c80,332,10,0xbe800000,3,1,0xffffffff,0xffffffff,0x38800,0x3c1000,0x7e4b00,0xe0f000,0
.long 16,48,6,0x7d800,0x1a010,0xe62c00,0xe71400,0x11c4c00,0x11c5000,0x3c1800,0x75800,0x123400,0x406bb000,0x40000280,0x3f000000,63,63,63,0x25a00,0x50d00,20,10,0xbe800000,3,0x80008000,0xffffffff,0xffffffff,0x39000,0x3c2000,0x7e5600,0xe1e000,0
.long 16,48,9,0x7d800,0x1a018,0xe71800,0xe71c00,0x11c5400,0x11c5800,0x3c2400,0x7d800,0x127400,0x406bbb00,0x40000280,0x3f000000,63,63,63,0x27a00,0x50d80,340,10,0xbe800000,3,0x80008000,0xffffffff,0xffffffff,0x39800,0x3c3000,0x7e6100,0xe2d000,0
.long 16,48,0,0x7dc00,0x1a000,0xe80400,0xe80800,0x1021c00,0x1022000,0x3e0000,0x65c00,0x103c00,0x4060b000,0x40000280,0x3f000000,63,63,63,0x21e00,0x50e00,14,10,0xbe800000,3,1,0xffffffff,0xffffffff,0x3c000,0x3e0000,0x7fa000,0xe00000,0
.long 16,48,3,0x7dc00,0x1a008,0xe80c00,0xe8f400,0x1022400,0x1022800,0x3e0c00,0x6dc00,0x107c00,0x4060bb00,0x40000280,0x3f000000,63,63,63,0x23e00,0x50e80,334,10,0xbe800000,3,1,0xffffffff,0xffffffff,0x3c800,0x3e1000,0x7fab00,0xe0f000,0
.long 16,48,6,0x7dc00,0x1a010,0xe8f800,0xe8fc00,0x1022c00,0x105dc00,0x3e1800,0x75c00,0x123c00,0x4060b000,0x40000280,0x3f000000,63,63,63,0x25e00,0x50f00,18,10,0xbe800000,3,0x80008000,0xffffffff,0xffffffff,0x3d000,0x3e2000,0x7fb600,0xe1e000,0
.long 16,48,9,0x7dc00,0x1a018,0xe9e400,0xe9e800,0x105e000,0x105e400,0x3e2400,0x7dc00,0x127c00,0x4060bb00,0x40000280,0x3f000000,63,63,63,0x27e00,0x50f80,338,10,0xbe800000,3,0x80008000,0xffffffff,0xffffffff,0x3d800,0x3e3000,0x7fc100,0xe2d000,0
.long 16,48,12,0x64000,0x1a000,0xe9ec00,0xead400,0x105e800,0x105ec00,0x304000,0x64080,0x140400,0x4060b000,0x40000280,0x3f000000,63,63,63,0x28200,0x51000,1,10,0xbe800000,3,1,0xffffffff,0xffffffff,0x22000,0x304000,0x762c00,0xe3c000,0
.long 16,48,15,0x64000,0x1a008,0xead800,0xeadc00,0x1099c00,0x109a000,0x304c00,0x6c080,0x144400,0x4060bb00,0x40000280,0x3f000000,63,63,63,0x2a200,0x51080,321,10,0xbe800000,3,1,0xffffffff,0xffffffff,0x22800,0x305000,0x763700,0xe4b000,0
.long 16,48,18,0x64000,0x1a010,0xebc400,0xebc800,0x109a400,0x109a800,0x305800,0x74080,0x160400,0x4060b000,0x40000280,0x3f000000,63,63,63,0x2c200,0x51100,31,10,0xbe800000,3,0x80008000,0xffffffff,0xffffffff,0x23000,0x306000,0x764200,0xe5a000,0
.long 16,48,21,0x64000,0x1a018,0xebcc00,0xecb400,0x109ac00,0x10d5c00,0x306400,0x7c080,0x164400,0x4060bb00,0x40000280,0x3f000000,63,63,63,0x2e200,0x51180,351,10,0xbe800000,3,0x80008000,0xffffffff,0xffffffff,0x23800,0x307000,0x764d00,0xe69000,0
.long 16,48,12,0x64400,0x1a000,0xecb800,0xecbc00,0x10d6000,0x10d6400,0x324000,0x64480,0x140c00,0x406bb000,0x40000280,0x3f000000,63,63,63,0x28600,0x51200,3,10,0xbe800000,3,1,0xffffffff,0xffffffff,0x26000,0x324000,0x778c00,0xe3c000,0
.long 16,48,15,0x64400,0x1a008,0xeda400,0xeda800,0x10d6800,0x10d6c00,0x324c00,0x6c480,0x144c00,0x406bbb00,0x40000280,0x3f000000,63,63,63,0x2a600,0x51280,323,10,0xbe800000,3,1,0xffffffff,0xffffffff,0x26800,0x325000,0x779700,0xe4b000,0
.long 16,48,18,0x64400,0x1a010,0xedac00,0xee9400,0x1111c00,0x1112000,0x325800,0x74480,0x160c00,0x406bb000,0x40000280,0x3f000000,63,63,63,0x2c600,0x51300,29,10,0xbe800000,3,0x80008000,0xffffffff,0xffffffff,0x27000,0x326000,0x77a200,0xe5a000,0
.long 16,48,21,0x64400,0x1a018,0xee9800,0xee9c00,0x1112400,0x1112800,0x326400,0x7c480,0x164c00,0x406bbb00,0x40000280,0x3f000000,63,63,63,0x2e600,0x51380,349,10,0xbe800000,3,0x80008000,0xffffffff,0xffffffff,0x27800,0x327000,0x77ad00,0xe69000,0
.long 16,48,12,0x6c800,0x1a000,0xef8400,0xef8800,0x1112c00,0x114dc00,0x344000,0x64880,0x141400,0x4076b000,0x40000280,0x3f000000,63,63,63,0x28a00,0x51400,5,10,0xbe800000,3,1,0xffffffff,0xffffffff,0x2a000,0x344000,0x78ec00,0xe3c000,0
.long 16,48,15,0x6c800,0x1a008,0xef8c00,0xf07400,0x114e000,0x114e400,0x344c00,0x6c880,0x145400,0x4076bb00,0x40000280,0x3f000000,63,63,63,0x2aa00,0x51480,325,10,0xbe800000,3,1,0xffffffff,0xffffffff,0x2a800,0x345000,0x78f700,0xe4b000,0
.long 16,48,18,0x6c800,0x1a010,0xf07800,0xf07c00,0x114e800,0x114ec00,0x345800,0x74880,0x161400,0x4076b000,0x40000280,0x3f000000,63,63,63,0x2ca00,0x51500,27,10,0xbe800000,3,0x80008000,0xffffffff,0xffffffff,0x2b000,0x346000,0x790200,0xe5a000,0
.long 16,48,21,0x6c800,0x1a018,0xf16400,0xf16800,0x1189c00,0x118a000,0x346400,0x7c880,0x165400,0x4076bb00,0x40000280,0x3f000000,63,63,63,0x2ea00,0x51580,347,10,0xbe800000,3,0x80008000,0xffffffff,0xffffffff,0x2b800,0x347000,0x790d00,0xe69000,0
.long 16,48,12,0x6cc00,0x1a000,0xf16c00,0xf25400,0x118a400,0x118a800,0x364000,0x64c80,0x141c00,0x4081b000,0x40000280,0x3f000000,63,63,63,0x28e00,0x51600,7,10,0xbe800000,3,1,0xffffffff,0xffffffff,0x2e000,0x364000,0x7a4c00,0xe3c000,0
.long 16,48,15,0x6cc00,0x1a008,0xf25800,0xf25c00,0x118ac00,0x11c5c00,0x364c00,0x6cc80,0x145c00,0x4081bb00,0x40000280,0x3f000000,63,63,63,0x2ae00,0x51680,327,10,0xbe800000,3,1,0xffffffff,0xffffffff,0x2e800,0x365000,0x7a5700,0xe4b000,0
.long 16,48,18,0x6cc00,0x1a010,0xf34400,0xf34800,0x11c6000,0x11c6400,0x365800,0x74c80,0x161c00,0x4081b000,0x40000280,0x3f000000,63,63,63,0x2ce00,0x51700,25,10,0xbe800000,3,0x80008000,0xffffffff,0xffffffff,0x2f000,0x366000,0x7a6200,0xe5a000,0
.long 16,48,21,0x6cc00,0x1a018,0xf34c00,0xf43400,0x11c6800,0x11c6c00,0x366400,0x7cc80,0x165c00,0x4081bb00,0x40000280,0x3f000000,63,63,63,0x2ee00,0x51780,345,10,0xbe800000,3,0x80008000,0xffffffff,0xffffffff,0x2f800,0x367000,0x7a6d00,0xe69000,0
.long 16,48,12,0x75000,0x1a000,0xf43800,0xf43c00,0x1023000,0x1023400,0x384000,0x65080,0x142400,0x4081b000,0x40000280,0x3f000000,63,63,63,0x29200,0x51800,9,10,0xbe800000,3,1,0xffffffff,0xffffffff,0x32000,0x384000,0x7bac00,0xe3c000,0
.long 16,48,15,0x75000,0x1a008,0xf52400,0xf52800,0x1023800,0x1023c00,0x384c00,0x6d080,0x146400,0x4081bb00,0x40000280,0x3f000000,63,63,63,0x2b200,0x51880,329,10,0xbe800000,3,1,0xffffffff,0xffffffff,0x32800,0x385000,0x7bb700,0xe4b000,0
.long 16,48,18,0x75000,0x1a010,0xf52c00,0xf61400,0x1024000,0x105f000,0x385800,0x75080,0x162400,0x4081b000,0x40000280,0x3f000000,63,63,63,0x2d200,0x51900,23,10,0xbe800000,3,0x80008000,0xffffffff,0xffffffff,0x33000,0x386000,0x7bc200,0xe5a000,0
.long 16,48,21,0x75000,0x1a018,0xf61800,0xf61c00,0x105f400,0x105f800,0x386400,0x7d080,0x166400,0x4081bb00,0x40000280,0x3f000000,63,63,63,0x2f200,0x51980,343,10,0xbe800000,3,0x80008000,0xffffffff,0xffffffff,0x33800,0x387000,0x7bcd00,0xe69000,0
.long 16,48,12,0x75400,0x1a000,0xf70400,0xf70800,0x105fc00,0x1060000,0x3a4000,0x65480,0x142c00,0x4076b000,0x40000280,0x3f000000,63,63,63,0x29600,0x51a00,11,10,0xbe800000,3,1,0xffffffff,0xffffffff,0x36000,0x3a4000,0x7d0c00,0xe3c000,0
.long 16,48,15,0x75400,0x1a008,0xf70c00,0xf7f400,0x109b000,0x109b400,0x3a4c00,0x6d480,0x146c00,0x4076bb00,0x40000280,0x3f000000,63,63,63,0x2b600,0x51a80,331,10,0xbe800000,3,1,0xffffffff,0xffffffff,0x36800,0x3a5000,0x7d1700,0xe4b000,0
.long 16,48,18,0x75400,0x1a010,0xf7f800,0xf7fc00,0x109b800,0x109bc00,0x3a5800,0x75480,0x162c00,0x4076b000,0x40000280,0x3f000000,63,63,63,0x2d600,0x51b00,21,10,0xbe800000,3,0x80008000,0xffffffff,0xffffffff,0x37000,0x3a6000,0x7d2200,0xe5a000,0
.long 16,48,21,0x75400,0x1a018,0xf8e400,0xf8e800,0x109c000,0x10d7000,0x3a6400,0x7d480,0x166c00,0x4076bb00,0x40000280,0x3f000000,63,63,63,0x2f600,0x51b80,341,10,0xbe800000,3,0x80008000,0xffffffff,0xffffffff,0x37800,0x3a7000,0x7d2d00,0xe69000,0
.long 16,48,12,0x7d800,0x1a000,0xf8ec00,0xf9d400,0x10d7400,0x10d7800,0x3c4000,0x65880,0x143400,0x406bb000,0x40000280,0x3f000000,63,63,63,0x29a00,0x51c00,13,10,0xbe800000,3,1,0xffffffff,0xffffffff,0x3a000,0x3c4000,0x7e6c00,0xe3c000,0
.long 16,48,15,0x7d800,0x1a008,0xf9d800,0xf9dc00,0x10d7c00,0x10d8000,0x3c4c00,0x6d880,0x147400,0x406bbb00,0x40000280,0x3f000000,63,63,63,0x2ba00,0x51c80,333,10,0xbe800000,3,1,0xffffffff,0xffffffff,0x3a800,0x3c5000,0x7e7700,0xe4b000,0
.long 16,48,18,0x7d800,0x1a010,0xfac400,0xfac800,0x1113000,0x1113400,0x3c5800,0x75880,0x163400,0x406bb000,0x40000280,0x3f000000,63,63,63,0x2da00,0x51d00,19,10,0xbe800000,3,0x80008000,0xffffffff,0xffffffff,0x3b000,0x3c6000,0x7e8200,0xe5a000,0
.long 16,48,21,0x7d800,0x1a018,0xfacc00,0xfbb400,0x1113800,0x1113c00,0x3c6400,0x7d880,0x167400,0x406bbb00,0x40000280,0x3f000000,63,63,63,0x2fa00,0x51d80,339,10,0xbe800000,3,0x80008000,0xffffffff,0xffffffff,0x3b800,0x3c7000,0x7e8d00,0xe69000,0
.long 16,48,12,0x7dc00,0x1a000,0xfbb800,0xfbbc00,0x1114000,0x114f000,0x3e4000,0x65c80,0x143c00,0x4060b000,0x40000280,0x3f000000,63,63,63,0x29e00,0x51e00,15,10,0xbe800000,3,1,0xffffffff,0xffffffff,0x3e000,0x3e4000,0x7fcc00,0xe3c000,0
.long 16,48,15,0x7dc00,0x1a008,0xfca400,0xfca800,0x114f400,0x114f800,0x3e4c00,0x6dc80,0x147c00,0x4060bb00,0x40000280,0x3f000000,63,63,63,0x2be00,0x51e80,335,10,0xbe800000,3,1,0xffffffff,0xffffffff,0x3e800,0x3e5000,0x7fd700,0xe4b000,0
.long 16,48,18,0x7dc00,0x1a010,0xfcac00,0xfd9400,0x114fc00,0x1150000,0x3e5800,0x75c80,0x163c00,0x4060b000,0x40000280,0x3f000000,63,63,63,0x2de00,0x51f00,17,10,0xbe800000,3,0x80008000,0xffffffff,0xffffffff,0x3f000,0x3e6000,0x7fe200,0xe5a000,0
.long 16,48,21,0x7dc00,0x1a018,0xfd9800,0xfd9c00,0x118b000,0x118b400,0x3e6400,0x7dc80,0x167c00,0x4060bb00,0x40000280,0x3f000000,63,63,63,0x2fe00,0x51f80,337,10,0xbe800000,3,0x80008000,0xffffffff,0xffffffff,0x3f800,0x3e7000,0x7fed00,0xe69000,0
.long 18,46,24,0x64000,0x1a000,0xe09000,0xe09400,0x118b800,0x118bc00,0x308000,0x64100,0x180400,0x4060b000,0x40000280,0x3f000000,63,63,63,0x30200,0x52000,0,10,0xbe800000,3,0,0xffffffff,0,0x20000,0x308000,0x765800,0xe78000,0
.long 18,46,27,0x64000,0x1a008,0xe09800,0xe18000,0x118c000,0x11c7000,0x308c00,0x6c100,0x184400,0x4060bb00,0x40000280,0x3f000000,63,63,63,0x32200,0x52080,320,10,0xbe800000,3,0,0xffffffff,0,0x20800,0x309000,0x766300,0xe87000,0
.long 18,46,30,0x64000,0x1a010,0xe18400,0xe18800,0x11c7400,0x11c7800,0x309800,0x74100,0x1a0400,0x4060b000,0x40000280,0x3f000000,63,63,63,0x34200,0x52100,16,10,0xbe800000,3,0,0,0xffffffff,0x21000,0x30a000,0x766e00,0xe96000,0
.long 18,46,33,0x64000,0x1a018,0xe27000,0xe27400,0x11c7c00,0x11c8000,0x30a400,0x7c100,0x1a4400,0x4060bb00,0x40000280,0x3f000000,63,63,63,0x36200,0x52180,336,10,0xbe800000,3,0,0,0xffffffff,0x21800,0x30b000,0x767900,0xea5000,0
.long 18,46,24,0x64400,0x1a000,0xe27800,0xe36000,0x1024400,0x1024800,0x328000,0x64500,0x180c00,0x406bb000,0x40000280,0x3f000000,63,63,63,0x30600,0x52200,2,10,0xbe800000,3,1,0xffffffff,0xffffffff,0x24000,0x328000,0x77b800,0xe78000,0
.long 18,46,27,0x64400,0x1a008,0xe36400,0xe36800,0x1024c00,0x1025000,0x328c00,0x6c500,0x184c00,0x406bbb00,0x40000280,0x3f000000,63,63,63,0x32600,0x52280,322,10,0xbe800000,3,1,0xffffffff,0xffffffff,0x24800,0x329000,0x77c300,0xe87000,0
.long 18,46,30,0x64400,0x1a010,0xe45000,0xe45400,0x1025400,0x1060400,0x329800,0x74500,0x1a0c00,0x406bb000,0x40000280,0x3f000000,63,63,63,0x34600,0x52300,30,10,0xbe800000,3,0x80008000,0xffffffff,0xffffffff,0x25000,0x32a000,0x77ce00,0xe96000,0
.long 18,46,33,0x64400,0x1a018,0xe45800,0xe54000,0x1060800,0x1060c00,0x32a400,0x7c500,0x1a4c00,0x406bbb00,0x40000280,0x3f000000,63,63,63,0x36600,0x52380,350,10,0xbe800000,3,0x80008000,0xffffffff,0xffffffff,0x25800,0x32b000,0x77d900,0xea5000,0
.long 18,46,24,0x6c800,0x1a000,0xe54400,0xe54800,0x1061000,0x1061400,0x348000,0x64900,0x181400,0x4076b000,0x40000280,0x3f000000,63,63,63,0x30a00,0x52400,4,10,0xbe800000,3,1,0xffffffff,0xffffffff,0x28000,0x348000,0x791800,0xe78000,0
.long 18,46,27,0x6c800,0x1a008,0xe63000,0xe63400,0x109c400,0x109c800,0x348c00,0x6c900,0x185400,0x4076bb00,0x40000280,0x3f000000,63,63,63,0x32a00,0x52480,324,10,0xbe800000,3,1,0xffffffff,0xffffffff,0x28800,0x349000,0x792300,0xe87000,0
.long 18,46,30,0x6c800,0x1a010,0xe63800,0xe72000,0x109cc00,0x109d000,0x349800,0x74900,0x1a1400,0x4076b000,0x40000280,0x3f000000,63,63,63,0x34a00,0x52500,28,10,0xbe800000,3,0x80008000,0xffffffff,0xffffffff,0x29000,0x34a000,0x792e00,0xe96000,0
.long 18,46,33,0x6c800,0x1a018,0xe72400,0xe72800,0x109d400,0x10d8400,0x34a400,0x7c900,0x1a5400,0x4076bb00,0x40000280,0x3f000000,63,63,63,0x36a00,0x52580,348,10,0xbe800000,3,0x80008000,0xffffffff,0xffffffff,0x29800,0x34b000,0x793900,0xea5000,0
.long 18,46,24,0x6cc00,0x1a000,0xe81000,0xe81400,0x10d8800,0x10d8c00,0x368000,0x64d00,0x181c00,0x4081b000,0x40000280,0x3f000000,63,63,63,0x30e00,0x52600,6,10,0xbe800000,3,1,0xffffffff,0xffffffff,0x2c000,0x368000,0x7a7800,0xe78000,0
.long 18,46,27,0x6cc00,0x1a008,0xe81800,0xe90000,0x10d9000,0x10d9400,0x368c00,0x6cd00,0x185c00,0x4081bb00,0x40000280,0x3f000000,63,63,63,0x32e00,0x52680,326,10,0xbe800000,3,1,0xffffffff,0xffffffff,0x2c800,0x369000,0x7a8300,0xe87000,0
.long 18,46,30,0x6cc00,0x1a010,0xe90400,0xe90800,0x1114400,0x1114800,0x369800,0x74d00,0x1a1c00,0x4081b000,0x40000280,0x3f000000,63,63,63,0x34e00,0x52700,26,10,0xbe800000,3,0x80008000,0xffffffff,0xffffffff,0x2d000,0x36a000,0x7a8e00,0xe96000,0
.long 18,46,33,0x6cc00,0x1a018,0xe9f000,0xe9f400,0x1114c00,0x1115000,0x36a400,0x7cd00,0x1a5c00,0x4081bb00,0x40000280,0x3f000000,63,63,63,0x36e00,0x52780,346,10,0xbe800000,3,0x80008000,0xffffffff,0xffffffff,0x2d800,0x36b000,0x7a9900,0xea5000,0
.long 18,46,24,0x75000,0x1a000,0xe9f800,0xeae000,0x1115400,0x1150400,0x388000,0x65100,0x182400,0x4081b000,0x40000280,0x3f000000,63,63,63,0x31200,0x52800,8,10,0xbe800000,3,1,0xffffffff,0xffffffff,0x30000,0x388000,0x7bd800,0xe78000,0
.long 18,46,27,0x75000,0x1a008,0xeae400,0xeae800,0x1150800,0x1150c00,0x388c00,0x6d100,0x186400,0x4081bb00,0x40000280,0x3f000000,63,63,63,0x33200,0x52880,328,10,0xbe800000,3,1,0xffffffff,0xffffffff,0x30800,0x389000,0x7be300,0xe87000,0
.long 18,46,30,0x75000,0x1a010,0xebd000,0xebd400,0x1151000,0x1151400,0x389800,0x75100,0x1a2400,0x4081b000,0x40000280,0x3f000000,63,63,63,0x35200,0x52900,24,10,0xbe800000,3,0x80008000,0xffffffff,0xffffffff,0x31000,0x38a000,0x7bee00,0xe96000,0
.long 18,46,33,0x75000,0x1a018,0xebd800,0xecc000,0x118c400,0x118c800,0x38a400,0x7d100,0x1a6400,0x4081bb00,0x40000280,0x3f000000,63,63,63,0x37200,0x52980,344,10,0xbe800000,3,0x80008000,0xffffffff,0xffffffff,0x31800,0x38b000,0x7bf900,0xea5000,0
.long 18,46,24,0x75400,0x1a000,0xecc400,0xecc800,0x118cc00,0x118d000,0x3a8000,0x65500,0x182c00,0x4076b000,0x40000280,0x3f000000,63,63,63,0x31600,0x52a00,10,10,0xbe800000,3,1,0xffffffff,0xffffffff,0x34000,0x3a8000,0x7d3800,0xe78000,0
.long 18,46,27,0x75400,0x1a008,0xedb000,0xedb400,0x118d400,0x11c8400,0x3a8c00,0x6d500,0x186c00,0x4076bb00,0x40000280,0x3f000000,63,63,63,0x33600,0x52a80,330,10,0xbe800000,3,1,0xffffffff,0xffffffff,0x34800,0x3a9000,0x7d4300,0xe87000,0
.long 18,46,30,0x75400,0x1a010,0xedb800,0xeea000,0x11c8800,0x11c8c00,0x3a9800,0x75500,0x1a2c00,0x4076b000,0x40000280,0x3f000000,63,63,63,0x35600,0x52b00,22,10,0xbe800000,3,0x80008000,0xffffffff,0xffffffff,0x35000,0x3aa000,0x7d4e00,0xe96000,0
.long 18,46,33,0x75400,0x1a018,0xeea400,0xeea800,0x11c9000,0x11c9400,0x3aa400,0x7d500,0x1a6c00,0x4076bb00,0x40000280,0x3f000000,63,63,63,0x37600,0x52b80,342,10,0xbe800000,3,0x80008000,0xffffffff,0xffffffff,0x35800,0x3ab000,0x7d5900,0xea5000,0
.long 18,46,24,0x7d800,0x1a000,0xef9000,0xef9400,0x1025800,0x1025c00,0x3c8000,0x65900,0x183400,0x406bb000,0x40000280,0x3f000000,63,63,63,0x31a00,0x52c00,12,10,0xbe800000,3,1,0xffffffff,0xffffffff,0x38000,0x3c8000,0x7e9800,0xe78000,0
.long 18,46,27,0x7d800,0x1a008,0xef9800,0xf08000,0x1026000,0x1026400,0x3c8c00,0x6d900,0x187400,0x406bbb00,0x40000280,0x3f000000,63,63,63,0x33a00,0x52c80,332,10,0xbe800000,3,1,0xffffffff,0xffffffff,0x38800,0x3c9000,0x7ea300,0xe87000,0
.long 18,46,30,0x7d800,0x1a010,0xf08400,0xf08800,0x1026800,0x1061800,0x3c9800,0x75900,0x1a3400,0x406bb000,0x40000280,0x3f000000,63,63,63,0x35a00,0x52d00,20,10,0xbe800000,3,0x80008000,0xffffffff,0xffffffff,0x39000,0x3ca000,0x7eae00,0xe96000,0
.long 18,46,33,0x7d800,0x1a018,0xf17000,0xf17400,0x1061c00,0x1062000,0x3ca400,0x7d900,0x1a7400,0x406bbb00,0x40000280,0x3f000000,63,63,63,0x37a00,0x52d80,340,10,0xbe800000,3,0x80008000,0xffffffff,0xffffffff,0x39800,0x3cb000,0x7eb900,0xea5000,0
.long 18,46,24,0x7dc00,0x1a000,0xf17800,0xf26000,0x1062400,0x1062800,0x3e8000,0x65d00,0x183c00,0x4060b000,0x40000280,0x3f000000,63,63,63,0x31e00,0x52e00,14,10,0xbe800000,3,1,0xffffffff,0xffffffff,0x3c000,0x3e8000,0x7ff800,0xe78000,0
.long 18,46,27,0x7dc00,0x1a008,0xf26400,0xf26800,0x109d800,0x109dc00,0x3e8c00,0x6dd00,0x187c00,0x4060bb00,0x40000280,0x3f000000,63,63,63,0x33e00,0x52e80,334,10,0xbe800000,3,1,0xffffffff,0xffffffff,0x3c800,0x3e9000,0x800300,0xe87000,0
.long 18,46,30,0x7dc00,0x1a010,0xf35000,0xf35400,0x109e000,0x109e400,0x3e9800,0x75d00,0x1a3c00,0x4060b000,0x40000280,0x3f000000,63,63,63,0x35e00,0x52f00,18,10,0xbe800000,3,0x80008000,0xffffffff,0xffffffff,0x3d000,0x3ea000,0x800e00,0xe96000,0
.long 18,46,33,0x7dc00,0x1a018,0xf35800,0xf44000,0x109e800,0x10d9800,0x3ea400,0x7dd00,0x1a7c00,0x4060bb00,0x40000280,0x3f000000,63,63,63,0x37e00,0x52f80,338,10,0xbe800000,3,0x80008000,0xffffffff,0xffffffff,0x3d800,0x3eb000,0x801900,0xea5000,0
.long 18,46,36,0x64000,0x1a000,0xf44400,0xf44800,0x10d9c00,0x10da000,0x30c000,0x64180,0x1c0400,0x4060b000,0x40000280,0x3f000000,63,63,63,0x38200,0x53000,1,10,0xbe800000,3,1,0xffffffff,0xffffffff,0x22000,0x30c000,0x768400,0xeb4000,0
.long 18,46,39,0x64000,0x1a008,0xf53000,0xf53400,0x10da400,0x10da800,0x30cc00,0x6c180,0x1c4400,0x4060bb00,0x40000280,0x3f000000,63,63,63,0x3a200,0x53080,321,10,0xbe800000,3,1,0xffffffff,0xffffffff,0x22800,0x30d000,0x768f00,0xec3000,0
.long 18,46,42,0x64000,0x1a010,0xf53800,0xf62000,0x1115800,0x1115c00,0x30d800,0x74180,0x1e0400,0x4060b000,0x40000280,0x3f000000,63,63,63,0x3c200,0x53100,31,10,0xbe800000,3,0x80008000,0xffffffff,0xffffffff,0x23000,0x30e000,0x769a00,0xed2000,0
.long 18,46,45,0x64000,0x1a018,0xf62400,0xf62800,0x1116000,0x1116400,0x30e400,0x7c180,0x1e4400,0x4060bb00,0x40000280,0x3f000000,63,63,63,0x3e200,0x53180,351,10,0xbe800000,3,0x80008000,0xffffffff,0xffffffff,0x23800,0x30f000,0x76a500,0xee1000,0
.long 18,46,36,0x64400,0x1a000,0xf71000,0xf71400,0x1116800,0x1151800,0x32c000,0x64580,0x1c0c00,0x406bb000,0x40000280,0x3f000000,63,63,63,0x38600,0x53200,3,10,0xbe800000,3,1,0xffffffff,0xffffffff,0x26000,0x32c000,0x77e400,0xeb4000,0
.long 18,46,39,0x64400,0x1a008,0xf71800,0xf80000,0x1151c00,0x1152000,0x32cc00,0x6c580,0x1c4c00,0x406bbb00,0x40000280,0x3f000000,63,63,63,0x3a600,0x53280,323,10,0xbe800000,3,1,0xffffffff,0xffffffff,0x26800,0x32d000,0x77ef00,0xec3000,0
.long 18,46,42,0x64400,0x1a010,0xf80400,0xf80800,0x1152400,0x1152800,0x32d800,0x74580,0x1e0c00,0x406bb000,0x40000280,0x3f000000,63,63,63,0x3c600,0x53300,29,10,0xbe800000,3,0x80008000,0xffffffff,0xffffffff,0x27000,0x32e000,0x77fa00,0xed2000,0
.long 18,46,45,0x64400,0x1a018,0xf8f000,0xf8f400,0x118d800,0x118dc00,0x32e400,0x7c580,0x1e4c00,0x406bbb00,0x40000280,0x3f000000,63,63,63,0x3e600,0x53380,349,10,0xbe800000,3,0x80008000,0xffffffff,0xffffffff,0x27800,0x32f000,0x780500,0xee1000,0
.long 18,46,36,0x6c800,0x1a000,0xf8f800,0xf9e000,0x118e000,0x118e400,0x34c000,0x64980,0x1c1400,0x4076b000,0x40000280,0x3f000000,63,63,63,0x38a00,0x53400,5,10,0xbe800000,3,1,0xffffffff,0xffffffff,0x2a000,0x34c000,0x794400,0xeb4000,0
.long 18,46,39,0x6c800,0x1a008,0xf9e400,0xf9e800,0x118e800,0x11c9800,0x34cc00,0x6c980,0x1c5400,0x4076bb00,0x40000280,0x3f000000,63,63,63,0x3aa00,0x53480,325,10,0xbe800000,3,1,0xffffffff,0xffffffff,0x2a800,0x34d000,0x794f00,0xec3000,0
.long 18,46,42,0x6c800,0x1a010,0xfad000,0xfad400,0x11c9c00,0x11ca000,0x34d800,0x74980,0x1e1400,0x4076b000,0x40000280,0x3f000000,63,63,63,0x3ca00,0x53500,27,10,0xbe800000,3,0x80008000,0xffffffff,0xffffffff,0x2b000,0x34e000,0x795a00,0xed2000,0
.long 18,46,45,0x6c800,0x1a018,0xfad800,0xfbc000,0x11ca400,0x11ca800,0x34e400,0x7c980,0x1e5400,0x4076bb00,0x40000280,0x3f000000,63,63,63,0x3ea00,0x53580,347,10,0xbe800000,3,0x80008000,0xffffffff,0xffffffff,0x2b800,0x34f000,0x796500,0xee1000,0
.long 18,46,36,0x6cc00,0x1a000,0xfbc400,0xfbc800,0x1026c00,0x1027000,0x36c000,0x64d80,0x1c1c00,0x4081b000,0x40000280,0x3f000000,63,63,63,0x38e00,0x53600,7,10,0xbe800000,3,1,0xffffffff,0xffffffff,0x2e000,0x36c000,0x7aa400,0xeb4000,0
.long 18,46,39,0x6cc00,0x1a008,0xfcb000,0xfcb400,0x1027400,0x1027800,0x36cc00,0x6cd80,0x1c5c00,0x4081bb00,0x40000280,0x3f000000,63,63,63,0x3ae00,0x53680,327,10,0xbe800000,3,1,0xffffffff,0xffffffff,0x2e800,0x36d000,0x7aaf00,0xec3000,0
.long 18,46,42,0x6cc00,0x1a010,0xfcb800,0xfda000,0x1027c00,0x1062c00,0x36d800,0x74d80,0x1e1c00,0x4081b000,0x40000280,0x3f000000,63,63,63,0x3ce00,0x53700,25,10,0xbe800000,3,0x80008000,0xffffffff,0xffffffff,0x2f000,0x36e000,0x7aba00,0xed2000,0
.long 18,46,45,0x6cc00,0x1a018,0xfda400,0xfda800,0x1063000,0x1063400,0x36e400,0x7cd80,0x1e5c00,0x4081bb00,0x40000280,0x3f000000,63,63,63,0x3ee00,0x53780,345,10,0xbe800000,3,0x80008000,0xffffffff,0xffffffff,0x2f800,0x36f000,0x7ac500,0xee1000,0
.long 18,46,36,0x75000,0x1a000,0xe09c00,0xe0a000,0x1063800,0x1063c00,0x38c000,0x65180,0x1c2400,0x4081b000,0x40000280,0x3f000000,63,63,63,0x39200,0x53800,9,10,0xbe800000,3,1,0xffffffff,0xffffffff,0x32000,0x38c000,0x7c0400,0xeb4000,0
.long 18,46,39,0x75000,0x1a008,0xe0a400,0xe18c00,0x109ec00,0x109f000,0x38cc00,0x6d180,0x1c6400,0x4081bb00,0x40000280,0x3f000000,63,63,63,0x3b200,0x53880,329,10,0xbe800000,3,1,0xffffffff,0xffffffff,0x32800,0x38d000,0x7c0f00,0xec3000,0
.long 18,46,42,0x75000,0x1a010,0xe19000,0xe19400,0x109f400,0x109f800,0x38d800,0x75180,0x1e2400,0x4081b000,0x40000280,0x3f000000,63,63,63,0x3d200,0x53900,23,10,0xbe800000,3,0x80008000,0xffffffff,0xffffffff,0x33000,0x38e000,0x7c1a00,0xed2000,0
.long 18,46,45,0x75000,0x1a018,0xe27c00,0xe28000,0x109fc00,0x10dac00,0x38e400,0x7d180,0x1e6400,0x4081bb00,0x40000280,0x3f000000,63,63,63,0x3f200,0x53980,343,10,0xbe800000,3,0x80008000,0xffffffff,0xffffffff,0x33800,0x38f000,0x7c2500,0xee1000,0
.long 18,46,36,0x75400,0x1a000,0xe28400,0xe36c00,0x10db000,0x10db400,0x3ac000,0x65580,0x1c2c00,0x4076b000,0x40000280,0x3f000000,63,63,63,0x39600,0x53a00,11,10,0xbe800000,3,1,0xffffffff,0xffffffff,0x36000,0x3ac000,0x7d6400,0xeb4000,0
.long 18,46,39,0x75400,0x1a008,0xe37000,0xe37400,0x10db800,0x10dbc00,0x3acc00,0x6d580,0x1c6c00,0x4076bb00,0x40000280,0x3f000000,63,63,63,0x3b600,0x53a80,331,10,0xbe800000,3,1,0xffffffff,0xffffffff,0x36800,0x3ad000,0x7d6f00,0xec3000,0
.long 18,46,42,0x75400,0x1a010,0xe45c00,0xe46000,0x1116c00,0x1117000,0x3ad800,0x75580,0x1e2c00,0x4076b000,0x40000280,0x3f000000,63,63,63,0x3d600,0x53b00,21,10,0xbe800000,3,0x80008000,0xffffffff,0xffffffff,0x37000,0x3ae000,0x7d7a00,0xed2000,0
.long 18,46,45,0x75400,0x1a018,0xe46400,0xe54c00,0x1117400,0x1117800,0x3ae400,0x7d580,0x1e6c00,0x4076bb00,0x40000280,0x3f000000,63,63,63,0x3f600,0x53b80,341,10,0xbe800000,3,0x80008000,0xffffffff,0xffffffff,0x37800,0x3af000,0x7d8500,0xee1000,0
.long 18,46,36,0x7d800,0x1a000,0xe55000,0xe55400,0x1117c00,0x1152c00,0x3cc000,0x65980,0x1c3400,0x406bb000,0x40000280,0x3f000000,63,63,63,0x39a00,0x53c00,13,10,0xbe800000,3,1,0xffffffff,0xffffffff,0x3a000,0x3cc000,0x7ec400,0xeb4000,0
.long 18,46,39,0x7d800,0x1a008,0xe63c00,0xe64000,0x1153000,0x1153400,0x3ccc00,0x6d980,0x1c7400,0x406bbb00,0x40000280,0x3f000000,63,63,63,0x3ba00,0x53c80,333,10,0xbe800000,3,1,0xffffffff,0xffffffff,0x3a800,0x3cd000,0x7ecf00,0xec3000,0
.long 18,46,42,0x7d800,0x1a010,0xe64400,0xe72c00,0x1153800,0x1153c00,0x3cd800,0x75980,0x1e3400,0x406bb000,0x40000280,0x3f000000,63,63,63,0x3da00,0x53d00,19,10,0xbe800000,3,0x80008000,0xffffffff,0xffffffff,0x3b000,0x3ce000,0x7eda00,0xed2000,0
.long 18,46,45,0x7d800,0x1a018,0xe73000,0xe73400,0x118ec00,0x118f000,0x3ce400,0x7d980,0x1e7400,0x406bbb00,0x40000280,0x3f000000,63,63,63,0x3fa00,0x53d80,339,10,0xbe800000,3,0x80008000,0xffffffff,0xffffffff,0x3b800,0x3cf000,0x7ee500,0xee1000,0
.long 18,46,36,0x7dc00,0x1a000,0xe81c00,0xe82000,0x118f400,0x118f800,0x3ec000,0x65d80,0x1c3c00,0x4060b000,0x40000280,0x3f000000,63,63,63,0x39e00,0x53e00,15,10,0xbe800000,3,1,0xffffffff,0xffffffff,0x3e000,0x3ec000,0x802400,0xeb4000,0
.long 18,46,39,0x7dc00,0x1a008,0xe82400,0xe90c00,0x118fc00,0x11cac00,0x3ecc00,0x6dd80,0x1c7c00,0x4060bb00,0x40000280,0x3f000000,63,63,63,0x3be00,0x53e80,335,10,0xbe800000,3,1,0xffffffff,0xffffffff,0x3e800,0x3ed000,0x802f00,0xec3000,0
.long 18,46,42,0x7dc00,0x1a010,0xe91000,0xe91400,0x11cb000,0x11cb400,0x3ed800,0x75d80,0x1e3c00,0x4060b000,0x40000280,0x3f000000,63,63,63,0x3de00,0x53f00,17,10,0xbe800000,3,0x80008000,0xffffffff,0xffffffff,0x3f000,0x3ee000,0x803a00,0xed2000,0
.long 18,46,45,0x7dc00,0x1a018,0xe9fc00,0xea0000,0x11cb800,0x11cbc00,0x3ee400,0x7dd80,0x1e7c00,0x4060bb00,0x40000280,0x3f000000,63,63,63,0x3fe00,0x53f80,337,10,0xbe800000,3,0x80008000,0xffffffff,0xffffffff,0x3f800,0x3ef000,0x804500,0xee1000,0
.long 20,44,48,0x64000,0x1a000,0xea0400,0xeaec00,0x1028000,0x1028400,0x310000,0x64200,0x100500,0x4060b000,0x40000280,0x3f000000,63,63,63,0x20280,0x54000,0,10,0xbe800000,3,0,0xffffffff,0,0x20000,0x310000,0x76b000,0xef0000,0
.long 20,44,51,0x64000,0x1a008,0xeaf000,0xeaf400,0x1028800,0x1028c00,0x310c00,0x6c200,0x104500,0x4060bb00,0x40000280,0x3f000000,63,63,63,0x22280,0x54080,320,10,0xbe800000,3,0,0xffffffff,0,0x20800,0x311000,0x76bb00,0xeff000,0
.long 20,44,54,0x64000,0x1a010,0xebdc00,0xebe000,0x1029000,0x1064000,0x311800,0x74200,0x120500,0x4060b000,0x40000280,0x3f000000,63,63,63,0x24280,0x54100,16,10,0xbe800000,3,0,0,0xffffffff,0x21000,0x312000,0x76c600,0xf0e000,0
.long 20,44,57,0x64000,0x1a018,0xebe400,0xeccc00,0x1064400,0x1064800,0x312400,0x7c200,0x124500,0x4060bb00,0x40000280,0x3f000000,63,63,63,0x26280,0x54180,336,10,0xbe800000,3,0,0,0xffffffff,0x21800,0x313000,0x76d100,0xf1d000,0
.long 20,44,48,0x64400,0x1a000,0xecd000,0xecd400,0x1064c00,0x1065000,0x330000,0x64600,0x100d00,0x406bb000,0x40000280,0x3f000000,63,63,63,0x20680,0x54200,2,10,0xbe800000,3,1,0xffffffff,0xffffffff,0x24000,0x330000,0x781000,0xef0000,0
.long 20,44,51,0x64400,0x1a008,0xedbc00,0xedc000,0x10a0000,0x10a0400,0x330c00,0x6c600,0x104d00,0x406bbb00,0x40000280,0x3f000000,63,63,63,0x22680,0x54280,322,10,0xbe800000,3,1,0xffffffff,0xffffffff,0x24800,0x331000,0x781b00,0xeff000,0
.long 20,44,54,0x64400,0x1a010,0xedc400,0xeeac00,0x10a0800,0x10a0c00,0x331800,0x74600,0x120d00,0x406bb000,0x40000280,0x3f000000,63,63,63,0x24680,0x54300,30,10,0xbe800000,3,0x80008000,0xffffffff,0xffffffff,0x25000,0x332000,0x782600,0xf0e000,0
.long 20,44,57,0x64400,0x1a018,0xeeb000,0xeeb400,0x10a1000,0x10dc000,0x332400,0x7c600,0x124d00,0x406bbb00,0x40000280,0x3f000000,63,63,63,0x26680,0x54380,350,10,0xbe800000,3,0x80008000,0xffffffff,0xffffffff,0x25800,0x333000,0x783100,0xf1d000,0
.long 20,44,48,0x6c800,0x1a000,0xef9c00,0xefa000,0x10dc400,0x10dc800,0x350000,0x64a00,0x101500,0x4076b000,0x40000280,0x3f000000,63,63,63,0x20a80,0x54400,4,10,0xbe800000,3,1,0xffffffff,0xffffffff,0x28000,0x350000,0x797000,0xef0000,0
.long 20,44,51,0x6c800,0x1a008,0xefa400,0xf08c00,0x10dcc00,0x10dd000,0x350c00,0x6ca00,0x105500,0x4076bb00,0x40000280,0x3f000000,63,63,63,0x22a80,0x54480,324,10,0xbe800000,3,1,0xffffffff,0xffffffff,0x28800,0x351000,0x797b00,0xeff000,0
.long 20,44,54,0x6c800,0x1a010,0xf09000,0xf09400,0x1118000,0x1118400,0x351800,0x74a00,0x121500,0x4076b000,0x40000280,0x3f000000,63,63,63,0x24a80,0x54500,28,10,0xbe800000,3,0x80008000,0xffffffff,0xffffffff,0x29000,0x352000,0x798600,0xf0e000,0
.long 20,44,57,0x6c800,0x1a018,0xf17c00,0xf18000,0x1118800,0x1118c00,0x352400,0x7ca00,0x125500,0x4076bb00,0x40000280,0x3f000000,63,63,63,0x26a80,0x54580,348,10,0xbe800000,3,0x80008000,0xffffffff,0xffffffff,0x29800,0x353000,0x799100,0xf1d000,0
.long 20,44,48,0x6cc00,0x1a000,0xf18400,0xf26c00,0x1119000,0x1154000,0x370000,0x64e00,0x101d00,0x4081b000,0x40000280,0x3f000000,63,63,63,0x20e80,0x54600,6,10,0xbe800000,3,1,0xffffffff,0xffffffff,0x2c000,0x370000,0x7ad000,0xef0000,0
.long 20,44,51,0x6cc00,0x1a008,0xf27000,0xf27400,0x1154400,0x1154800,0x370c00,0x6ce00,0x105d00,0x4081bb00,0x40000280,0x3f000000,63,63,63,0x22e80,0x54680,326,10,0xbe800000,3,1,0xffffffff,0xffffffff,0x2c800,0x371000,0x7adb00,0xeff000,0
.long 20,44,54,0x6cc00,0x1a010,0xf35c00,0xf36000,0x1154c00,0x1155000,0x371800,0x74e00,0x121d00,0x4081b000,0x40000280,0x3f000000,63,63,63,0x24e80,0x54700,26,10,0xbe800000,3,0x80008000,0xffffffff,0xffffffff,0x2d000,0x372000,0x7ae600,0xf0e000,0
.long 20,44,57,0x6cc00,0x1a018,0xf36400,0xf44c00,0x1190000,0x1190400,0x372400,0x7ce00,0x125d00,0x4081bb00,0x40000280,0x3f000000,63,63,63,0x26e80,0x54780,346,10,0xbe800000,3,0x80008000,0xffffffff,0xffffffff,0x2d800,0x373000,0x7af100,0xf1d000,0
.long 20,44,48,0x75000,0x1a000,0xf45000,0xf45400,0x1190800,0x1190c00,0x390000,0x65200,0x102500,0x4081b000,0x40000280,0x3f000000,63,63,63,0x21280,0x54800,8,10,0xbe800000,3,1,0xffffffff,0xffffffff,0x30000,0x390000,0x7c3000,0xef0000,0
.long 20,44,51,0x75000,0x1a008,0xf53c00,0xf54000,0x1191000,0x11cc000,0x390c00,0x6d200,0x106500,0x4081bb00,0x40000280,0x3f000000,63,63,63,0x23280,0x54880,328,10,0xbe800000,3,1,0xffffffff,0xffffffff,0x30800,0x391000,0x7c3b00,0xeff000,0
.long 20,44,54,0x75000,0x1a010,0xf54400,0xf62c00,0x11cc400,0x11cc800,0x391800,0x75200,0x122500,0x4081b000,0x40000280,0x3f000000,63,63,63,0x25280,0x54900,24,10,0xbe800000,3,0x80008000,0xffffffff,0xffffffff,0x31000,0x392000,0x7c4600,0xf0e000,0
.long 20,44,57,0x75000,0x1a018,0xf63000,0xf63400,0x11ccc00,0x11cd000,0x392400,0x7d200,0x126500,0x4081bb00,0x40000280,0x3f000000,63,63,63,0x27280,0x54980,344,10,0xbe800000,3,0x80008000,0xffffffff,0xffffffff,0x31800,0x393000,0x7c5100,0xf1d000,0
.long 20,44,48,0x75400,0x1a000,0xf71c00,0xf72000,0x1029400,0x1029800,0x3b0000,0x65600,0x102d00,0x4076b000,0x40000280,0x3f000000,63,63,63,0x21680,0x54a00,10,10,0xbe800000,3,1,0xffffffff,0xffffffff,0x34000,0x3b0000,0x7d9000,0xef0000,0
.long 20,44,51,0x75400,0x1a008,0xf72400,0xf80c00,0x1029c00,0x102a000,0x3b0c00,0x6d600,0x106d00,0x4076bb00,0x40000280,0x3f000000,63,63,63,0x23680,0x54a80,330,10,0xbe800000,3,1,0xffffffff,0xffffffff,0x34800,0x3b1000,0x7d9b00,0xeff000,0
.long 20,44,54,0x75400,0x1a010,0xf81000,0xf81400,0x102a400,0x1065400,0x3b1800,0x75600,0x122d00,0x4076b000,0x40000280,0x3f000000,63,63,63,0x25680,0x54b00,22,10,0xbe800000,3,0x80008000,0xffffffff,0xffffffff,0x35000,0x3b2000,0x7da600,0xf0e000,0
.long 20,44,57,0x75400,0x1a018,0xf8fc00,0xf90000,0x1065800,0x1065c00,0x3b2400,0x7d600,0x126d00,0x4076bb00,0x40000280,0x3f000000,63,63,63,0x27680,0x54b80,342,10,0xbe800000,3,0x80008000,0xffffffff,0xffffffff,0x35800,0x3b3000,0x7db100,0xf1d000,0
.long 20,44,48,0x7d800,0x1a000,0xf90400,0xf9ec00,0x1066000,0x1066400,0x3d0000,0x65a00,0x103500,0x406bb000,0x40000280,0x3f000000,63,63,63,0x21a80,0x54c00,12,10,0xbe800000,3,1,0xffffffff,0xffffffff,0x38000,0x3d0000,0x7ef000,0xef0000,0
.long 20,44,51,0x7d800,0x1a008,0xf9f000,0xf9f400,0x10a1400,0x10a1800,0x3d0c00,0x6da00,0x107500,0x406bbb00,0x40000280,0x3f000000,63,63,63,0x23a80,0x54c80,332,10,0xbe800000,3,1,0xffffffff,0xffffffff,0x38800,0x3d1000,0x7efb00,0xeff000,0
.long 20,44,54,0x7d800,0x1a010,0xfadc00,0xfae000,0x10a1c00,0x10a2000,0x3d1800,0x75a00,0x123500,0x406bb000,0x40000280,0x3f000000,63,63,63,0x25a80,0x54d00,20,10,0xbe800000,3,0x80008000,0xffffffff,0xffffffff,0x39000,0x3d2000,0x7f0600,0xf0e000,0
.long 20,44,57,0x7d800,0x1a018,0xfae400,0xfbcc00,0x10a2400,0x10dd400,0x3d2400,0x7da00,0x127500,0x406bbb00,0x40000280,0x3f000000,63,63,63,0x27a80,0x54d80,340,10,0xbe800000,3,0x80008000,0xffffffff,0xffffffff,0x39800,0x3d3000,0x7f1100,0xf1d000,0
.long 20,44,48,0x7dc00,0x1a000,0xfbd000,0xfbd400,0x10dd800,0x10ddc00,0x3f0000,0x65e00,0x103d00,0x4060b000,0x40000280,0x3f000000,63,63,63,0x21e80,0x54e00,14,10,0xbe800000,3,1,0xffffffff,0xffffffff,0x3c000,0x3f0000,0x805000,0xef0000,0
.long 20,44,51,0x7dc00,0x1a008,0xfcbc00,0xfcc000,0x10de000,0x10de400,0x3f0c00,0x6de00,0x107d00,0x4060bb00,0x40000280,0x3f000000,63,63,63,0x23e80,0x54e80,334,10,0xbe800000,3,1,0xffffffff,0xffffffff,0x3c800,0x3f1000,0x805b00,0xeff000,0
.long 20,44,54,0x7dc00,0x1a010,0xfcc400,0xfdac00,0x1119400,0x1119800,0x3f1800,0x75e00,0x123d00,0x4060b000,0x40000280,0x3f000000,63,63,63,0x25e80,0x54f00,18,10,0xbe800000,3,0x80008000,0xffffffff,0xffffffff,0x3d000,0x3f2000,0x806600,0xf0e000,0
.long 20,44,57,0x7dc00,0x1a018,0xfdb000,0xfdb400,0x1119c00,0x111a000,0x3f2400,0x7de00,0x127d00,0x4060bb00,0x40000280,0x3f000000,63,63,63,0x27e80,0x54f80,338,10,0xbe800000,3,0x80008000,0xffffffff,0xffffffff,0x3d800,0x3f3000,0x807100,0xf1d000,0
.long 20,44,60,0x64000,0x1a000,0xe0a800,0xe0ac00,0x111a400,0x1155400,0x314000,0x64280,0x140500,0x4060b000,0x40000280,0x3f000000,63,63,63,0x28280,0x55000,1,10,0xbe800000,3,1,0xffffffff,0xffffffff,0x22000,0x314000,0x76dc00,0xf2c000,0
.long 20,44,63,0x64000,0x1a008,0xe0b000,0xe19800,0x1155800,0x1155c00,0x314c00,0x6c280,0x144500,0x4060bb00,0x40000280,0x3f000000,63,63,63,0x2a280,0x55080,321,10,0xbe800000,3,1,0xffffffff,0xffffffff,0x22800,0x315000,0x76e700,0xf3b000,0
.long 20,44,66,0x64000,0x1a010,0xe19c00,0xe1a000,0x1156000,0x1156400,0x315800,0x74280,0x160500,0x4060b000,0x40000280,0x3f000000,63,63,63,0x2c280,0x55100,31,10,0xbe800000,3,0x80008000,0xffffffff,0xffffffff,0x23000,0x316000,0x76f200,0xf4a000,0
.long 20,44,69,0x64000,0x1a018,0xe28800,0xe28c00,0x1191400,0x1191800,0x316400,0x7c280,0x164500,0x4060bb00,0x40000280,0x3f000000,63,63,63,0x2e280,0x55180,351,10,0xbe800000,3,0x80008000,0xffffffff,0xffffffff,0x23800,0x317000,0x76fd00,0xf59000,0
.long 20,44,60,0x64400,0x1a000,0xe29000,0xe37800,0x1191c00,0x1192000,0x334000,0x64680,0x140d00,0x406bb000,0x40000280,0x3f000000,63,63,63,0x28680,0x55200,3,10,0xbe800000,3,1,0xffffffff,0xffffffff,0x26000,0x334000,0x783c00,0xf2c000,0
.long 20,44,63,0x64400,0x1a008,0xe37c00,0xe38000,0x1192400,0x11cd400,0x334c00,0x6c680,0x144d00,0x406bbb00,0x40000280,0x3f000000,63,63,63,0x2a680,0x55280,323,10,0xbe800000,3,1,0xffffffff,0xffffffff,0x26800,0x335000,0x784700,0xf3b000,0
.long 20,44,66,0x64400,0x1a010,0xe46800,0xe46c00,0x11cd800,0x11cdc00,0x335800,0x74680,0x160d00,0x406bb000,0x40000280,0x3f000000,63,63,63,0x2c680,0x55300,29,10,0xbe800000,3,0x80008000,0xffffffff,0xffffffff,0x27000,0x336000,0x785200,0xf4a000,0
.long 20,44,69,0x64400,0x1a018,0xe47000,0xe55800,0x11ce000,0x11ce400,0x336400,0x7c680,0x164d00,0x406bbb00,0x40000280,0x3f000000,63,63,63,0x2e680,0x55380,349,10,0xbe800000,3,0x80008000,0xffffffff,0xffffffff,0x27800,0x337000,0x785d00,0xf59000,0
.long 20,44,60,0x6c800,0x1a000,0xe55c00,0xe56000,0x102a800,0x102ac00,0x354000,0x64a80,0x141500,0x4076b000,0x40000280,0x3f000000,63,63,63,0x28a80,0x55400,5,10,0xbe800000,3,1,0xffffffff,0xffffffff,0x2a000,0x354000,0x799c00,0xf2c000,0
.long 20,44,63,0x6c800,0x1a008,0xe64800,0xe64c00,0x102b000,0x102b400,0x354c00,0x6ca80,0x145500,0x4076bb00,0x40000280,0x3f000000,63,63,63,0x2aa80,0x55480,325,10,0xbe800000,3,1,0xffffffff,0xffffffff,0x2a800,0x355000,0x79a700,0xf3b000,0
.long 20,44,66,0x6c800,0x1a010,0xe65000,0xe73800,0x102b800,0x1066800,0x355800,0x74a80,0x161500,0x4076b000,0x40000280,0x3f000000,63,63,63,0x2ca80,0x55500,27,10,0xbe800000,3,0x80008000,0xffffffff,0xffffffff,0x2b000,0x356000,0x79b200,0xf4a000,0
.long 20,44,69,0x6c800,0x1a018,0xe73c00,0xe74000,0x1066c00,0x1067000,0x356400,0x7ca80,0x165500,0x4076bb00,0x40000280,0x3f000000,63,63,63,0x2ea80,0x55580,347,10,0xbe800000,3,0x80008000,0xffffffff,0xffffffff,0x2b800,0x357000,0x79bd00,0xf59000,0
.long 20,44,60,0x6cc00,0x1a000,0xe82800,0xe82c00,0x1067400,0x1067800,0x374000,0x64e80,0x141d00,0x4081b000,0x40000280,0x3f000000,63,63,63,0x28e80,0x55600,7,10,0xbe800000,3,1,0xffffffff,0xffffffff,0x2e000,0x374000,0x7afc00,0xf2c000,0
.long 20,44,63,0x6cc00,0x1a008,0xe83000,0xe91800,0x10a2800,0x10a2c00,0x374c00,0x6ce80,0x145d00,0x4081bb00,0x40000280,0x3f000000,63,63,63,0x2ae80,0x55680,327,10,0xbe800000,3,1,0xffffffff,0xffffffff,0x2e800,0x375000,0x7b0700,0xf3b000,0
.long 20,44,66,0x6cc00,0x1a010,0xe91c00,0xe92000,0x10a3000,0x10a3400,0x375800,0x74e80,0x161d00,0x4081b000,0x40000280,0x3f000000,63,63,63,0x2ce80,0x55700,25,10,0xbe800000,3,0x80008000,0xffffffff,0xffffffff,0x2f000,0x376000,0x7b1200,0xf4a000,0
.long 20,44,69,0x6cc00,0x1a018,0xea0800,0xea0c00,0x10a3800,0x10de800,0x376400,0x7ce80,0x165d00,0x4081bb00,0x40000280,0x3f000000,63,63,63,0x2ee80,0x55780,345,10,0xbe800000,3,0x80008000,0xffffffff,0xffffffff,0x2f800,0x377000,0x7b1d00,0xf59000,0
.long 20,44,60,0x75000,0x1a000,0xea1000,0xeaf800,0x10dec00,0x10df000,0x394000,0x65280,0x142500,0x4081b000,0x40000280,0x3f000000,63,63,63,0x29280,0x55800,9,10,0xbe800000,3,1,0xffffffff,0xffffffff,0x32000,0x394000,0x7c5c00,0xf2c000,0
.long 20,44,63,0x75000,0x1a008,0xeafc00,0xeb0000,0x10df400,0x10df800,0x394c00,0x6d280,0x146500,0x4081bb00,0x40000280,0x3f000000,63,63,63,0x2b280,0x55880,329,10,0xbe800000,3,1,0xffffffff,0xffffffff,0x32800,0x395000,0x7c6700,0xf3b000,0
.long 20,44,66,0x75000,0x1a010,0xebe800,0xebec00,0x111a800,0x111ac00,0x395800,0x75280,0x162500,0x4081b000,0x40000280,0x3f000000,63,63,63,0x2d280,0x55900,23,10,0xbe800000,3,0x80008000,0xffffffff,0xffffffff,0x33000,0x396000,0x7c7200,0xf4a000,0
.long 20,44,69,0x75000,0x1a018,0xebf000,0xecd800,0x111b000,0x111b400,0x396400,0x7d280,0x166500,0x4081bb00,0x40000280,0x3f000000,63,63,63,0x2f280,0x55980,343,10,0xbe800000,3,0x80008000,0xffffffff,0xffffffff,0x33800,0x397000,0x7c7d00,0xf59000,0
.long 20,44,60,0x75400,0x1a000,0xecdc00,0xece000,0x111b800,0x1156800,0x3b4000,0x65680,0x142d00,0x4076b000,0x40000280,0x3f000000,63,63,63,0x29680,0x55a00,11,10,0xbe800000,3,1,0xffffffff,0xffffffff,0x36000,0x3b4000,0x7dbc00,0xf2c000,0
.long 20,44,63,0x75400,0x1a008,0xedc800,0xedcc00,0x1156c00,0x1157000,0x3b4c00,0x6d680,0x146d00,0x4076bb00,0x40000280,0x3f000000,63,63,63,0x2b680,0x55a80,331,10,0xbe800000,3,1,0xffffffff,0xffffffff,0x36800,0x3b5000,0x7dc700,0xf3b000,0
.long 20,44,66,0x75400,0x1a010,0xedd000,0xeeb800,0x1157400,0x1157800,0x3b5800,0x75680,0x162d00,0x4076b000,0x40000280,0x3f000000,63,63,63,0x2d680,0x55b00,21,10,0xbe800000,3,0x80008000,0xffffffff,0xffffffff,0x37000,0x3b6000,0x7dd200,0xf4a000,0
.long 20,44,69,0x75400,0x1a018,0xeebc00,0xeec000,0x1192800,0x1192c00,0x3b6400,0x7d680,0x166d00,0x4076bb00,0x40000280,0x3f000000,63,63,63,0x2f680,0x55b80,341,10,0xbe800000,3,0x80008000,0xffffffff,0xffffffff,0x37800,0x3b7000,0x7ddd00,0xf59000,0
.long 20,44,60,0x7d800,0x1a000,0xefa800,0xefac00,0x1193000,0x1193400,0x3d4000,0x65a80,0x143500,0x406bb000,0x40000280,0x3f000000,63,63,63,0x29a80,0x55c00,13,10,0xbe800000,3,1,0xffffffff,0xffffffff,0x3a000,0x3d4000,0x7f1c00,0xf2c000,0
.long 20,44,63,0x7d800,0x1a008,0xefb000,0xf09800,0x1193800,0x11ce800,0x3d4c00,0x6da80,0x147500,0x406bbb00,0x40000280,0x3f000000,63,63,63,0x2ba80,0x55c80,333,10,0xbe800000,3,1,0xffffffff,0xffffffff,0x3a800,0x3d5000,0x7f2700,0xf3b000,0
.long 20,44,66,0x7d800,0x1a010,0xf09c00,0xf0a000,0x11cec00,0x11cf000,0x3d5800,0x75a80,0x163500,0x406bb000,0x40000280,0x3f000000,63,63,63,0x2da80,0x55d00,19,10,0xbe800000,3,0x80008000,0xffffffff,0xffffffff,0x3b000,0x3d6000,0x7f3200,0xf4a000,0
.long 20,44,69,0x7d800,0x1a018,0xf18800,0xf18c00,0x11cf400,0x11cf800,0x3d6400,0x7da80,0x167500,0x406bbb00,0x40000280,0x3f000000,63,63,63,0x2fa80,0x55d80,339,10,0xbe800000,3,0x80008000,0xffffffff,0xffffffff,0x3b800,0x3d7000,0x7f3d00,0xf59000,0
.long 20,44,60,0x7dc00,0x1a000,0xf19000,0xf27800,0x102bc00,0x102c000,0x3f4000,0x65e80,0x143d00,0x4060b000,0x40000280,0x3f000000,63,63,63,0x29e80,0x55e00,15,10,0xbe800000,3,1,0xffffffff,0xffffffff,0x3e000,0x3f4000,0x807c00,0xf2c000,0
.long 20,44,63,0x7dc00,0x1a008,0xf27c00,0xf28000,0x102c400,0x102c800,0x3f4c00,0x6de80,0x147d00,0x4060bb00,0x40000280,0x3f000000,63,63,63,0x2be80,0x55e80,335,10,0xbe800000,3,1,0xffffffff,0xffffffff,0x3e800,0x3f5000,0x808700,0xf3b000,0
.long 20,44,66,0x7dc00,0x1a010,0xf36800,0xf36c00,0x102cc00,0x1067c00,0x3f5800,0x75e80,0x163d00,0x4060b000,0x40000280,0x3f000000,63,63,63,0x2de80,0x55f00,17,10,0xbe800000,3,0x80008000,0xffffffff,0xffffffff,0x3f000,0x3f6000,0x809200,0xf4a000,0
.long 20,44,69,0x7dc00,0x1a018,0xf37000,0xf45800,0x1068000,0x1068400,0x3f6400,0x7de80,0x167d00,0x4060bb00,0x40000280,0x3f000000,63,63,63,0x2fe80,0x55f80,337,10,0xbe800000,3,0x80008000,0xffffffff,0xffffffff,0x3f800,0x3f7000,0x809d00,0xf59000,0
.long 22,42,72,0x64000,0x1a000,0xf45c00,0xf46000,0x1068800,0x1068c00,0x318000,0x64300,0x180500,0x4060b000,0x40000280,0x3f000000,63,63,63,0x30280,0x56000,0,10,0xbe800000,3,0,0xffffffff,0,0x20000,0x318000,0x770800,0xf68000,0
.long 22,42,75,0x64000,0x1a008,0xf54800,0xf54c00,0x10a3c00,0x10a4000,0x318c00,0x6c300,0x184500,0x4060bb00,0x40000280,0x3f000000,63,63,63,0x32280,0x56080,320,10,0xbe800000,3,0,0xffffffff,0,0x20800,0x319000,0x771300,0xf77000,0
.long 22,42,78,0x64000,0x1a010,0xf55000,0xf63800,0x10a4400,0x10a4800,0x319800,0x74300,0x1a0500,0x4060b000,0x40000280,0x3f000000,63,63,63,0x34280,0x56100,16,10,0xbe800000,3,0,0,0xffffffff,0x21000,0x31a000,0x771e00,0xf86000,0
.long 22,42,81,0x64000,0x1a018,0xf63c00,0xf64000,0x10a4c00,0x10dfc00,0x31a400,0x7c300,0x1a4500,0x4060bb00,0x40000280,0x3f000000,63,63,63,0x36280,0x56180,336,10,0xbe800000,3,0,0,0xffffffff,0x21800,0x31b000,0x772900,0xf95000,0
.long 22,42,72,0x64400,0x1a000,0xf72800,0xf72c00,0x10e0000,0x10e0400,0x338000,0x64700,0x180d00,0x406bb000,0x40000280,0x3f000000,63,63,63,0x30680,0x56200,2,10,0xbe800000,3,1,0xffffffff,0xffffffff,0x24000,0x338000,0x786800,0xf68000,0
.long 22,42,75,0x64400,0x1a008,0xf73000,0xf81800,0x10e0800,0x10e0c00,0x338c00,0x6c700,0x184d00,0x406bbb00,0x40000280,0x3f000000,63,63,63,0x32680,0x56280,322,10,0xbe800000,3,1,0xffffffff,0xffffffff,0x24800,0x339000,0x787300,0xf77000,0
.long 22,42,78,0x64400,0x1a010,0xf81c00,0xf82000,0x111bc00,0x111c000,0x339800,0x74700,0x1a0d00,0x406bb000,0x40000280,0x3f000000,63,63,63,0x34680,0x56300,30,10,0xbe800000,3,0x80008000,0xffffffff,0xffffffff,0x25000,0x33a000,0x787e00,0xf86000,0
.long 22,42,81,0x64400,0x1a018,0xf90800,0xf90c00,0x111c400,0x111c800,0x33a400,0x7c700,0x1a4d00,0x406bbb00,0x40000280,0x3f000000,63,63,63,0x36680,0x56380,350,10,0xbe800000,3,0x80008000,0xffffffff,0xffffffff,0x25800,0x33b000,0x788900,0xf95000,0
.long 22,42,72,0x6c800,0x1a000,0xf91000,0xf9f800,0x111cc00,0x1157c00,0x358000,0x64b00,0x181500,0x4076b000,0x40000280,0x3f000000,63,63,63,0x30a80,0x56400,4,10,0xbe800000,3,1,0xffffffff,0xffffffff,0x28000,0x358000,0x79c800,0xf68000,0
.long 22,42,75,0x6c800,0x1a008,0xf9fc00,0xfa0000,0x1158000,0x1158400,0x358c00,0x6cb00,0x185500,0x4076bb00,0x40000280,0x3f000000,63,63,63,0x32a80,0x56480,324,10,0xbe800000,3,1,0xffffffff,0xffffffff,0x28800,0x359000,0x79d300,0xf77000,0
.long 22,42,78,0x6c800,0x1a010,0xfae800,0xfaec00,0x1158800,0x1158c00,0x359800,0x74b00,0x1a1500,0x4076b000,0x40000280,0x3f000000,63,63,63,0x34a80,0x56500,28,10,0xbe800000,3,0x80008000,0xffffffff,0xffffffff,0x29000,0x35a000,0x79de00,0xf86000,0
.long 22,42,81,0x6c800,0x1a018,0xfaf000,0xfbd800,0x1193c00,0x1194000,0x35a400,0x7cb00,0x1a5500,0x4076bb00,0x40000280,0x3f000000,63,63,63,0x36a80,0x56580,348,10,0xbe800000,3,0x80008000,0xffffffff,0xffffffff,0x29800,0x35b000,0x79e900,0xf95000,0
.long 22,42,72,0x6cc00,0x1a000,0xfbdc00,0xfbe000,0x1194400,0x1194800,0x378000,0x64f00,0x181d00,0x4081b000,0x40000280,0x3f000000,63,63,63,0x30e80,0x56600,6,10,0xbe800000,3,1,0xffffffff,0xffffffff,0x2c000,0x378000,0x7b2800,0xf68000,0
.long 22,42,75,0x6cc00,0x1a008,0xfcc800,0xfccc00,0x1194c00,0x11cfc00,0x378c00,0x6cf00,0x185d00,0x4081bb00,0x40000280,0x3f000000,63,63,63,0x32e80,0x56680,326,10,0xbe800000,3,1,0xffffffff,0xffffffff,0x2c800,0x379000,0x7b3300,0xf77000,0
.long 22,42,78,0x6cc00,0x1a010,0xfcd000,0xfdb800,0x11d0000,0x11d0400,0x379800,0x74f00,0x1a1d00,0x4081b000,0x40000280,0x3f000000,63,63,63,0x34e80,0x56700,26,10,0xbe800000,3,0x80008000,0xffffffff,0xffffffff,0x2d000,0x37a000,0x7b3e00,0xf86000,0
.long 22,42,81,0x6cc00,0x1a018,0xfdbc00,0xfdc000,0x11d0800,0x11d0c00,0x37a400,0x7cf00,0x1a5d00,0x4081bb00,0x40000280,0x3f000000,63,63,63,0x36e80,0x56780,346,10,0xbe800000,3,0x80008000,0xffffffff,0xffffffff,0x2d800,0x37b000,0x7b4900,0xf95000,0
.long 22,42,72,0x75000,0x1a000,0xe0b400,0xe0b800,0x102d000,0x102d400,0x398000,0x65300,0x182500,0x4081b000,0x40000280,0x3f000000,63,63,63,0x31280,0x56800,8,10,0xbe800000,3,1,0xffffffff,0xffffffff,0x30000,0x398000,0x7c8800,0xf68000,0
.long 22,42,75,0x75000,0x1a008,0xe0bc00,0xe1a400,0x102d800,0x102dc00,0x398c00,0x6d300,0x186500,0x4081bb00,0x40000280,0x3f000000,63,63,63,0x33280,0x56880,328,10,0xbe800000,3,1,0xffffffff,0xffffffff,0x30800,0x399000,0x7c9300,0xf77000,0
.long 22,42,78,0x75000,0x1a010,0xe1a800,0xe1ac00,0x102e000,0x1069000,0x399800,0x75300,0x1a2500,0x4081b000,0x40000280,0x3f000000,63,63,63,0x35280,0x56900,24,10,0xbe800000,3,0x80008000,0xffffffff,0xffffffff,0x31000,0x39a000,0x7c9e00,0xf86000,0
.long 22,42,81,0x75000,0x1a018,0xe29400,0xe29800,0x1069400,0x1069800,0x39a400,0x7d300,0x1a6500,0x4081bb00,0x40000280,0x3f000000,63,63,63,0x37280,0x56980,344,10,0xbe800000,3,0x80008000,0xffffffff,0xffffffff,0x31800,0x39b000,0x7ca900,0xf95000,0
.long 22,42,72,0x75400,0x1a000,0xe29c00,0xe38400,0x1069c00,0x106a000,0x3b8000,0x65700,0x182d00,0x4076b000,0x40000280,0x3f000000,63,63,63,0x31680,0x56a00,10,10,0xbe800000,3,1,0xffffffff,0xffffffff,0x34000,0x3b8000,0x7de800,0xf68000,0
.long 22,42,75,0x75400,0x1a008,0xe38800,0xe38c00,0x10a5000,0x10a5400,0x3b8c00,0x6d700,0x186d00,0x4076bb00,0x40000280,0x3f000000,63,63,63,0x33680,0x56a80,330,10,0xbe800000,3,1,0xffffffff,0xffffffff,0x34800,0x3b9000,0x7df300,0xf77000,0
.long 22,42,78,0x75400,0x1a010,0xe47400,0xe47800,0x10a5800,0x10a5c00,0x3b9800,0x75700,0x1a2d00,0x4076b000,0x40000280,0x3f000000,63,63,63,0x35680,0x56b00,22,10,0xbe800000,3,0x80008000,0xffffffff,0xffffffff,0x35000,0x3ba000,0x7dfe00,0xf86000,0
.long 22,42,81,0x75400,0x1a018,0xe47c00,0xe56400,0x10a6000,0x10e1000,0x3ba400,0x7d700,0x1a6d00,0x4076bb00,0x40000280,0x3f000000,63,63,63,0x37680,0x56b80,342,10,0xbe800000,3,0x80008000,0xffffffff,0xffffffff,0x35800,0x3bb000,0x7e0900,0xf95000,0
.long 22,42,72,0x7d800,0x1a000,0xe56800,0xe56c00,0x10e1400,0x10e1800,0x3d8000,0x65b00,0x183500,0x406bb000,0x40000280,0x3f000000,63,63,63,0x31a80,0x56c00,12,10,0xbe800000,3,1,0xffffffff,0xffffffff,0x38000,0x3d8000,0x7f4800,0xf68000,0
.long 22,42,75,0x7d800,0x1a008,0xe65400,0xe65800,0x10e1c00,0x10e2000,0x3d8c00,0x6db00,0x187500,0x406bbb00,0x40000280,0x3f000000,63,63,63,0x33a80,0x56c80,332,10,0xbe800000,3,1,0xffffffff,0xffffffff,0x38800,0x3d9000,0x7f5300,0xf77000,0
.long 22,42,78,0x7d800,0x1a010,0xe65c00,0xe74400,0x111d000,0x111d400,0x3d9800,0x75b00,0x1a3500,0x406bb000,0x40000280,0x3f000000,63,63,63,0x35a80,0x56d00,20,10,0xbe800000,3,0x80008000,0xffffffff,0xffffffff,0x39000,0x3da000,0x7f5e00,0xf86000,0
.long 22,42,81,0x7d800,0x1a018,0xe74800,0xe74c00,0x111d800,0x111dc00,0x3da400,0x7db00,0x1a7500,0x406bbb00,0x40000280,0x3f000000,63,63,63,0x37a80,0x56d80,340,10,0xbe800000,3,0x80008000,0xffffffff,0xffffffff,0x39800,0x3db000,0x7f6900,0xf95000,0
.long 22,42,72,0x7dc00,0x1a000,0xe83400,0xe83800,0x111e000,0x1159000,0x3f8000,0x65f00,0x183d00,0x4060b000,0x40000280,0x3f000000,63,63,63,0x31e80,0x56e00,14,10,0xbe800000,3,1,0xffffffff,0xffffffff,0x3c000,0x3f8000,0x80a800,0xf68000,0
.long 22,42,75,0x7dc00,0x1a008,0xe83c00,0xe92400,0x1159400,0x1159800,0x3f8c00,0x6df00,0x187d00,0x4060bb00,0x40000280,0x3f000000,63,63,63,0x33e80,0x56e80,334,10,0xbe800000,3,1,0xffffffff,0xffffffff,0x3c800,0x3f9000,0x80b300,0xf77000,0
.long 22,42,78,0x7dc00,0x1a010,0xe92800,0xe92c00,0x1159c00,0x115a000,0x3f9800,0x75f00,0x1a3d00,0x4060b000,0x40000280,0x3f000000,63,63,63,0x35e80,0x56f00,18,10,0xbe800000,3,0x80008000,0xffffffff,0xffffffff,0x3d000,0x3fa000,0x80be00,0xf86000,0
.long 22,42,81,0x7dc00,0x1a018,0xea1400,0xea1800,0x1195000,0x1195400,0x3fa400,0x7df00,0x1a7d00,0x4060bb00,0x40000280,0x3f000000,63,63,63,0x37e80,0x56f80,338,10,0xbe800000,3,0x80008000,0xffffffff,0xffffffff,0x3d800,0x3fb000,0x80c900,0xf95000,0
.long 22,42,84,0x64000,0x1a000,0xea1c00,0xeb0400,0x1195800,0x1195c00,0x31c000,0x64380,0x1c0500,0x4060b000,0x40000280,0x3f000000,63,63,63,0x38280,0x57000,1,10,0xbe800000,3,1,0xffffffff,0xffffffff,0x22000,0x31c000,0x773400,0xfa4000,0
.long 22,42,87,0x64000,0x1a008,0xeb0800,0xeb0c00,0x1196000,0x11d1000,0x31cc00,0x6c380,0x1c4500,0x4060bb00,0x40000280,0x3f000000,63,63,63,0x3a280,0x57080,321,10,0xbe800000,3,1,0xffffffff,0xffffffff,0x22800,0x31d000,0x773f00,0xfb3000,0
.long 22,42,90,0x64000,0x1a010,0xebf400,0xebf800,0x11d1400,0x11d1800,0x31d800,0x74380,0x1e0500,0x4060b000,0x40000280,0x3f000000,63,63,63,0x3c280,0x57100,31,10,0xbe800000,3,0x80008000,0xffffffff,0xffffffff,0x23000,0x31e000,0x774a00,0xfc2000,0
.long 22,42,93,0x64000,0x1a018,0xebfc00,0xece400,0x11d1c00,0x11d2000,0x31e400,0x7c380,0x1e4500,0x4060bb00,0x40000280,0x3f000000,63,63,63,0x3e280,0x57180,351,10,0xbe800000,3,0x80008000,0xffffffff,0xffffffff,0x23800,0x31f000,0x775500,0xfd1000,0
.long 22,42,84,0x64400,0x1a000,0xece800,0xecec00,0x102e400,0x102e800,0x33c000,0x64780,0x1c0d00,0x406bb000,0x40000280,0x3f000000,63,63,63,0x38680,0x57200,3,10,0xbe800000,3,1,0xffffffff,0xffffffff,0x26000,0x33c000,0x789400,0xfa4000,0
.long 22,42,87,0x64400,0x1a008,0xedd400,0xedd800,0x102ec00,0x102f000,0x33cc00,0x6c780,0x1c4d00,0x406bbb00,0x40000280,0x3f000000,63,63,63,0x3a680,0x57280,323,10,0xbe800000,3,1,0xffffffff,0xffffffff,0x26800,0x33d000,0x789f00,0xfb3000,0
.long 22,42,90,0x64400,0x1a010,0xeddc00,0xeec400,0x102f400,0x106a400,0x33d800,0x74780,0x1e0d00,0x406bb000,0x40000280,0x3f000000,63,63,63,0x3c680,0x57300,29,10,0xbe800000,3,0x80008000,0xffffffff,0xffffffff,0x27000,0x33e000,0x78aa00,0xfc2000,0
.long 22,42,93,0x64400,0x1a018,0xeec800,0xeecc00,0x106a800,0x106ac00,0x33e400,0x7c780,0x1e4d00,0x406bbb00,0x40000280,0x3f000000,63,63,63,0x3e680,0x57380,349,10,0xbe800000,3,0x80008000,0xffffffff,0xffffffff,0x27800,0x33f000,0x78b500,0xfd1000,0
.long 22,42,84,0x6c800,0x1a000,0xefb400,0xefb800,0x106b000,0x106b400,0x35c000,0x64b80,0x1c1500,0x4076b000,0x40000280,0x3f000000,63,63,63,0x38a80,0x57400,5,10,0xbe800000,3,1,0xffffffff,0xffffffff,0x2a000,0x35c000,0x79f400,0xfa4000,0
.long 22,42,87,0x6c800,0x1a008,0xefbc00,0xf0a400,0x10a6400,0x10a6800,0x35cc00,0x6cb80,0x1c5500,0x4076bb00,0x40000280,0x3f000000,63,63,63,0x3aa80,0x57480,325,10,0xbe800000,3,1,0xffffffff,0xffffffff,0x2a800,0x35d000,0x79ff00,0xfb3000,0
.long 22,42,90,0x6c800,0x1a010,0xf0a800,0xf0ac00,0x10a6c00,0x10a7000,0x35d800,0x74b80,0x1e1500,0x4076b000,0x40000280,0x3f000000,63,63,63,0x3ca80,0x57500,27,10,0xbe800000,3,0x80008000,0xffffffff,0xffffffff,0x2b000,0x35e000,0x7a0a00,0xfc2000,0
.long 22,42,93,0x6c800,0x1a018,0xf19400,0xf19800,0x10a7400,0x10e2400,0x35e400,0x7cb80,0x1e5500,0x4076bb00,0x40000280,0x3f000000,63,63,63,0x3ea80,0x57580,347,10,0xbe800000,3,0x80008000,0xffffffff,0xffffffff,0x2b800,0x35f000,0x7a1500,0xfd1000,0
.long 22,42,84,0x6cc00,0x1a000,0xf19c00,0xf28400,0x10e2800,0x10e2c00,0x37c000,0x64f80,0x1c1d00,0x4081b000,0x40000280,0x3f000000,63,63,63,0x38e80,0x57600,7,10,0xbe800000,3,1,0xffffffff,0xffffffff,0x2e000,0x37c000,0x7b5400,0xfa4000,0
.long 22,42,87,0x6cc00,0x1a008,0xf28800,0xf28c00,0x10e3000,0x10e3400,0x37cc00,0x6cf80,0x1c5d00,0x4081bb00,0x40000280,0x3f000000,63,63,63,0x3ae80,0x57680,327,10,0xbe800000,3,1,0xffffffff,0xffffffff,0x2e800,0x37d000,0x7b5f00,0xfb3000,0
.long 22,42,90,0x6cc00,0x1a010,0xf37400,0xf37800,0x111e400,0x111e800,0x37d800,0x74f80,0x1e1d00,0x4081b000,0x40000280,0x3f000000,63,63,63,0x3ce80,0x57700,25,10,0xbe800000,3,0x80008000,0xffffffff,0xffffffff,0x2f000,0x37e000,0x7b6a00,0xfc2000,0
.long 22,42,93,0x6cc00,0x1a018,0xf37c00,0xf46400,0x111ec00,0x111f000,0x37e400,0x7cf80,0x1e5d00,0x4081bb00,0x40000280,0x3f000000,63,63,63,0x3ee80,0x57780,345,10,0xbe800000,3,0x80008000,0xffffffff,0xffffffff,0x2f800,0x37f000,0x7b7500,0xfd1000,0
.long 22,42,84,0x75000,0x1a000,0xf46800,0xf46c00,0x111f400,0x115a400,0x39c000,0x65380,0x1c2500,0x4081b000,0x40000280,0x3f000000,63,63,63,0x39280,0x57800,9,10,0xbe800000,3,1,0xffffffff,0xffffffff,0x32000,0x39c000,0x7cb400,0xfa4000,0
.long 22,42,87,0x75000,0x1a008,0xf55400,0xf55800,0x115a800,0x115ac00,0x39cc00,0x6d380,0x1c6500,0x4081bb00,0x40000280,0x3f000000,63,63,63,0x3b280,0x57880,329,10,0xbe800000,3,1,0xffffffff,0xffffffff,0x32800,0x39d000,0x7cbf00,0xfb3000,0
.long 22,42,90,0x75000,0x1a010,0xf55c00,0xf64400,0x115b000,0x115b400,0x39d800,0x75380,0x1e2500,0x4081b000,0x40000280,0x3f000000,63,63,63,0x3d280,0x57900,23,10,0xbe800000,3,0x80008000,0xffffffff,0xffffffff,0x33000,0x39e000,0x7cca00,0xfc2000,0
.long 22,42,93,0x75000,0x1a018,0xf64800,0xf64c00,0x1196400,0x1196800,0x39e400,0x7d380,0x1e6500,0x4081bb00,0x40000280,0x3f000000,63,63,63,0x3f280,0x57980,343,10,0xbe800000,3,0x80008000,0xffffffff,0xffffffff,0x33800,0x39f000,0x7cd500,0xfd1000,0
.long 22,42,84,0x75400,0x1a000,0xf73400,0xf73800,0x1196c00,0x1197000,0x3bc000,0x65780,0x1c2d00,0x4076b000,0x40000280,0x3f000000,63,63,63,0x39680,0x57a00,11,10,0xbe800000,3,1,0xffffffff,0xffffffff,0x36000,0x3bc000,0x7e1400,0xfa4000,0
.long 22,42,87,0x75400,0x1a008,0xf73c00,0xf82400,0x1197400,0x11d2400,0x3bcc00,0x6d780,0x1c6d00,0x4076bb00,0x40000280,0x3f000000,63,63,63,0x3b680,0x57a80,331,10,0xbe800000,3,1,0xffffffff,0xffffffff,0x36800,0x3bd000,0x7e1f00,0xfb3000,0
.long 22,42,90,0x75400,0x1a010,0xf82800,0xf82c00,0x11d2800,0x11d2c00,0x3bd800,0x75780,0x1e2d00,0x4076b000,0x40000280,0x3f000000,63,63,63,0x3d680,0x57b00,21,10,0xbe800000,3,0x80008000,0xffffffff,0xffffffff,0x37000,0x3be000,0x7e2a00,0xfc2000,0
.long 22,42,93,0x75400,0x1a018,0xf91400,0xf91800,0x11d3000,0x11d3400,0x3be400,0x7d780,0x1e6d00,0x4076bb00,0x40000280,0x3f000000,63,63,63,0x3f680,0x57b80,341,10,0xbe800000,3,0x80008000,0xffffffff,0xffffffff,0x37800,0x3bf000,0x7e3500,0xfd1000,0
.long 22,42,84,0x7d800,0x1a000,0xf91c00,0xfa0400,0x102f800,0x102fc00,0x3dc000,0x65b80,0x1c3500,0x406bb000,0x40000280,0x3f000000,63,63,63,0x39a80,0x57c00,13,10,0xbe800000,3,1,0xffffffff,0xffffffff,0x3a000,0x3dc000,0x7f7400,0xfa4000,0
.long 22,42,87,0x7d800,0x1a008,0xfa0800,0xfa0c00,0x1030000,0x1030400,0x3dcc00,0x6db80,0x1c7500,0x406bbb00,0x40000280,0x3f000000,63,63,63,0x3ba80,0x57c80,333,10,0xbe800000,3,1,0xffffffff,0xffffffff,0x3a800,0x3dd000,0x7f7f00,0xfb3000,0
.long 22,42,90,0x7d800,0x1a010,0xfaf400,0xfaf800,0x1030800,0x106b800,0x3dd800,0x75b80,0x1e3500,0x406bb000,0x40000280,0x3f000000,63,63,63,0x3da80,0x57d00,19,10,0xbe800000,3,0x80008000,0xffffffff,0xffffffff,0x3b000,0x3de000,0x7f8a00,0xfc2000,0
.long 22,42,93,0x7d800,0x1a018,0xfafc00,0xfbe400,0x106bc00,0x106c000,0x3de400,0x7db80,0x1e7500,0x406bbb00,0x40000280,0x3f000000,63,63,63,0x3fa80,0x57d80,339,10,0xbe800000,3,0x80008000,0xffffffff,0xffffffff,0x3b800,0x3df000,0x7f9500,0xfd1000,0
.long 22,42,84,0x7dc00,0x1a000,0xfbe800,0xfbec00,0x106c400,0x106c800,0x3fc000,0x65f80,0x1c3d00,0x4060b000,0x40000280,0x3f000000,63,63,63,0x39e80,0x57e00,15,10,0xbe800000,3,1,0xffffffff,0xffffffff,0x3e000,0x3fc000,0x80d400,0xfa4000,0
.long 22,42,87,0x7dc00,0x1a008,0xfcd400,0xfcd800,0x10a7800,0x10a7c00,0x3fcc00,0x6df80,0x1c7d00,0x4060bb00,0x40000280,0x3f000000,63,63,63,0x3be80,0x57e80,335,10,0xbe800000,3,1,0xffffffff,0xffffffff,0x3e800,0x3fd000,0x80df00,0xfb3000,0
.long 22,42,90,0x7dc00,0x1a010,0xfcdc00,0xfdc400,0x10a8000,0x10a8400,0x3fd800,0x75f80,0x1e3d00,0x4060b000,0x40000280,0x3f000000,63,63,63,0x3de80,0x57f00,17,10,0xbe800000,3,0x80008000,0xffffffff,0xffffffff,0x3f000,0x3fe000,0x80ea00,0xfc2000,0
.long 22,42,93,0x7dc00,0x1a018,0xfdc800,0xfdcc00,0x10a8800,0x10e3800,0x3fe400,0x7df80,0x1e7d00,0x4060bb00,0x40000280,0x3f000000,63,63,63,0x3fe80,0x57f80,337,10,0xbe800000,3,0x80008000,0xffffffff,0xffffffff,0x3f800,0x3ff000,0x80f500,0xfd1000,0
.long 24,40,0,0x66000,0x1a002,0xe0c000,0xe0c400,0x10e3c00,0x10e4000,0x400000,0x66000,0x100600,0x40610800,0x40000280,0x3f000000,63,63,63,0x20300,0x58000,0,10,0xbe800000,3,0,0xffffffff,0,0x20000,0x400000,0x810000,0xe00000,0
.long 24,40,3,0x66000,0x1a00a,0xe0c800,0xe1b000,0x10e4400,0x10e4800,0x400c00,0x6e000,0x104600,0x40611300,0x40000280,0x3f000000,63,63,63,0x22300,0x58080,320,10,0xbe800000,3,0,0xffffffff,0,0x20800,0x401000,0x810b00,0xe0f000,0
.long 24,40,6,0x66000,0x1a012,0xe1b400,0xe1b800,0x111f800,0x111fc00,0x401800,0x76000,0x120600,0x610800,0x40000280,0x3f000000,63,63,63,0x24300,0x58100,16,10,0xbe800000,3,0,0,0xffffffff,0x21000,0x402000,0x811600,0xe1e000,0
.long 24,40,9,0x66000,0x1a01a,0xe2a000,0xe2a400,0x1120000,0x1120400,0x402400,0x7e000,0x124600,0x611300,640,0x3f000000,63,63,63,0x26300,0x58180,336,10,0xbe800000,3,0,0,0xffffffff,0x21800,0x403000,0x812100,0xe2d000,0
.long 24,40,0,0x66400,0x1a002,0xe2a800,0xe39000,0x1120800,0x115b800,0x420000,0x66400,0x100e00,0x406c0800,0x40000280,0x3f000000,63,63,63,0x20700,0x58200,2,10,0xbe800000,3,1,0xffffffff,0xffffffff,0x24000,0x420000,0x826000,0xe00000,0
.long 24,40,3,0x66400,0x1a00a,0xe39400,0xe39800,0x115bc00,0x115c000,0x420c00,0x6e400,0x104e00,0x406c1300,0x40000280,0x3f000000,63,63,63,0x22700,0x58280,322,10,0xbe800000,3,1,0xffffffff,0xffffffff,0x24800,0x421000,0x826b00,0xe0f000,0
.long 24,40,6,0x66400,0x1a012,0xe48000,0xe48400,0x115c400,0x115c800,0x421800,0x76400,0x120e00,0x6c0800,0x40000280,0x3f000000,63,63,63,0x24700,0x58300,30,10,0xbe800000,3,0x80008000,0xffffffff,0xffffffff,0x25000,0x422000,0x827600,0xe1e000,0
.long 24,40,9,0x66400,0x1a01a,0xe48800,0xe57000,0x1197800,0x1197c00,0x422400,0x7e400,0x124e00,0x6c1300,640,0x3f000000,63,63,63,0x26700,0x58380,350,10,0xbe800000,3,0x80008000,0xffffffff,0xffffffff,0x25800,0x423000,0x828100,0xe2d000,0
.long 24,40,0,0x6e800,0x1a002,0xe57400,0xe57800,0x1198000,0x1198400,0x440000,0x66800,0x101600,0x40770800,0x40000280,0x3f000000,63,63,63,0x20b00,0x58400,4,10,0xbe800000,3,1,0xffffffff,0xffffffff,0x28000,0x440000,0x83c000,0xe00000,0
.long 24,40,3,0x6e800,0x1a00a,0xe66000,0xe66400,0x1198800,0x11d3800,0x440c00,0x6e800,0x105600,0x40771300,0x40000280,0x3f000000,63,63,63,0x22b00,0x58480,324,10,0xbe800000,3,1,0xffffffff,0xffffffff,0x28800,0x441000,0x83cb00,0xe0f000,0
.long 24,40,6,0x6e800,0x1a012,0xe66800,0xe75000,0x11d3c00,0x11d4000,0x441800,0x76800,0x121600,0x770800,0x40000280,0x3f000000,63,63,63,0x24b00,0x58500,28,10,0xbe800000,3,0x80008000,0xffffffff,0xffffffff,0x29000,0x442000,0x83d600,0xe1e000,0
.long 24,40,9,0x6e800,0x1a01a,0xe75400,0xe75800,0x11d4400,0x11d4800,0x442400,0x7e800,0x125600,0x771300,640,0x3f000000,63,63,63,0x26b00,0x58580,348,10,0xbe800000,3,0x80008000,0xffffffff,0xffffffff,0x29800,0x443000,0x83e100,0xe2d000,0
.long 24,40,0,0x6ec00,0x1a002,0xe84000,0xe84400,0x1030c00,0x1031000,0x460000,0x66c00,0x101e00,0x40820800,0x40000280,0x3f000000,63,63,63,0x20f00,0x58600,6,10,0xbe800000,3,1,0xffffffff,0xffffffff,0x2c000,0x460000,0x852000,0xe00000,0
.long 24,40,3,0x6ec00,0x1a00a,0xe84800,0xe93000,0x1031400,0x1031800,0x460c00,0x6ec00,0x105e00,0x40821300,0x40000280,0x3f000000,63,63,63,0x22f00,0x58680,326,10,0xbe800000,3,1,0xffffffff,0xffffffff,0x2c800,0x461000,0x852b00,0xe0f000,0
.long 24,40,6,0x6ec00,0x1a012,0xe93400,0xe93800,0x1031c00,0x106cc00,0x461800,0x76c00,0x121e00,0x820800,0x40000280,0x3f000000,63,63,63,0x24f00,0x58700,26,10,0xbe800000,3,0x80008000,0xffffffff,0xffffffff,0x2d000,0x462000,0x853600,0xe1e000,0
.long 24,40,9,0x6ec00,0x1a01a,0xea2000,0xea2400,0x106d000,0x106d400,0x462400,0x7ec00,0x125e00,0x821300,640,0x3f000000,63,63,63,0x26f00,0x58780,346,10,0xbe800000,3,0x80008000,0xffffffff,0xffffffff,0x2d800,0x463000,0x854100,0xe2d000,0
.long 24,40,0,0x77000,0x1a002,0xea2800,0xeb1000,0x106d800,0x106dc00,0x480000,0x67000,0x102600,0x40815800,0x40000280,0x3f000000,63,63,63,0x21300,0x58800,8,10,0xbe800000,3,1,0xffffffff,0xffffffff,0x30000,0x480000,0x868000,0xe00000,0
.long 24,40,3,0x77000,0x1a00a,0xeb1400,0xeb1800,0x10a8c00,0x10a9000,0x480c00,0x6f000,0x106600,0x40816300,0x40000280,0x3f000000,63,63,63,0x23300,0x58880,328,10,0xbe800000,3,1,0xffffffff,0xffffffff,0x30800,0x481000,0x868b00,0xe0f000,0
.long 24,40,6,0x77000,0x1a012,0xec0000,0xec0400,0x10a9400,0x10a9800,0x481800,0x77000,0x122600,0x40815800,0x40000280,0x3f000000,63,63,63,0x25300,0x58900,24,10,0xbe800000,3,0x80008000,0xffffffff,0xffffffff,0x31000,0x482000,0x869600,0xe1e000,0
.long 24,40,9,0x77000,0x1a01a,0xec0800,0xecf000,0x10a9c00,0x10e4c00,0x482400,0x7f000,0x126600,0x40816300,0x40000280,0x3f000000,63,63,63,0x27300,0x58980,344,10,0xbe800000,3,0x80008000,0xffffffff,0xffffffff,0x31800,0x483000,0x86a100,0xe2d000,0
.long 24,40,0,0x77400,0x1a002,0xecf400,0xecf800,0x10e5000,0x10e5400,0x4a0000,0x67400,0x102e00,0x40765800,0x40000280,0x3f000000,63,63,63,0x21700,0x58a00,10,10,0xbe800000,3,1,0xffffffff,0xffffffff,0x34000,0x4a0000,0x87e000,0xe00000,0
.long 24,40,3,0x77400,0x1a00a,0xede000,0xede400,0x10e5800,0x10e5c00,0x4a0c00,0x6f400,0x106e00,0x40766300,0x40000280,0x3f000000,63,63,63,0x23700,0x58a80,330,10,0xbe800000,3,1,0xffffffff,0xffffffff,0x34800,0x4a1000,0x87eb00,0xe0f000,0
.long 24,40,6,0x77400,0x1a012,0xede800,0xeed000,0x1120c00,0x1121000,0x4a1800,0x77400,0x122e00,0x40765800,0x40000280,0x3f000000,63,63,63,0x25700,0x58b00,22,10,0xbe800000,3,0x80008000,0xffffffff,0xffffffff,0x35000,0x4a2000,0x87f600,0xe1e000,0
.long 24,40,9,0x77400,0x1a01a,0xeed400,0xeed800,0x1121400,0x1121800,0x4a2400,0x7f400,0x126e00,0x40766300,0x40000280,0x3f000000,63,63,63,0x27700,0x58b80,342,10,0xbe800000,3,0x80008000,0xffffffff,0xffffffff,0x35800,0x4a3000,0x880100,0xe2d000,0
.long 24,40,0,0x7f800,0x1a002,0xefc000,0xefc400,0x1121c00,0x115cc00,0x4c0000,0x67800,0x103600,0x406b5800,0x40000280,0x3f000000,63,63,63,0x21b00,0x58c00,12,10,0xbe800000,3,1,0xffffffff,0xffffffff,0x38000,0x4c0000,0x894000,0xe00000,0
.long 24,40,3,0x7f800,0x1a00a,0xefc800,0xf0b000,0x115d000,0x115d400,0x4c0c00,0x6f800,0x107600,0x406b6300,0x40000280,0x3f000000,63,63,63,0x23b00,0x58c80,332,10,0xbe800000,3,1,0xffffffff,0xffffffff,0x38800,0x4c1000,0x894b00,0xe0f000,0
.long 24,40,6,0x7f800,0x1a012,0xf0b400,0xf0b800,0x115d800,0x115dc00,0x4c1800,0x77800,0x123600,0x406b5800,0x40000280,0x3f000000,63,63,63,0x25b00,0x58d00,20,10,0xbe800000,3,0x80008000,0xffffffff,0xffffffff,0x39000,0x4c2000,0x895600,0xe1e000,0
.long 24,40,9,0x7f800,0x1a01a,0xf1a000,0xf1a400,0x1198c00,0x1199000,0x4c2400,0x7f800,0x127600,0x406b6300,0x40000280,0x3f000000,63,63,63,0x27b00,0x58d80,340,10,0xbe800000,3,0x80008000,0xffffffff,0xffffffff,0x39800,0x4c3000,0x896100,0xe2d000,0
.long 24,40,0,0x7fc00,0x1a002,0xf1a800,0xf29000,0x1199400,0x1199800,0x4e0000,0x67c00,0x103e00,0x40605800,0x40000280,0x3f000000,63,63,63,0x21f00,0x58e00,14,10,0xbe800000,3,1,0xffffffff,0xffffffff,0x3c000,0x4e0000,0x8aa000,0xe00000,0
.long 24,40,3,0x7fc00,0x1a00a,0xf29400,0xf29800,0x1199c00,0x11d4c00,0x4e0c00,0x6fc00,0x107e00,0x40606300,0x40000280,0x3f000000,63,63,63,0x23f00,0x58e80,334,10,0xbe800000,3,1,0xffffffff,0xffffffff,0x3c800,0x4e1000,0x8aab00,0xe0f000,0
.long 24,40,6,0x7fc00,0x1a012,0xf38000,0xf38400,0x11d5000,0x11d5400,0x4e1800,0x77c00,0x123e00,0x40605800,0x40000280,0x3f000000,63,63,63,0x25f00,0x58f00,18,10,0xbe800000,3,0x80008000,0xffffffff,0xffffffff,0x3d000,0x4e2000,0x8ab600,0xe1e000,0
.long 24,40,9,0x7fc00,0x1a01a,0xf38800,0xf47000,0x11d5800,0x11d5c00,0x4e2400,0x7fc00,0x127e00,0x40606300,0x40000280,0x3f000000,63,63,63,0x27f00,0x58f80,338,10,0xbe800000,3,0x80008000,0xffffffff,0xffffffff,0x3d800,0x4e3000,0x8ac100,0xe2d000,0
.long 24,40,12,0x66000,0x1a002,0xf47400,0xf47800,0x1032000,0x1032400,0x404000,0x66080,0x140600,0x40610800,0x40000280,0x3f000000,63,63,63,0x28300,0x59000,1,10,0xbe800000,3,1,0xffffffff,0xffffffff,0x22000,0x404000,0x812c00,0xe3c000,0
.long 24,40,15,0x66000,0x1a00a,0xf56000,0xf56400,0x1032800,0x1032c00,0x404c00,0x6e080,0x144600,0x40611300,0x40000280,0x3f000000,63,63,63,0x2a300,0x59080,321,10,0xbe800000,3,1,0xffffffff,0xffffffff,0x22800,0x405000,0x813700,0xe4b000,0
.long 24,40,18,0x66000,0x1a012,0xf56800,0xf65000,0x1033000,0x106e000,0x405800,0x76080,0x160600,0x40610800,0x40000280,0x3f000000,63,63,63,0x2c300,0x59100,31,10,0xbe800000,3,0x80008000,0xffffffff,0xffffffff,0x23000,0x406000,0x814200,0xe5a000,0
.long 24,40,21,0x66000,0x1a01a,0xf65400,0xf65800,0x106e400,0x106e800,0x406400,0x7e080,0x164600,0x40611300,0x40000280,0x3f000000,63,63,63,0x2e300,0x59180,351,10,0xbe800000,3,0x80008000,0xffffffff,0xffffffff,0x23800,0x407000,0x814d00,0xe69000,0
.long 24,40,12,0x66400,0x1a002,0xf74000,0xf74400,0x106ec00,0x106f000,0x424000,0x66480,0x140e00,0x406c0800,0x40000280,0x3f000000,63,63,63,0x28700,0x59200,3,10,0xbe800000,3,1,0xffffffff,0xffffffff,0x26000,0x424000,0x828c00,0xe3c000,0
.long 24,40,15,0x66400,0x1a00a,0xf74800,0xf83000,0x10aa000,0x10aa400,0x424c00,0x6e480,0x144e00,0x406c1300,0x40000280,0x3f000000,63,63,63,0x2a700,0x59280,323,10,0xbe800000,3,1,0xffffffff,0xffffffff,0x26800,0x425000,0x829700,0xe4b000,0
.long 24,40,18,0x66400,0x1a012,0xf83400,0xf83800,0x10aa800,0x10aac00,0x425800,0x76480,0x160e00,0x406c0800,0x40000280,0x3f000000,63,63,63,0x2c700,0x59300,29,10,0xbe800000,3,0x80008000,0xffffffff,0xffffffff,0x27000,0x426000,0x82a200,0xe5a000,0
.long 24,40,21,0x66400,0x1a01a,0xf92000,0xf92400,0x10ab000,0x10e6000,0x426400,0x7e480,0x164e00,0x406c1300,0x40000280,0x3f000000,63,63,63,0x2e700,0x59380,349,10,0xbe800000,3,0x80008000,0xffffffff,0xffffffff,0x27800,0x427000,0x82ad00,0xe69000,0
.long 24,40,12,0x6e800,0x1a002,0xf92800,0xfa1000,0x10e6400,0x10e6800,0x444000,0x66880,0x141600,0x40770800,0x40000280,0x3f000000,63,63,63,0x28b00,0x59400,5,10,0xbe800000,3,1,0xffffffff,0xffffffff,0x2a000,0x444000,0x83ec00,0xe3c000,0
.long 24,40,15,0x6e800,0x1a00a,0xfa1400,0xfa1800,0x10e6c00,0x10e7000,0x444c00,0x6e880,0x145600,0x40771300,0x40000280,0x3f000000,63,63,63,0x2ab00,0x59480,325,10,0xbe800000,3,1,0xffffffff,0xffffffff,0x2a800,0x445000,0x83f700,0xe4b000,0
.long 24,40,18,0x6e800,0x1a012,0xfb0000,0xfb0400,0x1122000,0x1122400,0x445800,0x76880,0x161600,0x40770800,0x40000280,0x3f000000,63,63,63,0x2cb00,0x59500,27,10,0xbe800000,3,0x80008000,0xffffffff,0xffffffff,0x2b000,0x446000,0x840200,0xe5a000,0
.long 24,40,21,0x6e800,0x1a01a,0xfb0800,0xfbf000,0x1122800,0x1122c00,0x446400,0x7e880,0x165600,0x40771300,0x40000280,0x3f000000,63,63,63,0x2eb00,0x59580,347,10,0xbe800000,3,0x80008000,0xffffffff,0xffffffff,0x2b800,0x447000,0x840d00,0xe69000,0
.long 24,40,12,0x6ec00,0x1a002,0xfbf400,0xfbf800,0x1123000,0x115e000,0x464000,0x66c80,0x141e00,0x40820800,0x40000280,0x3f000000,63,63,63,0x28f00,0x59600,7,10,0xbe800000,3,1,0xffffffff,0xffffffff,0x2e000,0x464000,0x854c00,0xe3c000,0
.long 24,40,15,0x6ec00,0x1a00a,0xfce000,0xfce400,0x115e400,0x115e800,0x464c00,0x6ec80,0x145e00,0x40821300,0x40000280,0x3f000000,63,63,63,0x2af00,0x59680,327,10,0xbe800000,3,1,0xffffffff,0xffffffff,0x2e800,0x465000,0x855700,0xe4b000,0
.long 24,40,18,0x6ec00,0x1a012,0xfce800,0xfdd000,0x115ec00,0x115f000,0x465800,0x76c80,0x161e00,0x40820800,0x40000280,0x3f000000,63,63,63,0x2cf00,0x59700,25,10,0xbe800000,3,0x80008000,0xffffffff,0xffffffff,0x2f000,0x466000,0x856200,0xe5a000,0
.long 24,40,21,0x6ec00,0x1a01a,0xfdd400,0xfdd800,0x119a000,0x119a400,0x466400,0x7ec80,0x165e00,0x40821300,0x40000280,0x3f000000,63,63,63,0x2ef00,0x59780,345,10,0xbe800000,3,0x80008000,0xffffffff,0xffffffff,0x2f800,0x467000,0x856d00,0xe69000,0
.long 24,40,12,0x77000,0x1a002,0xe0cc00,0xe0d000,0x119a800,0x119ac00,0x484000,0x67080,0x142600,0x40815800,0x40000280,0x3f000000,63,63,63,0x29300,0x59800,9,10,0xbe800000,3,1,0xffffffff,0xffffffff,0x32000,0x484000,0x86ac00,0xe3c000,0
.long 24,40,15,0x77000,0x1a00a,0xe0d400,0xe1bc00,0x119b000,0x11d6000,0x484c00,0x6f080,0x146600,0x40816300,0x40000280,0x3f000000,63,63,63,0x2b300,0x59880,329,10,0xbe800000,3,1,0xffffffff,0xffffffff,0x32800,0x485000,0x86b700,0xe4b000,0
.long 24,40,18,0x77000,0x1a012,0xe1c000,0xe1c400,0x11d6400,0x11d6800,0x485800,0x77080,0x162600,0x40815800,0x40000280,0x3f000000,63,63,63,0x2d300,0x59900,23,10,0xbe800000,3,0x80008000,0xffffffff,0xffffffff,0x33000,0x486000,0x86c200,0xe5a000,0
.long 24,40,21,0x77000,0x1a01a,0xe2ac00,0xe2b000,0x11d6c00,0x11d7000,0x486400,0x7f080,0x166600,0x40816300,0x40000280,0x3f000000,63,63,63,0x2f300,0x59980,343,10,0xbe800000,3,0x80008000,0xffffffff,0xffffffff,0x33800,0x487000,0x86cd00,0xe69000,0
.long 24,40,12,0x77400,0x1a002,0xe2b400,0xe39c00,0x1033400,0x1033800,0x4a4000,0x67480,0x142e00,0x40765800,0x40000280,0x3f000000,63,63,63,0x29700,0x59a00,11,10,0xbe800000,3,1,0xffffffff,0xffffffff,0x36000,0x4a4000,0x880c00,0xe3c000,0
.long 24,40,15,0x77400,0x1a00a,0xe3a000,0xe3a400,0x1033c00,0x1034000,0x4a4c00,0x6f480,0x146e00,0x40766300,0x40000280,0x3f000000,63,63,63,0x2b700,0x59a80,331,10,0xbe800000,3,1,0xffffffff,0xffffffff,0x36800,0x4a5000,0x881700,0xe4b000,0
.long 24,40,18,0x77400,0x1a012,0xe48c00,0xe49000,0x1034400,0x106f400,0x4a5800,0x77480,0x162e00,0x40765800,0x40000280,0x3f000000,63,63,63,0x2d700,0x59b00,21,10,0xbe800000,3,0x80008000,0xffffffff,0xffffffff,0x37000,0x4a6000,0x882200,0xe5a000,0
.long 24,40,21,0x77400,0x1a01a,0xe49400,0xe57c00,0x106f800,0x106fc00,0x4a6400,0x7f480,0x166e00,0x40766300,0x40000280,0x3f000000,63,63,63,0x2f700,0x59b80,341,10,0xbe800000,3,0x80008000,0xffffffff,0xffffffff,0x37800,0x4a7000,0x882d00,0xe69000,0
.long 24,40,12,0x7f800,0x1a002,0xe58000,0xe58400,0x1070000,0x1070400,0x4c4000,0x67880,0x143600,0x406b5800,0x40000280,0x3f000000,63,63,63,0x29b00,0x59c00,13,10,0xbe800000,3,1,0xffffffff,0xffffffff,0x3a000,0x4c4000,0x896c00,0xe3c000,0
.long 24,40,15,0x7f800,0x1a00a,0xe66c00,0xe67000,0x10ab400,0x10ab800,0x4c4c00,0x6f880,0x147600,0x406b6300,0x40000280,0x3f000000,63,63,63,0x2bb00,0x59c80,333,10,0xbe800000,3,1,0xffffffff,0xffffffff,0x3a800,0x4c5000,0x897700,0xe4b000,0
.long 24,40,18,0x7f800,0x1a012,0xe67400,0xe75c00,0x10abc00,0x10ac000,0x4c5800,0x77880,0x163600,0x406b5800,0x40000280,0x3f000000,63,63,63,0x2db00,0x59d00,19,10,0xbe800000,3,0x80008000,0xffffffff,0xffffffff,0x3b000,0x4c6000,0x898200,0xe5a000,0
.long 24,40,21,0x7f800,0x1a01a,0xe76000,0xe76400,0x10ac400,0x10e7400,0x4c6400,0x7f880,0x167600,0x406b6300,0x40000280,0x3f000000,63,63,63,0x2fb00,0x59d80,339,10,0xbe800000,3,0x80008000,0xffffffff,0xffffffff,0x3b800,0x4c7000,0x898d00,0xe69000,0
.long 24,40,12,0x7fc00,0x1a002,0xe84c00,0xe85000,0x10e7800,0x10e7c00,0x4e4000,0x67c80,0x143e00,0x40605800,0x40000280,0x3f000000,63,63,63,0x29f00,0x59e00,15,10,0xbe800000,3,1,0xffffffff,0xffffffff,0x3e000,0x4e4000,0x8acc00,0xe3c000,0
.long 24,40,15,0x7fc00,0x1a00a,0xe85400,0xe93c00,0x10e8000,0x10e8400,0x4e4c00,0x6fc80,0x147e00,0x40606300,0x40000280,0x3f000000,63,63,63,0x2bf00,0x59e80,335,10,0xbe800000,3,1,0xffffffff,0xffffffff,0x3e800,0x4e5000,0x8ad700,0xe4b000,0
.long 24,40,18,0x7fc00,0x1a012,0xe94000,0xe94400,0x1123400,0x1123800,0x4e5800,0x77c80,0x163e00,0x40605800,0x40000280,0x3f000000,63,63,63,0x2df00,0x59f00,17,10,0xbe800000,3,0x80008000,0xffffffff,0xffffffff,0x3f000,0x4e6000,0x8ae200,0xe5a000,0
.long 24,40,21,0x7fc00,0x1a01a,0xea2c00,0xea3000,0x1123c00,0x1124000,0x4e6400,0x7fc80,0x167e00,0x40606300,0x40000280,0x3f000000,63,63,63,0x2ff00,0x59f80,337,10,0xbe800000,3,0x80008000,0xffffffff,0xffffffff,0x3f800,0x4e7000,0x8aed00,0xe69000,0
.long 26,38,24,0x66000,0x1a002,0xea3400,0xeb1c00,0x1124400,0x115f400,0x408000,0x66100,0x180600,0x40610800,0x40000280,0x3f000000,63,63,63,0x30300,0x5a000,0,10,0xbe800000,3,0,0xffffffff,0,0x20000,0x408000,0x815800,0xe78000,0
.long 26,38,27,0x66000,0x1a00a,0xeb2000,0xeb2400,0x115f800,0x115fc00,0x408c00,0x6e100,0x184600,0x40611300,0x40000280,0x3f000000,63,63,63,0x32300,0x5a080,320,10,0xbe800000,3,0,0xffffffff,0,0x20800,0x409000,0x816300,0xe87000,0
.long 26,38,30,0x66000,0x1a012,0xec0c00,0xec1000,0x1160000,0x1160400,0x409800,0x76100,0x1a0600,0x40610800,0x40000280,0x3f000000,63,63,63,0x34300,0x5a100,16,10,0xbe800000,3,0,0,0xffffffff,0x21000,0x40a000,0x816e00,0xe96000,0
.long 26,38,33,0x66000,0x1a01a,0xec1400,0xecfc00,0x119b400,0x119b800,0x40a400,0x7e100,0x1a4600,0x40611300,0x40000280,0x3f000000,63,63,63,0x36300,0x5a180,336,10,0xbe800000,3,0,0,0xffffffff,0x21800,0x40b000,0x817900,0xea5000,0
.long 26,38,24,0x66400,0x1a002,0xed0000,0xed0400,0x119bc00,0x119c000,0x428000,0x66500,0x180e00,0x406c0800,0x40000280,0x3f000000,63,63,63,0x30700,0x5a200,2,10,0xbe800000,3,1,0xffffffff,0xffffffff,0x24000,0x428000,0x82b800,0xe78000,0
.long 26,38,27,0x66400,0x1a00a,0xedec00,0xedf000,0x119c400,0x11d7400,0x428c00,0x6e500,0x184e00,0x406c1300,0x40000280,0x3f000000,63,63,63,0x32700,0x5a280,322,10,0xbe800000,3,1,0xffffffff,0xffffffff,0x24800,0x429000,0x82c300,0xe87000,0
.long 26,38,30,0x66400,0x1a012,0xedf400,0xeedc00,0x11d7800,0x11d7c00,0x429800,0x76500,0x1a0e00,0x406c0800,0x40000280,0x3f000000,63,63,63,0x34700,0x5a300,30,10,0xbe800000,3,0x80008000,0xffffffff,0xffffffff,0x25000,0x42a000,0x82ce00,0xe96000,0
.long 26,38,33,0x66400,0x1a01a,0xeee000,0xeee400,0x11d8000,0x11d8400,0x42a400,0x7e500,0x1a4e00,0x406c1300,0x40000280,0x3f000000,63,63,63,0x36700,0x5a380,350,10,0xbe800000,3,0x80008000,0xffffffff,0xffffffff,0x25800,0x42b000,0x82d900,0xea5000,0
.long 26,38,24,0x6e800,0x1a002,0xefcc00,0xefd000,0x1034800,0x1034c00,0x448000,0x66900,0x181600,0x40770800,0x40000280,0x3f000000,63,63,63,0x30b00,0x5a400,4,10,0xbe800000,3,1,0xffffffff,0xffffffff,0x28000,0x448000,0x841800,0xe78000,0
.long 26,38,27,0x6e800,0x1a00a,0xefd400,0xf0bc00,0x1035000,0x1035400,0x448c00,0x6e900,0x185600,0x40771300,0x40000280,0x3f000000,63,63,63,0x32b00,0x5a480,324,10,0xbe800000,3,1,0xffffffff,0xffffffff,0x28800,0x449000,0x842300,0xe87000,0
.long 26,38,30,0x6e800,0x1a012,0xf0c000,0xf0c400,0x1035800,0x1070800,0x449800,0x76900,0x1a1600,0x40770800,0x40000280,0x3f000000,63,63,63,0x34b00,0x5a500,28,10,0xbe800000,3,0x80008000,0xffffffff,0xffffffff,0x29000,0x44a000,0x842e00,0xe96000,0
.long 26,38,33,0x6e800,0x1a01a,0xf1ac00,0xf1b000,0x1070c00,0x1071000,0x44a400,0x7e900,0x1a5600,0x40771300,0x40000280,0x3f000000,63,63,63,0x36b00,0x5a580,348,10,0xbe800000,3,0x80008000,0xffffffff,0xffffffff,0x29800,0x44b000,0x843900,0xea5000,0
.long 26,38,24,0x6ec00,0x1a002,0xf1b400,0xf29c00,0x1071400,0x1071800,0x468000,0x66d00,0x181e00,0x40820800,0x40000280,0x3f000000,63,63,63,0x30f00,0x5a600,6,10,0xbe800000,3,1,0xffffffff,0xffffffff,0x2c000,0x468000,0x857800,0xe78000,0
.long 26,38,27,0x6ec00,0x1a00a,0xf2a000,0xf2a400,0x10ac800,0x10acc00,0x468c00,0x6ed00,0x185e00,0x40821300,0x40000280,0x3f000000,63,63,63,0x32f00,0x5a680,326,10,0xbe800000,3,1,0xffffffff,0xffffffff,0x2c800,0x469000,0x858300,0xe87000,0
.long 26,38,30,0x6ec00,0x1a012,0xf38c00,0xf39000,0x10ad000,0x10ad400,0x469800,0x76d00,0x1a1e00,0x40820800,0x40000280,0x3f000000,63,63,63,0x34f00,0x5a700,26,10,0xbe800000,3,0x80008000,0xffffffff,0xffffffff,0x2d000,0x46a000,0x858e00,0xe96000,0
.long 26,38,33,0x6ec00,0x1a01a,0xf39400,0xf47c00,0x10ad800,0x10e8800,0x46a400,0x7ed00,0x1a5e00,0x40821300,0x40000280,0x3f000000,63,63,63,0x36f00,0x5a780,346,10,0xbe800000,3,0x80008000,0xffffffff,0xffffffff,0x2d800,0x46b000,0x859900,0xea5000,0
.long 26,38,24,0x77000,0x1a002,0xf48000,0xf48400,0x10e8c00,0x10e9000,0x488000,0x67100,0x182600,0x40815800,0x40000280,0x3f000000,63,63,63,0x31300,0x5a800,8,10,0xbe800000,3,1,0xffffffff,0xffffffff,0x30000,0x488000,0x86d800,0xe78000,0
.long 26,38,27,0x77000,0x1a00a,0xf56c00,0xf57000,0x10e9400,0x10e9800,0x488c00,0x6f100,0x186600,0x40816300,0x40000280,0x3f000000,63,63,63,0x33300,0x5a880,328,10,0xbe800000,3,1,0xffffffff,0xffffffff,0x30800,0x489000,0x86e300,0xe87000,0
.long 26,38,30,0x77000,0x1a012,0xf57400,0xf65c00,0x1124800,0x1124c00,0x489800,0x77100,0x1a2600,0x40815800,0x40000280,0x3f000000,63,63,63,0x35300,0x5a900,24,10,0xbe800000,3,0x80008000,0xffffffff,0xffffffff,0x31000,0x48a000,0x86ee00,0xe96000,0
.long 26,38,33,0x77000,0x1a01a,0xf66000,0xf66400,0x1125000,0x1125400,0x48a400,0x7f100,0x1a6600,0x40816300,0x40000280,0x3f000000,63,63,63,0x37300,0x5a980,344,10,0xbe800000,3,0x80008000,0xffffffff,0xffffffff,0x31800,0x48b000,0x86f900,0xea5000,0
.long 26,38,24,0x77400,0x1a002,0xf74c00,0xf75000,0x1125800,0x1160800,0x4a8000,0x67500,0x182e00,0x40765800,0x40000280,0x3f000000,63,63,63,0x31700,0x5aa00,10,10,0xbe800000,3,1,0xffffffff,0xffffffff,0x34000,0x4a8000,0x883800,0xe78000,0
.long 26,38,27,0x77400,0x1a00a,0xf75400,0xf83c00,0x1160c00,0x1161000,0x4a8c00,0x6f500,0x186e00,0x40766300,0x40000280,0x3f000000,63,63,63,0x33700,0x5aa80,330,10,0xbe800000,3,1,0xffffffff,0xffffffff,0x34800,0x4a9000,0x884300,0xe87000,0
.long 26,38,30,0x77400,0x1a012,0xf84000,0xf84400,0x1161400,0x1161800,0x4a9800,0x77500,0x1a2e00,0x40765800,0x40000280,0x3f000000,63,63,63,0x35700,0x5ab00,22,10,0xbe800000,3,0x80008000,0xffffffff,0xffffffff,0x35000,0x4aa000,0x884e00,0xe96000,0
.long 26,38,33,0x77400,0x1a01a,0xf92c00,0xf93000,0x119c800,0x119cc00,0x4aa400,0x7f500,0x1a6e00,0x40766300,0x40000280,0x3f000000,63,63,63,0x37700,0x5ab80,342,10,0xbe800000,3,0x80008000,0xffffffff,0xffffffff,0x35800,0x4ab000,0x885900,0xea5000,0
.long 26,38,24,0x7f800,0x1a002,0xf93400,0xfa1c00,0x119d000,0x119d400,0x4c8000,0x67900,0x183600,0x406b5800,0x40000280,0x3f000000,63,63,63,0x31b00,0x5ac00,12,10,0xbe800000,3,1,0xffffffff,0xffffffff,0x38000,0x4c8000,0x899800,0xe78000,0
.long 26,38,27,0x7f800,0x1a00a,0xfa2000,0xfa2400,0x119d800,0x11d8800,0x4c8c00,0x6f900,0x187600,0x406b6300,0x40000280,0x3f000000,63,63,63,0x33b00,0x5ac80,332,10,0xbe800000,3,1,0xffffffff,0xffffffff,0x38800,0x4c9000,0x89a300,0xe87000,0
.long 26,38,30,0x7f800,0x1a012,0xfb0c00,0xfb1000,0x11d8c00,0x11d9000,0x4c9800,0x77900,0x1a3600,0x406b5800,0x40000280,0x3f000000,63,63,63,0x35b00,0x5ad00,20,10,0xbe800000,3,0x80008000,0xffffffff,0xffffffff,0x39000,0x4ca000,0x89ae00,0xe96000,0
.long 26,38,33,0x7f800,0x1a01a,0xfb1400,0xfbfc00,0x11d9400,0x11d9800,0x4ca400,0x7f900,0x1a7600,0x406b6300,0x40000280,0x3f000000,63,63,63,0x37b00,0x5ad80,340,10,0xbe800000,3,0x80008000,0xffffffff,0xffffffff,0x39800,0x4cb000,0x89b900,0xea5000,0
.long 26,38,24,0x7fc00,0x1a002,0xfc0000,0xfc0400,0x1035c00,0x1036000,0x4e8000,0x67d00,0x183e00,0x40605800,0x40000280,0x3f000000,63,63,63,0x31f00,0x5ae00,14,10,0xbe800000,3,1,0xffffffff,0xffffffff,0x3c000,0x4e8000,0x8af800,0xe78000,0
.long 26,38,27,0x7fc00,0x1a00a,0xfcec00,0xfcf000,0x1036400,0x1036800,0x4e8c00,0x6fd00,0x187e00,0x40606300,0x40000280,0x3f000000,63,63,63,0x33f00,0x5ae80,334,10,0xbe800000,3,1,0xffffffff,0xffffffff,0x3c800,0x4e9000,0x8b0300,0xe87000,0
.long 26,38,30,0x7fc00,0x1a012,0xfcf400,0xfddc00,0x1036c00,0x1071c00,0x4e9800,0x77d00,0x1a3e00,0x40605800,0x40000280,0x3f000000,63,63,63,0x35f00,0x5af00,18,10,0xbe800000,3,0x80008000,0xffffffff,0xffffffff,0x3d000,0x4ea000,0x8b0e00,0xe96000,0
.long 26,38,33,0x7fc00,0x1a01a,0xfde000,0xfde400,0x1072000,0x1072400,0x4ea400,0x7fd00,0x1a7e00,0x40606300,0x40000280,0x3f000000,63,63,63,0x37f00,0x5af80,338,10,0xbe800000,3,0x80008000,0xffffffff,0xffffffff,0x3d800,0x4eb000,0x8b1900,0xea5000,0
.long 26,38,36,0x66000,0x1a002,0xe0d800,0xe0dc00,0x1072800,0x1072c00,0x40c000,0x66180,0x1c0600,0x40610800,0x40000280,0x3f000000,63,63,63,0x38300,0x5b000,1,10,0xbe800000,3,1,0xffffffff,0xffffffff,0x22000,0x40c000,0x818400,0xeb4000,0
.long 26,38,39,0x66000,0x1a00a,0xe0e000,0xe1c800,0x10adc00,0x10ae000,0x40cc00,0x6e180,0x1c4600,0x40611300,0x40000280,0x3f000000,63,63,63,0x3a300,0x5b080,321,10,0xbe800000,3,1,0xffffffff,0xffffffff,0x22800,0x40d000,0x818f00,0xec3000,0
.long 26,38,42,0x66000,0x1a012,0xe1cc00,0xe1d000,0x10ae400,0x10ae800,0x40d800,0x76180,0x1e0600,0x40610800,0x40000280,0x3f000000,63,63,63,0x3c300,0x5b100,31,10,0xbe800000,3,0x80008000,0xffffffff,0xffffffff,0x23000,0x40e000,0x819a00,0xed2000,0
.long 26,38,45,0x66000,0x1a01a,0xe2b800,0xe2bc00,0x10aec00,0x10e9c00,0x40e400,0x7e180,0x1e4600,0x40611300,0x40000280,0x3f000000,63,63,63,0x3e300,0x5b180,351,10,0xbe800000,3,0x80008000,0xffffffff,0xffffffff,0x23800,0x40f000,0x81a500,0xee1000,0
.long 26,38,36,0x66400,0x1a002,0xe2c000,0xe3a800,0x10ea000,0x10ea400,0x42c000,0x66580,0x1c0e00,0x406c0800,0x40000280,0x3f000000,63,63,63,0x38700,0x5b200,3,10,0xbe800000,3,1,0xffffffff,0xffffffff,0x26000,0x42c000,0x82e400,0xeb4000,0
.long 26,38,39,0x66400,0x1a00a,0xe3ac00,0xe3b000,0x10ea800,0x10eac00,0x42cc00,0x6e580,0x1c4e00,0x406c1300,0x40000280,0x3f000000,63,63,63,0x3a700,0x5b280,323,10,0xbe800000,3,1,0xffffffff,0xffffffff,0x26800,0x42d000,0x82ef00,0xec3000,0
.long 26,38,42,0x66400,0x1a012,0xe49800,0xe49c00,0x1125c00,0x1126000,0x42d800,0x76580,0x1e0e00,0x406c0800,0x40000280,0x3f000000,63,63,63,0x3c700,0x5b300,29,10,0xbe800000,3,0x80008000,0xffffffff,0xffffffff,0x27000,0x42e000,0x82fa00,0xed2000,0
.long 26,38,45,0x66400,0x1a01a,0xe4a000,0xe58800,0x1126400,0x1126800,0x42e400,0x7e580,0x1e4e00,0x406c1300,0x40000280,0x3f000000,63,63,63,0x3e700,0x5b380,349,10,0xbe800000,3,0x80008000,0xffffffff,0xffffffff,0x27800,0x42f000,0x830500,0xee1000,0
.long 26,38,36,0x6e800,0x1a002,0xe58c00,0xe59000,0x1126c00,0x1161c00,0x44c000,0x66980,0x1c1600,0x40770800,0x40000280,0x3f000000,63,63,63,0x38b00,0x5b400,5,10,0xbe800000,3,1,0xffffffff,0xffffffff,0x2a000,0x44c000,0x844400,0xeb4000,0
.long 26,38,39,0x6e800,0x1a00a,0xe67800,0xe67c00,0x1162000,0x1162400,0x44cc00,0x6e980,0x1c5600,0x40771300,0x40000280,0x3f000000,63,63,63,0x3ab00,0x5b480,325,10,0xbe800000,3,1,0xffffffff,0xffffffff,0x2a800,0x44d000,0x844f00,0xec3000,0
.long 26,38,42,0x6e800,0x1a012,0xe68000,0xe76800,0x1162800,0x1162c00,0x44d800,0x76980,0x1e1600,0x40770800,0x40000280,0x3f000000,63,63,63,0x3cb00,0x5b500,27,10,0xbe800000,3,0x80008000,0xffffffff,0xffffffff,0x2b000,0x44e000,0x845a00,0xed2000,0
.long 26,38,45,0x6e800,0x1a01a,0xe76c00,0xe77000,0x119dc00,0x119e000,0x44e400,0x7e980,0x1e5600,0x40771300,0x40000280,0x3f000000,63,63,63,0x3eb00,0x5b580,347,10,0xbe800000,3,0x80008000,0xffffffff,0xffffffff,0x2b800,0x44f000,0x846500,0xee1000,0
.long 26,38,36,0x6ec00,0x1a002,0xe85800,0xe85c00,0x119e400,0x119e800,0x46c000,0x66d80,0x1c1e00,0x40820800,0x40000280,0x3f000000,63,63,63,0x38f00,0x5b600,7,10,0xbe800000,3,1,0xffffffff,0xffffffff,0x2e000,0x46c000,0x85a400,0xeb4000,0
.long 26,38,39,0x6ec00,0x1a00a,0xe86000,0xe94800,0x119ec00,0x11d9c00,0x46cc00,0x6ed80,0x1c5e00,0x40821300,0x40000280,0x3f000000,63,63,63,0x3af00,0x5b680,327,10,0xbe800000,3,1,0xffffffff,0xffffffff,0x2e800,0x46d000,0x85af00,0xec3000,0
.long 26,38,42,0x6ec00,0x1a012,0xe94c00,0xe95000,0x11da000,0x11da400,0x46d800,0x76d80,0x1e1e00,0x40820800,0x40000280,0x3f000000,63,63,63,0x3cf00,0x5b700,25,10,0xbe800000,3,0x80008000,0xffffffff,0xffffffff,0x2f000,0x46e000,0x85ba00,0xed2000,0
.long 26,38,45,0x6ec00,0x1a01a,0xea3800,0xea3c00,0x11da800,0x11dac00,0x46e400,0x7ed80,0x1e5e00,0x40821300,0x40000280,0x3f000000,63,63,63,0x3ef00,0x5b780,345,10,0xbe800000,3,0x80008000,0xffffffff,0xffffffff,0x2f800,0x46f000,0x85c500,0xee1000,0
.long 26,38,36,0x77000,0x1a002,0xea4000,0xeb2800,0x1037000,0x1037400,0x48c000,0x67180,0x1c2600,0x40815800,0x40000280,0x3f000000,63,63,63,0x39300,0x5b800,9,10,0xbe800000,3,1,0xffffffff,0xffffffff,0x32000,0x48c000,0x870400,0xeb4000,0
.long 26,38,39,0x77000,0x1a00a,0xeb2c00,0xeb3000,0x1037800,0x1037c00,0x48cc00,0x6f180,0x1c6600,0x40816300,0x40000280,0x3f000000,63,63,63,0x3b300,0x5b880,329,10,0xbe800000,3,1,0xffffffff,0xffffffff,0x32800,0x48d000,0x870f00,0xec3000,0
.long 26,38,42,0x77000,0x1a012,0xec1800,0xec1c00,0x1038000,0x1073000,0x48d800,0x77180,0x1e2600,0x40815800,0x40000280,0x3f000000,63,63,63,0x3d300,0x5b900,23,10,0xbe800000,3,0x80008000,0xffffffff,0xffffffff,0x33000,0x48e000,0x871a00,0xed2000,0
.long 26,38,45,0x77000,0x1a01a,0xec2000,0xed0800,0x1073400,0x1073800,0x48e400,0x7f180,0x1e6600,0x40816300,0x40000280,0x3f000000,63,63,63,0x3f300,0x5b980,343,10,0xbe800000,3,0x80008000,0xffffffff,0xffffffff,0x33800,0x48f000,0x872500,0xee1000,0
.long 26,38,36,0x77400,0x1a002,0xed0c00,0xed1000,0x1073c00,0x1074000,0x4ac000,0x67580,0x1c2e00,0x40765800,0x40000280,0x3f000000,63,63,63,0x39700,0x5ba00,11,10,0xbe800000,3,1,0xffffffff,0xffffffff,0x36000,0x4ac000,0x886400,0xeb4000,0
.long 26,38,39,0x77400,0x1a00a,0xedf800,0xedfc00,0x10af000,0x10af400,0x4acc00,0x6f580,0x1c6e00,0x40766300,0x40000280,0x3f000000,63,63,63,0x3b700,0x5ba80,331,10,0xbe800000,3,1,0xffffffff,0xffffffff,0x36800,0x4ad000,0x886f00,0xec3000,0
.long 26,38,42,0x77400,0x1a012,0xee0000,0xeee800,0x10af800,0x10afc00,0x4ad800,0x77580,0x1e2e00,0x40765800,0x40000280,0x3f000000,63,63,63,0x3d700,0x5bb00,21,10,0xbe800000,3,0x80008000,0xffffffff,0xffffffff,0x37000,0x4ae000,0x887a00,0xed2000,0
.long 26,38,45,0x77400,0x1a01a,0xeeec00,0xeef000,0x10b0000,0x10eb000,0x4ae400,0x7f580,0x1e6e00,0x40766300,0x40000280,0x3f000000,63,63,63,0x3f700,0x5bb80,341,10,0xbe800000,3,0x80008000,0xffffffff,0xffffffff,0x37800,0x4af000,0x888500,0xee1000,0
.long 26,38,36,0x7f800,0x1a002,0xefd800,0xefdc00,0x10eb400,0x10eb800,0x4cc000,0x67980,0x1c3600,0x406b5800,0x40000280,0x3f000000,63,63,63,0x39b00,0x5bc00,13,10,0xbe800000,3,1,0xffffffff,0xffffffff,0x3a000,0x4cc000,0x89c400,0xeb4000,0
.long 26,38,39,0x7f800,0x1a00a,0xefe000,0xf0c800,0x10ebc00,0x10ec000,0x4ccc00,0x6f980,0x1c7600,0x406b6300,0x40000280,0x3f000000,63,63,63,0x3bb00,0x5bc80,333,10,0xbe800000,3,1,0xffffffff,0xffffffff,0x3a800,0x4cd000,0x89cf00,0xec3000,0
.long 26,38,42,0x7f800,0x1a012,0xf0cc00,0xf0d000,0x1127000,0x1127400,0x4cd800,0x77980,0x1e3600,0x406b5800,0x40000280,0x3f000000,63,63,63,0x3db00,0x5bd00,19,10,0xbe800000,3,0x80008000,0xffffffff,0xffffffff,0x3b000,0x4ce000,0x89da00,0xed2000,0
.long 26,38,45,0x7f800,0x1a01a,0xf1b800,0xf1bc00,0x1127800,0x1127c00,0x4ce400,0x7f980,0x1e7600,0x406b6300,0x40000280,0x3f000000,63,63,63,0x3fb00,0x5bd80,339,10,0xbe800000,3,0x80008000,0xffffffff,0xffffffff,0x3b800,0x4cf000,0x89e500,0xee1000,0
.long 26,38,36,0x7fc00,0x1a002,0xf1c000,0xf2a800,0x1128000,0x1163000,0x4ec000,0x67d80,0x1c3e00,0x40605800,0x40000280,0x3f000000,63,63,63,0x39f00,0x5be00,15,10,0xbe800000,3,1,0xffffffff,0xffffffff,0x3e000,0x4ec000,0x8b2400,0xeb4000,0
.long 26,38,39,0x7fc00,0x1a00a,0xf2ac00,0xf2b000,0x1163400,0x1163800,0x4ecc00,0x6fd80,0x1c7e00,0x40606300,0x40000280,0x3f000000,63,63,63,0x3bf00,0x5be80,335,10,0xbe800000,3,1,0xffffffff,0xffffffff,0x3e800,0x4ed000,0x8b2f00,0xec3000,0
.long 26,38,42,0x7fc00,0x1a012,0xf39800,0xf39c00,0x1163c00,0x1164000,0x4ed800,0x77d80,0x1e3e00,0x40605800,0x40000280,0x3f000000,63,63,63,0x3df00,0x5bf00,17,10,0xbe800000,3,0x80008000,0xffffffff,0xffffffff,0x3f000,0x4ee000,0x8b3a00,0xed2000,0
.long 26,38,45,0x7fc00,0x1a01a,0xf3a000,0xf48800,0x119f000,0x119f400,0x4ee400,0x7fd80,0x1e7e00,0x40606300,0x40000280,0x3f000000,63,63,63,0x3ff00,0x5bf80,337,10,0xbe800000,3,0x80008000,0xffffffff,0xffffffff,0x3f800,0x4ef000,0x8b4500,0xee1000,0
.long 28,36,48,0x66000,0x1a002,0xf48c00,0xf49000,0x119f800,0x119fc00,0x410000,0x66200,0x100700,0x40610800,0x40000280,0x3f000000,63,63,63,0x20380,0x5c000,0,10,0xbe800000,3,0,0xffffffff,0,0x20000,0x410000,0x81b000,0xef0000,0
.long 28,36,51,0x66000,0x1a00a,0xf57800,0xf57c00,0x11a0000,0x11db000,0x410c00,0x6e200,0x104700,0x40611300,0x40000280,0x3f000000,63,63,63,0x22380,0x5c080,320,10,0xbe800000,3,0,0xffffffff,0,0x20800,0x411000,0x81bb00,0xeff000,0
.long 28,36,54,0x66000,0x1a012,0xf58000,0xf66800,0x11db400,0x11db800,0x411800,0x76200,0x120700,0x40610800,0x40000280,0x3f000000,63,63,63,0x24380,0x5c100,16,10,0xbe800000,3,0,0,0xffffffff,0x21000,0x412000,0x81c600,0xf0e000,0
.long 28,36,57,0x66000,0x1a01a,0xf66c00,0xf67000,0x11dbc00,0x11dc000,0x412400,0x7e200,0x124700,0x40611300,0x40000280,0x3f000000,63,63,63,0x26380,0x5c180,336,10,0xbe800000,3,0,0,0xffffffff,0x21800,0x413000,0x81d100,0xf1d000,0
.long 28,36,48,0x66400,0x1a002,0xf75800,0xf75c00,0x1038400,0x1038800,0x430000,0x66600,0x100f00,0x406c0800,0x40000280,0x3f000000,63,63,63,0x20780,0x5c200,2,10,0xbe800000,3,1,0xffffffff,0xffffffff,0x24000,0x430000,0x831000,0xef0000,0
.long 28,36,51,0x66400,0x1a00a,0xf76000,0xf84800,0x1038c00,0x1039000,0x430c00,0x6e600,0x104f00,0x406c1300,0x40000280,0x3f000000,63,63,63,0x22780,0x5c280,322,10,0xbe800000,3,1,0xffffffff,0xffffffff,0x24800,0x431000,0x831b00,0xeff000,0
.long 28,36,54,0x66400,0x1a012,0xf84c00,0xf85000,0x1039400,0x1074400,0x431800,0x76600,0x120f00,0x406c0800,0x40000280,0x3f000000,63,63,63,0x24780,0x5c300,30,10,0xbe800000,3,0x80008000,0xffffffff,0xffffffff,0x25000,0x432000,0x832600,0xf0e000,0
.long 28,36,57,0x66400,0x1a01a,0xf93800,0xf93c00,0x1074800,0x1074c00,0x432400,0x7e600,0x124f00,0x406c1300,0x40000280,0x3f000000,63,63,63,0x26780,0x5c380,350,10,0xbe800000,3,0x80008000,0xffffffff,0xffffffff,0x25800,0x433000,0x833100,0xf1d000,0
.long 28,36,48,0x6e800,0x1a002,0xf94000,0xfa2800,0x1075000,0x1075400,0x450000,0x66a00,0x101700,0x40770800,0x40000280,0x3f000000,63,63,63,0x20b80,0x5c400,4,10,0xbe800000,3,1,0xffffffff,0xffffffff,0x28000,0x450000,0x847000,0xef0000,0
.long 28,36,51,0x6e800,0x1a00a,0xfa2c00,0xfa3000,0x10b0400,0x10b0800,0x450c00,0x6ea00,0x105700,0x40771300,0x40000280,0x3f000000,63,63,63,0x22b80,0x5c480,324,10,0xbe800000,3,1,0xffffffff,0xffffffff,0x28800,0x451000,0x847b00,0xeff000,0
.long 28,36,54,0x6e800,0x1a012,0xfb1800,0xfb1c00,0x10b0c00,0x10b1000,0x451800,0x76a00,0x121700,0x40770800,0x40000280,0x3f000000,63,63,63,0x24b80,0x5c500,28,10,0xbe800000,3,0x80008000,0xffffffff,0xffffffff,0x29000,0x452000,0x848600,0xf0e000,0
.long 28,36,57,0x6e800,0x1a01a,0xfb2000,0xfc0800,0x10b1400,0x10ec400,0x452400,0x7ea00,0x125700,0x40771300,0x40000280,0x3f000000,63,63,63,0x26b80,0x5c580,348,10,0xbe800000,3,0x80008000,0xffffffff,0xffffffff,0x29800,0x453000,0x849100,0xf1d000,0
.long 28,36,48,0x6ec00,0x1a002,0xfc0c00,0xfc1000,0x10ec800,0x10ecc00,0x470000,0x66e00,0x101f00,0x40820800,0x40000280,0x3f000000,63,63,63,0x20f80,0x5c600,6,10,0xbe800000,3,1,0xffffffff,0xffffffff,0x2c000,0x470000,0x85d000,0xef0000,0
.long 28,36,51,0x6ec00,0x1a00a,0xfcf800,0xfcfc00,0x10ed000,0x10ed400,0x470c00,0x6ee00,0x105f00,0x40821300,0x40000280,0x3f000000,63,63,63,0x22f80,0x5c680,326,10,0xbe800000,3,1,0xffffffff,0xffffffff,0x2c800,0x471000,0x85db00,0xeff000,0
.long 28,36,54,0x6ec00,0x1a012,0xfd0000,0xfde800,0x1128400,0x1128800,0x471800,0x76e00,0x121f00,0x40820800,0x40000280,0x3f000000,63,63,63,0x24f80,0x5c700,26,10,0xbe800000,3,0x80008000,0xffffffff,0xffffffff,0x2d000,0x472000,0x85e600,0xf0e000,0
.long 28,36,57,0x6ec00,0x1a01a,0xfdec00,0xfdf000,0x1128c00,0x1129000,0x472400,0x7ee00,0x125f00,0x40821300,0x40000280,0x3f000000,63,63,63,0x26f80,0x5c780,346,10,0xbe800000,3,0x80008000,0xffffffff,0xffffffff,0x2d800,0x473000,0x85f100,0xf1d000,0
.long 28,36,48,0x77000,0x1a002,0xe0e400,0xe0e800,0x1129400,0x1164400,0x490000,0x67200,0x102700,0x40815800,0x40000280,0x3f000000,63,63,63,0x21380,0x5c800,8,10,0xbe800000,3,1,0xffffffff,0xffffffff,0x30000,0x490000,0x873000,0xef0000,0
.long 28,36,51,0x77000,0x1a00a,0xe0ec00,0xe1d400,0x1164800,0x1164c00,0x490c00,0x6f200,0x106700,0x40816300,0x40000280,0x3f000000,63,63,63,0x23380,0x5c880,328,10,0xbe800000,3,1,0xffffffff,0xffffffff,0x30800,0x491000,0x873b00,0xeff000,0
.long 28,36,54,0x77000,0x1a012,0xe1d800,0xe1dc00,0x1165000,0x1165400,0x491800,0x77200,0x122700,0x40815800,0x40000280,0x3f000000,63,63,63,0x25380,0x5c900,24,10,0xbe800000,3,0x80008000,0xffffffff,0xffffffff,0x31000,0x492000,0x874600,0xf0e000,0
.long 28,36,57,0x77000,0x1a01a,0xe2c400,0xe2c800,0x11a0400,0x11a0800,0x492400,0x7f200,0x126700,0x40816300,0x40000280,0x3f000000,63,63,63,0x27380,0x5c980,344,10,0xbe800000,3,0x80008000,0xffffffff,0xffffffff,0x31800,0x493000,0x875100,0xf1d000,0
.long 28,36,48,0x77400,0x1a002,0xe2cc00,0xe3b400,0x11a0c00,0x11a1000,0x4b0000,0x67600,0x102f00,0x40765800,0x40000280,0x3f000000,63,63,63,0x21780,0x5ca00,10,10,0xbe800000,3,1,0xffffffff,0xffffffff,0x34000,0x4b0000,0x889000,0xef0000,0
.long 28,36,51,0x77400,0x1a00a,0xe3b800,0xe3bc00,0x11a1400,0x11dc400,0x4b0c00,0x6f600,0x106f00,0x40766300,0x40000280,0x3f000000,63,63,63,0x23780,0x5ca80,330,10,0xbe800000,3,1,0xffffffff,0xffffffff,0x34800,0x4b1000,0x889b00,0xeff000,0
.long 28,36,54,0x77400,0x1a012,0xe4a400,0xe4a800,0x11dc800,0x11dcc00,0x4b1800,0x77600,0x122f00,0x40765800,0x40000280,0x3f000000,63,63,63,0x25780,0x5cb00,22,10,0xbe800000,3,0x80008000,0xffffffff,0xffffffff,0x35000,0x4b2000,0x88a600,0xf0e000,0
.long 28,36,57,0x77400,0x1a01a,0xe4ac00,0xe59400,0x11dd000,0x11dd400,0x4b2400,0x7f600,0x126f00,0x40766300,0x40000280,0x3f000000,63,63,63,0x27780,0x5cb80,342,10,0xbe800000,3,0x80008000,0xffffffff,0xffffffff,0x35800,0x4b3000,0x88b100,0xf1d000,0
.long 28,36,48,0x7f800,0x1a002,0xe59800,0xe59c00,0x1039800,0x1039c00,0x4d0000,0x67a00,0x103700,0x406b5800,0x40000280,0x3f000000,63,63,63,0x21b80,0x5cc00,12,10,0xbe800000,3,1,0xffffffff,0xffffffff,0x38000,0x4d0000,0x89f000,0xef0000,0
.long 28,36,51,0x7f800,0x1a00a,0xe68400,0xe68800,0x103a000,0x103a400,0x4d0c00,0x6fa00,0x107700,0x406b6300,0x40000280,0x3f000000,63,63,63,0x23b80,0x5cc80,332,10,0xbe800000,3,1,0xffffffff,0xffffffff,0x38800,0x4d1000,0x89fb00,0xeff000,0
.long 28,36,54,0x7f800,0x1a012,0xe68c00,0xe77400,0x103a800,0x1075800,0x4d1800,0x77a00,0x123700,0x406b5800,0x40000280,0x3f000000,63,63,63,0x25b80,0x5cd00,20,10,0xbe800000,3,0x80008000,0xffffffff,0xffffffff,0x39000,0x4d2000,0x8a0600,0xf0e000,0
.long 28,36,57,0x7f800,0x1a01a,0xe77800,0xe77c00,0x1075c00,0x1076000,0x4d2400,0x7fa00,0x127700,0x406b6300,0x40000280,0x3f000000,63,63,63,0x27b80,0x5cd80,340,10,0xbe800000,3,0x80008000,0xffffffff,0xffffffff,0x39800,0x4d3000,0x8a1100,0xf1d000,0
.long 28,36,48,0x7fc00,0x1a002,0xe86400,0xe86800,0x1076400,0x1076800,0x4f0000,0x67e00,0x103f00,0x40605800,0x40000280,0x3f000000,63,63,63,0x21f80,0x5ce00,14,10,0xbe800000,3,1,0xffffffff,0xffffffff,0x3c000,0x4f0000,0x8b5000,0xef0000,0
.long 28,36,51,0x7fc00,0x1a00a,0xe86c00,0xe95400,0x10b1800,0x10b1c00,0x4f0c00,0x6fe00,0x107f00,0x40606300,0x40000280,0x3f000000,63,63,63,0x23f80,0x5ce80,334,10,0xbe800000,3,1,0xffffffff,0xffffffff,0x3c800,0x4f1000,0x8b5b00,0xeff000,0
.long 28,36,54,0x7fc00,0x1a012,0xe95800,0xe95c00,0x10b2000,0x10b2400,0x4f1800,0x77e00,0x123f00,0x40605800,0x40000280,0x3f000000,63,63,63,0x25f80,0x5cf00,18,10,0xbe800000,3,0x80008000,0xffffffff,0xffffffff,0x3d000,0x4f2000,0x8b6600,0xf0e000,0
.long 28,36,57,0x7fc00,0x1a01a,0xea4400,0xea4800,0x10b2800,0x10ed800,0x4f2400,0x7fe00,0x127f00,0x40606300,0x40000280,0x3f000000,63,63,63,0x27f80,0x5cf80,338,10,0xbe800000,3,0x80008000,0xffffffff,0xffffffff,0x3d800,0x4f3000,0x8b7100,0xf1d000,0
.long 28,36,60,0x66000,0x1a002,0xea4c00,0xeb3400,0x10edc00,0x10ee000,0x414000,0x66280,0x140700,0x40610800,0x40000280,0x3f000000,63,63,63,0x28380,0x5d000,1,10,0xbe800000,3,1,0xffffffff,0xffffffff,0x22000,0x414000,0x81dc00,0xf2c000,0
.long 28,36,63,0x66000,0x1a00a,0xeb3800,0xeb3c00,0x10ee400,0x10ee800,0x414c00,0x6e280,0x144700,0x40611300,0x40000280,0x3f000000,63,63,63,0x2a380,0x5d080,321,10,0xbe800000,3,1,0xffffffff,0xffffffff,0x22800,0x415000,0x81e700,0xf3b000,0
.long 28,36,66,0x66000,0x1a012,0xec2400,0xec2800,0x1129800,0x1129c00,0x415800,0x76280,0x160700,0x40610800,0x40000280,0x3f000000,63,63,63,0x2c380,0x5d100,31,10,0xbe800000,3,0x80008000,0xffffffff,0xffffffff,0x23000,0x416000,0x81f200,0xf4a000,0
.long 28,36,69,0x66000,0x1a01a,0xec2c00,0xed1400,0x112a000,0x112a400,0x416400,0x7e280,0x164700,0x40611300,0x40000280,0x3f000000,63,63,63,0x2e380,0x5d180,351,10,0xbe800000,3,0x80008000,0xffffffff,0xffffffff,0x23800,0x417000,0x81fd00,0xf59000,0
.long 28,36,60,0x66400,0x1a002,0xed1800,0xed1c00,0x112a800,0x1165800,0x434000,0x66680,0x140f00,0x406c0800,0x40000280,0x3f000000,63,63,63,0x28780,0x5d200,3,10,0xbe800000,3,1,0xffffffff,0xffffffff,0x26000,0x434000,0x833c00,0xf2c000,0
.long 28,36,63,0x66400,0x1a00a,0xee0400,0xee0800,0x1165c00,0x1166000,0x434c00,0x6e680,0x144f00,0x406c1300,0x40000280,0x3f000000,63,63,63,0x2a780,0x5d280,323,10,0xbe800000,3,1,0xffffffff,0xffffffff,0x26800,0x435000,0x834700,0xf3b000,0
.long 28,36,66,0x66400,0x1a012,0xee0c00,0xeef400,0x1166400,0x1166800,0x435800,0x76680,0x160f00,0x406c0800,0x40000280,0x3f000000,63,63,63,0x2c780,0x5d300,29,10,0xbe800000,3,0x80008000,0xffffffff,0xffffffff,0x27000,0x436000,0x835200,0xf4a000,0
.long 28,36,69,0x66400,0x1a01a,0xeef800,0xeefc00,0x11a1800,0x11a1c00,0x436400,0x7e680,0x164f00,0x406c1300,0x40000280,0x3f000000,63,63,63,0x2e780,0x5d380,349,10,0xbe800000,3,0x80008000,0xffffffff,0xffffffff,0x27800,0x437000,0x835d00,0xf59000,0
.long 28,36,60,0x6e800,0x1a002,0xefe400,0xefe800,0x11a2000,0x11a2400,0x454000,0x66a80,0x141700,0x40770800,0x40000280,0x3f000000,63,63,63,0x28b80,0x5d400,5,10,0xbe800000,3,1,0xffffffff,0xffffffff,0x2a000,0x454000,0x849c00,0xf2c000,0
.long 28,36,63,0x6e800,0x1a00a,0xefec00,0xf0d400,0x11a2800,0x11dd800,0x454c00,0x6ea80,0x145700,0x40771300,0x40000280,0x3f000000,63,63,63,0x2ab80,0x5d480,325,10,0xbe800000,3,1,0xffffffff,0xffffffff,0x2a800,0x455000,0x84a700,0xf3b000,0
.long 28,36,66,0x6e800,0x1a012,0xf0d800,0xf0dc00,0x11ddc00,0x11de000,0x455800,0x76a80,0x161700,0x40770800,0x40000280,0x3f000000,63,63,63,0x2cb80,0x5d500,27,10,0xbe800000,3,0x80008000,0xffffffff,0xffffffff,0x2b000,0x456000,0x84b200,0xf4a000,0
.long 28,36,69,0x6e800,0x1a01a,0xf1c400,0xf1c800,0x11de400,0x11de800,0x456400,0x7ea80,0x165700,0x40771300,0x40000280,0x3f000000,63,63,63,0x2eb80,0x5d580,347,10,0xbe800000,3,0x80008000,0xffffffff,0xffffffff,0x2b800,0x457000,0x84bd00,0xf59000,0
.long 28,36,60,0x6ec00,0x1a002,0xf1cc00,0xf2b400,0x103ac00,0x103b000,0x474000,0x66e80,0x141f00,0x40820800,0x40000280,0x3f000000,63,63,63,0x28f80,0x5d600,7,10,0xbe800000,3,1,0xffffffff,0xffffffff,0x2e000,0x474000,0x85fc00,0xf2c000,0
.long 28,36,63,0x6ec00,0x1a00a,0xf2b800,0xf2bc00,0x103b400,0x103b800,0x474c00,0x6ee80,0x145f00,0x40821300,0x40000280,0x3f000000,63,63,63,0x2af80,0x5d680,327,10,0xbe800000,3,1,0xffffffff,0xffffffff,0x2e800,0x475000,0x860700,0xf3b000,0
.long 28,36,66,0x6ec00,0x1a012,0xf3a400,0xf3a800,0x103bc00,0x1076c00,0x475800,0x76e80,0x161f00,0x40820800,0x40000280,0x3f000000,63,63,63,0x2cf80,0x5d700,25,10,0xbe800000,3,0x80008000,0xffffffff,0xffffffff,0x2f000,0x476000,0x861200,0xf4a000,0
.long 28,36,69,0x6ec00,0x1a01a,0xf3ac00,0xf49400,0x1077000,0x1077400,0x476400,0x7ee80,0x165f00,0x40821300,0x40000280,0x3f000000,63,63,63,0x2ef80,0x5d780,345,10,0xbe800000,3,0x80008000,0xffffffff,0xffffffff,0x2f800,0x477000,0x861d00,0xf59000,0
.long 28,36,60,0x77000,0x1a002,0xf49800,0xf49c00,0x1077800,0x1077c00,0x494000,0x67280,0x142700,0x40815800,0x40000280,0x3f000000,63,63,63,0x29380,0x5d800,9,10,0xbe800000,3,1,0xffffffff,0xffffffff,0x32000,0x494000,0x875c00,0xf2c000,0
.long 28,36,63,0x77000,0x1a00a,0xf58400,0xf58800,0x10b2c00,0x10b3000,0x494c00,0x6f280,0x146700,0x40816300,0x40000280,0x3f000000,63,63,63,0x2b380,0x5d880,329,10,0xbe800000,3,1,0xffffffff,0xffffffff,0x32800,0x495000,0x876700,0xf3b000,0
.long 28,36,66,0x77000,0x1a012,0xf58c00,0xf67400,0x10b3400,0x10b3800,0x495800,0x77280,0x162700,0x40815800,0x40000280,0x3f000000,63,63,63,0x2d380,0x5d900,23,10,0xbe800000,3,0x80008000,0xffffffff,0xffffffff,0x33000,0x496000,0x877200,0xf4a000,0
.long 28,36,69,0x77000,0x1a01a,0xf67800,0xf67c00,0x10b3c00,0x10eec00,0x496400,0x7f280,0x166700,0x40816300,0x40000280,0x3f000000,63,63,63,0x2f380,0x5d980,343,10,0xbe800000,3,0x80008000,0xffffffff,0xffffffff,0x33800,0x497000,0x877d00,0xf59000,0
.long 28,36,60,0x77400,0x1a002,0xf76400,0xf76800,0x10ef000,0x10ef400,0x4b4000,0x67680,0x142f00,0x40765800,0x40000280,0x3f000000,63,63,63,0x29780,0x5da00,11,10,0xbe800000,3,1,0xffffffff,0xffffffff,0x36000,0x4b4000,0x88bc00,0xf2c000,0
.long 28,36,63,0x77400,0x1a00a,0xf76c00,0xf85400,0x10ef800,0x10efc00,0x4b4c00,0x6f680,0x146f00,0x40766300,0x40000280,0x3f000000,63,63,63,0x2b780,0x5da80,331,10,0xbe800000,3,1,0xffffffff,0xffffffff,0x36800,0x4b5000,0x88c700,0xf3b000,0
.long 28,36,66,0x77400,0x1a012,0xf85800,0xf85c00,0x112ac00,0x112b000,0x4b5800,0x77680,0x162f00,0x40765800,0x40000280,0x3f000000,63,63,63,0x2d780,0x5db00,21,10,0xbe800000,3,0x80008000,0xffffffff,0xffffffff,0x37000,0x4b6000,0x88d200,0xf4a000,0
.long 28,36,69,0x77400,0x1a01a,0xf94400,0xf94800,0x112b400,0x112b800,0x4b6400,0x7f680,0x166f00,0x40766300,0x40000280,0x3f000000,63,63,63,0x2f780,0x5db80,341,10,0xbe800000,3,0x80008000,0xffffffff,0xffffffff,0x37800,0x4b7000,0x88dd00,0xf59000,0
.long 28,36,60,0x7f800,0x1a002,0xf94c00,0xfa3400,0x112bc00,0x1166c00,0x4d4000,0x67a80,0x143700,0x406b5800,0x40000280,0x3f000000,63,63,63,0x29b80,0x5dc00,13,10,0xbe800000,3,1,0xffffffff,0xffffffff,0x3a000,0x4d4000,0x8a1c00,0xf2c000,0
.long 28,36,63,0x7f800,0x1a00a,0xfa3800,0xfa3c00,0x1167000,0x1167400,0x4d4c00,0x6fa80,0x147700,0x406b6300,0x40000280,0x3f000000,63,63,63,0x2bb80,0x5dc80,333,10,0xbe800000,3,1,0xffffffff,0xffffffff,0x3a800,0x4d5000,0x8a2700,0xf3b000,0
.long 28,36,66,0x7f800,0x1a012,0xfb2400,0xfb2800,0x1167800,0x1167c00,0x4d5800,0x77a80,0x163700,0x406b5800,0x40000280,0x3f000000,63,63,63,0x2db80,0x5dd00,19,10,0xbe800000,3,0x80008000,0xffffffff,0xffffffff,0x3b000,0x4d6000,0x8a3200,0xf4a000,0
.long 28,36,69,0x7f800,0x1a01a,0xfb2c00,0xfc1400,0x11a2c00,0x11a3000,0x4d6400,0x7fa80,0x167700,0x406b6300,0x40000280,0x3f000000,63,63,63,0x2fb80,0x5dd80,339,10,0xbe800000,3,0x80008000,0xffffffff,0xffffffff,0x3b800,0x4d7000,0x8a3d00,0xf59000,0
.long 28,36,60,0x7fc00,0x1a002,0xfc1800,0xfc1c00,0x11a3400,0x11a3800,0x4f4000,0x67e80,0x143f00,0x40605800,0x40000280,0x3f000000,63,63,63,0x29f80,0x5de00,15,10,0xbe800000,3,1,0xffffffff,0xffffffff,0x3e000,0x4f4000,0x8b7c00,0xf2c000,0
.long 28,36,63,0x7fc00,0x1a00a,0xfd0400,0xfd0800,0x11a3c00,0x11dec00,0x4f4c00,0x6fe80,0x147f00,0x40606300,0x40000280,0x3f000000,63,63,63,0x2bf80,0x5de80,335,10,0xbe800000,3,1,0xffffffff,0xffffffff,0x3e800,0x4f5000,0x8b8700,0xf3b000,0
.long 28,36,66,0x7fc00,0x1a012,0xfd0c00,0xfdf400,0x11df000,0x11df400,0x4f5800,0x77e80,0x163f00,0x40605800,0x40000280,0x3f000000,63,63,63,0x2df80,0x5df00,17,10,0xbe800000,3,0x80008000,0xffffffff,0xffffffff,0x3f000,0x4f6000,0x8b9200,0xf4a000,0
.long 28,36,69,0x7fc00,0x1a01a,0xfdf800,0xfdfc00,0x11df800,0x11dfc00,0x4f6400,0x7fe80,0x167f00,0x40606300,0x40000280,0x3f000000,63,63,63,0x2ff80,0x5df80,337,10,0xbe800000,3,0x80008000,0xffffffff,0xffffffff,0x3f800,0x4f7000,0x8b9d00,0xf59000,0
.long 30,34,72,0x66000,0x1a002,0x40e0f000,0x40e0f400,0x4103c000,0x4103c400,0x418000,0x66300,0x180700,0x40610800,0x40000280,0x3f000000,63,63,63,0x30380,0x5e000,0,10,0xbe800000,3,0,0xffffffff,0,0x20000,0x418000,0x820800,0xf68000,0
.long 30,34,75,0x66000,0x1a00a,0x40e0f800,0x40e1e000,0x4103c800,0x4103cc00,0x418c00,0x6e300,0x184700,0x40611300,0x40000280,0x3f000000,63,63,63,0x32380,0x5e080,320,10,0xbe800000,3,0,0xffffffff,0,0x20800,0x419000,0x821300,0xf77000,0
.long 30,34,78,0x66000,0x1a012,0x40e1e400,0x40e1e800,0x4103d000,0x41078000,0x419800,0x76300,0x1a0700,0x40610800,0x40000280,0x3f000000,63,63,63,0x34380,0x5e100,16,10,0xbe800000,3,0,0,0xffffffff,0x21000,0x41a000,0x821e00,0xf86000,0
.long 30,34,81,0x66000,0x1a01a,0x40e2d000,0x40e2d400,0x41078400,0x41078800,0x41a400,0x7e300,0x1a4700,0x40611300,0x40000280,0x3f000000,63,63,63,0x36380,0x5e180,336,10,0xbe800000,3,0,0,0xffffffff,0x21800,0x41b000,0x822900,0xf95000,0
.long 30,34,72,0x66400,0x1a002,0x40e2d800,0x40e3c000,0x41078c00,0x41079000,0x438000,0x66700,0x180f00,0x406c0800,0x40000280,0x3f000000,63,63,63,0x30780,0x5e200,2,10,0xbe800000,3,1,0xffffffff,0xffffffff,0x24000,0x438000,0x836800,0xf68000,0
.long 30,34,75,0x66400,0x1a00a,0x40e3c400,0x40e3c800,0x410b4000,0x410b4400,0x438c00,0x6e700,0x184f00,0x406c1300,0x40000280,0x3f000000,63,63,63,0x32780,0x5e280,322,10,0xbe800000,3,1,0xffffffff,0xffffffff,0x24800,0x439000,0x837300,0xf77000,0
.long 30,34,78,0x66400,0x1a012,0x40e4b000,0x40e4b400,0x410b4800,0x410b4c00,0x439800,0x76700,0x1a0f00,0x406c0800,0x40000280,0x3f000000,63,63,63,0x34780,0x5e300,30,10,0xbe800000,3,0x80008000,0xffffffff,0xffffffff,0x25000,0x43a000,0x837e00,0xf86000,0
.long 30,34,81,0x66400,0x1a01a,0x40e4b800,0x40e5a000,0x410b5000,0x410f0000,0x43a400,0x7e700,0x1a4f00,0x406c1300,0x40000280,0x3f000000,63,63,63,0x36780,0x5e380,350,10,0xbe800000,3,0x80008000,0xffffffff,0xffffffff,0x25800,0x43b000,0x838900,0xf95000,0
.long 30,34,72,0x6e800,0x1a002,0x40e5a400,0x40e5a800,0x410f0400,0x410f0800,0x458000,0x66b00,0x181700,0x40770800,0x40000280,0x3f000000,63,63,63,0x30b80,0x5e400,4,10,0xbe800000,3,1,0xffffffff,0xffffffff,0x28000,0x458000,0x84c800,0xf68000,0
.long 30,34,75,0x6e800,0x1a00a,0x40e69000,0x40e69400,0x410f0c00,0x410f1000,0x458c00,0x6eb00,0x185700,0x40771300,0x40000280,0x3f000000,63,63,63,0x32b80,0x5e480,324,10,0xbe800000,3,1,0xffffffff,0xffffffff,0x28800,0x459000,0x84d300,0xf77000,0
.long 30,34,78,0x6e800,0x1a012,0x40e69800,0x40e78000,0x4112c000,0x4112c400,0x459800,0x76b00,0x1a1700,0x40770800,0x40000280,0x3f000000,63,63,63,0x34b80,0x5e500,28,10,0xbe800000,3,0x80008000,0xffffffff,0xffffffff,0x29000,0x45a000,0x84de00,0xf86000,0
.long 30,34,81,0x6e800,0x1a01a,0x40e78400,0x40e78800,0x4112c800,0x4112cc00,0x45a400,0x7eb00,0x1a5700,0x40771300,0x40000280,0x3f000000,63,63,63,0x36b80,0x5e580,348,10,0xbe800000,3,0x80008000,0xffffffff,0xffffffff,0x29800,0x45b000,0x84e900,0xf95000,0
.long 30,34,72,0x6ec00,0x1a002,0x40e87000,0x40e87400,0x4112d000,0x41168000,0x478000,0x66f00,0x181f00,0x40820800,0x40000280,0x3f000000,63,63,63,0x30f80,0x5e600,6,10,0xbe800000,3,1,0xffffffff,0xffffffff,0x2c000,0x478000,0x862800,0xf68000,0
.long 30,34,75,0x6ec00,0x1a00a,0x40e87800,0x40e96000,0x41168400,0x41168800,0x478c00,0x6ef00,0x185f00,0x40821300,0x40000280,0x3f000000,63,63,63,0x32f80,0x5e680,326,10,0xbe800000,3,1,0xffffffff,0xffffffff,0x2c800,0x479000,0x863300,0xf77000,0
.long 30,34,78,0x6ec00,0x1a012,0x40e96400,0x40e96800,0x41168c00,0x41169000,0x479800,0x76f00,0x1a1f00,0x40820800,0x40000280,0x3f000000,63,63,63,0x34f80,0x5e700,26,10,0xbe800000,3,0x80008000,0xffffffff,0xffffffff,0x2d000,0x47a000,0x863e00,0xf86000,0
.long 30,34,81,0x6ec00,0x1a01a,0x40ea5000,0x40ea5400,0x411a4000,0x411a4400,0x47a400,0x7ef00,0x1a5f00,0x40821300,0x40000280,0x3f000000,63,63,63,0x36f80,0x5e780,346,10,0xbe800000,3,0x80008000,0xffffffff,0xffffffff,0x2d800,0x47b000,0x864900,0xf95000,0
.long 30,34,72,0x77000,0x1a002,0x40ea5800,0x40eb4000,0x411a4800,0x411a4c00,0x498000,0x67300,0x182700,0x40815800,0x40000280,0x3f000000,63,63,63,0x31380,0x5e800,8,10,0xbe800000,3,1,0xffffffff,0xffffffff,0x30000,0x498000,0x878800,0xf68000,0
.long 30,34,75,0x77000,0x1a00a,0x40eb4400,0x40eb4800,0x411a5000,0x411e0000,0x498c00,0x6f300,0x186700,0x40816300,0x40000280,0x3f000000,63,63,63,0x33380,0x5e880,328,10,0xbe800000,3,1,0xffffffff,0xffffffff,0x30800,0x499000,0x879300,0xf77000,0
.long 30,34,78,0x77000,0x1a012,0x40ec3000,0x40ec3400,0x411e0400,0x411e0800,0x499800,0x77300,0x1a2700,0x40815800,0x40000280,0x3f000000,63,63,63,0x35380,0x5e900,24,10,0xbe800000,3,0x80008000,0xffffffff,0xffffffff,0x31000,0x49a000,0x879e00,0xf86000,0
.long 30,34,81,0x77000,0x1a01a,0x40ec3800,0x40ed2000,0x411e0c00,0x411e1000,0x49a400,0x7f300,0x1a6700,0x40816300,0x40000280,0x3f000000,63,63,63,0x37380,0x5e980,344,10,0xbe800000,3,0x80008000,0xffffffff,0xffffffff,0x31800,0x49b000,0x87a900,0xf95000,0
.long 30,34,72,0x77400,0x1a002,0x40ed2400,0x40ed2800,0x4103d400,0x4103d800,0x4b8000,0x67700,0x182f00,0x40765800,0x40000280,0x3f000000,63,63,63,0x31780,0x5ea00,10,10,0xbe800000,3,1,0xffffffff,0xffffffff,0x34000,0x4b8000,0x88e800,0xf68000,0
.long 30,34,75,0x77400,0x1a00a,0x40ee1000,0x40ee1400,0x4103dc00,0x4103e000,0x4b8c00,0x6f700,0x186f00,0x40766300,0x40000280,0x3f000000,63,63,63,0x33780,0x5ea80,330,10,0xbe800000,3,1,0xffffffff,0xffffffff,0x34800,0x4b9000,0x88f300,0xf77000,0
.long 30,34,78,0x77400,0x1a012,0x40ee1800,0x40ef0000,0x4103e400,0x41079400,0x4b9800,0x77700,0x1a2f00,0x40765800,0x40000280,0x3f000000,63,63,63,0x35780,0x5eb00,22,10,0xbe800000,3,0x80008000,0xffffffff,0xffffffff,0x35000,0x4ba000,0x88fe00,0xf86000,0
.long 30,34,81,0x77400,0x1a01a,0x40ef0400,0x40ef0800,0x41079800,0x41079c00,0x4ba400,0x7f700,0x1a6f00,0x40766300,0x40000280,0x3f000000,63,63,63,0x37780,0x5eb80,342,10,0xbe800000,3,0x80008000,0xffffffff,0xffffffff,0x35800,0x4bb000,0x890900,0xf95000,0
.long 30,34,72,0x7f800,0x1a002,0x40eff000,0x40eff400,0x4107a000,0x4107a400,0x4d8000,0x67b00,0x183700,0x406b5800,0x40000280,0x3f000000,63,63,63,0x31b80,0x5ec00,12,10,0xbe800000,3,1,0xffffffff,0xffffffff,0x38000,0x4d8000,0x8a4800,0xf68000,0
.long 30,34,75,0x7f800,0x1a00a,0x40eff800,0x40f0e000,0x410b5400,0x410b5800,0x4d8c00,0x6fb00,0x187700,0x406b6300,0x40000280,0x3f000000,63,63,63,0x33b80,0x5ec80,332,10,0xbe800000,3,1,0xffffffff,0xffffffff,0x38800,0x4d9000,0x8a5300,0xf77000,0
.long 30,34,78,0x7f800,0x1a012,0x40f0e400,0x40f0e800,0x410b5c00,0x410b6000,0x4d9800,0x77b00,0x1a3700,0x406b5800,0x40000280,0x3f000000,63,63,63,0x35b80,0x5ed00,20,10,0xbe800000,3,0x80008000,0xffffffff,0xffffffff,0x39000,0x4da000,0x8a5e00,0xf86000,0
.long 30,34,81,0x7f800,0x1a01a,0x40f1d000,0x40f1d400,0x410b6400,0x410f1400,0x4da400,0x7fb00,0x1a7700,0x406b6300,0x40000280,0x3f000000,63,63,63,0x37b80,0x5ed80,340,10,0xbe800000,3,0x80008000,0xffffffff,0xffffffff,0x39800,0x4db000,0x8a6900,0xf95000,0
.long 30,34,72,0x7fc00,0x1a002,0x40f1d800,0x40f2c000,0x410f1800,0x410f1c00,0x4f8000,0x67f00,0x183f00,0x40605800,0x40000280,0x3f000000,63,63,63,0x31f80,0x5ee00,14,10,0xbe800000,3,1,0xffffffff,0xffffffff,0x3c000,0x4f8000,0x8ba800,0xf68000,0
.long 30,34,75,0x7fc00,0x1a00a,0x40f2c400,0x40f2c800,0x410f2000,0x410f2400,0x4f8c00,0x6ff00,0x187f00,0x40606300,0x40000280,0x3f000000,63,63,63,0x33f80,0x5ee80,334,10,0xbe800000,3,1,0xffffffff,0xffffffff,0x3c800,0x4f9000,0x8bb300,0xf77000,0
.long 30,34,78,0x7fc00,0x1a012,0x40f3b000,0x40f3b400,0x4112d400,0x4112d800,0x4f9800,0x77f00,0x1a3f00,0x40605800,0x40000280,0x3f000000,63,63,63,0x35f80,0x5ef00,18,10,0xbe800000,3,0x80008000,0xffffffff,0xffffffff,0x3d000,0x4fa000,0x8bbe00,0xf86000,0
.long 30,34,81,0x7fc00,0x1a01a,0x40f3b800,0x40f4a000,0x4112dc00,0x4112e000,0x4fa400,0x7ff00,0x1a7f00,0x40606300,0x40000280,0x3f000000,63,63,63,0x37f80,0x5ef80,338,10,0xbe800000,3,0x80008000,0xffffffff,0xffffffff,0x3d800,0x4fb000,0x8bc900,0xf95000,0
.long 30,34,84,0x66000,0x1a002,0x40f4a400,0x40f4a800,0x4112e400,0x41169400,0x41c000,0x66380,0x1c0700,0x40610800,0x40000280,0x3f000000,63,63,63,0x38380,0x5f000,1,10,0xbe800000,3,1,0xffffffff,0xffffffff,0x22000,0x41c000,0x823400,0xfa4000,0
.long 30,34,87,0x66000,0x1a00a,0x40f59000,0x40f59400,0x41169800,0x41169c00,0x41cc00,0x6e380,0x1c4700,0x40611300,0x40000280,0x3f000000,63,63,63,0x3a380,0x5f080,321,10,0xbe800000,3,1,0xffffffff,0xffffffff,0x22800,0x41d000,0x823f00,0xfb3000,0
.long 30,34,90,0x66000,0x1a012,0x40f59800,0x40f68000,0x4116a000,0x4116a400,0x41d800,0x76380,0x1e0700,0x40610800,0x40000280,0x3f000000,63,63,63,0x3c380,0x5f100,31,10,0xbe800000,3,0x80008000,0xffffffff,0xffffffff,0x23000,0x41e000,0x824a00,0xfc2000,0
.long 30,34,93,0x66000,0x1a01a,0x40f68400,0x40f68800,0x411a5400,0x411a5800,0x41e400,0x7e380,0x1e4700,0x40611300,0x40000280,0x3f000000,63,63,63,0x3e380,0x5f180,351,10,0xbe800000,3,0x80008000,0xffffffff,0xffffffff,0x23800,0x41f000,0x825500,0xfd1000,0
.long 30,34,84,0x66400,0x1a002,0x40f77000,0x40f77400,0x411a5c00,0x411a6000,0x43c000,0x66780,0x1c0f00,0x406c0800,0x40000280,0x3f000000,63,63,63,0x38780,0x5f200,3,10,0xbe800000,3,1,0xffffffff,0xffffffff,0x26000,0x43c000,0x839400,0xfa4000,0
.long 30,34,87,0x66400,0x1a00a,0x40f77800,0x40f86000,0x411a6400,0x411e1400,0x43cc00,0x6e780,0x1c4f00,0x406c1300,0x40000280,0x3f000000,63,63,63,0x3a780,0x5f280,323,10,0xbe800000,3,1,0xffffffff,0xffffffff,0x26800,0x43d000,0x839f00,0xfb3000,0
.long 30,34,90,0x66400,0x1a012,0x40f86400,0x40f86800,0x411e1800,0x411e1c00,0x43d800,0x76780,0x1e0f00,0x406c0800,0x40000280,0x3f000000,63,63,63,0x3c780,0x5f300,29,10,0xbe800000,3,0x80008000,0xffffffff,0xffffffff,0x27000,0x43e000,0x83aa00,0xfc2000,0
.long 30,34,93,0x66400,0x1a01a,0x40f95000,0x40f95400,0x411e2000,0x411e2400,0x43e400,0x7e780,0x1e4f00,0x406c1300,0x40000280,0x3f000000,63,63,63,0x3e780,0x5f380,349,10,0xbe800000,3,0x80008000,0xffffffff,0xffffffff,0x27800,0x43f000,0x83b500,0xfd1000,0
.long 30,34,84,0x6e800,0x1a002,0x40f95800,0x40fa4000,0x4103e800,0x4103ec00,0x45c000,0x66b80,0x1c1700,0x40770800,0x40000280,0x3f000000,63,63,63,0x38b80,0x5f400,5,10,0xbe800000,3,1,0xffffffff,0xffffffff,0x2a000,0x45c000,0x84f400,0xfa4000,0
.long 30,34,87,0x6e800,0x1a00a,0x40fa4400,0x40fa4800,0x4103f000,0x4103f400,0x45cc00,0x6eb80,0x1c5700,0x40771300,0x40000280,0x3f000000,63,63,63,0x3ab80,0x5f480,325,10,0xbe800000,3,1,0xffffffff,0xffffffff,0x2a800,0x45d000,0x84ff00,0xfb3000,0
.long 30,34,90,0x6e800,0x1a012,0x40fb3000,0x40fb3400,0x4103f800,0x4107a800,0x45d800,0x76b80,0x1e1700,0x40770800,0x40000280,0x3f000000,63,63,63,0x3cb80,0x5f500,27,10,0xbe800000,3,0x80008000,0xffffffff,0xffffffff,0x2b000,0x45e000,0x850a00,0xfc2000,0
.long 30,34,93,0x6e800,0x1a01a,0x40fb3800,0x40fc2000,0x4107ac00,0x4107b000,0x45e400,0x7eb80,0x1e5700,0x40771300,0x40000280,0x3f000000,63,63,63,0x3eb80,0x5f580,347,10,0xbe800000,3,0x80008000,0xffffffff,0xffffffff,0x2b800,0x45f000,0x851500,0xfd1000,0
.long 30,34,84,0x6ec00,0x1a002,0x40fc2400,0x40fc2800,0x4107b400,0x4107b800,0x47c000,0x66f80,0x1c1f00,0x40820800,0x40000280,0x3f000000,63,63,63,0x38f80,0x5f600,7,10,0xbe800000,3,1,0xffffffff,0xffffffff,0x2e000,0x47c000,0x865400,0xfa4000,0
.long 30,34,87,0x6ec00,0x1a00a,0x40fd1000,0x40fd1400,0x410b6800,0x410b6c00,0x47cc00,0x6ef80,0x1c5f00,0x40821300,0x40000280,0x3f000000,63,63,63,0x3af80,0x5f680,327,10,0xbe800000,3,1,0xffffffff,0xffffffff,0x2e800,0x47d000,0x865f00,0xfb3000,0
.long 30,34,90,0x6ec00,0x1a012,0x40fd1800,0x40fe0000,0x410b7000,0x410b7400,0x47d800,0x76f80,0x1e1f00,0x40820800,0x40000280,0x3f000000,63,63,63,0x3cf80,0x5f700,25,10,0xbe800000,3,0x80008000,0xffffffff,0xffffffff,0x2f000,0x47e000,0x866a00,0xfc2000,0
.long 30,34,93,0x6ec00,0x1a01a,0x40fe0400,0x40fe0800,0x410b7800,0x410f2800,0x47e400,0x7ef80,0x1e5f00,0x40821300,0x40000280,0x3f000000,63,63,63,0x3ef80,0x5f780,345,10,0xbe800000,3,0x80008000,0xffffffff,0xffffffff,0x2f800,0x47f000,0x867500,0xfd1000,0
.long 30,34,84,0x77000,0x1a002,0x40e0fc00,0x40e10000,0x410f2c00,0x410f3000,0x49c000,0x67380,0x1c2700,0x40815800,0x40000280,0x3f000000,63,63,63,0x39380,0x5f800,9,10,0xbe800000,3,1,0xffffffff,0xffffffff,0x32000,0x49c000,0x87b400,0xfa4000,0
.long 30,34,87,0x77000,0x1a00a,0x40e10400,0x40e1ec00,0x410f3400,0x410f3800,0x49cc00,0x6f380,0x1c6700,0x40816300,0x40000280,0x3f000000,63,63,63,0x3b380,0x5f880,329,10,0xbe800000,3,1,0xffffffff,0xffffffff,0x32800,0x49d000,0x87bf00,0xfb3000,0
.long 30,34,90,0x77000,0x1a012,0x40e1f000,0x40e1f400,0x4112e800,0x4112ec00,0x49d800,0x77380,0x1e2700,0x40815800,0x40000280,0x3f000000,63,63,63,0x3d380,0x5f900,23,10,0xbe800000,3,0x80008000,0xffffffff,0xffffffff,0x33000,0x49e000,0x87ca00,0xfc2000,0
.long 30,34,93,0x77000,0x1a01a,0x40e2dc00,0x40e2e000,0x4112f000,0x4112f400,0x49e400,0x7f380,0x1e6700,0x40816300,0x40000280,0x3f000000,63,63,63,0x3f380,0x5f980,343,10,0xbe800000,3,0x80008000,0xffffffff,0xffffffff,0x33800,0x49f000,0x87d500,0xfd1000,0
.long 30,34,84,0x77400,0x1a002,0x40e2e400,0x40e3cc00,0x4112f800,0x4116a800,0x4bc000,0x67780,0x1c2f00,0x40765800,0x40000280,0x3f000000,63,63,63,0x39780,0x5fa00,11,10,0xbe800000,3,1,0xffffffff,0xffffffff,0x36000,0x4bc000,0x891400,0xfa4000,0
.long 30,34,87,0x77400,0x1a00a,0x40e3d000,0x40e3d400,0x4116ac00,0x4116b000,0x4bcc00,0x6f780,0x1c6f00,0x40766300,0x40000280,0x3f000000,63,63,63,0x3b780,0x5fa80,331,10,0xbe800000,3,1,0xffffffff,0xffffffff,0x36800,0x4bd000,0x891f00,0xfb3000,0
.long 30,34,90,0x77400,0x1a012,0x40e4bc00,0x40e4c000,0x4116b400,0x4116b800,0x4bd800,0x77780,0x1e2f00,0x40765800,0x40000280,0x3f000000,63,63,63,0x3d780,0x5fb00,21,10,0xbe800000,3,0x80008000,0xffffffff,0xffffffff,0x37000,0x4be000,0x892a00,0xfc2000,0
.long 30,34,93,0x77400,0x1a01a,0x40e4c400,0x40e5ac00,0x411a6800,0x411a6c00,0x4be400,0x7f780,0x1e6f00,0x40766300,0x40000280,0x3f000000,63,63,63,0x3f780,0x5fb80,341,10,0xbe800000,3,0x80008000,0xffffffff,0xffffffff,0x37800,0x4bf000,0x893500,0xfd1000,0
.long 30,34,84,0x7f800,0x1a002,0x40e5b000,0x40e5b400,0x411a7000,0x411a7400,0x4dc000,0x67b80,0x1c3700,0x406b5800,0x40000280,0x3f000000,63,63,63,0x39b80,0x5fc00,13,10,0xbe800000,3,1,0xffffffff,0xffffffff,0x3a000,0x4dc000,0x8a7400,0xfa4000,0
.long 30,34,87,0x7f800,0x1a00a,0x40e69c00,0x40e6a000,0x411a7800,0x411e2800,0x4dcc00,0x6fb80,0x1c7700,0x406b6300,0x40000280,0x3f000000,63,63,63,0x3bb80,0x5fc80,333,10,0xbe800000,3,1,0xffffffff,0xffffffff,0x3a800,0x4dd000,0x8a7f00,0xfb3000,0
.long 30,34,90,0x7f800,0x1a012,0x40e6a400,0x40e78c00,0x411e2c00,0x411e3000,0x4dd800,0x77b80,0x1e3700,0x406b5800,0x40000280,0x3f000000,63,63,63,0x3db80,0x5fd00,19,10,0xbe800000,3,0x80008000,0xffffffff,0xffffffff,0x3b000,0x4de000,0x8a8a00,0xfc2000,0
.long 30,34,93,0x7f800,0x1a01a,0x40e79000,0x40e79400,0x411e3400,0x411e3800,0x4de400,0x7fb80,0x1e7700,0x406b6300,0x40000280,0x3f000000,63,63,63,0x3fb80,0x5fd80,339,10,0xbe800000,3,0x80008000,0xffffffff,0xffffffff,0x3b800,0x4df000,0x8a9500,0xfd1000,0
.long 30,34,84,0x7fc00,0x1a002,0x40e87c00,0x40e88000,0x4103fc00,0x41040000,0x4fc000,0x67f80,0x1c3f00,0x40605800,0x40000280,0x3f000000,63,63,63,0x39f80,0x5fe00,15,10,0xbe800000,3,1,0xffffffff,0xffffffff,0x3e000,0x4fc000,0x8bd400,0xfa4000,0
.long 30,34,87,0x7fc00,0x1a00a,0x40e88400,0x40e96c00,0x41040400,0x41040800,0x4fcc00,0x6ff80,0x1c7f00,0x40606300,0x40000280,0x3f000000,63,63,63,0x3bf80,0x5fe80,335,10,0xbe800000,3,1,0xffffffff,0xffffffff,0x3e800,0x4fd000,0x8bdf00,0xfb3000,0
.long 30,34,90,0x7fc00,0x1a012,0x40e97000,0x40e97400,0x41040c00,0x4107bc00,0x4fd800,0x77f80,0x1e3f00,0x40605800,0x40000280,0x3f000000,63,63,63,0x3df80,0x5ff00,17,10,0xbe800000,3,0x80008000,0xffffffff,0xffffffff,0x3f000,0x4fe000,0x8bea00,0xfc2000,0
.long 30,34,93,0x7fc00,0x1a01a,0x40ea5c00,0x40ea6000,0x4107c000,0x4107c400,0x4fe400,0x7ff80,0x1e7f00,0x40606300,0x40000280,0x3f000000,63,63,63,0x3ff80,0x5ff80,337,10,0xbe800000,3,0x80008000,0xffffffff,0xffffffff,0x3f800,0x4ff000,0x8bf500,0xfd1000,0
.size L_tab, 131072
.p2align 8
.type L_wd,@object
L_wd:
.long 0x40000000,0x600b00,0x600100,0x602c00,0x8069e000,0x602d00,0x616000,0x8069b400,0x616100,0x618c00,0x80688000,0x618d00,0x62c000,0x80685400,0x62c100,0x62ec00,0x80672000,0x62ed00,0x642000,0x8066f400,0x642100,0x644c00,0x8065c000,0x644d00,0x658000,0x80659400,0x40000000,0x65ac00,0x80646000,0x40000000,0x66e000,0x80643400,0x40000000,0x670c00,0x80630000,0x40000000,0x684000,0x8062d400,0x40000000,0x686c00,0x8061a000,0x40000000,0x69a000,0x80617400,0x40000000,0x69cc00,0x80604000,0x40000000
.long 0x40000000,0x6b1600,0x6b0100,0x6b2c00,0x74e200,0x6b2d00,0x6c6000,0x74b600,0x6c6100,0x6c8c00,0x738200,0x6c8d00,0x6dc000,0x735600,0x6dc100,0x6dec00,0x722200,0x6ded00,0x6f2000,0x71f600,0x6f2100,0x6f4c00,0x70c200,0x6f4d00,0x708000,0x709600,0x40000000,0x70ac00,0x6f6200,0x40000000,0x71e000,0x6f3600,0x40000000,0x720c00,0x6e0200,0x40000000,0x734000,0x6dd600,0x40000000,0x736c00,0x6ca200,0x40000000,0x74a000,0x6c7600,0x40000000,0x74cc00,0x6b4200,0x40000000
.long 0x40000000,0x761600,0x760100,0x762c00,0x7fe200,0x762d00,0x776000,0x7fb600,0x776100,0x778c00,0x7e8200,0x778d00,0x78c000,0x7e5600,0x78c100,0x78ec00,0x7d2200,0x78ed00,0x7a2000,0x7cf600,0x7a2100,0x7a4c00,0x7bc200,0x7a4d00,0x7b8000,0x7b9600,0x40000000,0x7bac00,0x7a6200,0x40000000,0x7ce000,0x7a3600,0x40000000,0x7d0c00,0x790200,0x40000000,0x7e4000,0x78d600,0x40000000,0x7e6c00,0x77a200,0x40000000,0x7fa000,0x777600,0x40000000,0x7fcc00,0x764200,0x40000000
.long 0x40000000,0x811600,0x810100,0x812c00,0x8ae200,0x812d00,0x826000,0x8ab600,0x826100,0x828c00,0x898200,0x828d00,0x83c000,0x895600,0x83c100,0x83ec00,0x882200,0x83ed00,0x852000,0x87f600,0x852100,0x854c00,0x86c200,0x854d00,0x868000,0x869600,0x40000000,0x86ac00,0x856200,0x40000000,0x87e000,0x853600,0x40000000,0x880c00,0x840200,0x40000000,0x894000,0x83d600,0x40000000,0x896c00,0x82a200,0x40000000,0x8aa000,0x827600,0x40000000,0x8acc00,0x814200,0x40000000
.long 0x40000000,0x602100,0x601700,0x604200,0x8069f600,0x604300,0x617600,0x8069ca00,0x617700,0x61a200,0x80689600,0x61a300,0x62d600,0x80686a00,0x62d700,0x630200,0x80673600,0x630300,0x643600,0x80670a00,0x643700,0x646200,0x8065d600,0x646300,0x659600,0x8065aa00,0x40000000,0x65c200,0x80647600,0x40000000,0x66f600,0x80644a00,0x40000000,0x672200,0x80631600,0x40000000,0x685600,0x8062ea00,0x40000000,0x688200,0x8061b600,0x40000000,0x69b600,0x80618a00,0x40000000,0x69e200,0x80605600,0x40000000
.long 0x40000000,0x80812a00,0x80811400,0x80815600,0x808ae000,0x80815500,0x80828a00,0x808ab400,0x80828900,0x8082b600,0x80898000,0x8082b500,0x8083ea00,0x80895400,0x8083e900,0x80841600,0x80882000,0x80841500,0x80854a00,0x8087f400,0x80854900,0x80857600,0x8086c000,0x80857500,0x8086aa00,0x80869400,0x40000000,0x8086d600,0x80856000,0x40000000,0x80880a00,0x80853400,0x40000000,0x80883600,0x80840000,0x40000000,0x80896a00,0x8083d400,0x40000000,0x80899600,0x8082a000,0x40000000,0x808aca00,0x80827400,0x40000000,0x808af600,0x80814000,0x40000000
.long 0x40000000,0x80762a00,0x80761400,0x80765600,0x807fe000,0x80765500,0x80778a00,0x807fb400,0x80778900,0x8077b600,0x807e8000,0x8077b500,0x8078ea00,0x807e5400,0x8078e900,0x80791600,0x807d2000,0x80791500,0x807a4a00,0x807cf400,0x807a4900,0x807a7600,0x807bc000,0x807a7500,0x807baa00,0x807b9400,0x40000000,0x807bd600,0x807a6000,0x40000000,0x807d0a00,0x807a3400,0x40000000,0x807d3600,0x80790000,0x40000000,0x807e6a00,0x8078d400,0x40000000,0x807e9600,0x8077a000,0x40000000,0x807fca00,0x80777400,0x40000000,0x807ff600,0x80764000,0x40000000
.long 0x40000000,0x806b2a00,0x806b1400,0x806b5600,0x8074e000,0x806b5500,0x806c8a00,0x8074b400,0x806c8900,0x806cb600,0x80738000,0x806cb500,0x806dea00,0x80735400,0x806de900,0x806e1600,0x80722000,0x806e1500,0x806f4a00,0x8071f400,0x806f4900,0x806f7600,0x8070c000,0x806f7500,0x8070aa00,0x80709400,0x40000000,0x8070d600,0x806f6000,0x40000000,0x80720a00,0x806f3400,0x40000000,0x80723600,0x806e0000,0x40000000,0x80736a00,0x806dd400,0x40000000,0x80739600,0x806ca000,0x40000000,0x8074ca00,0x806c7400,0x40000000,0x8074f600,0x806b4000,0x40000000
.long 0x658100,0x80659300,0x658200,0x65ad00,0x80645f00,0x65ae00,0x66e100,0x80643300,0x66e200,0x670d00,0x8062ff00,0x670e00,0x684100,0x8062d300,0x684200,0x686d00,0x80619f00,0x686e00,0x69a100,0x80617300,0x69a200,0x69cd00,0x80603f00,0x69ce00,0x600c00,0x600200,0x40000000,0x8069df00,0x602e00,0x40000000,0x8069b300,0x616200,0x40000000,0x80687f00,0x618e00,0x40000000,0x80685300,0x62c200,0x40000000,0x80671f00,0x62ee00,0x40000000,0x8066f300,0x642200,0x40000000,0x8065bf00,0x644e00,0x40000000
.long 0x708100,0x709700,0x708200,0x70ad00,0x6f6300,0x70ae00,0x71e100,0x6f3700,0x71e200,0x720d00,0x6e0300,0x720e00,0x734100,0x6dd700,0x734200,0x736d00,0x6ca300,0x736e00,0x74a100,0x6c7700,0x74a200,0x74cd00,0x6b4300,0x74ce00,0x6b1700,0x6b0200,0x40000000,0x74e300,0x6b2e00,0x40000000,0x74b700,0x6c6200,0x40000000,0x738300,0x6c8e00,0x40000000,0x735700,0x6dc200,0x40000000,0x722300,0x6dee00,0x40000000,0x71f700,0x6f2200,0x40000000,0x70c300,0x6f4e00,0x40000000
.long 0x7b8100,0x7b9700,0x7b8200,0x7bad00,0x7a6300,0x7bae00,0x7ce100,0x7a3700,0x7ce200,0x7d0d00,0x790300,0x7d0e00,0x7e4100,0x78d700,0x7e4200,0x7e6d00,0x77a300,0x7e6e00,0x7fa100,0x777700,0x7fa200,0x7fcd00,0x764300,0x7fce00,0x761700,0x760200,0x40000000,0x7fe300,0x762e00,0x40000000,0x7fb700,0x776200,0x40000000,0x7e8300,0x778e00,0x40000000,0x7e5700,0x78c200,0x40000000,0x7d2300,0x78ee00,0x40000000,0x7cf700,0x7a2200,0x40000000,0x7bc300,0x7a4e00,0x40000000
.long 0x868100,0x869700,0x868200,0x86ad00,0x856300,0x86ae00,0x87e100,0x853700,0x87e200,0x880d00,0x840300,0x880e00,0x894100,0x83d700,0x894200,0x896d00,0x82a300,0x896e00,0x8aa100,0x827700,0x8aa200,0x8acd00,0x814300,0x8ace00,0x811700,0x810200,0x40000000,0x8ae300,0x812e00,0x40000000,0x8ab700,0x826200,0x40000000,0x898300,0x828e00,0x40000000,0x895700,0x83c200,0x40000000,0x882300,0x83ee00,0x40000000,0x87f700,0x852200,0x40000000,0x86c300,0x854e00,0x40000000
.long 0x659700,0x8065a900,0x659800,0x65c300,0x80647500,0x65c400,0x66f700,0x80644900,0x66f800,0x672300,0x80631500,0x672400,0x685700,0x8062e900,0x685800,0x688300,0x8061b500,0x688400,0x69b700,0x80618900,0x69b800,0x69e300,0x80605500,0x69e400,0x602200,0x601800,0x40000000,0x8069f500,0x604400,0x40000000,0x8069c900,0x617800,0x40000000,0x80689500,0x61a400,0x40000000,0x80686900,0x62d800,0x40000000,0x80673500,0x630400,0x40000000,0x80670900,0x643800,0x40000000,0x8065d500,0x646400,0x40000000
.long 0x8086a900,0x80869300,0x8086a800,0x8086d500,0x80855f00,0x8086d400,0x80880900,0x80853300,0x80880800,0x80883500,0x8083ff00,0x80883400,0x80896900,0x8083d300,0x80896800,0x80899500,0x80829f00,0x80899400,0x808ac900,0x80827300,0x808ac800,0x808af500,0x80813f00,0x808af400,0x80812900,0x80811300,0x40000000,0x808adf00,0x80815400,0x40000000,0x808ab300,0x80828800,0x40000000,0x80897f00,0x8082b400,0x40000000,0x80895300,0x8083e800,0x40000000,0x80881f00,0x80841400,0x40000000,0x8087f300,0x80854800,0x40000000,0x8086bf00,0x80857400,0x40000000
.long 0x807ba900,0x807b9300,0x807ba800,0x807bd500,0x807a5f00,0x807bd400,0x807d0900,0x807a3300,0x807d0800,0x807d3500,0x8078ff00,0x807d3400,0x807e6900,0x8078d300,0x807e6800,0x807e9500,0x80779f00,0x807e9400,0x807fc900,0x80777300,0x807fc800,0x807ff500,0x80763f00,0x807ff400,0x80762900,0x80761300,0x40000000,0x807fdf00,0x80765400,0x40000000,0x807fb300,0x80778800,0x40000000,0x807e7f00,0x8077b400,0x40000000,0x807e5300,0x8078e800,0x40000000,0x807d1f00,0x80791400,0x40000000,0x807cf300,0x807a4800,0x40000000,0x807bbf00,0x807a7400,0x40000000
.long 0x8070a900,0x80709300,0x8070a800,0x8070d500,0x806f5f00,0x8070d400,0x80720900,0x806f3300,0x80720800,0x80723500,0x806dff00,0x80723400,0x80736900,0x806dd300,0x80736800,0x80739500,0x806c9f00,0x80739400,0x8074c900,0x806c7300,0x8074c800,0x8074f500,0x806b3f00,0x8074f400,0x806b2900,0x806b1300,0x40000000,0x8074df00,0x806b5400,0x40000000,0x8074b300,0x806c8800,0x40000000,0x80737f00,0x806cb400,0x40000000,0x80735300,0x806de800,0x40000000,0x80721f00,0x806e1400,0x40000000,0x8071f300,0x806f4800,0x40000000,0x8070bf00,0x806f7400,0x40000000
.long 0x600d00,0x600300,0x600e00,0x8069de00,0x602f00,0x8069dd00,0x8069b200,0x616300,0x8069b100,0x80687e00,0x618f00,0x80687d00,0x80685200,0x62c300,0x80685100,0x80671e00,0x62ef00,0x80671d00,0x8066f200,0x642300,0x8066f100,0x8065be00,0x644f00,0x8065bd00,0x80659200,0x658300,0x40000000,0x80645e00,0x65af00,0x40000000,0x80643200,0x66e300,0x40000000,0x8062fe00,0x670f00,0x40000000,0x8062d200,0x684300,0x40000000,0x80619e00,0x686f00,0x40000000,0x80617200,0x69a300,0x40000000,0x80603e00,0x69cf00,0x40000000
.long 0x6b1800,0x6b0300,0x6b1900,0x74e400,0x6b2f00,0x74e500,0x74b800,0x6c6300,0x74b900,0x738400,0x6c8f00,0x738500,0x735800,0x6dc300,0x735900,0x722400,0x6def00,0x722500,0x71f800,0x6f2300,0x71f900,0x70c400,0x6f4f00,0x70c500,0x709800,0x708300,0x40000000,0x6f6400,0x70af00,0x40000000,0x6f3800,0x71e300,0x40000000,0x6e0400,0x720f00,0x40000000,0x6dd800,0x734300,0x40000000,0x6ca400,0x736f00,0x40000000,0x6c7800,0x74a300,0x40000000,0x6b4400,0x74cf00,0x40000000
.long 0x761800,0x760300,0x761900,0x7fe400,0x762f00,0x7fe500,0x7fb800,0x776300,0x7fb900,0x7e8400,0x778f00,0x7e8500,0x7e5800,0x78c300,0x7e5900,0x7d2400,0x78ef00,0x7d2500,0x7cf800,0x7a2300,0x7cf900,0x7bc400,0x7a4f00,0x7bc500,0x7b9800,0x7b8300,0x40000000,0x7a6400,0x7baf00,0x40000000,0x7a3800,0x7ce300,0x40000000,0x790400,0x7d0f00,0x40000000,0x78d800,0x7e4300,0x40000000,0x77a400,0x7e6f00,0x40000000,0x777800,0x7fa300,0x40000000,0x764400,0x7fcf00,0x40000000
.long 0x811800,0x810300,0x811900,0x8ae400,0x812f00,0x8ae500,0x8ab800,0x826300,0x8ab900,0x898400,0x828f00,0x898500,0x895800,0x83c300,0x895900,0x882400,0x83ef00,0x882500,0x87f800,0x852300,0x87f900,0x86c400,0x854f00,0x86c500,0x869800,0x868300,0x40000000,0x856400,0x86af00,0x40000000,0x853800,0x87e300,0x40000000,0x840400,0x880f00,0x40000000,0x83d800,0x894300,0x40000000,0x82a400,0x896f00,0x40000000,0x827800,0x8aa300,0x40000000,0x814400,0x8acf00,0x40000000
.long 0x602300,0x601900,0x602400,0x8069f400,0x604500,0x8069f300,0x8069c800,0x617900,0x8069c700,0x80689400,0x61a500,0x80689300,0x80686800,0x62d900,0x80686700,0x80673400,0x630500,0x80673300,0x80670800,0x643900,0x80670700,0x8065d400,0x646500,0x8065d300,0x8065a800,0x659900,0x40000000,0x80647400,0x65c500,0x40000000,0x80644800,0x66f900,0x40000000,0x80631400,0x672500,0x40000000,0x8062e800,0x685900,0x40000000,0x8061b400,0x688500,0x40000000,0x80618800,0x69b900,0x40000000,0x80605400,0x69e500,0x40000000
.long 0x80812800,0x80811200,0x80812700,0x808ade00,0x80815300,0x808add00,0x808ab200,0x80828700,0x808ab100,0x80897e00,0x8082b300,0x80897d00,0x80895200,0x8083e700,0x80895100,0x80881e00,0x80841300,0x80881d00,0x8087f200,0x80854700,0x8087f100,0x8086be00,0x80857300,0x8086bd00,0x80869200,0x8086a700,0x40000000,0x80855e00,0x8086d300,0x40000000,0x80853200,0x80880700,0x40000000,0x8083fe00,0x80883300,0x40000000,0x8083d200,0x80896700,0x40000000,0x80829e00,0x80899300,0x40000000,0x80827200,0x808ac700,0x40000000,0x80813e00,0x808af300,0x40000000
.long 0x80762800,0x80761200,0x80762700,0x807fde00,0x80765300,0x807fdd00,0x807fb200,0x80778700,0x807fb100,0x807e7e00,0x8077b300,0x807e7d00,0x807e5200,0x8078e700,0x807e5100,0x807d1e00,0x80791300,0x807d1d00,0x807cf200,0x807a4700,0x807cf100,0x807bbe00,0x807a7300,0x807bbd00,0x807b9200,0x807ba700,0x40000000,0x807a5e00,0x807bd300,0x40000000,0x807a3200,0x807d0700,0x40000000,0x8078fe00,0x807d3300,0x40000000,0x8078d200,0x807e6700,0x40000000,0x80779e00,0x807e9300,0x40000000,0x80777200,0x807fc700,0x40000000,0x80763e00,0x807ff300,0x40000000
.long 0x806b2800,0x806b1200,0x806b2700,0x8074de00,0x806b5300,0x8074dd00,0x8074b200,0x806c8700,0x8074b100,0x80737e00,0x806cb300,0x80737d00,0x80735200,0x806de700,0x80735100,0x80721e00,0x806e1300,0x80721d00,0x8071f200,0x806f4700,0x8071f100,0x8070be00,0x806f7300,0x8070bd00,0x80709200,0x8070a700,0x40000000,0x806f5e00,0x8070d300,0x40000000,0x806f3200,0x80720700,0x40000000,0x806dfe00,0x80723300,0x40000000,0x806dd200,0x80736700,0x40000000,0x806c9e00,0x80739300,0x40000000,0x806c7200,0x8074c700,0x40000000,0x806b3e00,0x8074f300,0x40000000
.long 0x80659100,0x658400,0x80659000,0x80645d00,0x65b000,0x80645c00,0x80643100,0x66e400,0x80643000,0x8062fd00,0x671000,0x8062fc00,0x8062d100,0x684400,0x8062d000,0x80619d00,0x687000,0x80619c00,0x80617100,0x69a400,0x80617000,0x80603d00,0x69d000,0x80603c00,0x600400,0x600f00,0x40000000,0x603000,0x8069dc00,0x40000000,0x616400,0x8069b000,0x40000000,0x619000,0x80687c00,0x40000000,0x62c400,0x80685000,0x40000000,0x62f000,0x80671c00,0x40000000,0x642400,0x8066f000,0x40000000,0x645000,0x8065bc00,0x40000000
.long 0x709900,0x708400,0x709a00,0x6f6500,0x70b000,0x6f6600,0x6f3900,0x71e400,0x6f3a00,0x6e0500,0x721000,0x6e0600,0x6dd900,0x734400,0x6dda00,0x6ca500,0x737000,0x6ca600,0x6c7900,0x74a400,0x6c7a00,0x6b4500,0x74d000,0x6b4600,0x6b0400,0x6b1a00,0x40000000,0x6b3000,0x74e600,0x40000000,0x6c6400,0x74ba00,0x40000000,0x6c9000,0x738600,0x40000000,0x6dc400,0x735a00,0x40000000,0x6df000,0x722600,0x40000000,0x6f2400,0x71fa00,0x40000000,0x6f5000,0x70c600,0x40000000
.long 0x7b9900,0x7b8400,0x7b9a00,0x7a6500,0x7bb000,0x7a6600,0x7a3900,0x7ce400,0x7a3a00,0x790500,0x7d1000,0x790600,0x78d900,0x7e4400,0x78da00,0x77a500,0x7e7000,0x77a600,0x777900,0x7fa400,0x777a00,0x764500,0x7fd000,0x764600,0x760400,0x761a00,0x40000000,0x763000,0x7fe600,0x40000000,0x776400,0x7fba00,0x40000000,0x779000,0x7e8600,0x40000000,0x78c400,0x7e5a00,0x40000000,0x78f000,0x7d2600,0x40000000,0x7a2400,0x7cfa00,0x40000000,0x7a5000,0x7bc600,0x40000000
.long 0x869900,0x868400,0x869a00,0x856500,0x86b000,0x856600,0x853900,0x87e400,0x853a00,0x840500,0x881000,0x840600,0x83d900,0x894400,0x83da00,0x82a500,0x897000,0x82a600,0x827900,0x8aa400,0x827a00,0x814500,0x8ad000,0x814600,0x810400,0x811a00,0x40000000,0x813000,0x8ae600,0x40000000,0x826400,0x8aba00,0x40000000,0x829000,0x898600,0x40000000,0x83c400,0x895a00,0x40000000,0x83f000,0x882600,0x40000000,0x852400,0x87fa00,0x40000000,0x855000,0x86c600,0x40000000
.long 0x8065a700,0x659a00,0x8065a600,0x80647300,0x65c600,0x80647200,0x80644700,0x66fa00,0x80644600,0x80631300,0x672600,0x80631200,0x8062e700,0x685a00,0x8062e600,0x8061b300,0x688600,0x8061b200,0x80618700,0x69ba00,0x80618600,0x80605300,0x69e600,0x80605200,0x601a00,0x602500,0x40000000,0x604600,0x8069f200,0x40000000,0x617a00,0x8069c600,0x40000000,0x61a600,0x80689200,0x40000000,0x62da00,0x80686600,0x40000000,0x630600,0x80673200,0x40000000,0x643a00,0x80670600,0x40000000,0x646600,0x8065d200,0x40000000
.long 0x80869100,0x8086a600,0x80869000,0x80855d00,0x8086d200,0x80855c00,0x80853100,0x80880600,0x80853000,0x8083fd00,0x80883200,0x8083fc00,0x8083d100,0x80896600,0x8083d000,0x80829d00,0x80899200,0x80829c00,0x80827100,0x808ac600,0x80827000,0x80813d00,0x808af200,0x80813c00,0x80811100,0x80812600,0x40000000,0x80815200,0x808adc00,0x40000000,0x80828600,0x808ab000,0x40000000,0x8082b200,0x80897c00,0x40000000,0x8083e600,0x80895000,0x40000000,0x80841200,0x80881c00,0x40000000,0x80854600,0x8087f000,0x40000000,0x80857200,0x8086bc00,0x40000000
.long 0x807b9100,0x807ba600,0x807b9000,0x807a5d00,0x807bd200,0x807a5c00,0x807a3100,0x807d0600,0x807a3000,0x8078fd00,0x807d3200,0x8078fc00,0x8078d100,0x807e6600,0x8078d000,0x80779d00,0x807e9200,0x80779c00,0x80777100,0x807fc600,0x80777000,0x80763d00,0x807ff200,0x80763c00,0x80761100,0x80762600,0x40000000,0x80765200,0x807fdc00,0x40000000,0x80778600,0x807fb000,0x40000000,0x8077b200,0x807e7c00,0x40000000,0x8078e600,0x807e5000,0x40000000,0x80791200,0x807d1c00,0x40000000,0x807a4600,0x807cf000,0x40000000,0x807a7200,0x807bbc00,0x40000000
.long 0x80709100,0x8070a600,0x80709000,0x806f5d00,0x8070d200,0x806f5c00,0x806f3100,0x80720600,0x806f3000,0x806dfd00,0x80723200,0x806dfc00,0x806dd100,0x80736600,0x806dd000,0x806c9d00,0x80739200,0x806c9c00,0x806c7100,0x8074c600,0x806c7000,0x806b3d00,0x8074f200,0x806b3c00,0x806b1100,0x806b2600,0x40000000,0x806b5200,0x8074dc00,0x40000000,0x806c8600,0x8074b000,0x40000000,0x806cb200,0x80737c00,0x40000000,0x806de600,0x80735000,0x40000000,0x806e1200,0x80721c00,0x40000000,0x806f4600,0x8071f000,0x40000000,0x806f7200,0x8070bc00,0x40000000
.long 0x600500,0x601000,0x600600,0x603100,0x8069db00,0x603200,0x616500,0x8069af00,0x616600,0x619100,0x80687b00,0x619200,0x62c500,0x80684f00,0x62c600,0x62f100,0x80671b00,0x62f200,0x642500,0x8066ef00,0x642600,0x645100,0x8065bb00,0x645200,0x658500,0x80658f00,0x40000000,0x65b100,0x80645b00,0x40000000,0x66e500,0x80642f00,0x40000000,0x671100,0x8062fb00,0x40000000,0x684500,0x8062cf00,0x40000000,0x687100,0x80619b00,0x40000000,0x69a500,0x80616f00,0x40000000,0x69d100,0x80603b00,0x40000000
.long 0x6b0500,0x6b1b00,0x6b0600,0x6b3100,0x74e700,0x6b3200,0x6c6500,0x74bb00,0x6c6600,0x6c9100,0x738700,0x6c9200,0x6dc500,0x735b00,0x6dc600,0x6df100,0x722700,0x6df200,0x6f2500,0x71fb00,0x6f2600,0x6f5100,0x70c700,0x6f5200,0x708500,0x709b00,0x40000000,0x70b100,0x6f6700,0x40000000,0x71e500,0x6f3b00,0x40000000,0x721100,0x6e0700,0x40000000,0x734500,0x6ddb00,0x40000000,0x737100,0x6ca700,0x40000000,0x74a500,0x6c7b00,0x40000000,0x74d100,0x6b4700,0x40000000
.long 0x760500,0x761b00,0x760600,0x763100,0x7fe700,0x763200,0x776500,0x7fbb00,0x776600,0x779100,0x7e8700,0x779200,0x78c500,0x7e5b00,0x78c600,0x78f100,0x7d2700,0x78f200,0x7a2500,0x7cfb00,0x7a2600,0x7a5100,0x7bc700,0x7a5200,0x7b8500,0x7b9b00,0x40000000,0x7bb100,0x7a6700,0x40000000,0x7ce500,0x7a3b00,0x40000000,0x7d1100,0x790700,0x40000000,0x7e4500,0x78db00,0x40000000,0x7e7100,0x77a700,0x40000000,0x7fa500,0x777b00,0x40000000,0x7fd100,0x764700,0x40000000
.long 0x810500,0x811b00,0x810600,0x813100,0x8ae700,0x813200,0x826500,0x8abb00,0x826600,0x829100,0x898700,0x829200,0x83c500,0x895b00,0x83c600,0x83f100,0x882700,0x83f200,0x852500,0x87fb00,0x852600,0x855100,0x86c700,0x855200,0x868500,0x869b00,0x40000000,0x86b100,0x856700,0x40000000,0x87e500,0x853b00,0x40000000,0x881100,0x840700,0x40000000,0x894500,0x83db00,0x40000000,0x897100,0x82a700,0x40000000,0x8aa500,0x827b00,0x40000000,0x8ad100,0x814700,0x40000000
.long 0x601b00,0x602600,0x601c00,0x604700,0x8069f100,0x604800,0x617b00,0x8069c500,0x617c00,0x61a700,0x80689100,0x61a800,0x62db00,0x80686500,0x62dc00,0x630700,0x80673100,0x630800,0x643b00,0x80670500,0x643c00,0x646700,0x8065d100,0x646800,0x659b00,0x8065a500,0x40000000,0x65c700,0x80647100,0x40000000,0x66fb00,0x80644500,0x40000000,0x672700,0x80631100,0x40000000,0x685b00,0x8062e500,0x40000000,0x688700,0x8061b100,0x40000000,0x69bb00,0x80618500,0x40000000,0x69e700,0x80605100,0x40000000
.long 0x80811000,0x80812500,0x80810f00,0x80815100,0x808adb00,0x80815000,0x80828500,0x808aaf00,0x80828400,0x8082b100,0x80897b00,0x8082b000,0x8083e500,0x80894f00,0x8083e400,0x80841100,0x80881b00,0x80841000,0x80854500,0x8087ef00,0x80854400,0x80857100,0x8086bb00,0x80857000,0x8086a500,0x80868f00,0x40000000,0x8086d100,0x80855b00,0x40000000,0x80880500,0x80852f00,0x40000000,0x80883100,0x8083fb00,0x40000000,0x80896500,0x8083cf00,0x40000000,0x80899100,0x80829b00,0x40000000,0x808ac500,0x80826f00,0x40000000,0x808af100,0x80813b00,0x40000000
.long 0x80761000,0x80762500,0x80760f00,0x80765100,0x807fdb00,0x80765000,0x80778500,0x807faf00,0x80778400,0x8077b100,0x807e7b00,0x8077b000,0x8078e500,0x807e4f00,0x8078e400,0x80791100,0x807d1b00,0x80791000,0x807a4500,0x807cef00,0x807a4400,0x807a7100,0x807bbb00,0x807a7000,0x807ba500,0x807b8f00,0x40000000,0x807bd100,0x807a5b00,0x40000000,0x807d0500,0x807a2f00,0x40000000,0x807d3100,0x8078fb00,0x40000000,0x807e6500,0x8078cf00,0x40000000,0x807e9100,0x80779b00,0x40000000,0x807fc500,0x80776f00,0x40000000,0x807ff100,0x80763b00,0x40000000
.long 0x806b1000,0x806b2500,0x806b0f00,0x806b5100,0x8074db00,0x806b5000,0x806c8500,0x8074af00,0x806c8400,0x806cb100,0x80737b00,0x806cb000,0x806de500,0x80734f00,0x806de400,0x806e1100,0x80721b00,0x806e1000,0x806f4500,0x8071ef00,0x806f4400,0x806f7100,0x8070bb00,0x806f7000,0x8070a500,0x80708f00,0x40000000,0x8070d100,0x806f5b00,0x40000000,0x80720500,0x806f2f00,0x40000000,0x80723100,0x806dfb00,0x40000000,0x80736500,0x806dcf00,0x40000000,0x80739100,0x806c9b00,0x40000000,0x8074c500,0x806c6f00,0x40000000,0x8074f100,0x806b3b00,0x40000000
.long 0x658600,0x80658e00,0x658700,0x65b200,0x80645a00,0x65b300,0x66e600,0x80642e00,0x66e700,0x671200,0x8062fa00,0x671300,0x684600,0x8062ce00,0x684700,0x687200,0x80619a00,0x687300,0x69a600,0x80616e00,0x69a700,0x69d200,0x80603a00,0x69d300,0x601100,0x600700,0x40000000,0x8069da00,0x603300,0x40000000,0x8069ae00,0x616700,0x40000000,0x80687a00,0x619300,0x40000000,0x80684e00,0x62c700,0x40000000,0x80671a00,0x62f300,0x40000000,0x8066ee00,0x642700,0x40000000,0x8065ba00,0x645300,0x40000000
.long 0x708600,0x709c00,0x708700,0x70b200,0x6f6800,0x70b300,0x71e600,0x6f3c00,0x71e700,0x721200,0x6e0800,0x721300,0x734600,0x6ddc00,0x734700,0x737200,0x6ca800,0x737300,0x74a600,0x6c7c00,0x74a700,0x74d200,0x6b4800,0x74d300,0x6b1c00,0x6b0700,0x40000000,0x74e800,0x6b3300,0x40000000,0x74bc00,0x6c6700,0x40000000,0x738800,0x6c9300,0x40000000,0x735c00,0x6dc700,0x40000000,0x722800,0x6df300,0x40000000,0x71fc00,0x6f2700,0x40000000,0x70c800,0x6f5300,0x40000000
.long 0x7b8600,0x7b9c00,0x7b8700,0x7bb200,0x7a6800,0x7bb300,0x7ce600,0x7a3c00,0x7ce700,0x7d1200,0x790800,0x7d1300,0x7e4600,0x78dc00,0x7e4700,0x7e7200,0x77a800,0x7e7300,0x7fa600,0x777c00,0x7fa700,0x7fd200,0x764800,0x7fd300,0x761c00,0x760700,0x40000000,0x7fe800,0x763300,0x40000000,0x7fbc00,0x776700,0x40000000,0x7e8800,0x779300,0x40000000,0x7e5c00,0x78c700,0x40000000,0x7d2800,0x78f300,0x40000000,0x7cfc00,0x7a2700,0x40000000,0x7bc800,0x7a5300,0x40000000
.long 0x868600,0x869c00,0x868700,0x86b200,0x856800,0x86b300,0x87e600,0x853c00,0x87e700,0x881200,0x840800,0x881300,0x894600,0x83dc00,0x894700,0x897200,0x82a800,0x897300,0x8aa600,0x827c00,0x8aa700,0x8ad200,0x814800,0x8ad300,0x811c00,0x810700,0x40000000,0x8ae800,0x813300,0x40000000,0x8abc00,0x826700,0x40000000,0x898800,0x829300,0x40000000,0x895c00,0x83c700,0x40000000,0x882800,0x83f300,0x40000000,0x87fc00,0x852700,0x40000000,0x86c800,0x855300,0x40000000
.long 0x659c00,0x8065a400,0x659d00,0x65c800,0x80647000,0x65c900,0x66fc00,0x80644400,0x66fd00,0x672800,0x80631000,0x672900,0x685c00,0x8062e400,0x685d00,0x688800,0x8061b000,0x688900,0x69bc00,0x80618400,0x69bd00,0x69e800,0x80605000,0x69e900,0x602700,0x601d00,0x40000000,0x8069f000,0x604900,0x40000000,0x8069c400,0x617d00,0x40000000,0x80689000,0x61a900,0x40000000,0x80686400,0x62dd00,0x40000000,0x80673000,0x630900,0x40000000,0x80670400,0x643d00,0x40000000,0x8065d000,0x646900,0x40000000
.long 0x8086a400,0x80868e00,0x8086a300,0x8086d000,0x80855a00,0x8086cf00,0x80880400,0x80852e00,0x80880300,0x80883000,0x8083fa00,0x80882f00,0x80896400,0x8083ce00,0x80896300,0x80899000,0x80829a00,0x80898f00,0x808ac400,0x80826e00,0x808ac300,0x808af000,0x80813a00,0x808aef00,0x80812400,0x80810e00,0x40000000,0x808ada00,0x80814f00,0x40000000,0x808aae00,0x80828300,0x40000000,0x80897a00,0x8082af00,0x40000000,0x80894e00,0x8083e300,0x40000000,0x80881a00,0x80840f00,0x40000000,0x8087ee00,0x80854300,0x40000000,0x8086ba00,0x80856f00,0x40000000
.long 0x807ba400,0x807b8e00,0x807ba300,0x807bd000,0x807a5a00,0x807bcf00,0x807d0400,0x807a2e00,0x807d0300,0x807d3000,0x8078fa00,0x807d2f00,0x807e6400,0x8078ce00,0x807e6300,0x807e9000,0x80779a00,0x807e8f00,0x807fc400,0x80776e00,0x807fc300,0x807ff000,0x80763a00,0x807fef00,0x80762400,0x80760e00,0x40000000,0x807fda00,0x80764f00,0x40000000,0x807fae00,0x80778300,0x40000000,0x807e7a00,0x8077af00,0x40000000,0x807e4e00,0x8078e300,0x40000000,0x807d1a00,0x80790f00,0x40000000,0x807cee00,0x807a4300,0x40000000,0x807bba00,0x807a6f00,0x40000000
.long 0x8070a400,0x80708e00,0x8070a300,0x8070d000,0x806f5a00,0x8070cf00,0x80720400,0x806f2e00,0x80720300,0x80723000,0x806dfa00,0x80722f00,0x80736400,0x806dce00,0x80736300,0x80739000,0x806c9a00,0x80738f00,0x8074c400,0x806c6e00,0x8074c300,0x8074f000,0x806b3a00,0x8074ef00,0x806b2400,0x806b0e00,0x40000000,0x8074da00,0x806b4f00,0x40000000,0x8074ae00,0x806c8300,0x40000000,0x80737a00,0x806caf00,0x40000000,0x80734e00,0x806de300,0x40000000,0x80721a00,0x806e0f00,0x40000000,0x8071ee00,0x806f4300,0x40000000,0x8070ba00,0x806f6f00,0x40000000
.long 0x601200,0x600800,0x601300,0x8069d900,0x603400,0x8069d800,0x8069ad00,0x616800,0x8069ac00,0x80687900,0x619400,0x80687800,0x80684d00,0x62c800,0x80684c00,0x80671900,0x62f400,0x80671800,0x8066ed00,0x642800,0x8066ec00,0x8065b900,0x645400,0x8065b800,0x80658d00,0x658800,0x40000000,0x80645900,0x65b400,0x40000000,0x80642d00,0x66e800,0x40000000,0x8062f900,0x671400,0x40000000,0x8062cd00,0x684800,0x40000000,0x80619900,0x687400,0x40000000,0x80616d00,0x69a800,0x40000000,0x80603900,0x69d400,0x40000000
.long 0x6b1d00,0x6b0800,0x6b1e00,0x74e900,0x6b3400,0x74ea00,0x74bd00,0x6c6800,0x74be00,0x738900,0x6c9400,0x738a00,0x735d00,0x6dc800,0x735e00,0x722900,0x6df400,0x722a00,0x71fd00,0x6f2800,0x71fe00,0x70c900,0x6f5400,0x70ca00,0x709d00,0x708800,0x40000000,0x6f6900,0x70b400,0x40000000,0x6f3d00,0x71e800,0x40000000,0x6e0900,0x721400,0x40000000,0x6ddd00,0x734800,0x40000000,0x6ca900,0x737400,0x40000000,0x6c7d00,0x74a800,0x40000000,0x6b4900,0x74d400,0x40000000
.long 0x761d00,0x760800,0x761e00,0x7fe900,0x763400,0x7fea00,0x7fbd00,0x776800,0x7fbe00,0x7e8900,0x779400,0x7e8a00,0x7e5d00,0x78c800,0x7e5e00,0x7d2900,0x78f400,0x7d2a00,0x7cfd00,0x7a2800,0x7cfe00,0x7bc900,0x7a5400,0x7bca00,0x7b9d00,0x7b8800,0x40000000,0x7a6900,0x7bb400,0x40000000,0x7a3d00,0x7ce800,0x40000000,0x790900,0x7d1400,0x40000000,0x78dd00,0x7e4800,0x40000000,0x77a900,0x7e7400,0x40000000,0x777d00,0x7fa800,0x40000000,0x764900,0x7fd400,0x40000000
.long 0x811d00,0x810800,0x811e00,0x8ae900,0x813400,0x8aea00,0x8abd00,0x826800,0x8abe00,0x898900,0x829400,0x898a00,0x895d00,0x83c800,0x895e00,0x882900,0x83f400,0x882a00,0x87fd00,0x852800,0x87fe00,0x86c900,0x855400,0x86ca00,0x869d00,0x868800,0x40000000,0x856900,0x86b400,0x40000000,0x853d00,0x87e800,0x40000000,0x840900,0x881400,0x40000000,0x83dd00,0x894800,0x40000000,0x82a900,0x897400,0x40000000,0x827d00,0x8aa800,0x40000000,0x814900,0x8ad400,0x40000000
.long 0x602800,0x601e00,0x602900,0x8069ef00,0x604a00,0x8069ee00,0x8069c300,0x617e00,0x8069c200,0x80688f00,0x61aa00,0x80688e00,0x80686300,0x62de00,0x80686200,0x80672f00,0x630a00,0x80672e00,0x80670300,0x643e00,0x80670200,0x8065cf00,0x646a00,0x8065ce00,0x8065a300,0x659e00,0x40000000,0x80646f00,0x65ca00,0x40000000,0x80644300,0x66fe00,0x40000000,0x80630f00,0x672a00,0x40000000,0x8062e300,0x685e00,0x40000000,0x8061af00,0x688a00,0x40000000,0x80618300,0x69be00,0x40000000,0x80604f00,0x69ea00,0x40000000
.long 0x80812300,0x80810d00,0x80812200,0x808ad900,0x80814e00,0x808ad800,0x808aad00,0x80828200,0x808aac00,0x80897900,0x8082ae00,0x80897800,0x80894d00,0x8083e200,0x80894c00,0x80881900,0x80840e00,0x80881800,0x8087ed00,0x80854200,0x8087ec00,0x8086b900,0x80856e00,0x8086b800,0x80868d00,0x8086a200,0x40000000,0x80855900,0x8086ce00,0x40000000,0x80852d00,0x80880200,0x40000000,0x8083f900,0x80882e00,0x40000000,0x8083cd00,0x80896200,0x40000000,0x80829900,0x80898e00,0x40000000,0x80826d00,0x808ac200,0x40000000,0x80813900,0x808aee00,0x40000000
.long 0x80762300,0x80760d00,0x80762200,0x807fd900,0x80764e00,0x807fd800,0x807fad00,0x80778200,0x807fac00,0x807e7900,0x8077ae00,0x807e7800,0x807e4d00,0x8078e200,0x807e4c00,0x807d1900,0x80790e00,0x807d1800,0x807ced00,0x807a4200,0x807cec00,0x807bb900,0x807a6e00,0x807bb800,0x807b8d00,0x807ba200,0x40000000,0x807a5900,0x807bce00,0x40000000,0x807a2d00,0x807d0200,0x40000000,0x8078f900,0x807d2e00,0x40000000,0x8078cd00,0x807e6200,0x40000000,0x80779900,0x807e8e00,0x40000000,0x80776d00,0x807fc200,0x40000000,0x80763900,0x807fee00,0x40000000
.long 0x806b2300,0x806b0d00,0x806b2200,0x8074d900,0x806b4e00,0x8074d800,0x8074ad00,0x806c8200,0x8074ac00,0x80737900,0x806cae00,0x80737800,0x80734d00,0x806de200,0x80734c00,0x80721900,0x806e0e00,0x80721800,0x8071ed00,0x806f4200,0x8071ec00,0x8070b900,0x806f6e00,0x8070b800,0x80708d00,0x8070a200,0x40000000,0x806f5900,0x8070ce00,0x40000000,0x806f2d00,0x80720200,0x40000000,0x806df900,0x80722e00,0x40000000,0x806dcd00,0x80736200,0x40000000,0x806c9900,0x80738e00,0x40000000,0x806c6d00,0x8074c200,0x40000000,0x806b3900,0x8074ee00,0x40000000
.long 0x80658c00,0x658900,0x80658b00,0x80645800,0x65b500,0x80645700,0x80642c00,0x66e900,0x80642b00,0x8062f800,0x671500,0x8062f700,0x8062cc00,0x684900,0x8062cb00,0x80619800,0x687500,0x80619700,0x80616c00,0x69a900,0x80616b00,0x80603800,0x69d500,0x80603700,0x600900,0x601400,0x40000000,0x603500,0x8069d700,0x40000000,0x616900,0x8069ab00,0x40000000,0x619500,0x80687700,0x40000000,0x62c900,0x80684b00,0x40000000,0x62f500,0x80671700,0x40000000,0x642900,0x8066eb00,0x40000000,0x645500,0x8065b700,0x40000000
.long 0x709e00,0x708900,0x709f00,0x6f6a00,0x70b500,0x6f6b00,0x6f3e00,0x71e900,0x6f3f00,0x6e0a00,0x721500,0x6e0b00,0x6dde00,0x734900,0x6ddf00,0x6caa00,0x737500,0x6cab00,0x6c7e00,0x74a900,0x6c7f00,0x6b4a00,0x74d500,0x6b4b00,0x6b0900,0x6b1f00,0x40000000,0x6b3500,0x74eb00,0x40000000,0x6c6900,0x74bf00,0x40000000,0x6c9500,0x738b00,0x40000000,0x6dc900,0x735f00,0x40000000,0x6df500,0x722b00,0x40000000,0x6f2900,0x71ff00,0x40000000,0x6f5500,0x70cb00,0x40000000
.long 0x7b9e00,0x7b8900,0x7b9f00,0x7a6a00,0x7bb500,0x7a6b00,0x7a3e00,0x7ce900,0x7a3f00,0x790a00,0x7d1500,0x790b00,0x78de00,0x7e4900,0x78df00,0x77aa00,0x7e7500,0x77ab00,0x777e00,0x7fa900,0x777f00,0x764a00,0x7fd500,0x764b00,0x760900,0x761f00,0x40000000,0x763500,0x7feb00,0x40000000,0x776900,0x7fbf00,0x40000000,0x779500,0x7e8b00,0x40000000,0x78c900,0x7e5f00,0x40000000,0x78f500,0x7d2b00,0x40000000,0x7a2900,0x7cff00,0x40000000,0x7a5500,0x7bcb00,0x40000000
.long 0x869e00,0x868900,0x869f00,0x856a00,0x86b500,0x856b00,0x853e00,0x87e900,0x853f00,0x840a00,0x881500,0x840b00,0x83de00,0x894900,0x83df00,0x82aa00,0x897500,0x82ab00,0x827e00,0x8aa900,0x827f00,0x814a00,0x8ad500,0x814b00,0x810900,0x811f00,0x40000000,0x813500,0x8aeb00,0x40000000,0x826900,0x8abf00,0x40000000,0x829500,0x898b00,0x40000000,0x83c900,0x895f00,0x40000000,0x83f500,0x882b00,0x40000000,0x852900,0x87ff00,0x40000000,0x855500,0x86cb00,0x40000000
.long 0x8065a200,0x659f00,0x8065a100,0x80646e00,0x65cb00,0x80646d00,0x80644200,0x66ff00,0x80644100,0x80630e00,0x672b00,0x80630d00,0x8062e200,0x685f00,0x8062e100,0x8061ae00,0x688b00,0x8061ad00,0x80618200,0x69bf00,0x80618100,0x80604e00,0x69eb00,0x80604d00,0x601f00,0x602a00,0x40000000,0x604b00,0x8069ed00,0x40000000,0x617f00,0x8069c100,0x40000000,0x61ab00,0x80688d00,0x40000000,0x62df00,0x80686100,0x40000000,0x630b00,0x80672d00,0x40000000,0x643f00,0x80670100,0x40000000,0x646b00,0x8065cd00,0x40000000
.long 0x80868c00,0x8086a100,0x80868b00,0x80855800,0x8086cd00,0x80855700,0x80852c00,0x80880100,0x80852b00,0x8083f800,0x80882d00,0x8083f700,0x8083cc00,0x80896100,0x8083cb00,0x80829800,0x80898d00,0x80829700,0x80826c00,0x808ac100,0x80826b00,0x80813800,0x808aed00,0x80813700,0x80810c00,0x80812100,0x40000000,0x80814d00,0x808ad700,0x40000000,0x80828100,0x808aab00,0x40000000,0x8082ad00,0x80897700,0x40000000,0x8083e100,0x80894b00,0x40000000,0x80840d00,0x80881700,0x40000000,0x80854100,0x8087eb00,0x40000000,0x80856d00,0x8086b700,0x40000000
.long 0x807b8c00,0x807ba100,0x807b8b00,0x807a5800,0x807bcd00,0x807a5700,0x807a2c00,0x807d0100,0x807a2b00,0x8078f800,0x807d2d00,0x8078f700,0x8078cc00,0x807e6100,0x8078cb00,0x80779800,0x807e8d00,0x80779700,0x80776c00,0x807fc100,0x80776b00,0x80763800,0x807fed00,0x80763700,0x80760c00,0x80762100,0x40000000,0x80764d00,0x807fd700,0x40000000,0x80778100,0x807fab00,0x40000000,0x8077ad00,0x807e7700,0x40000000,0x8078e100,0x807e4b00,0x40000000,0x80790d00,0x807d1700,0x40000000,0x807a4100,0x807ceb00,0x40000000,0x807a6d00,0x807bb700,0x40000000
.long 0x80708c00,0x8070a100,0x80708b00,0x806f5800,0x8070cd00,0x806f5700,0x806f2c00,0x80720100,0x806f2b00,0x806df800,0x80722d00,0x806df700,0x806dcc00,0x80736100,0x806dcb00,0x806c9800,0x80738d00,0x806c9700,0x806c6c00,0x8074c100,0x806c6b00,0x806b3800,0x8074ed00,0x806b3700,0x806b0c00,0x806b2100,0x40000000,0x806b4d00,0x8074d700,0x40000000,0x806c8100,0x8074ab00,0x40000000,0x806cad00,0x80737700,0x40000000,0x806de100,0x80734b00,0x40000000,0x806e0d00,0x80721700,0x40000000,0x806f4100,0x8071eb00,0x40000000,0x806f6d00,0x8070b700,0x40000000
.long 0x40000000,0x606e00,0x605900,0x608400,0x6a3a00,0x608500,0x61b800,0x6a0e00,0x61b900,0x61e400,0x68da00,0x61e500,0x631800,0x68ae00,0x631900,0x634400,0x677a00,0x634500,0x647800,0x674e00,0x647900,0x64a400,0x661a00,0x64a500,0x65d800,0x65ee00,0x40000000,0x660400,0x64ba00,0x40000000,0x673800,0x648e00,0x40000000,0x676400,0x635a00,0x40000000,0x689800,0x632e00,0x40000000,0x68c400,0x61fa00,0x40000000,0x69f800,0x61ce00,0x40000000,0x6a2400,0x609a00,0x40000000
.long 0x40000000,0x6b6e00,0x6b5900,0x6b8400,0x753a00,0x6b8500,0x6cb800,0x750e00,0x6cb900,0x6ce400,0x73da00,0x6ce500,0x6e1800,0x73ae00,0x6e1900,0x6e4400,0x727a00,0x6e4500,0x6f7800,0x724e00,0x6f7900,0x6fa400,0x711a00,0x6fa500,0x70d800,0x70ee00,0x40000000,0x710400,0x6fba00,0x40000000,0x723800,0x6f8e00,0x40000000,0x726400,0x6e5a00,0x40000000,0x739800,0x6e2e00,0x40000000,0x73c400,0x6cfa00,0x40000000,0x74f800,0x6cce00,0x40000000,0x752400,0x6b9a00,0x40000000
.long 0x40000000,0x766e00,0x765900,0x768400,0x803a00,0x768500,0x77b800,0x800e00,0x77b900,0x77e400,0x7eda00,0x77e500,0x791800,0x7eae00,0x791900,0x794400,0x7d7a00,0x794500,0x7a7800,0x7d4e00,0x7a7900,0x7aa400,0x7c1a00,0x7aa500,0x7bd800,0x7bee00,0x40000000,0x7c0400,0x7aba00,0x40000000,0x7d3800,0x7a8e00,0x40000000,0x7d6400,0x795a00,0x40000000,0x7e9800,0x792e00,0x40000000,0x7ec400,0x77fa00,0x40000000,0x7ff800,0x77ce00,0x40000000,0x802400,0x769a00,0x40000000
.long 0x40000000,0x816e00,0x815900,0x818400,0x8b3a00,0x818500,0x82b800,0x8b0e00,0x82b900,0x82e400,0x89da00,0x82e500,0x841800,0x89ae00,0x841900,0x844400,0x887a00,0x844500,0x857800,0x884e00,0x857900,0x85a400,0x871a00,0x85a500,0x86d800,0x86ee00,0x40000000,0x870400,0x85ba00,0x40000000,0x883800,0x858e00,0x40000000,0x886400,0x845a00,0x40000000,0x899800,0x842e00,0x40000000,0x89c400,0x82fa00,0x40000000,0x8af800,0x82ce00,0x40000000,0x8b2400,0x819a00,0x40000000
.long 0x40000000,0x80823200,0x80821c00,0x80825e00,0x808be800,0x80825d00,0x80839200,0x808bbc00,0x80839100,0x8083be00,0x808a8800,0x8083bd00,0x8084f200,0x808a5c00,0x8084f100,0x80851e00,0x80892800,0x80851d00,0x80865200,0x8088fc00,0x80865100,0x80867e00,0x8087c800,0x80867d00,0x8087b200,0x80879c00,0x40000000,0x8087de00,0x80866800,0x40000000,0x80891200,0x80863c00,0x40000000,0x80893e00,0x80850800,0x40000000,0x808a7200,0x8084dc00,0x40000000,0x808a9e00,0x8083a800,0x40000000,0x808bd200,0x80837c00,0x40000000,0x808bfe00,0x80824800,0x40000000
.long 0x40000000,0x80773200,0x80771c00,0x80775e00,0x8080e800,0x80775d00,0x80789200,0x8080bc00,0x80789100,0x8078be00,0x807f8800,0x8078bd00,0x8079f200,0x807f5c00,0x8079f100,0x807a1e00,0x807e2800,0x807a1d00,0x807b5200,0x807dfc00,0x807b5100,0x807b7e00,0x807cc800,0x807b7d00,0x807cb200,0x807c9c00,0x40000000,0x807cde00,0x807b6800,0x40000000,0x807e1200,0x807b3c00,0x40000000,0x807e3e00,0x807a0800,0x40000000,0x807f7200,0x8079dc00,0x40000000,0x807f9e00,0x8078a800,0x40000000,0x8080d200,0x80787c00,0x40000000,0x8080fe00,0x80774800,0x40000000
.long 0x40000000,0x806c3200,0x806c1c00,0x806c5e00,0x8075e800,0x806c5d00,0x806d9200,0x8075bc00,0x806d9100,0x806dbe00,0x80748800,0x806dbd00,0x806ef200,0x80745c00,0x806ef100,0x806f1e00,0x80732800,0x806f1d00,0x80705200,0x8072fc00,0x80705100,0x80707e00,0x8071c800,0x80707d00,0x8071b200,0x80719c00,0x40000000,0x8071de00,0x80706800,0x40000000,0x80731200,0x80703c00,0x40000000,0x80733e00,0x806f0800,0x40000000,0x80747200,0x806edc00,0x40000000,0x80749e00,0x806da800,0x40000000,0x8075d200,0x806d7c00,0x40000000,0x8075fe00,0x806c4800,0x40000000
.long 0x40000000,0x80613200,0x80611c00,0x80615e00,0x806ae800,0x80615d00,0x80629200,0x806abc00,0x80629100,0x8062be00,0x80698800,0x8062bd00,0x8063f200,0x80695c00,0x8063f100,0x80641e00,0x80682800,0x80641d00,0x80655200,0x8067fc00,0x80655100,0x80657e00,0x8066c800,0x80657d00,0x8066b200,0x80669c00,0x40000000,0x8066de00,0x80656800,0x40000000,0x80681200,0x80653c00,0x40000000,0x80683e00,0x80640800,0x40000000,0x80697200,0x8063dc00,0x40000000,0x80699e00,0x8062a800,0x40000000,0x806ad200,0x80627c00,0x40000000,0x806afe00,0x80614800,0x40000000
.long 0x65d900,0x65ef00,0x65da00,0x660500,0x64bb00,0x660600,0x673900,0x648f00,0x673a00,0x676500,0x635b00,0x676600,0x689900,0x632f00,0x689a00,0x68c500,0x61fb00,0x68c600,0x69f900,0x61cf00,0x69fa00,0x6a2500,0x609b00,0x6a2600,0x606f00,0x605a00,0x40000000,0x6a3b00,0x608600,0x40000000,0x6a0f00,0x61ba00,0x40000000,0x68db00,0x61e600,0x40000000,0x68af00,0x631a00,0x40000000,0x677b00,0x634600,0x40000000,0x674f00,0x647a00,0x40000000,0x661b00,0x64a600,0x40000000
.long 0x70d900,0x70ef00,0x70da00,0x710500,0x6fbb00,0x710600,0x723900,0x6f8f00,0x723a00,0x726500,0x6e5b00,0x726600,0x739900,0x6e2f00,0x739a00,0x73c500,0x6cfb00,0x73c600,0x74f900,0x6ccf00,0x74fa00,0x752500,0x6b9b00,0x752600,0x6b6f00,0x6b5a00,0x40000000,0x753b00,0x6b8600,0x40000000,0x750f00,0x6cba00,0x40000000,0x73db00,0x6ce600,0x40000000,0x73af00,0x6e1a00,0x40000000,0x727b00,0x6e4600,0x40000000,0x724f00,0x6f7a00,0x40000000,0x711b00,0x6fa600,0x40000000
.long 0x7bd900,0x7bef00,0x7bda00,0x7c0500,0x7abb00,0x7c0600,0x7d3900,0x7a8f00,0x7d3a00,0x7d6500,0x795b00,0x7d6600,0x7e9900,0x792f00,0x7e9a00,0x7ec500,0x77fb00,0x7ec600,0x7ff900,0x77cf00,0x7ffa00,0x802500,0x769b00,0x802600,0x766f00,0x765a00,0x40000000,0x803b00,0x768600,0x40000000,0x800f00,0x77ba00,0x40000000,0x7edb00,0x77e600,0x40000000,0x7eaf00,0x791a00,0x40000000,0x7d7b00,0x794600,0x40000000,0x7d4f00,0x7a7a00,0x40000000,0x7c1b00,0x7aa600,0x40000000
.long 0x86d900,0x86ef00,0x86da00,0x870500,0x85bb00,0x870600,0x883900,0x858f00,0x883a00,0x886500,0x845b00,0x886600,0x899900,0x842f00,0x899a00,0x89c500,0x82fb00,0x89c600,0x8af900,0x82cf00,0x8afa00,0x8b2500,0x819b00,0x8b2600,0x816f00,0x815a00,0x40000000,0x8b3b00,0x818600,0x40000000,0x8b0f00,0x82ba00,0x40000000,0x89db00,0x82e600,0x40000000,0x89af00,0x841a00,0x40000000,0x887b00,0x844600,0x40000000,0x884f00,0x857a00,0x40000000,0x871b00,0x85a600,0x40000000
.long 0x8087b100,0x80879b00,0x8087b000,0x8087dd00,0x80866700,0x8087dc00,0x80891100,0x80863b00,0x80891000,0x80893d00,0x80850700,0x80893c00,0x808a7100,0x8084db00,0x808a7000,0x808a9d00,0x8083a700,0x808a9c00,0x808bd100,0x80837b00,0x808bd000,0x808bfd00,0x80824700,0x808bfc00,0x80823100,0x80821b00,0x40000000,0x808be700,0x80825c00,0x40000000,0x808bbb00,0x80839000,0x40000000,0x808a8700,0x8083bc00,0x40000000,0x808a5b00,0x8084f000,0x40000000,0x80892700,0x80851c00,0x40000000,0x8088fb00,0x80865000,0x40000000,0x8087c700,0x80867c00,0x40000000
.long 0x807cb100,0x807c9b00,0x807cb000,0x807cdd00,0x807b6700,0x807cdc00,0x807e1100,0x807b3b00,0x807e1000,0x807e3d00,0x807a0700,0x807e3c00,0x807f7100,0x8079db00,0x807f7000,0x807f9d00,0x8078a700,0x807f9c00,0x8080d100,0x80787b00,0x8080d000,0x8080fd00,0x80774700,0x8080fc00,0x80773100,0x80771b00,0x40000000,0x8080e700,0x80775c00,0x40000000,0x8080bb00,0x80789000,0x40000000,0x807f8700,0x8078bc00,0x40000000,0x807f5b00,0x8079f000,0x40000000,0x807e2700,0x807a1c00,0x40000000,0x807dfb00,0x807b5000,0x40000000,0x807cc700,0x807b7c00,0x40000000
.long 0x8071b100,0x80719b00,0x8071b000,0x8071dd00,0x80706700,0x8071dc00,0x80731100,0x80703b00,0x80731000,0x80733d00,0x806f0700,0x80733c00,0x80747100,0x806edb00,0x80747000,0x80749d00,0x806da700,0x80749c00,0x8075d100,0x806d7b00,0x8075d000,0x8075fd00,0x806c4700,0x8075fc00,0x806c3100,0x806c1b00,0x40000000,0x8075e700,0x806c5c00,0x40000000,0x8075bb00,0x806d9000,0x40000000,0x80748700,0x806dbc00,0x40000000,0x80745b00,0x806ef000,0x40000000,0x80732700,0x806f1c00,0x40000000,0x8072fb00,0x80705000,0x40000000,0x8071c700,0x80707c00,0x40000000
.long 0x8066b100,0x80669b00,0x8066b000,0x8066dd00,0x80656700,0x8066dc00,0x80681100,0x80653b00,0x80681000,0x80683d00,0x80640700,0x80683c00,0x80697100,0x8063db00,0x80697000,0x80699d00,0x8062a700,0x80699c00,0x806ad100,0x80627b00,0x806ad000,0x806afd00,0x80614700,0x806afc00,0x80613100,0x80611b00,0x40000000,0x806ae700,0x80615c00,0x40000000,0x806abb00,0x80629000,0x40000000,0x80698700,0x8062bc00,0x40000000,0x80695b00,0x8063f000,0x40000000,0x80682700,0x80641c00,0x40000000,0x8067fb00,0x80655000,0x40000000,0x8066c700,0x80657c00,0x40000000
.long 0x607000,0x605b00,0x607100,0x6a3c00,0x608700,0x6a3d00,0x6a1000,0x61bb00,0x6a1100,0x68dc00,0x61e700,0x68dd00,0x68b000,0x631b00,0x68b100,0x677c00,0x634700,0x677d00,0x675000,0x647b00,0x675100,0x661c00,0x64a700,0x661d00,0x65f000,0x65db00,0x40000000,0x64bc00,0x660700,0x40000000,0x649000,0x673b00,0x40000000,0x635c00,0x676700,0x40000000,0x633000,0x689b00,0x40000000,0x61fc00,0x68c700,0x40000000,0x61d000,0x69fb00,0x40000000,0x609c00,0x6a2700,0x40000000
.long 0x6b7000,0x6b5b00,0x6b7100,0x753c00,0x6b8700,0x753d00,0x751000,0x6cbb00,0x751100,0x73dc00,0x6ce700,0x73dd00,0x73b000,0x6e1b00,0x73b100,0x727c00,0x6e4700,0x727d00,0x725000,0x6f7b00,0x725100,0x711c00,0x6fa700,0x711d00,0x70f000,0x70db00,0x40000000,0x6fbc00,0x710700,0x40000000,0x6f9000,0x723b00,0x40000000,0x6e5c00,0x726700,0x40000000,0x6e3000,0x739b00,0x40000000,0x6cfc00,0x73c700,0x40000000,0x6cd000,0x74fb00,0x40000000,0x6b9c00,0x752700,0x40000000
.long 0x767000,0x765b00,0x767100,0x803c00,0x768700,0x803d00,0x801000,0x77bb00,0x801100,0x7edc00,0x77e700,0x7edd00,0x7eb000,0x791b00,0x7eb100,0x7d7c00,0x794700,0x7d7d00,0x7d5000,0x7a7b00,0x7d5100,0x7c1c00,0x7aa700,0x7c1d00,0x7bf000,0x7bdb00,0x40000000,0x7abc00,0x7c0700,0x40000000,0x7a9000,0x7d3b00,0x40000000,0x795c00,0x7d6700,0x40000000,0x793000,0x7e9b00,0x40000000,0x77fc00,0x7ec700,0x40000000,0x77d000,0x7ffb00,0x40000000,0x769c00,0x802700,0x40000000
.long 0x817000,0x815b00,0x817100,0x8b3c00,0x818700,0x8b3d00,0x8b1000,0x82bb00,0x8b1100,0x89dc00,0x82e700,0x89dd00,0x89b000,0x841b00,0x89b100,0x887c00,0x844700,0x887d00,0x885000,0x857b00,0x885100,0x871c00,0x85a700,0x871d00,0x86f000,0x86db00,0x40000000,0x85bc00,0x870700,0x40000000,0x859000,0x883b00,0x40000000,0x845c00,0x886700,0x40000000,0x843000,0x899b00,0x40000000,0x82fc00,0x89c700,0x40000000,0x82d000,0x8afb00,0x40000000,0x819c00,0x8b2700,0x40000000
.long 0x80823000,0x80821a00,0x80822f00,0x808be600,0x80825b00,0x808be500,0x808bba00,0x80838f00,0x808bb900,0x808a8600,0x8083bb00,0x808a8500,0x808a5a00,0x8084ef00,0x808a5900,0x80892600,0x80851b00,0x80892500,0x8088fa00,0x80864f00,0x8088f900,0x8087c600,0x80867b00,0x8087c500,0x80879a00,0x8087af00,0x40000000,0x80866600,0x8087db00,0x40000000,0x80863a00,0x80890f00,0x40000000,0x80850600,0x80893b00,0x40000000,0x8084da00,0x808a6f00,0x40000000,0x8083a600,0x808a9b00,0x40000000,0x80837a00,0x808bcf00,0x40000000,0x80824600,0x808bfb00,0x40000000
.long 0x80773000,0x80771a00,0x80772f00,0x8080e600,0x80775b00,0x8080e500,0x8080ba00,0x80788f00,0x8080b900,0x807f8600,0x8078bb00,0x807f8500,0x807f5a00,0x8079ef00,0x807f5900,0x807e2600,0x807a1b00,0x807e2500,0x807dfa00,0x807b4f00,0x807df900,0x807cc600,0x807b7b00,0x807cc500,0x807c9a00,0x807caf00,0x40000000,0x807b6600,0x807cdb00,0x40000000,0x807b3a00,0x807e0f00,0x40000000,0x807a0600,0x807e3b00,0x40000000,0x8079da00,0x807f6f00,0x40000000,0x8078a600,0x807f9b00,0x40000000,0x80787a00,0x8080cf00,0x40000000,0x80774600,0x8080fb00,0x40000000
.long 0x806c3000,0x806c1a00,0x806c2f00,0x8075e600,0x806c5b00,0x8075e500,0x8075ba00,0x806d8f00,0x8075b900,0x80748600,0x806dbb00,0x80748500,0x80745a00,0x806eef00,0x80745900,0x80732600,0x806f1b00,0x80732500,0x8072fa00,0x80704f00,0x8072f900,0x8071c600,0x80707b00,0x8071c500,0x80719a00,0x8071af00,0x40000000,0x80706600,0x8071db00,0x40000000,0x80703a00,0x80730f00,0x40000000,0x806f0600,0x80733b00,0x40000000,0x806eda00,0x80746f00,0x40000000,0x806da600,0x80749b00,0x40000000,0x806d7a00,0x8075cf00,0x40000000,0x806c4600,0x8075fb00,0x40000000
.long 0x80613000,0x80611a00,0x80612f00,0x806ae600,0x80615b00,0x806ae500,0x806aba00,0x80628f00,0x806ab900,0x80698600,0x8062bb00,0x80698500,0x80695a00,0x8063ef00,0x80695900,0x80682600,0x80641b00,0x80682500,0x8067fa00,0x80654f00,0x8067f900,0x8066c600,0x80657b00,0x8066c500,0x80669a00,0x8066af00,0x40000000,0x80656600,0x8066db00,0x40000000,0x80653a00,0x80680f00,0x40000000,0x80640600,0x80683b00,0x40000000,0x8063da00,0x80696f00,0x40000000,0x8062a600,0x80699b00,0x40000000,0x80627a00,0x806acf00,0x40000000,0x80614600,0x806afb00,0x40000000
.long 0x65f100,0x65dc00,0x65f200,0x64bd00,0x660800,0x64be00,0x649100,0x673c00,0x649200,0x635d00,0x676800,0x635e00,0x633100,0x689c00,0x633200,0x61fd00,0x68c800,0x61fe00,0x61d100,0x69fc00,0x61d200,0x609d00,0x6a2800,0x609e00,0x605c00,0x607200,0x40000000,0x608800,0x6a3e00,0x40000000,0x61bc00,0x6a1200,0x40000000,0x61e800,0x68de00,0x40000000,0x631c00,0x68b200,0x40000000,0x634800,0x677e00,0x40000000,0x647c00,0x675200,0x40000000,0x64a800,0x661e00,0x40000000
.long 0x70f100,0x70dc00,0x70f200,0x6fbd00,0x710800,0x6fbe00,0x6f9100,0x723c00,0x6f9200,0x6e5d00,0x726800,0x6e5e00,0x6e3100,0x739c00,0x6e3200,0x6cfd00,0x73c800,0x6cfe00,0x6cd100,0x74fc00,0x6cd200,0x6b9d00,0x752800,0x6b9e00,0x6b5c00,0x6b7200,0x40000000,0x6b8800,0x753e00,0x40000000,0x6cbc00,0x751200,0x40000000,0x6ce800,0x73de00,0x40000000,0x6e1c00,0x73b200,0x40000000,0x6e4800,0x727e00,0x40000000,0x6f7c00,0x725200,0x40000000,0x6fa800,0x711e00,0x40000000
.long 0x7bf100,0x7bdc00,0x7bf200,0x7abd00,0x7c0800,0x7abe00,0x7a9100,0x7d3c00,0x7a9200,0x795d00,0x7d6800,0x795e00,0x793100,0x7e9c00,0x793200,0x77fd00,0x7ec800,0x77fe00,0x77d100,0x7ffc00,0x77d200,0x769d00,0x802800,0x769e00,0x765c00,0x767200,0x40000000,0x768800,0x803e00,0x40000000,0x77bc00,0x801200,0x40000000,0x77e800,0x7ede00,0x40000000,0x791c00,0x7eb200,0x40000000,0x794800,0x7d7e00,0x40000000,0x7a7c00,0x7d5200,0x40000000,0x7aa800,0x7c1e00,0x40000000
.long 0x86f100,0x86dc00,0x86f200,0x85bd00,0x870800,0x85be00,0x859100,0x883c00,0x859200,0x845d00,0x886800,0x845e00,0x843100,0x899c00,0x843200,0x82fd00,0x89c800,0x82fe00,0x82d100,0x8afc00,0x82d200,0x819d00,0x8b2800,0x819e00,0x815c00,0x817200,0x40000000,0x818800,0x8b3e00,0x40000000,0x82bc00,0x8b1200,0x40000000,0x82e800,0x89de00,0x40000000,0x841c00,0x89b200,0x40000000,0x844800,0x887e00,0x40000000,0x857c00,0x885200,0x40000000,0x85a800,0x871e00,0x40000000
.long 0x80879900,0x8087ae00,0x80879800,0x80866500,0x8087da00,0x80866400,0x80863900,0x80890e00,0x80863800,0x80850500,0x80893a00,0x80850400,0x8084d900,0x808a6e00,0x8084d800,0x8083a500,0x808a9a00,0x8083a400,0x80837900,0x808bce00,0x80837800,0x80824500,0x808bfa00,0x80824400,0x80821900,0x80822e00,0x40000000,0x80825a00,0x808be400,0x40000000,0x80838e00,0x808bb800,0x40000000,0x8083ba00,0x808a8400,0x40000000,0x8084ee00,0x808a5800,0x40000000,0x80851a00,0x80892400,0x40000000,0x80864e00,0x8088f800,0x40000000,0x80867a00,0x8087c400,0x40000000
.long 0x807c9900,0x807cae00,0x807c9800,0x807b6500,0x807cda00,0x807b6400,0x807b3900,0x807e0e00,0x807b3800,0x807a0500,0x807e3a00,0x807a0400,0x8079d900,0x807f6e00,0x8079d800,0x8078a500,0x807f9a00,0x8078a400,0x80787900,0x8080ce00,0x80787800,0x80774500,0x8080fa00,0x80774400,0x80771900,0x80772e00,0x40000000,0x80775a00,0x8080e400,0x40000000,0x80788e00,0x8080b800,0x40000000,0x8078ba00,0x807f8400,0x40000000,0x8079ee00,0x807f5800,0x40000000,0x807a1a00,0x807e2400,0x40000000,0x807b4e00,0x807df800,0x40000000,0x807b7a00,0x807cc400,0x40000000
.long 0x80719900,0x8071ae00,0x80719800,0x80706500,0x8071da00,0x80706400,0x80703900,0x80730e00,0x80703800,0x806f0500,0x80733a00,0x806f0400,0x806ed900,0x80746e00,0x806ed800,0x806da500,0x80749a00,0x806da400,0x806d7900,0x8075ce00,0x806d7800,0x806c4500,0x8075fa00,0x806c4400,0x806c1900,0x806c2e00,0x40000000,0x806c5a00,0x8075e400,0x40000000,0x806d8e00,0x8075b800,0x40000000,0x806dba00,0x80748400,0x40000000,0x806eee00,0x80745800,0x40000000,0x806f1a00,0x80732400,0x40000000,0x80704e00,0x8072f800,0x40000000,0x80707a00,0x8071c400,0x40000000
.long 0x80669900,0x8066ae00,0x80669800,0x80656500,0x8066da00,0x80656400,0x80653900,0x80680e00,0x80653800,0x80640500,0x80683a00,0x80640400,0x8063d900,0x80696e00,0x8063d800,0x8062a500,0x80699a00,0x8062a400,0x80627900,0x806ace00,0x80627800,0x80614500,0x806afa00,0x80614400,0x80611900,0x80612e00,0x40000000,0x80615a00,0x806ae400,0x40000000,0x80628e00,0x806ab800,0x40000000,0x8062ba00,0x80698400,0x40000000,0x8063ee00,0x80695800,0x40000000,0x80641a00,0x80682400,0x40000000,0x80654e00,0x8067f800,0x40000000,0x80657a00,0x8066c400,0x40000000
.long 0x605d00,0x607300,0x605e00,0x608900,0x6a3f00,0x608a00,0x61bd00,0x6a1300,0x61be00,0x61e900,0x68df00,0x61ea00,0x631d00,0x68b300,0x631e00,0x634900,0x677f00,0x634a00,0x647d00,0x675300,0x647e00,0x64a900,0x661f00,0x64aa00,0x65dd00,0x65f300,0x40000000,0x660900,0x64bf00,0x40000000,0x673d00,0x649300,0x40000000,0x676900,0x635f00,0x40000000,0x689d00,0x633300,0x40000000,0x68c900,0x61ff00,0x40000000,0x69fd00,0x61d300,0x40000000,0x6a2900,0x609f00,0x40000000
.long 0x6b5d00,0x6b7300,0x6b5e00,0x6b8900,0x753f00,0x6b8a00,0x6cbd00,0x751300,0x6cbe00,0x6ce900,0x73df00,0x6cea00,0x6e1d00,0x73b300,0x6e1e00,0x6e4900,0x727f00,0x6e4a00,0x6f7d00,0x725300,0x6f7e00,0x6fa900,0x711f00,0x6faa00,0x70dd00,0x70f300,0x40000000,0x710900,0x6fbf00,0x40000000,0x723d00,0x6f9300,0x40000000,0x726900,0x6e5f00,0x40000000,0x739d00,0x6e3300,0x40000000,0x73c900,0x6cff00,0x40000000,0x74fd00,0x6cd300,0x40000000,0x752900,0x6b9f00,0x40000000
.long 0x765d00,0x767300,0x765e00,0x768900,0x803f00,0x768a00,0x77bd00,0x801300,0x77be00,0x77e900,0x7edf00,0x77ea00,0x791d00,0x7eb300,0x791e00,0x794900,0x7d7f00,0x794a00,0x7a7d00,0x7d5300,0x7a7e00,0x7aa900,0x7c1f00,0x7aaa00,0x7bdd00,0x7bf300,0x40000000,0x7c0900,0x7abf00,0x40000000,0x7d3d00,0x7a9300,0x40000000,0x7d6900,0x795f00,0x40000000,0x7e9d00,0x793300,0x40000000,0x7ec900,0x77ff00,0x40000000,0x7ffd00,0x77d300,0x40000000,0x802900,0x769f00,0x40000000
.long 0x815d00,0x817300,0x815e00,0x818900,0x8b3f00,0x818a00,0x82bd00,0x8b1300,0x82be00,0x82e900,0x89df00,0x82ea00,0x841d00,0x89b300,0x841e00,0x844900,0x887f00,0x844a00,0x857d00,0x885300,0x857e00,0x85a900,0x871f00,0x85aa00,0x86dd00,0x86f300,0x40000000,0x870900,0x85bf00,0x40000000,0x883d00,0x859300,0x40000000,0x886900,0x845f00,0x40000000,0x899d00,0x843300,0x40000000,0x89c900,0x82ff00,0x40000000,0x8afd00,0x82d300,0x40000000,0x8b2900,0x819f00,0x40000000
.long 0x80821800,0x80822d00,0x80821700,0x80825900,0x808be300,0x80825800,0x80838d00,0x808bb700,0x80838c00,0x8083b900,0x808a8300,0x8083b800,0x8084ed00,0x808a5700,0x8084ec00,0x80851900,0x80892300,0x80851800,0x80864d00,0x8088f700,0x80864c00,0x80867900,0x8087c300,0x80867800,0x8087ad00,0x80879700,0x40000000,0x8087d900,0x80866300,0x40000000,0x80890d00,0x80863700,0x40000000,0x80893900,0x80850300,0x40000000,0x808a6d00,0x8084d700,0x40000000,0x808a9900,0x8083a300,0x40000000,0x808bcd00,0x80837700,0x40000000,0x808bf900,0x80824300,0x40000000
.long 0x80771800,0x80772d00,0x80771700,0x80775900,0x8080e300,0x80775800,0x80788d00,0x8080b700,0x80788c00,0x8078b900,0x807f8300,0x8078b800,0x8079ed00,0x807f5700,0x8079ec00,0x807a1900,0x807e2300,0x807a1800,0x807b4d00,0x807df700,0x807b4c00,0x807b7900,0x807cc300,0x807b7800,0x807cad00,0x807c9700,0x40000000,0x807cd900,0x807b6300,0x40000000,0x807e0d00,0x807b3700,0x40000000,0x807e3900,0x807a0300,0x40000000,0x807f6d00,0x8079d700,0x40000000,0x807f9900,0x8078a300,0x40000000,0x8080cd00,0x80787700,0x40000000,0x8080f900,0x80774300,0x40000000
.long 0x806c1800,0x806c2d00,0x806c1700,0x806c5900,0x8075e300,0x806c5800,0x806d8d00,0x8075b700,0x806d8c00,0x806db900,0x80748300,0x806db800,0x806eed00,0x80745700,0x806eec00,0x806f1900,0x80732300,0x806f1800,0x80704d00,0x8072f700,0x80704c00,0x80707900,0x8071c300,0x80707800,0x8071ad00,0x80719700,0x40000000,0x8071d900,0x80706300,0x40000000,0x80730d00,0x80703700,0x40000000,0x80733900,0x806f0300,0x40000000,0x80746d00,0x806ed700,0x40000000,0x80749900,0x806da300,0x40000000,0x8075cd00,0x806d7700,0x40000000,0x8075f900,0x806c4300,0x40000000
.long 0x80611800,0x80612d00,0x80611700,0x80615900,0x806ae300,0x80615800,0x80628d00,0x806ab700,0x80628c00,0x8062b900,0x80698300,0x8062b800,0x8063ed00,0x80695700,0x8063ec00,0x80641900,0x80682300,0x80641800,0x80654d00,0x8067f700,0x80654c00,0x80657900,0x8066c300,0x80657800,0x8066ad00,0x80669700,0x40000000,0x8066d900,0x80656300,0x40000000,0x80680d00,0x80653700,0x40000000,0x80683900,0x80640300,0x40000000,0x80696d00,0x8063d700,0x40000000,0x80699900,0x8062a300,0x40000000,0x806acd00,0x80627700,0x40000000,0x806af900,0x80614300,0x40000000
.long 0x65de00,0x65f400,0x65df00,0x660a00,0x64c000,0x660b00,0x673e00,0x649400,0x673f00,0x676a00,0x636000,0x676b00,0x689e00,0x633400,0x689f00,0x68ca00,0x620000,0x68cb00,0x69fe00,0x61d400,0x69ff00,0x6a2a00,0x60a000,0x6a2b00,0x607400,0x605f00,0x40000000,0x6a4000,0x608b00,0x40000000,0x6a1400,0x61bf00,0x40000000,0x68e000,0x61eb00,0x40000000,0x68b400,0x631f00,0x40000000,0x678000,0x634b00,0x40000000,0x675400,0x647f00,0x40000000,0x662000,0x64ab00,0x40000000
.long 0x70de00,0x70f400,0x70df00,0x710a00,0x6fc000,0x710b00,0x723e00,0x6f9400,0x723f00,0x726a00,0x6e6000,0x726b00,0x739e00,0x6e3400,0x739f00,0x73ca00,0x6d0000,0x73cb00,0x74fe00,0x6cd400,0x74ff00,0x752a00,0x6ba000,0x752b00,0x6b7400,0x6b5f00,0x40000000,0x754000,0x6b8b00,0x40000000,0x751400,0x6cbf00,0x40000000,0x73e000,0x6ceb00,0x40000000,0x73b400,0x6e1f00,0x40000000,0x728000,0x6e4b00,0x40000000,0x725400,0x6f7f00,0x40000000,0x712000,0x6fab00,0x40000000
.long 0x7bde00,0x7bf400,0x7bdf00,0x7c0a00,0x7ac000,0x7c0b00,0x7d3e00,0x7a9400,0x7d3f00,0x7d6a00,0x796000,0x7d6b00,0x7e9e00,0x793400,0x7e9f00,0x7eca00,0x780000,0x7ecb00,0x7ffe00,0x77d400,0x7fff00,0x802a00,0x76a000,0x802b00,0x767400,0x765f00,0x40000000,0x804000,0x768b00,0x40000000,0x801400,0x77bf00,0x40000000,0x7ee000,0x77eb00,0x40000000,0x7eb400,0x791f00,0x40000000,0x7d8000,0x794b00,0x40000000,0x7d5400,0x7a7f00,0x40000000,0x7c2000,0x7aab00,0x40000000
.long 0x86de00,0x86f400,0x86df00,0x870a00,0x85c000,0x870b00,0x883e00,0x859400,0x883f00,0x886a00,0x846000,0x886b00,0x899e00,0x843400,0x899f00,0x89ca00,0x830000,0x89cb00,0x8afe00,0x82d400,0x8aff00,0x8b2a00,0x81a000,0x8b2b00,0x817400,0x815f00,0x40000000,0x8b4000,0x818b00,0x40000000,0x8b1400,0x82bf00,0x40000000,0x89e000,0x82eb00,0x40000000,0x89b400,0x841f00,0x40000000,0x888000,0x844b00,0x40000000,0x885400,0x857f00,0x40000000,0x872000,0x85ab00,0x40000000
.long 0x8087ac00,0x80879600,0x8087ab00,0x8087d800,0x80866200,0x8087d700,0x80890c00,0x80863600,0x80890b00,0x80893800,0x80850200,0x80893700,0x808a6c00,0x8084d600,0x808a6b00,0x808a9800,0x8083a200,0x808a9700,0x808bcc00,0x80837600,0x808bcb00,0x808bf800,0x80824200,0x808bf700,0x80822c00,0x80821600,0x40000000,0x808be200,0x80825700,0x40000000,0x808bb600,0x80838b00,0x40000000,0x808a8200,0x8083b700,0x40000000,0x808a5600,0x8084eb00,0x40000000,0x80892200,0x80851700,0x40000000,0x8088f600,0x80864b00,0x40000000,0x8087c200,0x80867700,0x40000000
.long 0x807cac00,0x807c9600,0x807cab00,0x807cd800,0x807b6200,0x807cd700,0x807e0c00,0x807b3600,0x807e0b00,0x807e3800,0x807a0200,0x807e3700,0x807f6c00,0x8079d600,0x807f6b00,0x807f9800,0x8078a200,0x807f9700,0x8080cc00,0x80787600,0x8080cb00,0x8080f800,0x80774200,0x8080f700,0x80772c00,0x80771600,0x40000000,0x8080e200,0x80775700,0x40000000,0x8080b600,0x80788b00,0x40000000,0x807f8200,0x8078b700,0x40000000,0x807f5600,0x8079eb00,0x40000000,0x807e2200,0x807a1700,0x40000000,0x807df600,0x807b4b00,0x40000000,0x807cc200,0x807b7700,0x40000000
.long 0x8071ac00,0x80719600,0x8071ab00,0x8071d800,0x80706200,0x8071d700,0x80730c00,0x80703600,0x80730b00,0x80733800,0x806f0200,0x80733700,0x80746c00,0x806ed600,0x80746b00,0x80749800,0x806da200,0x80749700,0x8075cc00,0x806d7600,0x8075cb00,0x8075f800,0x806c4200,0x8075f700,0x806c2c00,0x806c1600,0x40000000,0x8075e200,0x806c5700,0x40000000,0x8075b600,0x806d8b00,0x40000000,0x80748200,0x806db700,0x40000000,0x80745600,0x806eeb00,0x40000000,0x80732200,0x806f1700,0x40000000,0x8072f600,0x80704b00,0x40000000,0x8071c200,0x80707700,0x40000000
.long 0x8066ac00,0x80669600,0x8066ab00,0x8066d800,0x80656200,0x8066d700,0x80680c00,0x80653600,0x80680b00,0x80683800,0x80640200,0x80683700,0x80696c00,0x8063d600,0x80696b00,0x80699800,0x8062a200,0x80699700,0x806acc00,0x80627600,0x806acb00,0x806af800,0x80614200,0x806af700,0x80612c00,0x80611600,0x40000000,0x806ae200,0x80615700,0x40000000,0x806ab600,0x80628b00,0x40000000,0x80698200,0x8062b700,0x40000000,0x80695600,0x8063eb00,0x40000000,0x80682200,0x80641700,0x40000000,0x8067f600,0x80654b00,0x40000000,0x8066c200,0x80657700,0x40000000
.long 0x607500,0x606000,0x607600,0x6a4100,0x608c00,0x6a4200,0x6a1500,0x61c000,0x6a1600,0x68e100,0x61ec00,0x68e200,0x68b500,0x632000,0x68b600,0x678100,0x634c00,0x678200,0x675500,0x648000,0x675600,0x662100,0x64ac00,0x662200,0x65f500,0x65e000,0x40000000,0x64c100,0x660c00,0x40000000,0x649500,0x674000,0x40000000,0x636100,0x676c00,0x40000000,0x633500,0x68a000,0x40000000,0x620100,0x68cc00,0x40000000,0x61d500,0x6a0000,0x40000000,0x60a100,0x6a2c00,0x40000000
.long 0x6b7500,0x6b6000,0x6b7600,0x754100,0x6b8c00,0x754200,0x751500,0x6cc000,0x751600,0x73e100,0x6cec00,0x73e200,0x73b500,0x6e2000,0x73b600,0x728100,0x6e4c00,0x728200,0x725500,0x6f8000,0x725600,0x712100,0x6fac00,0x712200,0x70f500,0x70e000,0x40000000,0x6fc100,0x710c00,0x40000000,0x6f9500,0x724000,0x40000000,0x6e6100,0x726c00,0x40000000,0x6e3500,0x73a000,0x40000000,0x6d0100,0x73cc00,0x40000000,0x6cd500,0x750000,0x40000000,0x6ba100,0x752c00,0x40000000
.long 0x767500,0x766000,0x767600,0x804100,0x768c00,0x804200,0x801500,0x77c000,0x801600,0x7ee100,0x77ec00,0x7ee200,0x7eb500,0x792000,0x7eb600,0x7d8100,0x794c00,0x7d8200,0x7d5500,0x7a8000,0x7d5600,0x7c2100,0x7aac00,0x7c2200,0x7bf500,0x7be000,0x40000000,0x7ac100,0x7c0c00,0x40000000,0x7a9500,0x7d4000,0x40000000,0x796100,0x7d6c00,0x40000000,0x793500,0x7ea000,0x40000000,0x780100,0x7ecc00,0x40000000,0x77d500,0x800000,0x40000000,0x76a100,0x802c00,0x40000000
.long 0x817500,0x816000,0x817600,0x8b4100,0x818c00,0x8b4200,0x8b1500,0x82c000,0x8b1600,0x89e100,0x82ec00,0x89e200,0x89b500,0x842000,0x89b600,0x888100,0x844c00,0x888200,0x885500,0x858000,0x885600,0x872100,0x85ac00,0x872200,0x86f500,0x86e000,0x40000000,0x85c100,0x870c00,0x40000000,0x859500,0x884000,0x40000000,0x846100,0x886c00,0x40000000,0x843500,0x89a000,0x40000000,0x830100,0x89cc00,0x40000000,0x82d500,0x8b0000,0x40000000,0x81a100,0x8b2c00,0x40000000
.long 0x80822b00,0x80821500,0x80822a00,0x808be100,0x80825600,0x808be000,0x808bb500,0x80838a00,0x808bb400,0x808a8100,0x8083b600,0x808a8000,0x808a5500,0x8084ea00,0x808a5400,0x80892100,0x80851600,0x80892000,0x8088f500,0x80864a00,0x8088f400,0x8087c100,0x80867600,0x8087c000,0x80879500,0x8087aa00,0x40000000,0x80866100,0x8087d600,0x40000000,0x80863500,0x80890a00,0x40000000,0x80850100,0x80893600,0x40000000,0x8084d500,0x808a6a00,0x40000000,0x8083a100,0x808a9600,0x40000000,0x80837500,0x808bca00,0x40000000,0x80824100,0x808bf600,0x40000000
.long 0x80772b00,0x80771500,0x80772a00,0x8080e100,0x80775600,0x8080e000,0x8080b500,0x80788a00,0x8080b400,0x807f8100,0x8078b600,0x807f8000,0x807f5500,0x8079ea00,0x807f5400,0x807e2100,0x807a1600,0x807e2000,0x807df500,0x807b4a00,0x807df400,0x807cc100,0x807b7600,0x807cc000,0x807c9500,0x807caa00,0x40000000,0x807b6100,0x807cd600,0x40000000,0x807b3500,0x807e0a00,0x40000000,0x807a0100,0x807e3600,0x40000000,0x8079d500,0x807f6a00,0x40000000,0x8078a100,0x807f9600,0x40000000,0x80787500,0x8080ca00,0x40000000,0x80774100,0x8080f600,0x40000000
.long 0x806c2b00,0x806c1500,0x806c2a00,0x8075e100,0x806c5600,0x8075e000,0x8075b500,0x806d8a00,0x8075b400,0x80748100,0x806db600,0x80748000,0x80745500,0x806eea00,0x80745400,0x80732100,0x806f1600,0x80732000,0x8072f500,0x80704a00,0x8072f400,0x8071c100,0x80707600,0x8071c000,0x80719500,0x8071aa00,0x40000000,0x80706100,0x8071d600,0x40000000,0x80703500,0x80730a00,0x40000000,0x806f0100,0x80733600,0x40000000,0x806ed500,0x80746a00,0x40000000,0x806da100,0x80749600,0x40000000,0x806d7500,0x8075ca00,0x40000000,0x806c4100,0x8075f600,0x40000000
.long 0x80612b00,0x80611500,0x80612a00,0x806ae100,0x80615600,0x806ae000,0x806ab500,0x80628a00,0x806ab400,0x80698100,0x8062b600,0x80698000,0x80695500,0x8063ea00,0x80695400,0x80682100,0x80641600,0x80682000,0x8067f500,0x80654a00,0x8067f400,0x8066c100,0x80657600,0x8066c000,0x80669500,0x8066aa00,0x40000000,0x80656100,0x8066d600,0x40000000,0x80653500,0x80680a00,0x40000000,0x80640100,0x80683600,0x40000000,0x8063d500,0x80696a00,0x40000000,0x8062a100,0x80699600,0x40000000,0x80627500,0x806aca00,0x40000000,0x80614100,0x806af600,0x40000000
.long 0x65f600,0x65e100,0x65f700,0x64c200,0x660d00,0x64c300,0x649600,0x674100,0x649700,0x636200,0x676d00,0x636300,0x633600,0x68a100,0x633700,0x620200,0x68cd00,0x620300,0x61d600,0x6a0100,0x61d700,0x60a200,0x6a2d00,0x60a300,0x606100,0x607700,0x40000000,0x608d00,0x6a4300,0x40000000,0x61c100,0x6a1700,0x40000000,0x61ed00,0x68e300,0x40000000,0x632100,0x68b700,0x40000000,0x634d00,0x678300,0x40000000,0x648100,0x675700,0x40000000,0x64ad00,0x662300,0x40000000
.long 0x70f600,0x70e100,0x70f700,0x6fc200,0x710d00,0x6fc300,0x6f9600,0x724100,0x6f9700,0x6e6200,0x726d00,0x6e6300,0x6e3600,0x73a100,0x6e3700,0x6d0200,0x73cd00,0x6d0300,0x6cd600,0x750100,0x6cd700,0x6ba200,0x752d00,0x6ba300,0x6b6100,0x6b7700,0x40000000,0x6b8d00,0x754300,0x40000000,0x6cc100,0x751700,0x40000000,0x6ced00,0x73e300,0x40000000,0x6e2100,0x73b700,0x40000000,0x6e4d00,0x728300,0x40000000,0x6f8100,0x725700,0x40000000,0x6fad00,0x712300,0x40000000
.long 0x7bf600,0x7be100,0x7bf700,0x7ac200,0x7c0d00,0x7ac300,0x7a9600,0x7d4100,0x7a9700,0x796200,0x7d6d00,0x796300,0x793600,0x7ea100,0x793700,0x780200,0x7ecd00,0x780300,0x77d600,0x800100,0x77d700,0x76a200,0x802d00,0x76a300,0x766100,0x767700,0x40000000,0x768d00,0x804300,0x40000000,0x77c100,0x801700,0x40000000,0x77ed00,0x7ee300,0x40000000,0x792100,0x7eb700,0x40000000,0x794d00,0x7d8300,0x40000000,0x7a8100,0x7d5700,0x40000000,0x7aad00,0x7c2300,0x40000000
.long 0x86f600,0x86e100,0x86f700,0x85c200,0x870d00,0x85c300,0x859600,0x884100,0x859700,0x846200,0x886d00,0x846300,0x843600,0x89a100,0x843700,0x830200,0x89cd00,0x830300,0x82d600,0x8b0100,0x82d700,0x81a200,0x8b2d00,0x81a300,0x816100,0x817700,0x40000000,0x818d00,0x8b4300,0x40000000,0x82c100,0x8b1700,0x40000000,0x82ed00,0x89e300,0x40000000,0x842100,0x89b700,0x40000000,0x844d00,0x888300,0x40000000,0x858100,0x885700,0x40000000,0x85ad00,0x872300,0x40000000
.long 0x80879400,0x8087a900,0x80879300,0x80866000,0x8087d500,0x80865f00,0x80863400,0x80890900,0x80863300,0x80850000,0x80893500,0x8084ff00,0x8084d400,0x808a6900,0x8084d300,0x8083a000,0x808a9500,0x80839f00,0x80837400,0x808bc900,0x80837300,0x80824000,0x808bf500,0x80823f00,0x80821400,0x80822900,0x40000000,0x80825500,0x808bdf00,0x40000000,0x80838900,0x808bb300,0x40000000,0x8083b500,0x808a7f00,0x40000000,0x8084e900,0x808a5300,0x40000000,0x80851500,0x80891f00,0x40000000,0x80864900,0x8088f300,0x40000000,0x80867500,0x8087bf00,0x40000000
.long 0x807c9400,0x807ca900,0x807c9300,0x807b6000,0x807cd500,0x807b5f00,0x807b3400,0x807e0900,0x807b3300,0x807a0000,0x807e3500,0x8079ff00,0x8079d400,0x807f6900,0x8079d300,0x8078a000,0x807f9500,0x80789f00,0x80787400,0x8080c900,0x80787300,0x80774000,0x8080f500,0x80773f00,0x80771400,0x80772900,0x40000000,0x80775500,0x8080df00,0x40000000,0x80788900,0x8080b300,0x40000000,0x8078b500,0x807f7f00,0x40000000,0x8079e900,0x807f5300,0x40000000,0x807a1500,0x807e1f00,0x40000000,0x807b4900,0x807df300,0x40000000,0x807b7500,0x807cbf00,0x40000000
.long 0x80719400,0x8071a900,0x80719300,0x80706000,0x8071d500,0x80705f00,0x80703400,0x80730900,0x80703300,0x806f0000,0x80733500,0x806eff00,0x806ed400,0x80746900,0x806ed300,0x806da000,0x80749500,0x806d9f00,0x806d7400,0x8075c900,0x806d7300,0x806c4000,0x8075f500,0x806c3f00,0x806c1400,0x806c2900,0x40000000,0x806c5500,0x8075df00,0x40000000,0x806d8900,0x8075b300,0x40000000,0x806db500,0x80747f00,0x40000000,0x806ee900,0x80745300,0x40000000,0x806f1500,0x80731f00,0x40000000,0x80704900,0x8072f300,0x40000000,0x80707500,0x8071bf00,0x40000000
.long 0x80669400,0x8066a900,0x80669300,0x80656000,0x8066d500,0x80655f00,0x80653400,0x80680900,0x80653300,0x80640000,0x80683500,0x8063ff00,0x8063d400,0x80696900,0x8063d300,0x8062a000,0x80699500,0x80629f00,0x80627400,0x806ac900,0x80627300,0x80614000,0x806af500,0x80613f00,0x80611400,0x80612900,0x40000000,0x80615500,0x806adf00,0x40000000,0x80628900,0x806ab300,0x40000000,0x8062b500,0x80697f00,0x40000000,0x8063e900,0x80695300,0x40000000,0x80641500,0x80681f00,0x40000000,0x80654900,0x8067f300,0x40000000,0x80657500,0x8066bf00,0x40000000
.long 0x40000000,0x60c600,0x60b100,0x60dc00,0x6a9200,0x60dd00,0x621000,0x6a6600,0x621100,0x623c00,0x693200,0x623d00,0x637000,0x690600,0x637100,0x639c00,0x67d200,0x639d00,0x64d000,0x67a600,0x64d100,0x64fc00,0x667200,0x64fd00,0x663000,0x664600,0x40000000,0x665c00,0x651200,0x40000000,0x679000,0x64e600,0x40000000,0x67bc00,0x63b200,0x40000000,0x68f000,0x638600,0x40000000,0x691c00,0x625200,0x40000000,0x6a5000,0x622600,0x40000000,0x6a7c00,0x60f200,0x40000000
.long 0x40000000,0x6bc600,0x6bb100,0x6bdc00,0x759200,0x6bdd00,0x6d1000,0x756600,0x6d1100,0x6d3c00,0x743200,0x6d3d00,0x6e7000,0x740600,0x6e7100,0x6e9c00,0x72d200,0x6e9d00,0x6fd000,0x72a600,0x6fd100,0x6ffc00,0x717200,0x6ffd00,0x713000,0x714600,0x40000000,0x715c00,0x701200,0x40000000,0x729000,0x6fe600,0x40000000,0x72bc00,0x6eb200,0x40000000,0x73f000,0x6e8600,0x40000000,0x741c00,0x6d5200,0x40000000,0x755000,0x6d2600,0x40000000,0x757c00,0x6bf200,0x40000000
.long 0x40000000,0x76c600,0x76b100,0x76dc00,0x809200,0x76dd00,0x781000,0x806600,0x781100,0x783c00,0x7f3200,0x783d00,0x797000,0x7f0600,0x797100,0x799c00,0x7dd200,0x799d00,0x7ad000,0x7da600,0x7ad100,0x7afc00,0x7c7200,0x7afd00,0x7c3000,0x7c4600,0x40000000,0x7c5c00,0x7b1200,0x40000000,0x7d9000,0x7ae600,0x40000000,0x7dbc00,0x79b200,0x40000000,0x7ef000,0x798600,0x40000000,0x7f1c00,0x785200,0x40000000,0x805000,0x782600,0x40000000,0x807c00,0x76f200,0x40000000
.long 0x40000000,0x81c600,0x81b100,0x81dc00,0x8b9200,0x81dd00,0x831000,0x8b6600,0x831100,0x833c00,0x8a3200,0x833d00,0x847000,0x8a0600,0x847100,0x849c00,0x88d200,0x849d00,0x85d000,0x88a600,0x85d100,0x85fc00,0x877200,0x85fd00,0x873000,0x874600,0x40000000,0x875c00,0x861200,0x40000000,0x889000,0x85e600,0x40000000,0x88bc00,0x84b200,0x40000000,0x89f000,0x848600,0x40000000,0x8a1c00,0x835200,0x40000000,0x8b5000,0x832600,0x40000000,0x8b7c00,0x81f200,0x40000000
.long 0x40000000,0x8081da00,0x8081c400,0x80820600,0x808b9000,0x80820500,0x80833a00,0x808b6400,0x80833900,0x80836600,0x808a3000,0x80836500,0x80849a00,0x808a0400,0x80849900,0x8084c600,0x8088d000,0x8084c500,0x8085fa00,0x8088a400,0x8085f900,0x80862600,0x80877000,0x80862500,0x80875a00,0x80874400,0x40000000,0x80878600,0x80861000,0x40000000,0x8088ba00,0x8085e400,0x40000000,0x8088e600,0x8084b000,0x40000000,0x808a1a00,0x80848400,0x40000000,0x808a4600,0x80835000,0x40000000,0x808b7a00,0x80832400,0x40000000,0x808ba600,0x8081f000,0x40000000
.long 0x40000000,0x8076da00,0x8076c400,0x80770600,0x80809000,0x80770500,0x80783a00,0x80806400,0x80783900,0x80786600,0x807f3000,0x80786500,0x80799a00,0x807f0400,0x80799900,0x8079c600,0x807dd000,0x8079c500,0x807afa00,0x807da400,0x807af900,0x807b2600,0x807c7000,0x807b2500,0x807c5a00,0x807c4400,0x40000000,0x807c8600,0x807b1000,0x40000000,0x807dba00,0x807ae400,0x40000000,0x807de600,0x8079b000,0x40000000,0x807f1a00,0x80798400,0x40000000,0x807f4600,0x80785000,0x40000000,0x80807a00,0x80782400,0x40000000,0x8080a600,0x8076f000,0x40000000
.long 0x40000000,0x806bda00,0x806bc400,0x806c0600,0x80759000,0x806c0500,0x806d3a00,0x80756400,0x806d3900,0x806d6600,0x80743000,0x806d6500,0x806e9a00,0x80740400,0x806e9900,0x806ec600,0x8072d000,0x806ec500,0x806ffa00,0x8072a400,0x806ff900,0x80702600,0x80717000,0x80702500,0x80715a00,0x80714400,0x40000000,0x80718600,0x80701000,0x40000000,0x8072ba00,0x806fe400,0x40000000,0x8072e600,0x806eb000,0x40000000,0x80741a00,0x806e8400,0x40000000,0x80744600,0x806d5000,0x40000000,0x80757a00,0x806d2400,0x40000000,0x8075a600,0x806bf000,0x40000000
.long 0x40000000,0x8060da00,0x8060c400,0x80610600,0x806a9000,0x80610500,0x80623a00,0x806a6400,0x80623900,0x80626600,0x80693000,0x80626500,0x80639a00,0x80690400,0x80639900,0x8063c600,0x8067d000,0x8063c500,0x8064fa00,0x8067a400,0x8064f900,0x80652600,0x80667000,0x80652500,0x80665a00,0x80664400,0x40000000,0x80668600,0x80651000,0x40000000,0x8067ba00,0x8064e400,0x40000000,0x8067e600,0x8063b000,0x40000000,0x80691a00,0x80638400,0x40000000,0x80694600,0x80625000,0x40000000,0x806a7a00,0x80622400,0x40000000,0x806aa600,0x8060f000,0x40000000
.long 0x663100,0x664700,0x663200,0x665d00,0x651300,0x665e00,0x679100,0x64e700,0x679200,0x67bd00,0x63b300,0x67be00,0x68f100,0x638700,0x68f200,0x691d00,0x625300,0x691e00,0x6a5100,0x622700,0x6a5200,0x6a7d00,0x60f300,0x6a7e00,0x60c700,0x60b200,0x40000000,0x6a9300,0x60de00,0x40000000,0x6a6700,0x621200,0x40000000,0x693300,0x623e00,0x40000000,0x690700,0x637200,0x40000000,0x67d300,0x639e00,0x40000000,0x67a700,0x64d200,0x40000000,0x667300,0x64fe00,0x40000000
.long 0x713100,0x714700,0x713200,0x715d00,0x701300,0x715e00,0x729100,0x6fe700,0x729200,0x72bd00,0x6eb300,0x72be00,0x73f100,0x6e8700,0x73f200,0x741d00,0x6d5300,0x741e00,0x755100,0x6d2700,0x755200,0x757d00,0x6bf300,0x757e00,0x6bc700,0x6bb200,0x40000000,0x759300,0x6bde00,0x40000000,0x756700,0x6d1200,0x40000000,0x743300,0x6d3e00,0x40000000,0x740700,0x6e7200,0x40000000,0x72d300,0x6e9e00,0x40000000,0x72a700,0x6fd200,0x40000000,0x717300,0x6ffe00,0x40000000
.long 0x7c3100,0x7c4700,0x7c3200,0x7c5d00,0x7b1300,0x7c5e00,0x7d9100,0x7ae700,0x7d9200,0x7dbd00,0x79b300,0x7dbe00,0x7ef100,0x798700,0x7ef200,0x7f1d00,0x785300,0x7f1e00,0x805100,0x782700,0x805200,0x807d00,0x76f300,0x807e00,0x76c700,0x76b200,0x40000000,0x809300,0x76de00,0x40000000,0x806700,0x781200,0x40000000,0x7f3300,0x783e00,0x40000000,0x7f0700,0x797200,0x40000000,0x7dd300,0x799e00,0x40000000,0x7da700,0x7ad200,0x40000000,0x7c7300,0x7afe00,0x40000000
.long 0x873100,0x874700,0x873200,0x875d00,0x861300,0x875e00,0x889100,0x85e700,0x889200,0x88bd00,0x84b300,0x88be00,0x89f100,0x848700,0x89f200,0x8a1d00,0x835300,0x8a1e00,0x8b5100,0x832700,0x8b5200,0x8b7d00,0x81f300,0x8b7e00,0x81c700,0x81b200,0x40000000,0x8b9300,0x81de00,0x40000000,0x8b6700,0x831200,0x40000000,0x8a3300,0x833e00,0x40000000,0x8a0700,0x847200,0x40000000,0x88d300,0x849e00,0x40000000,0x88a700,0x85d200,0x40000000,0x877300,0x85fe00,0x40000000
.long 0x80875900,0x80874300,0x80875800,0x80878500,0x80860f00,0x80878400,0x8088b900,0x8085e300,0x8088b800,0x8088e500,0x8084af00,0x8088e400,0x808a1900,0x80848300,0x808a1800,0x808a4500,0x80834f00,0x808a4400,0x808b7900,0x80832300,0x808b7800,0x808ba500,0x8081ef00,0x808ba400,0x8081d900,0x8081c300,0x40000000,0x808b8f00,0x80820400,0x40000000,0x808b6300,0x80833800,0x40000000,0x808a2f00,0x80836400,0x40000000,0x808a0300,0x80849800,0x40000000,0x8088cf00,0x8084c400,0x40000000,0x8088a300,0x8085f800,0x40000000,0x80876f00,0x80862400,0x40000000
.long 0x807c5900,0x807c4300,0x807c5800,0x807c8500,0x807b0f00,0x807c8400,0x807db900,0x807ae300,0x807db800,0x807de500,0x8079af00,0x807de400,0x807f1900,0x80798300,0x807f1800,0x807f4500,0x80784f00,0x807f4400,0x80807900,0x80782300,0x80807800,0x8080a500,0x8076ef00,0x8080a400,0x8076d900,0x8076c300,0x40000000,0x80808f00,0x80770400,0x40000000,0x80806300,0x80783800,0x40000000,0x807f2f00,0x80786400,0x40000000,0x807f0300,0x80799800,0x40000000,0x807dcf00,0x8079c400,0x40000000,0x807da300,0x807af800,0x40000000,0x807c6f00,0x807b2400,0x40000000
.long 0x80715900,0x80714300,0x80715800,0x80718500,0x80700f00,0x80718400,0x8072b900,0x806fe300,0x8072b800,0x8072e500,0x806eaf00,0x8072e400,0x80741900,0x806e8300,0x80741800,0x80744500,0x806d4f00,0x80744400,0x80757900,0x806d2300,0x80757800,0x8075a500,0x806bef00,0x8075a400,0x806bd900,0x806bc300,0x40000000,0x80758f00,0x806c0400,0x40000000,0x80756300,0x806d3800,0x40000000,0x80742f00,0x806d6400,0x40000000,0x80740300,0x806e9800,0x40000000,0x8072cf00,0x806ec400,0x40000000,0x8072a300,0x806ff800,0x40000000,0x80716f00,0x80702400,0x40000000
.long 0x80665900,0x80664300,0x80665800,0x80668500,0x80650f00,0x80668400,0x8067b900,0x8064e300,0x8067b800,0x8067e500,0x8063af00,0x8067e400,0x80691900,0x80638300,0x80691800,0x80694500,0x80624f00,0x80694400,0x806a7900,0x80622300,0x806a7800,0x806aa500,0x8060ef00,0x806aa400,0x8060d900,0x8060c300,0x40000000,0x806a8f00,0x80610400,0x40000000,0x806a6300,0x80623800,0x40000000,0x80692f00,0x80626400,0x40000000,0x80690300,0x80639800,0x40000000,0x8067cf00,0x8063c400,0x40000000,0x8067a300,0x8064f800,0x40000000,0x80666f00,0x80652400,0x40000000
.long 0x60c800,0x60b300,0x60c900,0x6a9400,0x60df00,0x6a9500,0x6a6800,0x621300,0x6a6900,0x693400,0x623f00,0x693500,0x690800,0x637300,0x690900,0x67d400,0x639f00,0x67d500,0x67a800,0x64d300,0x67a900,0x667400,0x64ff00,0x667500,0x664800,0x663300,0x40000000,0x651400,0x665f00,0x40000000,0x64e800,0x679300,0x40000000,0x63b400,0x67bf00,0x40000000,0x638800,0x68f300,0x40000000,0x625400,0x691f00,0x40000000,0x622800,0x6a5300,0x40000000,0x60f400,0x6a7f00,0x40000000
.long 0x6bc800,0x6bb300,0x6bc900,0x759400,0x6bdf00,0x759500,0x756800,0x6d1300,0x756900,0x743400,0x6d3f00,0x743500,0x740800,0x6e7300,0x740900,0x72d400,0x6e9f00,0x72d500,0x72a800,0x6fd300,0x72a900,0x717400,0x6fff00,0x717500,0x714800,0x713300,0x40000000,0x701400,0x715f00,0x40000000,0x6fe800,0x729300,0x40000000,0x6eb400,0x72bf00,0x40000000,0x6e8800,0x73f300,0x40000000,0x6d5400,0x741f00,0x40000000,0x6d2800,0x755300,0x40000000,0x6bf400,0x757f00,0x40000000
.long 0x76c800,0x76b300,0x76c900,0x809400,0x76df00,0x809500,0x806800,0x781300,0x806900,0x7f3400,0x783f00,0x7f3500,0x7f0800,0x797300,0x7f0900,0x7dd400,0x799f00,0x7dd500,0x7da800,0x7ad300,0x7da900,0x7c7400,0x7aff00,0x7c7500,0x7c4800,0x7c3300,0x40000000,0x7b1400,0x7c5f00,0x40000000,0x7ae800,0x7d9300,0x40000000,0x79b400,0x7dbf00,0x40000000,0x798800,0x7ef300,0x40000000,0x785400,0x7f1f00,0x40000000,0x782800,0x805300,0x40000000,0x76f400,0x807f00,0x40000000
.long 0x81c800,0x81b300,0x81c900,0x8b9400,0x81df00,0x8b9500,0x8b6800,0x831300,0x8b6900,0x8a3400,0x833f00,0x8a3500,0x8a0800,0x847300,0x8a0900,0x88d400,0x849f00,0x88d500,0x88a800,0x85d300,0x88a900,0x877400,0x85ff00,0x877500,0x874800,0x873300,0x40000000,0x861400,0x875f00,0x40000000,0x85e800,0x889300,0x40000000,0x84b400,0x88bf00,0x40000000,0x848800,0x89f300,0x40000000,0x835400,0x8a1f00,0x40000000,0x832800,0x8b5300,0x40000000,0x81f400,0x8b7f00,0x40000000
.long 0x8081d800,0x8081c200,0x8081d700,0x808b8e00,0x80820300,0x808b8d00,0x808b6200,0x80833700,0x808b6100,0x808a2e00,0x80836300,0x808a2d00,0x808a0200,0x80849700,0x808a0100,0x8088ce00,0x8084c300,0x8088cd00,0x8088a200,0x8085f700,0x8088a100,0x80876e00,0x80862300,0x80876d00,0x80874200,0x80875700,0x40000000,0x80860e00,0x80878300,0x40000000,0x8085e200,0x8088b700,0x40000000,0x8084ae00,0x8088e300,0x40000000,0x80848200,0x808a1700,0x40000000,0x80834e00,0x808a4300,0x40000000,0x80832200,0x808b7700,0x40000000,0x8081ee00,0x808ba300,0x40000000
.long 0x8076d800,0x8076c200,0x8076d700,0x80808e00,0x80770300,0x80808d00,0x80806200,0x80783700,0x80806100,0x807f2e00,0x80786300,0x807f2d00,0x807f0200,0x80799700,0x807f0100,0x807dce00,0x8079c300,0x807dcd00,0x807da200,0x807af700,0x807da100,0x807c6e00,0x807b2300,0x807c6d00,0x807c4200,0x807c5700,0x40000000,0x807b0e00,0x807c8300,0x40000000,0x807ae200,0x807db700,0x40000000,0x8079ae00,0x807de300,0x40000000,0x80798200,0x807f1700,0x40000000,0x80784e00,0x807f4300,0x40000000,0x80782200,0x80807700,0x40000000,0x8076ee00,0x8080a300,0x40000000
.long 0x806bd800,0x806bc200,0x806bd700,0x80758e00,0x806c0300,0x80758d00,0x80756200,0x806d3700,0x80756100,0x80742e00,0x806d6300,0x80742d00,0x80740200,0x806e9700,0x80740100,0x8072ce00,0x806ec300,0x8072cd00,0x8072a200,0x806ff700,0x8072a100,0x80716e00,0x80702300,0x80716d00,0x80714200,0x80715700,0x40000000,0x80700e00,0x80718300,0x40000000,0x806fe200,0x8072b700,0x40000000,0x806eae00,0x8072e300,0x40000000,0x806e8200,0x80741700,0x40000000,0x806d4e00,0x80744300,0x40000000,0x806d2200,0x80757700,0x40000000,0x806bee00,0x8075a300,0x40000000
.long 0x8060d800,0x8060c200,0x8060d700,0x806a8e00,0x80610300,0x806a8d00,0x806a6200,0x80623700,0x806a6100,0x80692e00,0x80626300,0x80692d00,0x80690200,0x80639700,0x80690100,0x8067ce00,0x8063c300,0x8067cd00,0x8067a200,0x8064f700,0x8067a100,0x80666e00,0x80652300,0x80666d00,0x80664200,0x80665700,0x40000000,0x80650e00,0x80668300,0x40000000,0x8064e200,0x8067b700,0x40000000,0x8063ae00,0x8067e300,0x40000000,0x80638200,0x80691700,0x40000000,0x80624e00,0x80694300,0x40000000,0x80622200,0x806a7700,0x40000000,0x8060ee00,0x806aa300,0x40000000
.long 0x664900,0x663400,0x664a00,0x651500,0x666000,0x651600,0x64e900,0x679400,0x64ea00,0x63b500,0x67c000,0x63b600,0x638900,0x68f400,0x638a00,0x625500,0x692000,0x625600,0x622900,0x6a5400,0x622a00,0x60f500,0x6a8000,0x60f600,0x60b400,0x60ca00,0x40000000,0x60e000,0x6a9600,0x40000000,0x621400,0x6a6a00,0x40000000,0x624000,0x693600,0x40000000,0x637400,0x690a00,0x40000000,0x63a000,0x67d600,0x40000000,0x64d400,0x67aa00,0x40000000,0x650000,0x667600,0x40000000
.long 0x714900,0x713400,0x714a00,0x701500,0x716000,0x701600,0x6fe900,0x729400,0x6fea00,0x6eb500,0x72c000,0x6eb600,0x6e8900,0x73f400,0x6e8a00,0x6d5500,0x742000,0x6d5600,0x6d2900,0x755400,0x6d2a00,0x6bf500,0x758000,0x6bf600,0x6bb400,0x6bca00,0x40000000,0x6be000,0x759600,0x40000000,0x6d1400,0x756a00,0x40000000,0x6d4000,0x743600,0x40000000,0x6e7400,0x740a00,0x40000000,0x6ea000,0x72d600,0x40000000,0x6fd400,0x72aa00,0x40000000,0x700000,0x717600,0x40000000
.long 0x7c4900,0x7c3400,0x7c4a00,0x7b1500,0x7c6000,0x7b1600,0x7ae900,0x7d9400,0x7aea00,0x79b500,0x7dc000,0x79b600,0x798900,0x7ef400,0x798a00,0x785500,0x7f2000,0x785600,0x782900,0x805400,0x782a00,0x76f500,0x808000,0x76f600,0x76b400,0x76ca00,0x40000000,0x76e000,0x809600,0x40000000,0x781400,0x806a00,0x40000000,0x784000,0x7f3600,0x40000000,0x797400,0x7f0a00,0x40000000,0x79a000,0x7dd600,0x40000000,0x7ad400,0x7daa00,0x40000000,0x7b0000,0x7c7600,0x40000000
.long 0x874900,0x873400,0x874a00,0x861500,0x876000,0x861600,0x85e900,0x889400,0x85ea00,0x84b500,0x88c000,0x84b600,0x848900,0x89f400,0x848a00,0x835500,0x8a2000,0x835600,0x832900,0x8b5400,0x832a00,0x81f500,0x8b8000,0x81f600,0x81b400,0x81ca00,0x40000000,0x81e000,0x8b9600,0x40000000,0x831400,0x8b6a00,0x40000000,0x834000,0x8a3600,0x40000000,0x847400,0x8a0a00,0x40000000,0x84a000,0x88d600,0x40000000,0x85d400,0x88aa00,0x40000000,0x860000,0x877600,0x40000000
.long 0x80874100,0x80875600,0x80874000,0x80860d00,0x80878200,0x80860c00,0x8085e100,0x8088b600,0x8085e000,0x8084ad00,0x8088e200,0x8084ac00,0x80848100,0x808a1600,0x80848000,0x80834d00,0x808a4200,0x80834c00,0x80832100,0x808b7600,0x80832000,0x8081ed00,0x808ba200,0x8081ec00,0x8081c100,0x8081d600,0x40000000,0x80820200,0x808b8c00,0x40000000,0x80833600,0x808b6000,0x40000000,0x80836200,0x808a2c00,0x40000000,0x80849600,0x808a0000,0x40000000,0x8084c200,0x8088cc00,0x40000000,0x8085f600,0x8088a000,0x40000000,0x80862200,0x80876c00,0x40000000
.long 0x807c4100,0x807c5600,0x807c4000,0x807b0d00,0x807c8200,0x807b0c00,0x807ae100,0x807db600,0x807ae000,0x8079ad00,0x807de200,0x8079ac00,0x80798100,0x807f1600,0x80798000,0x80784d00,0x807f4200,0x80784c00,0x80782100,0x80807600,0x80782000,0x8076ed00,0x8080a200,0x8076ec00,0x8076c100,0x8076d600,0x40000000,0x80770200,0x80808c00,0x40000000,0x80783600,0x80806000,0x40000000,0x80786200,0x807f2c00,0x40000000,0x80799600,0x807f0000,0x40000000,0x8079c200,0x807dcc00,0x40000000,0x807af600,0x807da000,0x40000000,0x807b2200,0x807c6c00,0x40000000
.long 0x80714100,0x80715600,0x80714000,0x80700d00,0x80718200,0x80700c00,0x806fe100,0x8072b600,0x806fe000,0x806ead00,0x8072e200,0x806eac00,0x806e8100,0x80741600,0x806e8000,0x806d4d00,0x80744200,0x806d4c00,0x806d2100,0x80757600,0x806d2000,0x806bed00,0x8075a200,0x806bec00,0x806bc100,0x806bd600,0x40000000,0x806c0200,0x80758c00,0x40000000,0x806d3600,0x80756000,0x40000000,0x806d6200,0x80742c00,0x40000000,0x806e9600,0x80740000,0x40000000,0x806ec200,0x8072cc00,0x40000000,0x806ff600,0x8072a000,0x40000000,0x80702200,0x80716c00,0x40000000
.long 0x80664100,0x80665600,0x80664000,0x80650d00,0x80668200,0x80650c00,0x8064e100,0x8067b600,0x8064e000,0x8063ad00,0x8067e200,0x8063ac00,0x80638100,0x80691600,0x80638000,0x80624d00,0x80694200,0x80624c00,0x80622100,0x806a7600,0x80622000,0x8060ed00,0x806aa200,0x8060ec00,0x8060c100,0x8060d600,0x40000000,0x80610200,0x806a8c00,0x40000000,0x80623600,0x806a6000,0x40000000,0x80626200,0x80692c00,0x40000000,0x80639600,0x80690000,0x40000000,0x8063c200,0x8067cc00,0x40000000,0x8064f600,0x8067a000,0x40000000,0x80652200,0x80666c00,0x40000000
.long 0x60b500,0x60cb00,0x60b600,0x60e100,0x6a9700,0x60e200,0x621500,0x6a6b00,0x621600,0x624100,0x693700,0x624200,0x637500,0x690b00,0x637600,0x63a100,0x67d700,0x63a200,0x64d500,0x67ab00,0x64d600,0x650100,0x667700,0x650200,0x663500,0x664b00,0x40000000,0x666100,0x651700,0x40000000,0x679500,0x64eb00,0x40000000,0x67c100,0x63b700,0x40000000,0x68f500,0x638b00,0x40000000,0x692100,0x625700,0x40000000,0x6a5500,0x622b00,0x40000000,0x6a8100,0x60f700,0x40000000
.long 0x6bb500,0x6bcb00,0x6bb600,0x6be100,0x759700,0x6be200,0x6d1500,0x756b00,0x6d1600,0x6d4100,0x743700,0x6d4200,0x6e7500,0x740b00,0x6e7600,0x6ea100,0x72d700,0x6ea200,0x6fd500,0x72ab00,0x6fd600,0x700100,0x717700,0x700200,0x713500,0x714b00,0x40000000,0x716100,0x701700,0x40000000,0x729500,0x6feb00,0x40000000,0x72c100,0x6eb700,0x40000000,0x73f500,0x6e8b00,0x40000000,0x742100,0x6d5700,0x40000000,0x755500,0x6d2b00,0x40000000,0x758100,0x6bf700,0x40000000
.long 0x76b500,0x76cb00,0x76b600,0x76e100,0x809700,0x76e200,0x781500,0x806b00,0x781600,0x784100,0x7f3700,0x784200,0x797500,0x7f0b00,0x797600,0x79a100,0x7dd700,0x79a200,0x7ad500,0x7dab00,0x7ad600,0x7b0100,0x7c7700,0x7b0200,0x7c3500,0x7c4b00,0x40000000,0x7c6100,0x7b1700,0x40000000,0x7d9500,0x7aeb00,0x40000000,0x7dc100,0x79b700,0x40000000,0x7ef500,0x798b00,0x40000000,0x7f2100,0x785700,0x40000000,0x805500,0x782b00,0x40000000,0x808100,0x76f700,0x40000000
.long 0x81b500,0x81cb00,0x81b600,0x81e100,0x8b9700,0x81e200,0x831500,0x8b6b00,0x831600,0x834100,0x8a3700,0x834200,0x847500,0x8a0b00,0x847600,0x84a100,0x88d700,0x84a200,0x85d500,0x88ab00,0x85d600,0x860100,0x877700,0x860200,0x873500,0x874b00,0x40000000,0x876100,0x861700,0x40000000,0x889500,0x85eb00,0x40000000,0x88c100,0x84b700,0x40000000,0x89f500,0x848b00,0x40000000,0x8a2100,0x835700,0x40000000,0x8b5500,0x832b00,0x40000000,0x8b8100,0x81f700,0x40000000
.long 0x8081c000,0x8081d500,0x8081bf00,0x80820100,0x808b8b00,0x80820000,0x80833500,0x808b5f00,0x80833400,0x80836100,0x808a2b00,0x80836000,0x80849500,0x8089ff00,0x80849400,0x8084c100,0x8088cb00,0x8084c000,0x8085f500,0x80889f00,0x8085f400,0x80862100,0x80876b00,0x80862000,0x80875500,0x80873f00,0x40000000,0x80878100,0x80860b00,0x40000000,0x8088b500,0x8085df00,0x40000000,0x8088e100,0x8084ab00,0x40000000,0x808a1500,0x80847f00,0x40000000,0x808a4100,0x80834b00,0x40000000,0x808b7500,0x80831f00,0x40000000,0x808ba100,0x8081eb00,0x40000000
.long 0x8076c000,0x8076d500,0x8076bf00,0x80770100,0x80808b00,0x80770000,0x80783500,0x80805f00,0x80783400,0x80786100,0x807f2b00,0x80786000,0x80799500,0x807eff00,0x80799400,0x8079c100,0x807dcb00,0x8079c000,0x807af500,0x807d9f00,0x807af400,0x807b2100,0x807c6b00,0x807b2000,0x807c5500,0x807c3f00,0x40000000,0x807c8100,0x807b0b00,0x40000000,0x807db500,0x807adf00,0x40000000,0x807de100,0x8079ab00,0x40000000,0x807f1500,0x80797f00,0x40000000,0x807f4100,0x80784b00,0x40000000,0x80807500,0x80781f00,0x40000000,0x8080a100,0x8076eb00,0x40000000
.long 0x806bc000,0x806bd500,0x806bbf00,0x806c0100,0x80758b00,0x806c0000,0x806d3500,0x80755f00,0x806d3400,0x806d6100,0x80742b00,0x806d6000,0x806e9500,0x8073ff00,0x806e9400,0x806ec100,0x8072cb00,0x806ec000,0x806ff500,0x80729f00,0x806ff400,0x80702100,0x80716b00,0x80702000,0x80715500,0x80713f00,0x40000000,0x80718100,0x80700b00,0x40000000,0x8072b500,0x806fdf00,0x40000000,0x8072e100,0x806eab00,0x40000000,0x80741500,0x806e7f00,0x40000000,0x80744100,0x806d4b00,0x40000000,0x80757500,0x806d1f00,0x40000000,0x8075a100,0x806beb00,0x40000000
.long 0x8060c000,0x8060d500,0x8060bf00,0x80610100,0x806a8b00,0x80610000,0x80623500,0x806a5f00,0x80623400,0x80626100,0x80692b00,0x80626000,0x80639500,0x8068ff00,0x80639400,0x8063c100,0x8067cb00,0x8063c000,0x8064f500,0x80679f00,0x8064f400,0x80652100,0x80666b00,0x80652000,0x80665500,0x80663f00,0x40000000,0x80668100,0x80650b00,0x40000000,0x8067b500,0x8064df00,0x40000000,0x8067e100,0x8063ab00,0x40000000,0x80691500,0x80637f00,0x40000000,0x80694100,0x80624b00,0x40000000,0x806a7500,0x80621f00,0x40000000,0x806aa100,0x8060eb00,0x40000000
.long 0x663600,0x664c00,0x663700,0x666200,0x651800,0x666300,0x679600,0x64ec00,0x679700,0x67c200,0x63b800,0x67c300,0x68f600,0x638c00,0x68f700,0x692200,0x625800,0x692300,0x6a5600,0x622c00,0x6a5700,0x6a8200,0x60f800,0x6a8300,0x60cc00,0x60b700,0x40000000,0x6a9800,0x60e300,0x40000000,0x6a6c00,0x621700,0x40000000,0x693800,0x624300,0x40000000,0x690c00,0x637700,0x40000000,0x67d800,0x63a300,0x40000000,0x67ac00,0x64d700,0x40000000,0x667800,0x650300,0x40000000
.long 0x713600,0x714c00,0x713700,0x716200,0x701800,0x716300,0x729600,0x6fec00,0x729700,0x72c200,0x6eb800,0x72c300,0x73f600,0x6e8c00,0x73f700,0x742200,0x6d5800,0x742300,0x755600,0x6d2c00,0x755700,0x758200,0x6bf800,0x758300,0x6bcc00,0x6bb700,0x40000000,0x759800,0x6be300,0x40000000,0x756c00,0x6d1700,0x40000000,0x743800,0x6d4300,0x40000000,0x740c00,0x6e7700,0x40000000,0x72d800,0x6ea300,0x40000000,0x72ac00,0x6fd700,0x40000000,0x717800,0x700300,0x40000000
.long 0x7c3600,0x7c4c00,0x7c3700,0x7c6200,0x7b1800,0x7c6300,0x7d9600,0x7aec00,0x7d9700,0x7dc200,0x79b800,0x7dc300,0x7ef600,0x798c00,0x7ef700,0x7f2200,0x785800,0x7f2300,0x805600,0x782c00,0x805700,0x808200,0x76f800,0x808300,0x76cc00,0x76b700,0x40000000,0x809800,0x76e300,0x40000000,0x806c00,0x781700,0x40000000,0x7f3800,0x784300,0x40000000,0x7f0c00,0x797700,0x40000000,0x7dd800,0x79a300,0x40000000,0x7dac00,0x7ad700,0x40000000,0x7c7800,0x7b0300,0x40000000
.long 0x873600,0x874c00,0x873700,0x876200,0x861800,0x876300,0x889600,0x85ec00,0x889700,0x88c200,0x84b800,0x88c300,0x89f600,0x848c00,0x89f700,0x8a2200,0x835800,0x8a2300,0x8b5600,0x832c00,0x8b5700,0x8b8200,0x81f800,0x8b8300,0x81cc00,0x81b700,0x40000000,0x8b9800,0x81e300,0x40000000,0x8b6c00,0x831700,0x40000000,0x8a3800,0x834300,0x40000000,0x8a0c00,0x847700,0x40000000,0x88d800,0x84a300,0x40000000,0x88ac00,0x85d700,0x40000000,0x877800,0x860300,0x40000000
.long 0x80875400,0x80873e00,0x80875300,0x80878000,0x80860a00,0x80877f00,0x8088b400,0x8085de00,0x8088b300,0x8088e000,0x8084aa00,0x8088df00,0x808a1400,0x80847e00,0x808a1300,0x808a4000,0x80834a00,0x808a3f00,0x808b7400,0x80831e00,0x808b7300,0x808ba000,0x8081ea00,0x808b9f00,0x8081d400,0x8081be00,0x40000000,0x808b8a00,0x8081ff00,0x40000000,0x808b5e00,0x80833300,0x40000000,0x808a2a00,0x80835f00,0x40000000,0x8089fe00,0x80849300,0x40000000,0x8088ca00,0x8084bf00,0x40000000,0x80889e00,0x8085f300,0x40000000,0x80876a00,0x80861f00,0x40000000
.long 0x807c5400,0x807c3e00,0x807c5300,0x807c8000,0x807b0a00,0x807c7f00,0x807db400,0x807ade00,0x807db300,0x807de000,0x8079aa00,0x807ddf00,0x807f1400,0x80797e00,0x807f1300,0x807f4000,0x80784a00,0x807f3f00,0x80807400,0x80781e00,0x80807300,0x8080a000,0x8076ea00,0x80809f00,0x8076d400,0x8076be00,0x40000000,0x80808a00,0x8076ff00,0x40000000,0x80805e00,0x80783300,0x40000000,0x807f2a00,0x80785f00,0x40000000,0x807efe00,0x80799300,0x40000000,0x807dca00,0x8079bf00,0x40000000,0x807d9e00,0x807af300,0x40000000,0x807c6a00,0x807b1f00,0x40000000
.long 0x80715400,0x80713e00,0x80715300,0x80718000,0x80700a00,0x80717f00,0x8072b400,0x806fde00,0x8072b300,0x8072e000,0x806eaa00,0x8072df00,0x80741400,0x806e7e00,0x80741300,0x80744000,0x806d4a00,0x80743f00,0x80757400,0x806d1e00,0x80757300,0x8075a000,0x806bea00,0x80759f00,0x806bd400,0x806bbe00,0x40000000,0x80758a00,0x806bff00,0x40000000,0x80755e00,0x806d3300,0x40000000,0x80742a00,0x806d5f00,0x40000000,0x8073fe00,0x806e9300,0x40000000,0x8072ca00,0x806ebf00,0x40000000,0x80729e00,0x806ff300,0x40000000,0x80716a00,0x80701f00,0x40000000
.long 0x80665400,0x80663e00,0x80665300,0x80668000,0x80650a00,0x80667f00,0x8067b400,0x8064de00,0x8067b300,0x8067e000,0x8063aa00,0x8067df00,0x80691400,0x80637e00,0x80691300,0x80694000,0x80624a00,0x80693f00,0x806a7400,0x80621e00,0x806a7300,0x806aa000,0x8060ea00,0x806a9f00,0x8060d400,0x8060be00,0x40000000,0x806a8a00,0x8060ff00,0x40000000,0x806a5e00,0x80623300,0x40000000,0x80692a00,0x80625f00,0x40000000,0x8068fe00,0x80639300,0x40000000,0x8067ca00,0x8063bf00,0x40000000,0x80679e00,0x8064f300,0x40000000,0x80666a00,0x80651f00,0x40000000
.long 0x60cd00,0x60b800,0x60ce00,0x6a9900,0x60e400,0x6a9a00,0x6a6d00,0x621800,0x6a6e00,0x693900,0x624400,0x693a00,0x690d00,0x637800,0x690e00,0x67d900,0x63a400,0x67da00,0x67ad00,0x64d800,0x67ae00,0x667900,0x650400,0x667a00,0x664d00,0x663800,0x40000000,0x651900,0x666400,0x40000000,0x64ed00,0x679800,0x40000000,0x63b900,0x67c400,0x40000000,0x638d00,0x68f800,0x40000000,0x625900,0x692400,0x40000000,0x622d00,0x6a5800,0x40000000,0x60f900,0x6a8400,0x40000000
.long 0x6bcd00,0x6bb800,0x6bce00,0x759900,0x6be400,0x759a00,0x756d00,0x6d1800,0x756e00,0x743900,0x6d4400,0x743a00,0x740d00,0x6e7800,0x740e00,0x72d900,0x6ea400,0x72da00,0x72ad00,0x6fd800,0x72ae00,0x717900,0x700400,0x717a00,0x714d00,0x713800,0x40000000,0x701900,0x716400,0x40000000,0x6fed00,0x729800,0x40000000,0x6eb900,0x72c400,0x40000000,0x6e8d00,0x73f800,0x40000000,0x6d5900,0x742400,0x40000000,0x6d2d00,0x755800,0x40000000,0x6bf900,0x758400,0x40000000
.long 0x76cd00,0x76b800,0x76ce00,0x809900,0x76e400,0x809a00,0x806d00,0x781800,0x806e00,0x7f3900,0x784400,0x7f3a00,0x7f0d00,0x797800,0x7f0e00,0x7dd900,0x79a400,0x7dda00,0x7dad00,0x7ad800,0x7dae00,0x7c7900,0x7b0400,0x7c7a00,0x7c4d00,0x7c3800,0x40000000,0x7b1900,0x7c6400,0x40000000,0x7aed00,0x7d9800,0x40000000,0x79b900,0x7dc400,0x40000000,0x798d00,0x7ef800,0x40000000,0x785900,0x7f2400,0x40000000,0x782d00,0x805800,0x40000000,0x76f900,0x808400,0x40000000
.long 0x81cd00,0x81b800,0x81ce00,0x8b9900,0x81e400,0x8b9a00,0x8b6d00,0x831800,0x8b6e00,0x8a3900,0x834400,0x8a3a00,0x8a0d00,0x847800,0x8a0e00,0x88d900,0x84a400,0x88da00,0x88ad00,0x85d800,0x88ae00,0x877900,0x860400,0x877a00,0x874d00,0x873800,0x40000000,0x861900,0x876400,0x40000000,0x85ed00,0x889800,0x40000000,0x84b900,0x88c400,0x40000000,0x848d00,0x89f800,0x40000000,0x835900,0x8a2400,0x40000000,0x832d00,0x8b5800,0x40000000,0x81f900,0x8b8400,0x40000000
.long 0x8081d300,0x8081bd00,0x8081d200,0x808b8900,0x8081fe00,0x808b8800,0x808b5d00,0x80833200,0x808b5c00,0x808a2900,0x80835e00,0x808a2800,0x8089fd00,0x80849200,0x8089fc00,0x8088c900,0x8084be00,0x8088c800,0x80889d00,0x8085f200,0x80889c00,0x80876900,0x80861e00,0x80876800,0x80873d00,0x80875200,0x40000000,0x80860900,0x80877e00,0x40000000,0x8085dd00,0x8088b200,0x40000000,0x8084a900,0x8088de00,0x40000000,0x80847d00,0x808a1200,0x40000000,0x80834900,0x808a3e00,0x40000000,0x80831d00,0x808b7200,0x40000000,0x8081e900,0x808b9e00,0x40000000
.long 0x8076d300,0x8076bd00,0x8076d200,0x80808900,0x8076fe00,0x80808800,0x80805d00,0x80783200,0x80805c00,0x807f2900,0x80785e00,0x807f2800,0x807efd00,0x80799200,0x807efc00,0x807dc900,0x8079be00,0x807dc800,0x807d9d00,0x807af200,0x807d9c00,0x807c6900,0x807b1e00,0x807c6800,0x807c3d00,0x807c5200,0x40000000,0x807b0900,0x807c7e00,0x40000000,0x807add00,0x807db200,0x40000000,0x8079a900,0x807dde00,0x40000000,0x80797d00,0x807f1200,0x40000000,0x80784900,0x807f3e00,0x40000000,0x80781d00,0x80807200,0x40000000,0x8076e900,0x80809e00,0x40000000
.long 0x806bd300,0x806bbd00,0x806bd200,0x80758900,0x806bfe00,0x80758800,0x80755d00,0x806d3200,0x80755c00,0x80742900,0x806d5e00,0x80742800,0x8073fd00,0x806e9200,0x8073fc00,0x8072c900,0x806ebe00,0x8072c800,0x80729d00,0x806ff200,0x80729c00,0x80716900,0x80701e00,0x80716800,0x80713d00,0x80715200,0x40000000,0x80700900,0x80717e00,0x40000000,0x806fdd00,0x8072b200,0x40000000,0x806ea900,0x8072de00,0x40000000,0x806e7d00,0x80741200,0x40000000,0x806d4900,0x80743e00,0x40000000,0x806d1d00,0x80757200,0x40000000,0x806be900,0x80759e00,0x40000000
.long 0x8060d300,0x8060bd00,0x8060d200,0x806a8900,0x8060fe00,0x806a8800,0x806a5d00,0x80623200,0x806a5c00,0x80692900,0x80625e00,0x80692800,0x8068fd00,0x80639200,0x8068fc00,0x8067c900,0x8063be00,0x8067c800,0x80679d00,0x8064f200,0x80679c00,0x80666900,0x80651e00,0x80666800,0x80663d00,0x80665200,0x40000000,0x80650900,0x80667e00,0x40000000,0x8064dd00,0x8067b200,0x40000000,0x8063a900,0x8067de00,0x40000000,0x80637d00,0x80691200,0x40000000,0x80624900,0x80693e00,0x40000000,0x80621d00,0x806a7200,0x40000000,0x8060e900,0x806a9e00,0x40000000
.long 0x664e00,0x663900,0x664f00,0x651a00,0x666500,0x651b00,0x64ee00,0x679900,0x64ef00,0x63ba00,0x67c500,0x63bb00,0x638e00,0x68f900,0x638f00,0x625a00,0x692500,0x625b00,0x622e00,0x6a5900,0x622f00,0x60fa00,0x6a8500,0x60fb00,0x60b900,0x60cf00,0x40000000,0x60e500,0x6a9b00,0x40000000,0x621900,0x6a6f00,0x40000000,0x624500,0x693b00,0x40000000,0x637900,0x690f00,0x40000000,0x63a500,0x67db00,0x40000000,0x64d900,0x67af00,0x40000000,0x650500,0x667b00,0x40000000
.long 0x714e00,0x713900,0x714f00,0x701a00,0x716500,0x701b00,0x6fee00,0x729900,0x6fef00,0x6eba00,0x72c500,0x6ebb00,0x6e8e00,0x73f900,0x6e8f00,0x6d5a00,0x742500,0x6d5b00,0x6d2e00,0x755900,0x6d2f00,0x6bfa00,0x758500,0x6bfb00,0x6bb900,0x6bcf00,0x40000000,0x6be500,0x759b00,0x40000000,0x6d1900,0x756f00,0x40000000,0x6d4500,0x743b00,0x40000000,0x6e7900,0x740f00,0x40000000,0x6ea500,0x72db00,0x40000000,0x6fd900,0x72af00,0x40000000,0x700500,0x717b00,0x40000000
.long 0x7c4e00,0x7c3900,0x7c4f00,0x7b1a00,0x7c6500,0x7b1b00,0x7aee00,0x7d9900,0x7aef00,0x79ba00,0x7dc500,0x79bb00,0x798e00,0x7ef900,0x798f00,0x785a00,0x7f2500,0x785b00,0x782e00,0x805900,0x782f00,0x76fa00,0x808500,0x76fb00,0x76b900,0x76cf00,0x40000000,0x76e500,0x809b00,0x40000000,0x781900,0x806f00,0x40000000,0x784500,0x7f3b00,0x40000000,0x797900,0x7f0f00,0x40000000,0x79a500,0x7ddb00,0x40000000,0x7ad900,0x7daf00,0x40000000,0x7b0500,0x7c7b00,0x40000000
.long 0x874e00,0x873900,0x874f00,0x861a00,0x876500,0x861b00,0x85ee00,0x889900,0x85ef00,0x84ba00,0x88c500,0x84bb00,0x848e00,0x89f900,0x848f00,0x835a00,0x8a2500,0x835b00,0x832e00,0x8b5900,0x832f00,0x81fa00,0x8b8500,0x81fb00,0x81b900,0x81cf00,0x40000000,0x81e500,0x8b9b00,0x40000000,0x831900,0x8b6f00,0x40000000,0x834500,0x8a3b00,0x40000000,0x847900,0x8a0f00,0x40000000,0x84a500,0x88db00,0x40000000,0x85d900,0x88af00,0x40000000,0x860500,0x877b00,0x40000000
.long 0x80873c00,0x80875100,0x80873b00,0x80860800,0x80877d00,0x80860700,0x8085dc00,0x8088b100,0x8085db00,0x8084a800,0x8088dd00,0x8084a700,0x80847c00,0x808a1100,0x80847b00,0x80834800,0x808a3d00,0x80834700,0x80831c00,0x808b7100,0x80831b00,0x8081e800,0x808b9d00,0x8081e700,0x8081bc00,0x8081d100,0x40000000,0x8081fd00,0x808b8700,0x40000000,0x80833100,0x808b5b00,0x40000000,0x80835d00,0x808a2700,0x40000000,0x80849100,0x8089fb00,0x40000000,0x8084bd00,0x8088c700,0x40000000,0x8085f100,0x80889b00,0x40000000,0x80861d00,0x80876700,0x40000000
.long 0x807c3c00,0x807c5100,0x807c3b00,0x807b0800,0x807c7d00,0x807b0700,0x807adc00,0x807db100,0x807adb00,0x8079a800,0x807ddd00,0x8079a700,0x80797c00,0x807f1100,0x80797b00,0x80784800,0x807f3d00,0x80784700,0x80781c00,0x80807100,0x80781b00,0x8076e800,0x80809d00,0x8076e700,0x8076bc00,0x8076d100,0x40000000,0x8076fd00,0x80808700,0x40000000,0x80783100,0x80805b00,0x40000000,0x80785d00,0x807f2700,0x40000000,0x80799100,0x807efb00,0x40000000,0x8079bd00,0x807dc700,0x40000000,0x807af100,0x807d9b00,0x40000000,0x807b1d00,0x807c6700,0x40000000
.long 0x80713c00,0x80715100,0x80713b00,0x80700800,0x80717d00,0x80700700,0x806fdc00,0x8072b100,0x806fdb00,0x806ea800,0x8072dd00,0x806ea700,0x806e7c00,0x80741100,0x806e7b00,0x806d4800,0x80743d00,0x806d4700,0x806d1c00,0x80757100,0x806d1b00,0x806be800,0x80759d00,0x806be700,0x806bbc00,0x806bd100,0x40000000,0x806bfd00,0x80758700,0x40000000,0x806d3100,0x80755b00,0x40000000,0x806d5d00,0x80742700,0x40000000,0x806e9100,0x8073fb00,0x40000000,0x806ebd00,0x8072c700,0x40000000,0x806ff100,0x80729b00,0x40000000,0x80701d00,0x80716700,0x40000000
.long 0x80663c00,0x80665100,0x80663b00,0x80650800,0x80667d00,0x80650700,0x8064dc00,0x8067b100,0x8064db00,0x8063a800,0x8067dd00,0x8063a700,0x80637c00,0x80691100,0x80637b00,0x80624800,0x80693d00,0x80624700,0x80621c00,0x806a7100,0x80621b00,0x8060e800,0x806a9d00,0x8060e700,0x8060bc00,0x8060d100,0x40000000,0x8060fd00,0x806a8700,0x40000000,0x80623100,0x806a5b00,0x40000000,0x80625d00,0x80692700,0x40000000,0x80639100,0x8068fb00,0x40000000,0x8063bd00,0x8067c700,0x40000000,0x8064f100,0x80679b00,0x40000000,0x80651d00,0x80666700,0x40000000
.long 0x40000000,0x611e00,0x610900,0x613400,0x6aea00,0x613500,0x626800,0x6abe00,0x626900,0x629400,0x698a00,0x629500,0x63c800,0x695e00,0x63c900,0x63f400,0x682a00,0x63f500,0x652800,0x67fe00,0x652900,0x655400,0x66ca00,0x655500,0x668800,0x669e00,0x40000000,0x66b400,0x656a00,0x40000000,0x67e800,0x653e00,0x40000000,0x681400,0x640a00,0x40000000,0x694800,0x63de00,0x40000000,0x697400,0x62aa00,0x40000000,0x6aa800,0x627e00,0x40000000,0x6ad400,0x614a00,0x40000000
.long 0x40000000,0x6c1e00,0x6c0900,0x6c3400,0x75ea00,0x6c3500,0x6d6800,0x75be00,0x6d6900,0x6d9400,0x748a00,0x6d9500,0x6ec800,0x745e00,0x6ec900,0x6ef400,0x732a00,0x6ef500,0x702800,0x72fe00,0x702900,0x705400,0x71ca00,0x705500,0x718800,0x719e00,0x40000000,0x71b400,0x706a00,0x40000000,0x72e800,0x703e00,0x40000000,0x731400,0x6f0a00,0x40000000,0x744800,0x6ede00,0x40000000,0x747400,0x6daa00,0x40000000,0x75a800,0x6d7e00,0x40000000,0x75d400,0x6c4a00,0x40000000
.long 0x40000000,0x771e00,0x770900,0x773400,0x80ea00,0x773500,0x786800,0x80be00,0x786900,0x789400,0x7f8a00,0x789500,0x79c800,0x7f5e00,0x79c900,0x79f400,0x7e2a00,0x79f500,0x7b2800,0x7dfe00,0x7b2900,0x7b5400,0x7cca00,0x7b5500,0x7c8800,0x7c9e00,0x40000000,0x7cb400,0x7b6a00,0x40000000,0x7de800,0x7b3e00,0x40000000,0x7e1400,0x7a0a00,0x40000000,0x7f4800,0x79de00,0x40000000,0x7f7400,0x78aa00,0x40000000,0x80a800,0x787e00,0x40000000,0x80d400,0x774a00,0x40000000
.long 0x40000000,0x821e00,0x820900,0x823400,0x8bea00,0x823500,0x836800,0x8bbe00,0x836900,0x839400,0x8a8a00,0x839500,0x84c800,0x8a5e00,0x84c900,0x84f400,0x892a00,0x84f500,0x862800,0x88fe00,0x862900,0x865400,0x87ca00,0x865500,0x878800,0x879e00,0x40000000,0x87b400,0x866a00,0x40000000,0x88e800,0x863e00,0x40000000,0x891400,0x850a00,0x40000000,0x8a4800,0x84de00,0x40000000,0x8a7400,0x83aa00,0x40000000,0x8ba800,0x837e00,0x40000000,0x8bd400,0x824a00,0x40000000
.long 0x40000000,0x80818200,0x80816c00,0x8081ae00,0x808b3800,0x8081ad00,0x8082e200,0x808b0c00,0x8082e100,0x80830e00,0x8089d800,0x80830d00,0x80844200,0x8089ac00,0x80844100,0x80846e00,0x80887800,0x80846d00,0x8085a200,0x80884c00,0x8085a100,0x8085ce00,0x80871800,0x8085cd00,0x80870200,0x8086ec00,0x40000000,0x80872e00,0x8085b800,0x40000000,0x80886200,0x80858c00,0x40000000,0x80888e00,0x80845800,0x40000000,0x8089c200,0x80842c00,0x40000000,0x8089ee00,0x8082f800,0x40000000,0x808b2200,0x8082cc00,0x40000000,0x808b4e00,0x80819800,0x40000000
.long 0x40000000,0x80768200,0x80766c00,0x8076ae00,0x80803800,0x8076ad00,0x8077e200,0x80800c00,0x8077e100,0x80780e00,0x807ed800,0x80780d00,0x80794200,0x807eac00,0x80794100,0x80796e00,0x807d7800,0x80796d00,0x807aa200,0x807d4c00,0x807aa100,0x807ace00,0x807c1800,0x807acd00,0x807c0200,0x807bec00,0x40000000,0x807c2e00,0x807ab800,0x40000000,0x807d6200,0x807a8c00,0x40000000,0x807d8e00,0x80795800,0x40000000,0x807ec200,0x80792c00,0x40000000,0x807eee00,0x8077f800,0x40000000,0x80802200,0x8077cc00,0x40000000,0x80804e00,0x80769800,0x40000000
.long 0x40000000,0x806b8200,0x806b6c00,0x806bae00,0x80753800,0x806bad00,0x806ce200,0x80750c00,0x806ce100,0x806d0e00,0x8073d800,0x806d0d00,0x806e4200,0x8073ac00,0x806e4100,0x806e6e00,0x80727800,0x806e6d00,0x806fa200,0x80724c00,0x806fa100,0x806fce00,0x80711800,0x806fcd00,0x80710200,0x8070ec00,0x40000000,0x80712e00,0x806fb800,0x40000000,0x80726200,0x806f8c00,0x40000000,0x80728e00,0x806e5800,0x40000000,0x8073c200,0x806e2c00,0x40000000,0x8073ee00,0x806cf800,0x40000000,0x80752200,0x806ccc00,0x40000000,0x80754e00,0x806b9800,0x40000000
.long 0x40000000,0x80608200,0x80606c00,0x8060ae00,0x806a3800,0x8060ad00,0x8061e200,0x806a0c00,0x8061e100,0x80620e00,0x8068d800,0x80620d00,0x80634200,0x8068ac00,0x80634100,0x80636e00,0x80677800,0x80636d00,0x8064a200,0x80674c00,0x8064a100,0x8064ce00,0x80661800,0x8064cd00,0x80660200,0x8065ec00,0x40000000,0x80662e00,0x8064b800,0x40000000,0x80676200,0x80648c00,0x40000000,0x80678e00,0x80635800,0x40000000,0x8068c200,0x80632c00,0x40000000,0x8068ee00,0x8061f800,0x40000000,0x806a2200,0x8061cc00,0x40000000,0x806a4e00,0x80609800,0x40000000
.long 0x668900,0x669f00,0x668a00,0x66b500,0x656b00,0x66b600,0x67e900,0x653f00,0x67ea00,0x681500,0x640b00,0x681600,0x694900,0x63df00,0x694a00,0x697500,0x62ab00,0x697600,0x6aa900,0x627f00,0x6aaa00,0x6ad500,0x614b00,0x6ad600,0x611f00,0x610a00,0x40000000,0x6aeb00,0x613600,0x40000000,0x6abf00,0x626a00,0x40000000,0x698b00,0x629600,0x40000000,0x695f00,0x63ca00,0x40000000,0x682b00,0x63f600,0x40000000,0x67ff00,0x652a00,0x40000000,0x66cb00,0x655600,0x40000000
.long 0x718900,0x719f00,0x718a00,0x71b500,0x706b00,0x71b600,0x72e900,0x703f00,0x72ea00,0x731500,0x6f0b00,0x731600,0x744900,0x6edf00,0x744a00,0x747500,0x6dab00,0x747600,0x75a900,0x6d7f00,0x75aa00,0x75d500,0x6c4b00,0x75d600,0x6c1f00,0x6c0a00,0x40000000,0x75eb00,0x6c3600,0x40000000,0x75bf00,0x6d6a00,0x40000000,0x748b00,0x6d9600,0x40000000,0x745f00,0x6eca00,0x40000000,0x732b00,0x6ef600,0x40000000,0x72ff00,0x702a00,0x40000000,0x71cb00,0x705600,0x40000000
.long 0x7c8900,0x7c9f00,0x7c8a00,0x7cb500,0x7b6b00,0x7cb600,0x7de900,0x7b3f00,0x7dea00,0x7e1500,0x7a0b00,0x7e1600,0x7f4900,0x79df00,0x7f4a00,0x7f7500,0x78ab00,0x7f7600,0x80a900,0x787f00,0x80aa00,0x80d500,0x774b00,0x80d600,0x771f00,0x770a00,0x40000000,0x80eb00,0x773600,0x40000000,0x80bf00,0x786a00,0x40000000,0x7f8b00,0x789600,0x40000000,0x7f5f00,0x79ca00,0x40000000,0x7e2b00,0x79f600,0x40000000,0x7dff00,0x7b2a00,0x40000000,0x7ccb00,0x7b5600,0x40000000
.long 0x878900,0x879f00,0x878a00,0x87b500,0x866b00,0x87b600,0x88e900,0x863f00,0x88ea00,0x891500,0x850b00,0x891600,0x8a4900,0x84df00,0x8a4a00,0x8a7500,0x83ab00,0x8a7600,0x8ba900,0x837f00,0x8baa00,0x8bd500,0x824b00,0x8bd600,0x821f00,0x820a00,0x40000000,0x8beb00,0x823600,0x40000000,0x8bbf00,0x836a00,0x40000000,0x8a8b00,0x839600,0x40000000,0x8a5f00,0x84ca00,0x40000000,0x892b00,0x84f600,0x40000000,0x88ff00,0x862a00,0x40000000,0x87cb00,0x865600,0x40000000
.long 0x80870100,0x8086eb00,0x80870000,0x80872d00,0x8085b700,0x80872c00,0x80886100,0x80858b00,0x80886000,0x80888d00,0x80845700,0x80888c00,0x8089c100,0x80842b00,0x8089c000,0x8089ed00,0x8082f700,0x8089ec00,0x808b2100,0x8082cb00,0x808b2000,0x808b4d00,0x80819700,0x808b4c00,0x80818100,0x80816b00,0x40000000,0x808b3700,0x8081ac00,0x40000000,0x808b0b00,0x8082e000,0x40000000,0x8089d700,0x80830c00,0x40000000,0x8089ab00,0x80844000,0x40000000,0x80887700,0x80846c00,0x40000000,0x80884b00,0x8085a000,0x40000000,0x80871700,0x8085cc00,0x40000000
.long 0x807c0100,0x807beb00,0x807c0000,0x807c2d00,0x807ab700,0x807c2c00,0x807d6100,0x807a8b00,0x807d6000,0x807d8d00,0x80795700,0x807d8c00,0x807ec100,0x80792b00,0x807ec000,0x807eed00,0x8077f700,0x807eec00,0x80802100,0x8077cb00,0x80802000,0x80804d00,0x80769700,0x80804c00,0x80768100,0x80766b00,0x40000000,0x80803700,0x8076ac00,0x40000000,0x80800b00,0x8077e000,0x40000000,0x807ed700,0x80780c00,0x40000000,0x807eab00,0x80794000,0x40000000,0x807d7700,0x80796c00,0x40000000,0x807d4b00,0x807aa000,0x40000000,0x807c1700,0x807acc00,0x40000000
.long 0x80710100,0x8070eb00,0x80710000,0x80712d00,0x806fb700,0x80712c00,0x80726100,0x806f8b00,0x80726000,0x80728d00,0x806e5700,0x80728c00,0x8073c100,0x806e2b00,0x8073c000,0x8073ed00,0x806cf700,0x8073ec00,0x80752100,0x806ccb00,0x80752000,0x80754d00,0x806b9700,0x80754c00,0x806b8100,0x806b6b00,0x40000000,0x80753700,0x806bac00,0x40000000,0x80750b00,0x806ce000,0x40000000,0x8073d700,0x806d0c00,0x40000000,0x8073ab00,0x806e4000,0x40000000,0x80727700,0x806e6c00,0x40000000,0x80724b00,0x806fa000,0x40000000,0x80711700,0x806fcc00,0x40000000
.long 0x80660100,0x8065eb00,0x80660000,0x80662d00,0x8064b700,0x80662c00,0x80676100,0x80648b00,0x80676000,0x80678d00,0x80635700,0x80678c00,0x8068c100,0x80632b00,0x8068c000,0x8068ed00,0x8061f700,0x8068ec00,0x806a2100,0x8061cb00,0x806a2000,0x806a4d00,0x80609700,0x806a4c00,0x80608100,0x80606b00,0x40000000,0x806a3700,0x8060ac00,0x40000000,0x806a0b00,0x8061e000,0x40000000,0x8068d700,0x80620c00,0x40000000,0x8068ab00,0x80634000,0x40000000,0x80677700,0x80636c00,0x40000000,0x80674b00,0x8064a000,0x40000000,0x80661700,0x8064cc00,0x40000000
.long 0x612000,0x610b00,0x612100,0x6aec00,0x613700,0x6aed00,0x6ac000,0x626b00,0x6ac100,0x698c00,0x629700,0x698d00,0x696000,0x63cb00,0x696100,0x682c00,0x63f700,0x682d00,0x680000,0x652b00,0x680100,0x66cc00,0x655700,0x66cd00,0x66a000,0x668b00,0x40000000,0x656c00,0x66b700,0x40000000,0x654000,0x67eb00,0x40000000,0x640c00,0x681700,0x40000000,0x63e000,0x694b00,0x40000000,0x62ac00,0x697700,0x40000000,0x628000,0x6aab00,0x40000000,0x614c00,0x6ad700,0x40000000
.long 0x6c2000,0x6c0b00,0x6c2100,0x75ec00,0x6c3700,0x75ed00,0x75c000,0x6d6b00,0x75c100,0x748c00,0x6d9700,0x748d00,0x746000,0x6ecb00,0x746100,0x732c00,0x6ef700,0x732d00,0x730000,0x702b00,0x730100,0x71cc00,0x705700,0x71cd00,0x71a000,0x718b00,0x40000000,0x706c00,0x71b700,0x40000000,0x704000,0x72eb00,0x40000000,0x6f0c00,0x731700,0x40000000,0x6ee000,0x744b00,0x40000000,0x6dac00,0x747700,0x40000000,0x6d8000,0x75ab00,0x40000000,0x6c4c00,0x75d700,0x40000000
.long 0x772000,0x770b00,0x772100,0x80ec00,0x773700,0x80ed00,0x80c000,0x786b00,0x80c100,0x7f8c00,0x789700,0x7f8d00,0x7f6000,0x79cb00,0x7f6100,0x7e2c00,0x79f700,0x7e2d00,0x7e0000,0x7b2b00,0x7e0100,0x7ccc00,0x7b5700,0x7ccd00,0x7ca000,0x7c8b00,0x40000000,0x7b6c00,0x7cb700,0x40000000,0x7b4000,0x7deb00,0x40000000,0x7a0c00,0x7e1700,0x40000000,0x79e000,0x7f4b00,0x40000000,0x78ac00,0x7f7700,0x40000000,0x788000,0x80ab00,0x40000000,0x774c00,0x80d700,0x40000000
.long 0x822000,0x820b00,0x822100,0x8bec00,0x823700,0x8bed00,0x8bc000,0x836b00,0x8bc100,0x8a8c00,0x839700,0x8a8d00,0x8a6000,0x84cb00,0x8a6100,0x892c00,0x84f700,0x892d00,0x890000,0x862b00,0x890100,0x87cc00,0x865700,0x87cd00,0x87a000,0x878b00,0x40000000,0x866c00,0x87b700,0x40000000,0x864000,0x88eb00,0x40000000,0x850c00,0x891700,0x40000000,0x84e000,0x8a4b00,0x40000000,0x83ac00,0x8a7700,0x40000000,0x838000,0x8bab00,0x40000000,0x824c00,0x8bd700,0x40000000
.long 0x80818000,0x80816a00,0x80817f00,0x808b3600,0x8081ab00,0x808b3500,0x808b0a00,0x8082df00,0x808b0900,0x8089d600,0x80830b00,0x8089d500,0x8089aa00,0x80843f00,0x8089a900,0x80887600,0x80846b00,0x80887500,0x80884a00,0x80859f00,0x80884900,0x80871600,0x8085cb00,0x80871500,0x8086ea00,0x8086ff00,0x40000000,0x8085b600,0x80872b00,0x40000000,0x80858a00,0x80885f00,0x40000000,0x80845600,0x80888b00,0x40000000,0x80842a00,0x8089bf00,0x40000000,0x8082f600,0x8089eb00,0x40000000,0x8082ca00,0x808b1f00,0x40000000,0x80819600,0x808b4b00,0x40000000
.long 0x80768000,0x80766a00,0x80767f00,0x80803600,0x8076ab00,0x80803500,0x80800a00,0x8077df00,0x80800900,0x807ed600,0x80780b00,0x807ed500,0x807eaa00,0x80793f00,0x807ea900,0x807d7600,0x80796b00,0x807d7500,0x807d4a00,0x807a9f00,0x807d4900,0x807c1600,0x807acb00,0x807c1500,0x807bea00,0x807bff00,0x40000000,0x807ab600,0x807c2b00,0x40000000,0x807a8a00,0x807d5f00,0x40000000,0x80795600,0x807d8b00,0x40000000,0x80792a00,0x807ebf00,0x40000000,0x8077f600,0x807eeb00,0x40000000,0x8077ca00,0x80801f00,0x40000000,0x80769600,0x80804b00,0x40000000
.long 0x806b8000,0x806b6a00,0x806b7f00,0x80753600,0x806bab00,0x80753500,0x80750a00,0x806cdf00,0x80750900,0x8073d600,0x806d0b00,0x8073d500,0x8073aa00,0x806e3f00,0x8073a900,0x80727600,0x806e6b00,0x80727500,0x80724a00,0x806f9f00,0x80724900,0x80711600,0x806fcb00,0x80711500,0x8070ea00,0x8070ff00,0x40000000,0x806fb600,0x80712b00,0x40000000,0x806f8a00,0x80725f00,0x40000000,0x806e5600,0x80728b00,0x40000000,0x806e2a00,0x8073bf00,0x40000000,0x806cf600,0x8073eb00,0x40000000,0x806cca00,0x80751f00,0x40000000,0x806b9600,0x80754b00,0x40000000
.long 0x80608000,0x80606a00,0x80607f00,0x806a3600,0x8060ab00,0x806a3500,0x806a0a00,0x8061df00,0x806a0900,0x8068d600,0x80620b00,0x8068d500,0x8068aa00,0x80633f00,0x8068a900,0x80677600,0x80636b00,0x80677500,0x80674a00,0x80649f00,0x80674900,0x80661600,0x8064cb00,0x80661500,0x8065ea00,0x8065ff00,0x40000000,0x8064b600,0x80662b00,0x40000000,0x80648a00,0x80675f00,0x40000000,0x80635600,0x80678b00,0x40000000,0x80632a00,0x8068bf00,0x40000000,0x8061f600,0x8068eb00,0x40000000,0x8061ca00,0x806a1f00,0x40000000,0x80609600,0x806a4b00,0x40000000
.long 0x66a100,0x668c00,0x66a200,0x656d00,0x66b800,0x656e00,0x654100,0x67ec00,0x654200,0x640d00,0x681800,0x640e00,0x63e100,0x694c00,0x63e200,0x62ad00,0x697800,0x62ae00,0x628100,0x6aac00,0x628200,0x614d00,0x6ad800,0x614e00,0x610c00,0x612200,0x40000000,0x613800,0x6aee00,0x40000000,0x626c00,0x6ac200,0x40000000,0x629800,0x698e00,0x40000000,0x63cc00,0x696200,0x40000000,0x63f800,0x682e00,0x40000000,0x652c00,0x680200,0x40000000,0x655800,0x66ce00,0x40000000
.long 0x71a100,0x718c00,0x71a200,0x706d00,0x71b800,0x706e00,0x704100,0x72ec00,0x704200,0x6f0d00,0x731800,0x6f0e00,0x6ee100,0x744c00,0x6ee200,0x6dad00,0x747800,0x6dae00,0x6d8100,0x75ac00,0x6d8200,0x6c4d00,0x75d800,0x6c4e00,0x6c0c00,0x6c2200,0x40000000,0x6c3800,0x75ee00,0x40000000,0x6d6c00,0x75c200,0x40000000,0x6d9800,0x748e00,0x40000000,0x6ecc00,0x746200,0x40000000,0x6ef800,0x732e00,0x40000000,0x702c00,0x730200,0x40000000,0x705800,0x71ce00,0x40000000
.long 0x7ca100,0x7c8c00,0x7ca200,0x7b6d00,0x7cb800,0x7b6e00,0x7b4100,0x7dec00,0x7b4200,0x7a0d00,0x7e1800,0x7a0e00,0x79e100,0x7f4c00,0x79e200,0x78ad00,0x7f7800,0x78ae00,0x788100,0x80ac00,0x788200,0x774d00,0x80d800,0x774e00,0x770c00,0x772200,0x40000000,0x773800,0x80ee00,0x40000000,0x786c00,0x80c200,0x40000000,0x789800,0x7f8e00,0x40000000,0x79cc00,0x7f6200,0x40000000,0x79f800,0x7e2e00,0x40000000,0x7b2c00,0x7e0200,0x40000000,0x7b5800,0x7cce00,0x40000000
.long 0x87a100,0x878c00,0x87a200,0x866d00,0x87b800,0x866e00,0x864100,0x88ec00,0x864200,0x850d00,0x891800,0x850e00,0x84e100,0x8a4c00,0x84e200,0x83ad00,0x8a7800,0x83ae00,0x838100,0x8bac00,0x838200,0x824d00,0x8bd800,0x824e00,0x820c00,0x822200,0x40000000,0x823800,0x8bee00,0x40000000,0x836c00,0x8bc200,0x40000000,0x839800,0x8a8e00,0x40000000,0x84cc00,0x8a6200,0x40000000,0x84f800,0x892e00,0x40000000,0x862c00,0x890200,0x40000000,0x865800,0x87ce00,0x40000000
.long 0x8086e900,0x8086fe00,0x8086e800,0x8085b500,0x80872a00,0x8085b400,0x80858900,0x80885e00,0x80858800,0x80845500,0x80888a00,0x80845400,0x80842900,0x8089be00,0x80842800,0x8082f500,0x8089ea00,0x8082f400,0x8082c900,0x808b1e00,0x8082c800,0x80819500,0x808b4a00,0x80819400,0x80816900,0x80817e00,0x40000000,0x8081aa00,0x808b3400,0x40000000,0x8082de00,0x808b0800,0x40000000,0x80830a00,0x8089d400,0x40000000,0x80843e00,0x8089a800,0x40000000,0x80846a00,0x80887400,0x40000000,0x80859e00,0x80884800,0x40000000,0x8085ca00,0x80871400,0x40000000
.long 0x807be900,0x807bfe00,0x807be800,0x807ab500,0x807c2a00,0x807ab400,0x807a8900,0x807d5e00,0x807a8800,0x80795500,0x807d8a00,0x80795400,0x80792900,0x807ebe00,0x80792800,0x8077f500,0x807eea00,0x8077f400,0x8077c900,0x80801e00,0x8077c800,0x80769500,0x80804a00,0x80769400,0x80766900,0x80767e00,0x40000000,0x8076aa00,0x80803400,0x40000000,0x8077de00,0x80800800,0x40000000,0x80780a00,0x807ed400,0x40000000,0x80793e00,0x807ea800,0x40000000,0x80796a00,0x807d7400,0x40000000,0x807a9e00,0x807d4800,0x40000000,0x807aca00,0x807c1400,0x40000000
.long 0x8070e900,0x8070fe00,0x8070e800,0x806fb500,0x80712a00,0x806fb400,0x806f8900,0x80725e00,0x806f8800,0x806e5500,0x80728a00,0x806e5400,0x806e2900,0x8073be00,0x806e2800,0x806cf500,0x8073ea00,0x806cf400,0x806cc900,0x80751e00,0x806cc800,0x806b9500,0x80754a00,0x806b9400,0x806b6900,0x806b7e00,0x40000000,0x806baa00,0x80753400,0x40000000,0x806cde00,0x80750800,0x40000000,0x806d0a00,0x8073d400,0x40000000,0x806e3e00,0x8073a800,0x40000000,0x806e6a00,0x80727400,0x40000000,0x806f9e00,0x80724800,0x40000000,0x806fca00,0x80711400,0x40000000
.long 0x8065e900,0x8065fe00,0x8065e800,0x8064b500,0x80662a00,0x8064b400,0x80648900,0x80675e00,0x80648800,0x80635500,0x80678a00,0x80635400,0x80632900,0x8068be00,0x80632800,0x8061f500,0x8068ea00,0x8061f400,0x8061c900,0x806a1e00,0x8061c800,0x80609500,0x806a4a00,0x80609400,0x80606900,0x80607e00,0x40000000,0x8060aa00,0x806a3400,0x40000000,0x8061de00,0x806a0800,0x40000000,0x80620a00,0x8068d400,0x40000000,0x80633e00,0x8068a800,0x40000000,0x80636a00,0x80677400,0x40000000,0x80649e00,0x80674800,0x40000000,0x8064ca00,0x80661400,0x40000000
.long 0x610d00,0x612300,0x610e00,0x613900,0x6aef00,0x613a00,0x626d00,0x6ac300,0x626e00,0x629900,0x698f00,0x629a00,0x63cd00,0x696300,0x63ce00,0x63f900,0x682f00,0x63fa00,0x652d00,0x680300,0x652e00,0x655900,0x66cf00,0x655a00,0x668d00,0x66a300,0x40000000,0x66b900,0x656f00,0x40000000,0x67ed00,0x654300,0x40000000,0x681900,0x640f00,0x40000000,0x694d00,0x63e300,0x40000000,0x697900,0x62af00,0x40000000,0x6aad00,0x628300,0x40000000,0x6ad900,0x614f00,0x40000000
.long 0x6c0d00,0x6c2300,0x6c0e00,0x6c3900,0x75ef00,0x6c3a00,0x6d6d00,0x75c300,0x6d6e00,0x6d9900,0x748f00,0x6d9a00,0x6ecd00,0x746300,0x6ece00,0x6ef900,0x732f00,0x6efa00,0x702d00,0x730300,0x702e00,0x705900,0x71cf00,0x705a00,0x718d00,0x71a300,0x40000000,0x71b900,0x706f00,0x40000000,0x72ed00,0x704300,0x40000000,0x731900,0x6f0f00,0x40000000,0x744d00,0x6ee300,0x40000000,0x747900,0x6daf00,0x40000000,0x75ad00,0x6d8300,0x40000000,0x75d900,0x6c4f00,0x40000000
.long 0x770d00,0x772300,0x770e00,0x773900,0x80ef00,0x773a00,0x786d00,0x80c300,0x786e00,0x789900,0x7f8f00,0x789a00,0x79cd00,0x7f6300,0x79ce00,0x79f900,0x7e2f00,0x79fa00,0x7b2d00,0x7e0300,0x7b2e00,0x7b5900,0x7ccf00,0x7b5a00,0x7c8d00,0x7ca300,0x40000000,0x7cb900,0x7b6f00,0x40000000,0x7ded00,0x7b4300,0x40000000,0x7e1900,0x7a0f00,0x40000000,0x7f4d00,0x79e300,0x40000000,0x7f7900,0x78af00,0x40000000,0x80ad00,0x788300,0x40000000,0x80d900,0x774f00,0x40000000
.long 0x820d00,0x822300,0x820e00,0x823900,0x8bef00,0x823a00,0x836d00,0x8bc300,0x836e00,0x839900,0x8a8f00,0x839a00,0x84cd00,0x8a6300,0x84ce00,0x84f900,0x892f00,0x84fa00,0x862d00,0x890300,0x862e00,0x865900,0x87cf00,0x865a00,0x878d00,0x87a300,0x40000000,0x87b900,0x866f00,0x40000000,0x88ed00,0x864300,0x40000000,0x891900,0x850f00,0x40000000,0x8a4d00,0x84e300,0x40000000,0x8a7900,0x83af00,0x40000000,0x8bad00,0x838300,0x40000000,0x8bd900,0x824f00,0x40000000
.long 0x80816800,0x80817d00,0x80816700,0x8081a900,0x808b3300,0x8081a800,0x8082dd00,0x808b0700,0x8082dc00,0x80830900,0x8089d300,0x80830800,0x80843d00,0x8089a700,0x80843c00,0x80846900,0x80887300,0x80846800,0x80859d00,0x80884700,0x80859c00,0x8085c900,0x80871300,0x8085c800,0x8086fd00,0x8086e700,0x40000000,0x80872900,0x8085b300,0x40000000,0x80885d00,0x80858700,0x40000000,0x80888900,0x80845300,0x40000000,0x8089bd00,0x80842700,0x40000000,0x8089e900,0x8082f300,0x40000000,0x808b1d00,0x8082c700,0x40000000,0x808b4900,0x80819300,0x40000000
.long 0x80766800,0x80767d00,0x80766700,0x8076a900,0x80803300,0x8076a800,0x8077dd00,0x80800700,0x8077dc00,0x80780900,0x807ed300,0x80780800,0x80793d00,0x807ea700,0x80793c00,0x80796900,0x807d7300,0x80796800,0x807a9d00,0x807d4700,0x807a9c00,0x807ac900,0x807c1300,0x807ac800,0x807bfd00,0x807be700,0x40000000,0x807c2900,0x807ab300,0x40000000,0x807d5d00,0x807a8700,0x40000000,0x807d8900,0x80795300,0x40000000,0x807ebd00,0x80792700,0x40000000,0x807ee900,0x8077f300,0x40000000,0x80801d00,0x8077c700,0x40000000,0x80804900,0x80769300,0x40000000
.long 0x806b6800,0x806b7d00,0x806b6700,0x806ba900,0x80753300,0x806ba800,0x806cdd00,0x80750700,0x806cdc00,0x806d0900,0x8073d300,0x806d0800,0x806e3d00,0x8073a700,0x806e3c00,0x806e6900,0x80727300,0x806e6800,0x806f9d00,0x80724700,0x806f9c00,0x806fc900,0x80711300,0x806fc800,0x8070fd00,0x8070e700,0x40000000,0x80712900,0x806fb300,0x40000000,0x80725d00,0x806f8700,0x40000000,0x80728900,0x806e5300,0x40000000,0x8073bd00,0x806e2700,0x40000000,0x8073e900,0x806cf300,0x40000000,0x80751d00,0x806cc700,0x40000000,0x80754900,0x806b9300,0x40000000
.long 0x80606800,0x80607d00,0x80606700,0x8060a900,0x806a3300,0x8060a800,0x8061dd00,0x806a0700,0x8061dc00,0x80620900,0x8068d300,0x80620800,0x80633d00,0x8068a700,0x80633c00,0x80636900,0x80677300,0x80636800,0x80649d00,0x80674700,0x80649c00,0x8064c900,0x80661300,0x8064c800,0x8065fd00,0x8065e700,0x40000000,0x80662900,0x8064b300,0x40000000,0x80675d00,0x80648700,0x40000000,0x80678900,0x80635300,0x40000000,0x8068bd00,0x80632700,0x40000000,0x8068e900,0x8061f300,0x40000000,0x806a1d00,0x8061c700,0x40000000,0x806a4900,0x80609300,0x40000000
.long 0x668e00,0x66a400,0x668f00,0x66ba00,0x657000,0x66bb00,0x67ee00,0x654400,0x67ef00,0x681a00,0x641000,0x681b00,0x694e00,0x63e400,0x694f00,0x697a00,0x62b000,0x697b00,0x6aae00,0x628400,0x6aaf00,0x6ada00,0x615000,0x6adb00,0x612400,0x610f00,0x40000000,0x6af000,0x613b00,0x40000000,0x6ac400,0x626f00,0x40000000,0x699000,0x629b00,0x40000000,0x696400,0x63cf00,0x40000000,0x683000,0x63fb00,0x40000000,0x680400,0x652f00,0x40000000,0x66d000,0x655b00,0x40000000
.long 0x718e00,0x71a400,0x718f00,0x71ba00,0x707000,0x71bb00,0x72ee00,0x704400,0x72ef00,0x731a00,0x6f1000,0x731b00,0x744e00,0x6ee400,0x744f00,0x747a00,0x6db000,0x747b00,0x75ae00,0x6d8400,0x75af00,0x75da00,0x6c5000,0x75db00,0x6c2400,0x6c0f00,0x40000000,0x75f000,0x6c3b00,0x40000000,0x75c400,0x6d6f00,0x40000000,0x749000,0x6d9b00,0x40000000,0x746400,0x6ecf00,0x40000000,0x733000,0x6efb00,0x40000000,0x730400,0x702f00,0x40000000,0x71d000,0x705b00,0x40000000
.long 0x7c8e00,0x7ca400,0x7c8f00,0x7cba00,0x7b7000,0x7cbb00,0x7dee00,0x7b4400,0x7def00,0x7e1a00,0x7a1000,0x7e1b00,0x7f4e00,0x79e400,0x7f4f00,0x7f7a00,0x78b000,0x7f7b00,0x80ae00,0x788400,0x80af00,0x80da00,0x775000,0x80db00,0x772400,0x770f00,0x40000000,0x80f000,0x773b00,0x40000000,0x80c400,0x786f00,0x40000000,0x7f9000,0x789b00,0x40000000,0x7f6400,0x79cf00,0x40000000,0x7e3000,0x79fb00,0x40000000,0x7e0400,0x7b2f00,0x40000000,0x7cd000,0x7b5b00,0x40000000
.long 0x878e00,0x87a400,0x878f00,0x87ba00,0x867000,0x87bb00,0x88ee00,0x864400,0x88ef00,0x891a00,0x851000,0x891b00,0x8a4e00,0x84e400,0x8a4f00,0x8a7a00,0x83b000,0x8a7b00,0x8bae00,0x838400,0x8baf00,0x8bda00,0x825000,0x8bdb00,0x822400,0x820f00,0x40000000,0x8bf000,0x823b00,0x40000000,0x8bc400,0x836f00,0x40000000,0x8a9000,0x839b00,0x40000000,0x8a6400,0x84cf00,0x40000000,0x893000,0x84fb00,0x40000000,0x890400,0x862f00,0x40000000,0x87d000,0x865b00,0x40000000
.long 0x8086fc00,0x8086e600,0x8086fb00,0x80872800,0x8085b200,0x80872700,0x80885c00,0x80858600,0x80885b00,0x80888800,0x80845200,0x80888700,0x8089bc00,0x80842600,0x8089bb00,0x8089e800,0x8082f200,0x8089e700,0x808b1c00,0x8082c600,0x808b1b00,0x808b4800,0x80819200,0x808b4700,0x80817c00,0x80816600,0x40000000,0x808b3200,0x8081a700,0x40000000,0x808b0600,0x8082db00,0x40000000,0x8089d200,0x80830700,0x40000000,0x8089a600,0x80843b00,0x40000000,0x80887200,0x80846700,0x40000000,0x80884600,0x80859b00,0x40000000,0x80871200,0x8085c700,0x40000000
.long 0x807bfc00,0x807be600,0x807bfb00,0x807c2800,0x807ab200,0x807c2700,0x807d5c00,0x807a8600,0x807d5b00,0x807d8800,0x80795200,0x807d8700,0x807ebc00,0x80792600,0x807ebb00,0x807ee800,0x8077f200,0x807ee700,0x80801c00,0x8077c600,0x80801b00,0x80804800,0x80769200,0x80804700,0x80767c00,0x80766600,0x40000000,0x80803200,0x8076a700,0x40000000,0x80800600,0x8077db00,0x40000000,0x807ed200,0x80780700,0x40000000,0x807ea600,0x80793b00,0x40000000,0x807d7200,0x80796700,0x40000000,0x807d4600,0x807a9b00,0x40000000,0x807c1200,0x807ac700,0x40000000
.long 0x8070fc00,0x8070e600,0x8070fb00,0x80712800,0x806fb200,0x80712700,0x80725c00,0x806f8600,0x80725b00,0x80728800,0x806e5200,0x80728700,0x8073bc00,0x806e2600,0x8073bb00,0x8073e800,0x806cf200,0x8073e700,0x80751c00,0x806cc600,0x80751b00,0x80754800,0x806b9200,0x80754700,0x806b7c00,0x806b6600,0x40000000,0x80753200,0x806ba700,0x40000000,0x80750600,0x806cdb00,0x40000000,0x8073d200,0x806d0700,0x40000000,0x8073a600,0x806e3b00,0x40000000,0x80727200,0x806e6700,0x40000000,0x80724600,0x806f9b00,0x40000000,0x80711200,0x806fc700,0x40000000
.long 0x8065fc00,0x8065e600,0x8065fb00,0x80662800,0x8064b200,0x80662700,0x80675c00,0x80648600,0x80675b00,0x80678800,0x80635200,0x80678700,0x8068bc00,0x80632600,0x8068bb00,0x8068e800,0x8061f200,0x8068e700,0x806a1c00,0x8061c600,0x806a1b00,0x806a4800,0x80609200,0x806a4700,0x80607c00,0x80606600,0x40000000,0x806a3200,0x8060a700,0x40000000,0x806a0600,0x8061db00,0x40000000,0x8068d200,0x80620700,0x40000000,0x8068a600,0x80633b00,0x40000000,0x80677200,0x80636700,0x40000000,0x80674600,0x80649b00,0x40000000,0x80661200,0x8064c700,0x40000000
.long 0x612500,0x611000,0x612600,0x6af100,0x613c00,0x6af200,0x6ac500,0x627000,0x6ac600,0x699100,0x629c00,0x699200,0x696500,0x63d000,0x696600,0x683100,0x63fc00,0x683200,0x680500,0x653000,0x680600,0x66d100,0x655c00,0x66d200,0x66a500,0x669000,0x40000000,0x657100,0x66bc00,0x40000000,0x654500,0x67f000,0x40000000,0x641100,0x681c00,0x40000000,0x63e500,0x695000,0x40000000,0x62b100,0x697c00,0x40000000,0x628500,0x6ab000,0x40000000,0x615100,0x6adc00,0x40000000
.long 0x6c2500,0x6c1000,0x6c2600,0x75f100,0x6c3c00,0x75f200,0x75c500,0x6d7000,0x75c600,0x749100,0x6d9c00,0x749200,0x746500,0x6ed000,0x746600,0x733100,0x6efc00,0x733200,0x730500,0x703000,0x730600,0x71d100,0x705c00,0x71d200,0x71a500,0x719000,0x40000000,0x707100,0x71bc00,0x40000000,0x704500,0x72f000,0x40000000,0x6f1100,0x731c00,0x40000000,0x6ee500,0x745000,0x40000000,0x6db100,0x747c00,0x40000000,0x6d8500,0x75b000,0x40000000,0x6c5100,0x75dc00,0x40000000
.long 0x772500,0x771000,0x772600,0x80f100,0x773c00,0x80f200,0x80c500,0x787000,0x80c600,0x7f9100,0x789c00,0x7f9200,0x7f6500,0x79d000,0x7f6600,0x7e3100,0x79fc00,0x7e3200,0x7e0500,0x7b3000,0x7e0600,0x7cd100,0x7b5c00,0x7cd200,0x7ca500,0x7c9000,0x40000000,0x7b7100,0x7cbc00,0x40000000,0x7b4500,0x7df000,0x40000000,0x7a1100,0x7e1c00,0x40000000,0x79e500,0x7f5000,0x40000000,0x78b100,0x7f7c00,0x40000000,0x788500,0x80b000,0x40000000,0x775100,0x80dc00,0x40000000
.long 0x822500,0x821000,0x822600,0x8bf100,0x823c00,0x8bf200,0x8bc500,0x837000,0x8bc600,0x8a9100,0x839c00,0x8a9200,0x8a6500,0x84d000,0x8a6600,0x893100,0x84fc00,0x893200,0x890500,0x863000,0x890600,0x87d100,0x865c00,0x87d200,0x87a500,0x879000,0x40000000,0x867100,0x87bc00,0x40000000,0x864500,0x88f000,0x40000000,0x851100,0x891c00,0x40000000,0x84e500,0x8a5000,0x40000000,0x83b100,0x8a7c00,0x40000000,0x838500,0x8bb000,0x40000000,0x825100,0x8bdc00,0x40000000
.long 0x80817b00,0x80816500,0x80817a00,0x808b3100,0x8081a600,0x808b3000,0x808b0500,0x8082da00,0x808b0400,0x8089d100,0x80830600,0x8089d000,0x8089a500,0x80843a00,0x8089a400,0x80887100,0x80846600,0x80887000,0x80884500,0x80859a00,0x80884400,0x80871100,0x8085c600,0x80871000,0x8086e500,0x8086fa00,0x40000000,0x8085b100,0x80872600,0x40000000,0x80858500,0x80885a00,0x40000000,0x80845100,0x80888600,0x40000000,0x80842500,0x8089ba00,0x40000000,0x8082f100,0x8089e600,0x40000000,0x8082c500,0x808b1a00,0x40000000,0x80819100,0x808b4600,0x40000000
.long 0x80767b00,0x80766500,0x80767a00,0x80803100,0x8076a600,0x80803000,0x80800500,0x8077da00,0x80800400,0x807ed100,0x80780600,0x807ed000,0x807ea500,0x80793a00,0x807ea400,0x807d7100,0x80796600,0x807d7000,0x807d4500,0x807a9a00,0x807d4400,0x807c1100,0x807ac600,0x807c1000,0x807be500,0x807bfa00,0x40000000,0x807ab100,0x807c2600,0x40000000,0x807a8500,0x807d5a00,0x40000000,0x80795100,0x807d8600,0x40000000,0x80792500,0x807eba00,0x40000000,0x8077f100,0x807ee600,0x40000000,0x8077c500,0x80801a00,0x40000000,0x80769100,0x80804600,0x40000000
.long 0x806b7b00,0x806b6500,0x806b7a00,0x80753100,0x806ba600,0x80753000,0x80750500,0x806cda00,0x80750400,0x8073d100,0x806d0600,0x8073d000,0x8073a500,0x806e3a00,0x8073a400,0x80727100,0x806e6600,0x80727000,0x80724500,0x806f9a00,0x80724400,0x80711100,0x806fc600,0x80711000,0x8070e500,0x8070fa00,0x40000000,0x806fb100,0x80712600,0x40000000,0x806f8500,0x80725a00,0x40000000,0x806e5100,0x80728600,0x40000000,0x806e2500,0x8073ba00,0x40000000,0x806cf100,0x8073e600,0x40000000,0x806cc500,0x80751a00,0x40000000,0x806b9100,0x80754600,0x40000000
.long 0x80607b00,0x80606500,0x80607a00,0x806a3100,0x8060a600,0x806a3000,0x806a0500,0x8061da00,0x806a0400,0x8068d100,0x80620600,0x8068d000,0x8068a500,0x80633a00,0x8068a400,0x80677100,0x80636600,0x80677000,0x80674500,0x80649a00,0x80674400,0x80661100,0x8064c600,0x80661000,0x8065e500,0x8065fa00,0x40000000,0x8064b100,0x80662600,0x40000000,0x80648500,0x80675a00,0x40000000,0x80635100,0x80678600,0x40000000,0x80632500,0x8068ba00,0x40000000,0x8061f100,0x8068e600,0x40000000,0x8061c500,0x806a1a00,0x40000000,0x80609100,0x806a4600,0x40000000
.long 0x66a600,0x669100,0x66a700,0x657200,0x66bd00,0x657300,0x654600,0x67f100,0x654700,0x641200,0x681d00,0x641300,0x63e600,0x695100,0x63e700,0x62b200,0x697d00,0x62b300,0x628600,0x6ab100,0x628700,0x615200,0x6add00,0x615300,0x611100,0x612700,0x40000000,0x613d00,0x6af300,0x40000000,0x627100,0x6ac700,0x40000000,0x629d00,0x699300,0x40000000,0x63d100,0x696700,0x40000000,0x63fd00,0x683300,0x40000000,0x653100,0x680700,0x40000000,0x655d00,0x66d300,0x40000000
.long 0x71a600,0x719100,0x71a700,0x707200,0x71bd00,0x707300,0x704600,0x72f100,0x704700,0x6f1200,0x731d00,0x6f1300,0x6ee600,0x745100,0x6ee700,0x6db200,0x747d00,0x6db300,0x6d8600,0x75b100,0x6d8700,0x6c5200,0x75dd00,0x6c5300,0x6c1100,0x6c2700,0x40000000,0x6c3d00,0x75f300,0x40000000,0x6d7100,0x75c700,0x40000000,0x6d9d00,0x749300,0x40000000,0x6ed100,0x746700,0x40000000,0x6efd00,0x733300,0x40000000,0x703100,0x730700,0x40000000,0x705d00,0x71d300,0x40000000
.long 0x7ca600,0x7c9100,0x7ca700,0x7b7200,0x7cbd00,0x7b7300,0x7b4600,0x7df100,0x7b4700,0x7a1200,0x7e1d00,0x7a1300,0x79e600,0x7f5100,0x79e700,0x78b200,0x7f7d00,0x78b300,0x788600,0x80b100,0x788700,0x775200,0x80dd00,0x775300,0x771100,0x772700,0x40000000,0x773d00,0x80f300,0x40000000,0x787100,0x80c700,0x40000000,0x789d00,0x7f9300,0x40000000,0x79d100,0x7f6700,0x40000000,0x79fd00,0x7e3300,0x40000000,0x7b3100,0x7e0700,0x40000000,0x7b5d00,0x7cd300,0x40000000
.long 0x87a600,0x879100,0x87a700,0x867200,0x87bd00,0x867300,0x864600,0x88f100,0x864700,0x851200,0x891d00,0x851300,0x84e600,0x8a5100,0x84e700,0x83b200,0x8a7d00,0x83b300,0x838600,0x8bb100,0x838700,0x825200,0x8bdd00,0x825300,0x821100,0x822700,0x40000000,0x823d00,0x8bf300,0x40000000,0x837100,0x8bc700,0x40000000,0x839d00,0x8a9300,0x40000000,0x84d100,0x8a6700,0x40000000,0x84fd00,0x893300,0x40000000,0x863100,0x890700,0x40000000,0x865d00,0x87d300,0x40000000
.long 0x8086e400,0x8086f900,0x8086e300,0x8085b000,0x80872500,0x8085af00,0x80858400,0x80885900,0x80858300,0x80845000,0x80888500,0x80844f00,0x80842400,0x8089b900,0x80842300,0x8082f000,0x8089e500,0x8082ef00,0x8082c400,0x808b1900,0x8082c300,0x80819000,0x808b4500,0x80818f00,0x80816400,0x80817900,0x40000000,0x8081a500,0x808b2f00,0x40000000,0x8082d900,0x808b0300,0x40000000,0x80830500,0x8089cf00,0x40000000,0x80843900,0x8089a300,0x40000000,0x80846500,0x80886f00,0x40000000,0x80859900,0x80884300,0x40000000,0x8085c500,0x80870f00,0x40000000
.long 0x807be400,0x807bf900,0x807be300,0x807ab000,0x807c2500,0x807aaf00,0x807a8400,0x807d5900,0x807a8300,0x80795000,0x807d8500,0x80794f00,0x80792400,0x807eb900,0x80792300,0x8077f000,0x807ee500,0x8077ef00,0x8077c400,0x80801900,0x8077c300,0x80769000,0x80804500,0x80768f00,0x80766400,0x80767900,0x40000000,0x8076a500,0x80802f00,0x40000000,0x8077d900,0x80800300,0x40000000,0x80780500,0x807ecf00,0x40000000,0x80793900,0x807ea300,0x40000000,0x80796500,0x807d6f00,0x40000000,0x807a9900,0x807d4300,0x40000000,0x807ac500,0x807c0f00,0x40000000
.long 0x8070e400,0x8070f900,0x8070e300,0x806fb000,0x80712500,0x806faf00,0x806f8400,0x80725900,0x806f8300,0x806e5000,0x80728500,0x806e4f00,0x806e2400,0x8073b900,0x806e2300,0x806cf000,0x8073e500,0x806cef00,0x806cc400,0x80751900,0x806cc300,0x806b9000,0x80754500,0x806b8f00,0x806b6400,0x806b7900,0x40000000,0x806ba500,0x80752f00,0x40000000,0x806cd900,0x80750300,0x40000000,0x806d0500,0x8073cf00,0x40000000,0x806e3900,0x8073a300,0x40000000,0x806e6500,0x80726f00,0x40000000,0x806f9900,0x80724300,0x40000000,0x806fc500,0x80710f00,0x40000000
.long 0x8065e400,0x8065f900,0x8065e300,0x8064b000,0x80662500,0x8064af00,0x80648400,0x80675900,0x80648300,0x80635000,0x80678500,0x80634f00,0x80632400,0x8068b900,0x80632300,0x8061f000,0x8068e500,0x8061ef00,0x8061c400,0x806a1900,0x8061c300,0x80609000,0x806a4500,0x80608f00,0x80606400,0x80607900,0x40000000,0x8060a500,0x806a2f00,0x40000000,0x8061d900,0x806a0300,0x40000000,0x80620500,0x8068cf00,0x40000000,0x80633900,0x8068a300,0x40000000,0x80636500,0x80676f00,0x40000000,0x80649900,0x80674300,0x40000000,0x8064c500,0x80660f00,0x40000000
.long 0,0,0,0,0,0,0,0,0,0,0,0,0,0,0,0
.size L_wd, 49216
.section .rodata,"a"
.p2align 6
.amdhsa_kernel sequential_preLN__spectral_gfnet__mixer_channel_mlp__prompt_kernel
  .amdhsa_next_free_vgpr 512
  .amdhsa_next_free_sgpr 102
  .amdhsa_accum_offset 256
  .amdhsa_group_segment_fixed_size 0
  .amdhsa_kernarg_size 88
  .amdhsa_user_sgpr_count 2
  .amdhsa_user_sgpr_kernarg_segment_ptr 1
  .amdhsa_system_sgpr_workgroup_id_x 1
  .amdhsa_float_denorm_mode_32 3
.end_amdhsa_kernel
```
